```python
import torch

def _softmax(x, axis=-1):
    return torch.softmax(x, dim=axis)

def _gelu(x):
    return torch.nn.functional.gelu(x, approximate='tanh')

def _silu(x):
    return torch.nn.functional.silu(x)

def _sigmoid(x):
    return torch.sigmoid(x)

def _layernorm(x, axis=-1, eps=1e-05):
    m = x.mean(dim=axis, keepdim=True)
    v = x.var(dim=axis, keepdim=True, unbiased=False)
    return (x - m) / torch.sqrt(v + eps)

def _scatter_add(tgt, idx, src, axis=0):
    return tgt.clone().index_add_(axis, idx, src)

def _segment_sum(src, seg, n):
    out = torch.zeros((n,) + src.shape[1:], dtype=src.dtype)
    return out.index_add_(0, seg, src)

def _pad(x, pw):
    flat = tuple((v for pair in reversed(pw) for v in pair))
    return torch.nn.functional.pad(x, flat)
kernel_name = 'interleave_layers__sliding_block__memory_aug_recurrent_mem_tr__prompt'

def setup_inputs():

    _w = lambda a: (lambda t: t.to(torch.bfloat16) if t.is_floating_point() else t)(torch.as_tensor(a))

    def _A_setup():
        B, S, D = (1, 2048, 512)
        return {'x': _w((lambda *s: torch.randn(*s, dtype=torch.bfloat16) * 0.05)(B, S, D)), 'wqkv': _w((lambda *s: torch.randn(*s, dtype=torch.bfloat16) * 0.05)(D, 3 * D)), 'wo': _w((lambda *s: torch.randn(*s, dtype=torch.bfloat16) * 0.05)(D, D))}
    _A_in = _A_setup()

    def _B_setup():
        B, S, Dm = (1, 2048, 512)
        H, Dh = (32, 128)
        M, seg = (8, 32)
        seg = min(seg, S)
        S = S // seg * seg
        return {'x': _w((lambda *s: torch.randn(*s, dtype=torch.bfloat16) * 0.05)(B, S, Dm)), 'mem0': _w((lambda *s: torch.randn(*s, dtype=torch.bfloat16) * 0.8)(B, M, Dm)), 'Wq': _w((lambda *s: torch.randn(*s, dtype=torch.bfloat16) * 1.6)(Dm, H, Dh) * Dm ** (-0.5)), 'Wk': _w((lambda *s: torch.randn(*s, dtype=torch.bfloat16) * 1.6)(Dm, H, Dh) * Dm ** (-0.5)), 'Wv': _w((lambda *s: torch.randn(*s, dtype=torch.bfloat16) * 0.8)(Dm, H, Dh) * Dm ** (-0.5)), 'Wo': _w((lambda *s: torch.randn(*s, dtype=torch.bfloat16) * 0.8)(H, Dh, Dm) * (H * Dh) ** (-0.5)), 'seg_len': seg}
    _B_in = _B_setup()
    return {'A_x': _A_in['x'], 'A_wqkv': _A_in['wqkv'], 'A_wo': _A_in['wo'], 'B_x': _B_in['x'], 'B_mem0': _B_in['mem0'], 'B_Wq': _B_in['Wq'], 'B_Wk': _B_in['Wk'], 'B_Wv': _B_in['Wv'], 'B_Wo': _B_in['Wo'], 'B_seg_len': _B_in['seg_len']}

def reference(A_x, A_wqkv, A_wo, B_x, B_mem0, B_Wq, B_Wk, B_Wv, B_Wo, B_seg_len):

    def _A_ref(x, wqkv, wo):
        B, S, D = x.shape
        H = 32
        Dh = D // H
        W = 256
        qkv = (lambda x, *d: x.permute(*d))((x @ wqkv).reshape(B, S, 3, H, Dh), 2, 0, 3, 1, 4)
        q, k, v = (qkv[0], qkv[1], qkv[2])
        scores = torch.einsum('bhqd,bhkd->bhqk', q, k) * Dh ** (-0.5)
        idx = torch.arange(S)
        mask = (idx[:, None] - idx[None, :] >= 0) & (idx[:, None] - idx[None, :] < W)
        scores = torch.where(mask[None, None], scores, -1000000000.0)
        p = _softmax(scores, axis=-1)
        o = torch.einsum('bhqk,bhkd->bhqd', p, v)
        return (lambda x, *d: x.permute(*d))(o, 0, 2, 1, 3).reshape(B, S, D) @ wo

    def _B_ref(x, mem0, Wq, Wk, Wv, Wo, seg_len):
        B, S, Dm = x.shape
        H, Dh = (Wq.shape[1], Wq.shape[2])
        M = mem0.shape[1]
        scale = Dh ** (-0.5)
        n_seg = S // seg_len
        L = M + seg_len
        idx = torch.arange(L)
        mask = (idx[:, None] < M) | (idx[:, None] >= idx[None, :])
        mem = mem0
        outs = []
        for s in range(n_seg):
            xs = x[:, s * seg_len:(s + 1) * seg_len, :].clone()
            h = torch.concatenate([mem, xs], axis=1)
            q = torch.einsum('btd,dhe->bhte', h, Wq)
            k = torch.einsum('btd,dhe->bhte', h, Wk)
            v = torch.einsum('btd,dhe->bhte', h, Wv)
            scores = torch.einsum('bhqe,bhke->bhqk', q, k) * scale
            scores = torch.where(mask[None, None], scores, -1000000000.0)
            p = _softmax(scores, axis=-1)
            o = torch.einsum('bhqk,bhke->bhqe', p, v)
            o = torch.einsum('bhte,hed->btd', o, Wo)
            mem = o[:, :M, :].clone()
            outs.append(o[:, M:, :])
        return torch.concatenate(outs, axis=1)
    x = A_x
    x = x + _A_ref(_layernorm(x, axis=-1), A_wqkv, A_wo)
    x = x + _B_ref(_layernorm(x, axis=-1), B_mem0, B_Wq, B_Wk, B_Wv, B_Wo, B_seg_len)
    x = x + _A_ref(_layernorm(x, axis=-1), A_wqkv, A_wo)
    x = x + _B_ref(_layernorm(x, axis=-1), B_mem0, B_Wq, B_Wk, B_Wv, B_Wo, B_seg_len)
    return x
```

```asm
; @launch kernel=prep_kernel grid=(256,1,1) block=(256,1,1) lds=0
; @launch kernel=interleave_layers__sliding_block__memory_aug_recurrent_mem_tr__prompt_kernel grid=(256,1,1) block=(256,1,1) lds=163840
.amdgcn_target "amdgcn-amd-amdhsa--gfx950"
.text
.globl prep_kernel
.p2align 8
.type prep_kernel,@function
prep_kernel:
  s_cmp_ge_u32 s2, 256
  s_cbranch_scc1 prep_exit
  s_load_dwordx2 s[4:5], s[0:1], 96
  s_waitcnt lgkmcnt(0)
  s_mov_b32 s6, 268435456
  s_mov_b32 s7, 0x20000
  s_load_dwordx2 s[8:9], s[0:1], 0
  s_waitcnt lgkmcnt(0)
  s_mov_b32 s10, 2097152
  s_mov_b32 s11, 0x20000
  v_lshrrev_b32 v1, 6, v0
  s_nop 0
  v_readfirstlane_b32 s12, v1
  v_and_b32 v2, 63, v0
  v_lshlrev_b32 v3, 4, v2
  s_lshl_b32 s16, s2, 2
  s_add_u32 s16, s16, s12
  s_lshl_b32 s16, s16, 11
  buffer_load_dwordx4 v[16:19], v3, s[8:11], s16 offen
  buffer_load_dwordx4 v[20:23], v3, s[8:11], s16 offen offset:1024
  v_lshlrev_b32 v4, 4, v0
  v_mov_b32 v8, -1
  v_mov_b32 v9, -1
  v_mov_b32 v10, -1
  v_mov_b32 v11, -1
  v_mov_b32 v12, 0
  v_mov_b32 v13, 0
  v_mov_b32 v14, 0
  v_mov_b32 v15, 0
  s_lshl_b32 s17, s2, 12
  s_add_u32 s18, s17, 0
  buffer_store_dwordx4 v[8:11], v4, s[4:7], s18 offen
  s_add_u32 s18, s17, 1048576
  buffer_store_dwordx4 v[8:11], v4, s[4:7], s18 offen
  s_add_u32 s18, s17, 2097152
  buffer_store_dwordx4 v[8:11], v4, s[4:7], s18 offen
  s_cmp_ge_u32 s2, 96
  s_cbranch_scc1 prep_nofl
  s_add_u32 s18, s17, 4194304
  buffer_store_dwordx4 v[12:15], v4, s[4:7], s18 offen
prep_nofl:
  s_lshl_b32 s18, s2, 8
  v_add_u32 v5, s18, v0
  v_cmp_gt_u32 vcc, 16896, v5
  s_and_saveexec_b64 s[20:21], vcc
  s_cbranch_execz prep_nomark
  v_lshlrev_b32 v5, 10, v5
  s_mov_b32 s18, 135266304
  buffer_store_dword v8, v5, s[4:7], s18 offen
prep_nomark:
  s_mov_b64 exec, s[20:21]
  s_waitcnt vmcnt(0)
  v_lshlrev_b32 v24, 16, v16
  v_lshlrev_b32 v32, 16, v20
  v_and_b32 v25, 0xffff0000, v16
  v_and_b32 v33, 0xffff0000, v20
  v_lshlrev_b32 v26, 16, v17
  v_lshlrev_b32 v34, 16, v21
  v_and_b32 v27, 0xffff0000, v17
  v_and_b32 v35, 0xffff0000, v21
  v_lshlrev_b32 v28, 16, v18
  v_lshlrev_b32 v36, 16, v22
  v_and_b32 v29, 0xffff0000, v18
  v_and_b32 v37, 0xffff0000, v22
  v_lshlrev_b32 v30, 16, v19
  v_lshlrev_b32 v38, 16, v23
  v_and_b32 v31, 0xffff0000, v19
  v_and_b32 v39, 0xffff0000, v23
  v_pk_add_f32 v[40:41], v[24:25], v[26:27]
  v_pk_add_f32 v[52:53], v[32:33], v[34:35]
  v_pk_add_f32 v[42:43], v[28:29], v[30:31]
  v_pk_add_f32 v[54:55], v[36:37], v[38:39]
  v_pk_add_f32 v[40:41], v[40:41], v[42:43]
  v_pk_add_f32 v[52:53], v[52:53], v[54:55]
  v_add_f32 v44, v40, v41
  v_add_f32 v56, v52, v53
  s_nop 0
  v_add_f32_dpp v44, v44, v44 quad_perm:[1,0,3,2] row_mask:0xf bank_mask:0xf
  v_add_f32_dpp v56, v56, v56 quad_perm:[1,0,3,2] row_mask:0xf bank_mask:0xf
  s_nop 0
  v_add_f32_dpp v44, v44, v44 quad_perm:[2,3,0,1] row_mask:0xf bank_mask:0xf
  v_add_f32_dpp v56, v56, v56 quad_perm:[2,3,0,1] row_mask:0xf bank_mask:0xf
  s_nop 0
  v_add_f32_dpp v44, v44, v44 row_ror:4 row_mask:0xf bank_mask:0xf
  v_add_f32_dpp v56, v56, v56 row_ror:4 row_mask:0xf bank_mask:0xf
  s_nop 0
  v_add_f32_dpp v44, v44, v44 row_ror:8 row_mask:0xf bank_mask:0xf
  v_add_f32_dpp v56, v56, v56 row_ror:8 row_mask:0xf bank_mask:0xf
  v_mov_b32 v45, v44
  v_mov_b32 v57, v56
  s_nop 0
  v_permlane16_swap_b32 v44, v45
  v_permlane16_swap_b32 v56, v57
  v_add_f32 v44, v44, v45
  v_add_f32 v56, v56, v57
  v_mov_b32 v45, v44
  v_mov_b32 v57, v56
  s_nop 0
  v_permlane32_swap_b32 v44, v45
  v_permlane32_swap_b32 v56, v57
  v_add_f32 v44, v44, v45
  v_add_f32 v56, v56, v57
  v_mul_f32 v44, 0xbb000000, v44
  v_mul_f32 v56, 0xbb000000, v56
  v_mov_b32 v45, v44
  v_mov_b32 v57, v56
  v_pk_add_f32 v[24:25], v[24:25], v[44:45]
  v_pk_add_f32 v[32:33], v[32:33], v[56:57]
  v_pk_add_f32 v[26:27], v[26:27], v[44:45]
  v_pk_add_f32 v[34:35], v[34:35], v[56:57]
  v_pk_add_f32 v[28:29], v[28:29], v[44:45]
  v_pk_add_f32 v[36:37], v[36:37], v[56:57]
  v_pk_add_f32 v[30:31], v[30:31], v[44:45]
  v_pk_add_f32 v[38:39], v[38:39], v[56:57]
  v_pk_mul_f32 v[40:41], v[24:25], v[24:25]
  v_pk_mul_f32 v[52:53], v[32:33], v[32:33]
  v_pk_fma_f32 v[40:41], v[26:27], v[26:27], v[40:41]
  v_pk_fma_f32 v[52:53], v[34:35], v[34:35], v[52:53]
  v_pk_fma_f32 v[40:41], v[28:29], v[28:29], v[40:41]
  v_pk_fma_f32 v[52:53], v[36:37], v[36:37], v[52:53]
  v_pk_fma_f32 v[40:41], v[30:31], v[30:31], v[40:41]
  v_pk_fma_f32 v[52:53], v[38:39], v[38:39], v[52:53]
  v_add_f32 v46, v40, v41
  v_add_f32 v58, v52, v53
  s_nop 0
  v_add_f32_dpp v46, v46, v46 quad_perm:[1,0,3,2] row_mask:0xf bank_mask:0xf
  v_add_f32_dpp v58, v58, v58 quad_perm:[1,0,3,2] row_mask:0xf bank_mask:0xf
  s_nop 0
  v_add_f32_dpp v46, v46, v46 quad_perm:[2,3,0,1] row_mask:0xf bank_mask:0xf
  v_add_f32_dpp v58, v58, v58 quad_perm:[2,3,0,1] row_mask:0xf bank_mask:0xf
  s_nop 0
  v_add_f32_dpp v46, v46, v46 row_ror:4 row_mask:0xf bank_mask:0xf
  v_add_f32_dpp v58, v58, v58 row_ror:4 row_mask:0xf bank_mask:0xf
  s_nop 0
  v_add_f32_dpp v46, v46, v46 row_ror:8 row_mask:0xf bank_mask:0xf
  v_add_f32_dpp v58, v58, v58 row_ror:8 row_mask:0xf bank_mask:0xf
  v_mov_b32 v47, v46
  v_mov_b32 v59, v58
  s_nop 0
  v_permlane16_swap_b32 v46, v47
  v_permlane16_swap_b32 v58, v59
  v_add_f32 v46, v46, v47
  v_add_f32 v58, v58, v59
  v_mov_b32 v47, v46
  v_mov_b32 v59, v58
  s_nop 0
  v_permlane32_swap_b32 v46, v47
  v_permlane32_swap_b32 v58, v59
  v_add_f32 v46, v46, v47
  v_add_f32 v58, v58, v59
  v_mov_b32 v47, 0x3727c5ac
  v_mov_b32 v59, 0x3727c5ac
  v_fmac_f32 v47, 0x3b000000, v46
  v_fmac_f32 v59, 0x3b000000, v58
  v_rsq_f32 v46, v47
  v_rsq_f32 v58, v59
  v_mov_b32 v47, v46
  v_mov_b32 v59, v58
  v_pk_mul_f32 v[24:25], v[24:25], v[46:47]
  v_pk_mul_f32 v[32:33], v[32:33], v[58:59]
  v_pk_mul_f32 v[26:27], v[26:27], v[46:47]
  v_pk_mul_f32 v[34:35], v[34:35], v[58:59]
  v_pk_mul_f32 v[28:29], v[28:29], v[46:47]
  v_pk_mul_f32 v[36:37], v[36:37], v[58:59]
  v_pk_mul_f32 v[30:31], v[30:31], v[46:47]
  v_pk_mul_f32 v[38:39], v[38:39], v[58:59]
  v_cvt_pk_bf16_f32 v40, v24, v25
  v_cvt_pk_bf16_f32 v52, v32, v33
  v_cvt_pk_bf16_f32 v41, v26, v27
  v_cvt_pk_bf16_f32 v53, v34, v35
  v_cvt_pk_bf16_f32 v42, v28, v29
  v_cvt_pk_bf16_f32 v54, v36, v37
  v_cvt_pk_bf16_f32 v43, v30, v31
  v_cvt_pk_bf16_f32 v55, v38, v39
  s_add_u32 s16, s16, 8388608
  buffer_store_dwordx4 v[40:43], v3, s[4:7], s16 offen
  buffer_store_dwordx4 v[52:55], v3, s[4:7], s16 offen offset:1024
  s_waitcnt vmcnt(0)
prep_exit:
  s_endpgm
.globl interleave_layers__sliding_block__memory_aug_recurrent_mem_tr__prompt_kernel
.p2align 8
.type interleave_layers__sliding_block__memory_aug_recurrent_mem_tr__prompt_kernel,@function
interleave_layers__sliding_block__memory_aug_recurrent_mem_tr__prompt_kernel:
  s_cmp_ge_u32 s2, 256
  s_cbranch_scc1 L_exit
  s_load_dwordx2 s[4:5], s[0:1], 96
  s_waitcnt lgkmcnt(0)
  s_mov_b32 s6, 268435456
  s_mov_b32 s7, 0x20000
  s_load_dwordx2 s[8:9], s[0:1], 88
  s_waitcnt lgkmcnt(0)
  s_mov_b32 s10, 256
  s_mov_b32 s11, 0x20000
  s_mov_b32 s15, 1048576
  s_getreg_b32 s20, hwreg(HW_REG_XCC_ID, 0, 4)
  s_and_b32 s20, s20, 7
  s_lshl_b32 s21, s20, 4
  v_mov_b32 v1, s21
  v_mov_b32 v2, 1
  v_cmp_eq_u32 vcc, 0, v0
  s_and_saveexec_b64 s[22:23], vcc
  s_cbranch_execz L_noat
  buffer_atomic_add v2, v1, s[8:11], 0 offen sc0
  s_waitcnt vmcnt(0)
  v_mov_b32 v1, 0
  ds_write_b32 v1, v2
  s_waitcnt lgkmcnt(0)
L_noat:
  s_mov_b64 exec, s[22:23]
  s_barrier
  v_mov_b32 v1, 0
  ds_read_b32 v2, v1
  s_waitcnt lgkmcnt(0)
  v_readfirstlane_b32 s13, v2
  v_lshrrev_b32 v1, 6, v0
  s_nop 0
  v_readfirstlane_b32 s12, v1
  v_and_b32 v0, 63, v0
  s_mov_b32 s99, s20
  s_barrier
  s_cmp_lt_u32 s13, 32
  s_cbranch_scc1 L_haveslot
  s_load_dwordx2 s[8:9], s[0:1], 88
  s_waitcnt lgkmcnt(0)
  s_mov_b32 s10, 256
  s_mov_b32 s11, 0x20000
  v_and_b32 v21, 7, v0
  v_lshlrev_b32 v21, 4, v21
census_ov:
  buffer_load_dword v20, v21, s[8:11], 0 offen sc1
  s_waitcnt vmcnt(0)
  s_mov_b32 s16, 0
  v_readlane_b32 s17, v20, 0
  s_nop 0
  s_add_u32 s16, s16, s17
  v_readlane_b32 s17, v20, 1
  s_nop 0
  s_add_u32 s16, s16, s17
  v_readlane_b32 s17, v20, 2
  s_nop 0
  s_add_u32 s16, s16, s17
  v_readlane_b32 s17, v20, 3
  s_nop 0
  s_add_u32 s16, s16, s17
  v_readlane_b32 s17, v20, 4
  s_nop 0
  s_add_u32 s16, s16, s17
  v_readlane_b32 s17, v20, 5
  s_nop 0
  s_add_u32 s16, s16, s17
  v_readlane_b32 s17, v20, 6
  s_nop 0
  s_add_u32 s16, s16, s17
  v_readlane_b32 s17, v20, 7
  s_nop 0
  s_add_u32 s16, s16, s17
  s_cmp_ge_u32 s16, 256
  s_cbranch_scc1 census_ov_ok
  s_sub_u32 s15, s15, 1
  s_cbranch_scc1 census_ov_ok
  s_branch census_ov
census_ov_ok:
  s_sub_u32 s18, s13, 32
  v_readlane_b32 s17, v20, 0
  s_nop 0
  s_max_u32 s17, s17, 32
  s_sub_u32 s17, s17, 32
  s_cmp_lt_u32 0, s99
  s_cselect_b32 s17, s17, 0
  s_add_u32 s18, s18, s17
  v_readlane_b32 s17, v20, 1
  s_nop 0
  s_max_u32 s17, s17, 32
  s_sub_u32 s17, s17, 32
  s_cmp_lt_u32 1, s99
  s_cselect_b32 s17, s17, 0
  s_add_u32 s18, s18, s17
  v_readlane_b32 s17, v20, 2
  s_nop 0
  s_max_u32 s17, s17, 32
  s_sub_u32 s17, s17, 32
  s_cmp_lt_u32 2, s99
  s_cselect_b32 s17, s17, 0
  s_add_u32 s18, s18, s17
  v_readlane_b32 s17, v20, 3
  s_nop 0
  s_max_u32 s17, s17, 32
  s_sub_u32 s17, s17, 32
  s_cmp_lt_u32 3, s99
  s_cselect_b32 s17, s17, 0
  s_add_u32 s18, s18, s17
  v_readlane_b32 s17, v20, 4
  s_nop 0
  s_max_u32 s17, s17, 32
  s_sub_u32 s17, s17, 32
  s_cmp_lt_u32 4, s99
  s_cselect_b32 s17, s17, 0
  s_add_u32 s18, s18, s17
  v_readlane_b32 s17, v20, 5
  s_nop 0
  s_max_u32 s17, s17, 32
  s_sub_u32 s17, s17, 32
  s_cmp_lt_u32 5, s99
  s_cselect_b32 s17, s17, 0
  s_add_u32 s18, s18, s17
  v_readlane_b32 s17, v20, 6
  s_nop 0
  s_max_u32 s17, s17, 32
  s_sub_u32 s17, s17, 32
  s_cmp_lt_u32 6, s99
  s_cselect_b32 s17, s17, 0
  s_add_u32 s18, s18, s17
  v_readlane_b32 s17, v20, 7
  s_nop 0
  s_max_u32 s17, s17, 32
  s_sub_u32 s17, s17, 32
  s_cmp_lt_u32 7, s99
  s_cselect_b32 s17, s17, 0
  s_add_u32 s18, s18, s17
  s_mov_b32 s19, 0
  v_readlane_b32 s17, v20, 0
  s_nop 0
  s_min_u32 s17, s17, 32
  s_sub_u32 s16, 32, s17
  s_cmp_lg_u32 s19, 0
  s_cbranch_scc1 L_vac0
  s_cmp_lt_u32 s18, s16
  s_cbranch_scc0 L_vac0_n
  s_mov_b32 s99, 0
  s_add_u32 s13, s17, s18
  s_mov_b32 s19, 1
  s_branch L_vac0
L_vac0_n:
  s_sub_u32 s18, s18, s16
L_vac0:
  v_readlane_b32 s17, v20, 1
  s_nop 0
  s_min_u32 s17, s17, 32
  s_sub_u32 s16, 32, s17
  s_cmp_lg_u32 s19, 0
  s_cbranch_scc1 L_vac1
  s_cmp_lt_u32 s18, s16
  s_cbranch_scc0 L_vac1_n
  s_mov_b32 s99, 1
  s_add_u32 s13, s17, s18
  s_mov_b32 s19, 1
  s_branch L_vac1
L_vac1_n:
  s_sub_u32 s18, s18, s16
L_vac1:
  v_readlane_b32 s17, v20, 2
  s_nop 0
  s_min_u32 s17, s17, 32
  s_sub_u32 s16, 32, s17
  s_cmp_lg_u32 s19, 0
  s_cbranch_scc1 L_vac2
  s_cmp_lt_u32 s18, s16
  s_cbranch_scc0 L_vac2_n
  s_mov_b32 s99, 2
  s_add_u32 s13, s17, s18
  s_mov_b32 s19, 1
  s_branch L_vac2
L_vac2_n:
  s_sub_u32 s18, s18, s16
L_vac2:
  v_readlane_b32 s17, v20, 3
  s_nop 0
  s_min_u32 s17, s17, 32
  s_sub_u32 s16, 32, s17
  s_cmp_lg_u32 s19, 0
  s_cbranch_scc1 L_vac3
  s_cmp_lt_u32 s18, s16
  s_cbranch_scc0 L_vac3_n
  s_mov_b32 s99, 3
  s_add_u32 s13, s17, s18
  s_mov_b32 s19, 1
  s_branch L_vac3
L_vac3_n:
  s_sub_u32 s18, s18, s16
L_vac3:
  v_readlane_b32 s17, v20, 4
  s_nop 0
  s_min_u32 s17, s17, 32
  s_sub_u32 s16, 32, s17
  s_cmp_lg_u32 s19, 0
  s_cbranch_scc1 L_vac4
  s_cmp_lt_u32 s18, s16
  s_cbranch_scc0 L_vac4_n
  s_mov_b32 s99, 4
  s_add_u32 s13, s17, s18
  s_mov_b32 s19, 1
  s_branch L_vac4
L_vac4_n:
  s_sub_u32 s18, s18, s16
L_vac4:
  v_readlane_b32 s17, v20, 5
  s_nop 0
  s_min_u32 s17, s17, 32
  s_sub_u32 s16, 32, s17
  s_cmp_lg_u32 s19, 0
  s_cbranch_scc1 L_vac5
  s_cmp_lt_u32 s18, s16
  s_cbranch_scc0 L_vac5_n
  s_mov_b32 s99, 5
  s_add_u32 s13, s17, s18
  s_mov_b32 s19, 1
  s_branch L_vac5
L_vac5_n:
  s_sub_u32 s18, s18, s16
L_vac5:
  v_readlane_b32 s17, v20, 6
  s_nop 0
  s_min_u32 s17, s17, 32
  s_sub_u32 s16, 32, s17
  s_cmp_lg_u32 s19, 0
  s_cbranch_scc1 L_vac6
  s_cmp_lt_u32 s18, s16
  s_cbranch_scc0 L_vac6_n
  s_mov_b32 s99, 6
  s_add_u32 s13, s17, s18
  s_mov_b32 s19, 1
  s_branch L_vac6
L_vac6_n:
  s_sub_u32 s18, s18, s16
L_vac6:
  v_readlane_b32 s17, v20, 7
  s_nop 0
  s_min_u32 s17, s17, 32
  s_sub_u32 s16, 32, s17
  s_cmp_lg_u32 s19, 0
  s_cbranch_scc1 L_vac7
  s_cmp_lt_u32 s18, s16
  s_cbranch_scc0 L_vac7_n
  s_mov_b32 s99, 7
  s_add_u32 s13, s17, s18
  s_mov_b32 s19, 1
  s_branch L_vac7
L_vac7_n:
  s_sub_u32 s18, s18, s16
L_vac7:
  s_cmp_eq_u32 s19, 0
  s_cbranch_scc1 L_exit
L_haveslot:
  s_cmp_eq_u32 s99, 0
  s_cbranch_scc1 J_R0
  s_cmp_eq_u32 s99, 1
  s_cbranch_scc1 J_R1
  s_cmp_eq_u32 s99, 5
  s_cbranch_scc1 J_O0
  s_cmp_eq_u32 s99, 6
  s_cbranch_scc1 J_O1
  s_sub_u32 s16, s99, 2
  s_cmp_eq_u32 s99, 7
  s_cselect_b32 s16, 3, s16
  s_lshr_b32 s17, s13, 3
  s_and_b32 s18, s13, 7
  s_lshl_b32 s19, s16, 3
  s_add_u32 s13, s19, s18
  s_cmp_eq_u32 s17, 0
  s_cbranch_scc1 J_T0
  s_cmp_eq_u32 s17, 1
  s_cbranch_scc1 J_T1
  s_cmp_eq_u32 s17, 2
  s_cbranch_scc1 J_Aq
  s_lshl_b32 s18, s18, 2
  s_add_u32 s13, s18, s16
  s_branch X7_entry
J_R0:
  s_mov_b32 s14, 0
  s_branch R_entry
J_R1:
  s_mov_b32 s14, 1
  s_branch R_entry
J_O0:
  s_mov_b32 s14, 0
  s_branch O_entry
J_O1:
  s_mov_b32 s14, 1
  s_branch X6_entry
J_T0:
  s_mov_b32 s14, 0
  s_branch T_entry
J_T1:
  s_mov_b32 s14, 1
  s_branch T_entry
J_Aq:
  s_mov_b32 s14, 0
  s_branch Aq_entry
L_exit:
  s_endpgm
R_entry:
  v_lshrrev_b32 v28, 4, v0
  v_and_b32 v29, 15, v0
  v_lshrrev_b32 v29, 1, v29
  v_xor_b32 v24, v29, v28
  v_xor_b32 v25, 4, v24
  v_lshlrev_b32 v24, 5, v24
  v_lshlrev_b32 v25, 5, v25
  v_lshlrev_b32 v28, 13, v28
  v_and_b32 v29, 1, v0
  v_lshlrev_b32 v29, 4, v29
  v_add3_u32 v24, v24, v28, v29
  v_add3_u32 v25, v25, v28, v29
  v_lshrrev_b32 v28, 4, v0
  v_bfe_u32 v29, v0, 2, 2
  v_lshlrev_b32 v26, 3, v28
  v_add_u32 v26, v26, v29
  v_lshlrev_b32 v26, 8, v26
  v_and_b32 v28, 1, v28
  v_lshl_add_u32 v29, v28, 2, v29
  v_bfe_u32 v28, v0, 1, 1
  s_lshl_b32 s16, s12, 1
  v_add_u32 v28, s16, v28
  v_xor_b32 v28, v28, v29
  v_lshl_add_u32 v26, v28, 5, v26
  v_and_b32 v28, 1, v0
  v_lshl_add_u32 v26, v28, 4, v26
  v_add_u32 v27, 0x10000, v26
  s_load_dwordx2 s[8:9], s[0:1], 40
  s_waitcnt lgkmcnt(0)
  s_mov_b32 s10, 4194304
  s_mov_b32 s11, 0x20000
  s_lshl_b32 s16, s12, 20
  s_lshl_b32 s17, s13, 8
  s_add_u32 s16, s16, s17
  s_lshl_b32 s17, s12, 15
  s_mov_b32 m0, s17
  s_add_u32 s17, s17, 1024
  buffer_load_dwordx4 v24, s[8:11], s16 offen lds
  s_add_u32 s16, s16, 32768
  s_mov_b32 m0, s17
  s_add_u32 s17, s17, 1024
  buffer_load_dwordx4 v24, s[8:11], s16 offen lds
  s_add_u32 s16, s16, 32768
  s_mov_b32 m0, s17
  s_add_u32 s17, s17, 1024
  buffer_load_dwordx4 v25, s[8:11], s16 offen lds
  s_add_u32 s16, s16, 32768
  s_mov_b32 m0, s17
  s_add_u32 s17, s17, 1024
  buffer_load_dwordx4 v25, s[8:11], s16 offen lds
  s_add_u32 s16, s16, 32768
  s_mov_b32 m0, s17
  s_add_u32 s17, s17, 1024
  buffer_load_dwordx4 v24, s[8:11], s16 offen lds
  s_add_u32 s16, s16, 32768
  s_mov_b32 m0, s17
  s_add_u32 s17, s17, 1024
  buffer_load_dwordx4 v24, s[8:11], s16 offen lds
  s_add_u32 s16, s16, 32768
  s_mov_b32 m0, s17
  s_add_u32 s17, s17, 1024
  buffer_load_dwordx4 v25, s[8:11], s16 offen lds
  s_add_u32 s16, s16, 32768
  s_mov_b32 m0, s17
  s_add_u32 s17, s17, 1024
  buffer_load_dwordx4 v25, s[8:11], s16 offen lds
  s_add_u32 s16, s16, 32768
  s_mov_b32 m0, s17
  s_add_u32 s17, s17, 1024
  buffer_load_dwordx4 v24, s[8:11], s16 offen lds
  s_add_u32 s16, s16, 32768
  s_mov_b32 m0, s17
  s_add_u32 s17, s17, 1024
  buffer_load_dwordx4 v24, s[8:11], s16 offen lds
  s_add_u32 s16, s16, 32768
  s_mov_b32 m0, s17
  s_add_u32 s17, s17, 1024
  buffer_load_dwordx4 v25, s[8:11], s16 offen lds
  s_add_u32 s16, s16, 32768
  s_mov_b32 m0, s17
  s_add_u32 s17, s17, 1024
  buffer_load_dwordx4 v25, s[8:11], s16 offen lds
  s_add_u32 s16, s16, 32768
  s_mov_b32 m0, s17
  s_add_u32 s17, s17, 1024
  buffer_load_dwordx4 v24, s[8:11], s16 offen lds
  s_add_u32 s16, s16, 32768
  s_mov_b32 m0, s17
  s_add_u32 s17, s17, 1024
  buffer_load_dwordx4 v24, s[8:11], s16 offen lds
  s_add_u32 s16, s16, 32768
  s_mov_b32 m0, s17
  s_add_u32 s17, s17, 1024
  buffer_load_dwordx4 v25, s[8:11], s16 offen lds
  s_add_u32 s16, s16, 32768
  s_mov_b32 m0, s17
  s_add_u32 s17, s17, 1024
  buffer_load_dwordx4 v25, s[8:11], s16 offen lds
  s_add_u32 s16, s16, 32768
  s_mov_b32 m0, s17
  s_add_u32 s17, s17, 1024
  buffer_load_dwordx4 v24, s[8:11], s16 offen lds
  s_add_u32 s16, s16, 32768
  s_mov_b32 m0, s17
  s_add_u32 s17, s17, 1024
  buffer_load_dwordx4 v24, s[8:11], s16 offen lds
  s_add_u32 s16, s16, 32768
  s_mov_b32 m0, s17
  s_add_u32 s17, s17, 1024
  buffer_load_dwordx4 v25, s[8:11], s16 offen lds
  s_add_u32 s16, s16, 32768
  s_mov_b32 m0, s17
  s_add_u32 s17, s17, 1024
  buffer_load_dwordx4 v25, s[8:11], s16 offen lds
  s_add_u32 s16, s16, 32768
  s_mov_b32 m0, s17
  s_add_u32 s17, s17, 1024
  buffer_load_dwordx4 v24, s[8:11], s16 offen lds
  s_add_u32 s16, s16, 32768
  s_mov_b32 m0, s17
  s_add_u32 s17, s17, 1024
  buffer_load_dwordx4 v24, s[8:11], s16 offen lds
  s_add_u32 s16, s16, 32768
  s_mov_b32 m0, s17
  s_add_u32 s17, s17, 1024
  buffer_load_dwordx4 v25, s[8:11], s16 offen lds
  s_add_u32 s16, s16, 32768
  s_mov_b32 m0, s17
  s_add_u32 s17, s17, 1024
  buffer_load_dwordx4 v25, s[8:11], s16 offen lds
  s_add_u32 s16, s16, 32768
  s_mov_b32 m0, s17
  s_add_u32 s17, s17, 1024
  buffer_load_dwordx4 v24, s[8:11], s16 offen lds
  s_add_u32 s16, s16, 32768
  s_mov_b32 m0, s17
  s_add_u32 s17, s17, 1024
  buffer_load_dwordx4 v24, s[8:11], s16 offen lds
  s_add_u32 s16, s16, 32768
  s_mov_b32 m0, s17
  s_add_u32 s17, s17, 1024
  buffer_load_dwordx4 v25, s[8:11], s16 offen lds
  s_add_u32 s16, s16, 32768
  s_mov_b32 m0, s17
  s_add_u32 s17, s17, 1024
  buffer_load_dwordx4 v25, s[8:11], s16 offen lds
  s_add_u32 s16, s16, 32768
  s_mov_b32 m0, s17
  s_add_u32 s17, s17, 1024
  buffer_load_dwordx4 v24, s[8:11], s16 offen lds
  s_add_u32 s16, s16, 32768
  s_mov_b32 m0, s17
  s_add_u32 s17, s17, 1024
  buffer_load_dwordx4 v24, s[8:11], s16 offen lds
  s_add_u32 s16, s16, 32768
  s_mov_b32 m0, s17
  s_add_u32 s17, s17, 1024
  buffer_load_dwordx4 v25, s[8:11], s16 offen lds
  s_add_u32 s16, s16, 32768
  s_mov_b32 m0, s17
  s_add_u32 s17, s17, 1024
  buffer_load_dwordx4 v25, s[8:11], s16 offen lds
  s_add_u32 s16, s16, 32768
  s_waitcnt vmcnt(0)
  s_barrier
  ds_read_b64_tr_b16 a[0:1], v26 offset:0
  ds_read_b64_tr_b16 a[2:3], v26 offset:1024
  ds_read_b64_tr_b16 a[4:5], v26 offset:8192
  ds_read_b64_tr_b16 a[6:7], v26 offset:9216
  ds_read_b64_tr_b16 a[8:9], v26 offset:16384
  ds_read_b64_tr_b16 a[10:11], v26 offset:17408
  ds_read_b64_tr_b16 a[12:13], v26 offset:24576
  ds_read_b64_tr_b16 a[14:15], v26 offset:25600
  ds_read_b64_tr_b16 a[16:17], v26 offset:32768
  ds_read_b64_tr_b16 a[18:19], v26 offset:33792
  ds_read_b64_tr_b16 a[20:21], v26 offset:40960
  ds_read_b64_tr_b16 a[22:23], v26 offset:41984
  ds_read_b64_tr_b16 a[24:25], v26 offset:49152
  ds_read_b64_tr_b16 a[26:27], v26 offset:50176
  ds_read_b64_tr_b16 a[28:29], v26 offset:57344
  ds_read_b64_tr_b16 a[30:31], v26 offset:58368
  ds_read_b64_tr_b16 a[32:33], v27 offset:0
  ds_read_b64_tr_b16 a[34:35], v27 offset:1024
  ds_read_b64_tr_b16 a[36:37], v27 offset:8192
  ds_read_b64_tr_b16 a[38:39], v27 offset:9216
  ds_read_b64_tr_b16 a[40:41], v27 offset:16384
  ds_read_b64_tr_b16 a[42:43], v27 offset:17408
  ds_read_b64_tr_b16 a[44:45], v27 offset:24576
  ds_read_b64_tr_b16 a[46:47], v27 offset:25600
  ds_read_b64_tr_b16 a[48:49], v27 offset:32768
  ds_read_b64_tr_b16 a[50:51], v27 offset:33792
  ds_read_b64_tr_b16 a[52:53], v27 offset:40960
  ds_read_b64_tr_b16 a[54:55], v27 offset:41984
  ds_read_b64_tr_b16 a[56:57], v27 offset:49152
  ds_read_b64_tr_b16 a[58:59], v27 offset:50176
  ds_read_b64_tr_b16 a[60:61], v27 offset:57344
  ds_read_b64_tr_b16 a[62:63], v27 offset:58368
  ds_read_b64_tr_b16 a[64:65], v26 offset:8
  ds_read_b64_tr_b16 a[66:67], v26 offset:1032
  ds_read_b64_tr_b16 a[68:69], v26 offset:8200
  ds_read_b64_tr_b16 a[70:71], v26 offset:9224
  ds_read_b64_tr_b16 a[72:73], v26 offset:16392
  ds_read_b64_tr_b16 a[74:75], v26 offset:17416
  ds_read_b64_tr_b16 a[76:77], v26 offset:24584
  ds_read_b64_tr_b16 a[78:79], v26 offset:25608
  ds_read_b64_tr_b16 a[80:81], v26 offset:32776
  ds_read_b64_tr_b16 a[82:83], v26 offset:33800
  ds_read_b64_tr_b16 a[84:85], v26 offset:40968
  ds_read_b64_tr_b16 a[86:87], v26 offset:41992
  ds_read_b64_tr_b16 a[88:89], v26 offset:49160
  ds_read_b64_tr_b16 a[90:91], v26 offset:50184
  ds_read_b64_tr_b16 a[92:93], v26 offset:57352
  ds_read_b64_tr_b16 a[94:95], v26 offset:58376
  ds_read_b64_tr_b16 a[96:97], v27 offset:8
  ds_read_b64_tr_b16 a[98:99], v27 offset:1032
  ds_read_b64_tr_b16 a[100:101], v27 offset:8200
  ds_read_b64_tr_b16 a[102:103], v27 offset:9224
  ds_read_b64_tr_b16 a[104:105], v27 offset:16392
  ds_read_b64_tr_b16 a[106:107], v27 offset:17416
  ds_read_b64_tr_b16 a[108:109], v27 offset:24584
  ds_read_b64_tr_b16 a[110:111], v27 offset:25608
  ds_read_b64_tr_b16 a[112:113], v27 offset:32776
  ds_read_b64_tr_b16 a[114:115], v27 offset:33800
  ds_read_b64_tr_b16 a[116:117], v27 offset:40968
  ds_read_b64_tr_b16 a[118:119], v27 offset:41992
  ds_read_b64_tr_b16 a[120:121], v27 offset:49160
  ds_read_b64_tr_b16 a[122:123], v27 offset:50184
  ds_read_b64_tr_b16 a[124:125], v27 offset:57352
  ds_read_b64_tr_b16 a[126:127], v27 offset:58376
  s_waitcnt lgkmcnt(0)
  s_barrier
  s_load_dwordx2 s[8:9], s[0:1], 48
  s_waitcnt lgkmcnt(0)
  s_mov_b32 s10, 4194304
  s_mov_b32 s11, 0x20000
  s_lshl_b32 s16, s12, 20
  s_lshl_b32 s17, s13, 8
  s_add_u32 s16, s16, s17
  s_lshl_b32 s17, s12, 15
  s_mov_b32 m0, s17
  s_add_u32 s17, s17, 1024
  buffer_load_dwordx4 v24, s[8:11], s16 offen lds
  s_add_u32 s16, s16, 32768
  s_mov_b32 m0, s17
  s_add_u32 s17, s17, 1024
  buffer_load_dwordx4 v24, s[8:11], s16 offen lds
  s_add_u32 s16, s16, 32768
  s_mov_b32 m0, s17
  s_add_u32 s17, s17, 1024
  buffer_load_dwordx4 v25, s[8:11], s16 offen lds
  s_add_u32 s16, s16, 32768
  s_mov_b32 m0, s17
  s_add_u32 s17, s17, 1024
  buffer_load_dwordx4 v25, s[8:11], s16 offen lds
  s_add_u32 s16, s16, 32768
  s_mov_b32 m0, s17
  s_add_u32 s17, s17, 1024
  buffer_load_dwordx4 v24, s[8:11], s16 offen lds
  s_add_u32 s16, s16, 32768
  s_mov_b32 m0, s17
  s_add_u32 s17, s17, 1024
  buffer_load_dwordx4 v24, s[8:11], s16 offen lds
  s_add_u32 s16, s16, 32768
  s_mov_b32 m0, s17
  s_add_u32 s17, s17, 1024
  buffer_load_dwordx4 v25, s[8:11], s16 offen lds
  s_add_u32 s16, s16, 32768
  s_mov_b32 m0, s17
  s_add_u32 s17, s17, 1024
  buffer_load_dwordx4 v25, s[8:11], s16 offen lds
  s_add_u32 s16, s16, 32768
  s_mov_b32 m0, s17
  s_add_u32 s17, s17, 1024
  buffer_load_dwordx4 v24, s[8:11], s16 offen lds
  s_add_u32 s16, s16, 32768
  s_mov_b32 m0, s17
  s_add_u32 s17, s17, 1024
  buffer_load_dwordx4 v24, s[8:11], s16 offen lds
  s_add_u32 s16, s16, 32768
  s_mov_b32 m0, s17
  s_add_u32 s17, s17, 1024
  buffer_load_dwordx4 v25, s[8:11], s16 offen lds
  s_add_u32 s16, s16, 32768
  s_mov_b32 m0, s17
  s_add_u32 s17, s17, 1024
  buffer_load_dwordx4 v25, s[8:11], s16 offen lds
  s_add_u32 s16, s16, 32768
  s_mov_b32 m0, s17
  s_add_u32 s17, s17, 1024
  buffer_load_dwordx4 v24, s[8:11], s16 offen lds
  s_add_u32 s16, s16, 32768
  s_mov_b32 m0, s17
  s_add_u32 s17, s17, 1024
  buffer_load_dwordx4 v24, s[8:11], s16 offen lds
  s_add_u32 s16, s16, 32768
  s_mov_b32 m0, s17
  s_add_u32 s17, s17, 1024
  buffer_load_dwordx4 v25, s[8:11], s16 offen lds
  s_add_u32 s16, s16, 32768
  s_mov_b32 m0, s17
  s_add_u32 s17, s17, 1024
  buffer_load_dwordx4 v25, s[8:11], s16 offen lds
  s_add_u32 s16, s16, 32768
  s_mov_b32 m0, s17
  s_add_u32 s17, s17, 1024
  buffer_load_dwordx4 v24, s[8:11], s16 offen lds
  s_add_u32 s16, s16, 32768
  s_mov_b32 m0, s17
  s_add_u32 s17, s17, 1024
  buffer_load_dwordx4 v24, s[8:11], s16 offen lds
  s_add_u32 s16, s16, 32768
  s_mov_b32 m0, s17
  s_add_u32 s17, s17, 1024
  buffer_load_dwordx4 v25, s[8:11], s16 offen lds
  s_add_u32 s16, s16, 32768
  s_mov_b32 m0, s17
  s_add_u32 s17, s17, 1024
  buffer_load_dwordx4 v25, s[8:11], s16 offen lds
  s_add_u32 s16, s16, 32768
  s_mov_b32 m0, s17
  s_add_u32 s17, s17, 1024
  buffer_load_dwordx4 v24, s[8:11], s16 offen lds
  s_add_u32 s16, s16, 32768
  s_mov_b32 m0, s17
  s_add_u32 s17, s17, 1024
  buffer_load_dwordx4 v24, s[8:11], s16 offen lds
  s_add_u32 s16, s16, 32768
  s_mov_b32 m0, s17
  s_add_u32 s17, s17, 1024
  buffer_load_dwordx4 v25, s[8:11], s16 offen lds
  s_add_u32 s16, s16, 32768
  s_mov_b32 m0, s17
  s_add_u32 s17, s17, 1024
  buffer_load_dwordx4 v25, s[8:11], s16 offen lds
  s_add_u32 s16, s16, 32768
  s_mov_b32 m0, s17
  s_add_u32 s17, s17, 1024
  buffer_load_dwordx4 v24, s[8:11], s16 offen lds
  s_add_u32 s16, s16, 32768
  s_mov_b32 m0, s17
  s_add_u32 s17, s17, 1024
  buffer_load_dwordx4 v24, s[8:11], s16 offen lds
  s_add_u32 s16, s16, 32768
  s_mov_b32 m0, s17
  s_add_u32 s17, s17, 1024
  buffer_load_dwordx4 v25, s[8:11], s16 offen lds
  s_add_u32 s16, s16, 32768
  s_mov_b32 m0, s17
  s_add_u32 s17, s17, 1024
  buffer_load_dwordx4 v25, s[8:11], s16 offen lds
  s_add_u32 s16, s16, 32768
  s_mov_b32 m0, s17
  s_add_u32 s17, s17, 1024
  buffer_load_dwordx4 v24, s[8:11], s16 offen lds
  s_add_u32 s16, s16, 32768
  s_mov_b32 m0, s17
  s_add_u32 s17, s17, 1024
  buffer_load_dwordx4 v24, s[8:11], s16 offen lds
  s_add_u32 s16, s16, 32768
  s_mov_b32 m0, s17
  s_add_u32 s17, s17, 1024
  buffer_load_dwordx4 v25, s[8:11], s16 offen lds
  s_add_u32 s16, s16, 32768
  s_mov_b32 m0, s17
  s_add_u32 s17, s17, 1024
  buffer_load_dwordx4 v25, s[8:11], s16 offen lds
  s_add_u32 s16, s16, 32768
  s_waitcnt vmcnt(0)
  s_barrier
  ds_read_b64_tr_b16 a[128:129], v26 offset:0
  ds_read_b64_tr_b16 a[130:131], v26 offset:1024
  ds_read_b64_tr_b16 a[132:133], v26 offset:8192
  ds_read_b64_tr_b16 a[134:135], v26 offset:9216
  ds_read_b64_tr_b16 a[136:137], v26 offset:16384
  ds_read_b64_tr_b16 a[138:139], v26 offset:17408
  ds_read_b64_tr_b16 a[140:141], v26 offset:24576
  ds_read_b64_tr_b16 a[142:143], v26 offset:25600
  ds_read_b64_tr_b16 a[144:145], v26 offset:32768
  ds_read_b64_tr_b16 a[146:147], v26 offset:33792
  ds_read_b64_tr_b16 a[148:149], v26 offset:40960
  ds_read_b64_tr_b16 a[150:151], v26 offset:41984
  ds_read_b64_tr_b16 a[152:153], v26 offset:49152
  ds_read_b64_tr_b16 a[154:155], v26 offset:50176
  ds_read_b64_tr_b16 a[156:157], v26 offset:57344
  ds_read_b64_tr_b16 a[158:159], v26 offset:58368
  ds_read_b64_tr_b16 a[160:161], v27 offset:0
  ds_read_b64_tr_b16 a[162:163], v27 offset:1024
  ds_read_b64_tr_b16 a[164:165], v27 offset:8192
  ds_read_b64_tr_b16 a[166:167], v27 offset:9216
  ds_read_b64_tr_b16 a[168:169], v27 offset:16384
  ds_read_b64_tr_b16 a[170:171], v27 offset:17408
  ds_read_b64_tr_b16 a[172:173], v27 offset:24576
  ds_read_b64_tr_b16 a[174:175], v27 offset:25600
  ds_read_b64_tr_b16 a[176:177], v27 offset:32768
  ds_read_b64_tr_b16 a[178:179], v27 offset:33792
  ds_read_b64_tr_b16 a[180:181], v27 offset:40960
  ds_read_b64_tr_b16 a[182:183], v27 offset:41984
  ds_read_b64_tr_b16 a[184:185], v27 offset:49152
  ds_read_b64_tr_b16 a[186:187], v27 offset:50176
  ds_read_b64_tr_b16 a[188:189], v27 offset:57344
  ds_read_b64_tr_b16 a[190:191], v27 offset:58368
  ds_read_b64_tr_b16 a[192:193], v26 offset:8
  ds_read_b64_tr_b16 a[194:195], v26 offset:1032
  ds_read_b64_tr_b16 a[196:197], v26 offset:8200
  ds_read_b64_tr_b16 a[198:199], v26 offset:9224
  ds_read_b64_tr_b16 a[200:201], v26 offset:16392
  ds_read_b64_tr_b16 a[202:203], v26 offset:17416
  ds_read_b64_tr_b16 a[204:205], v26 offset:24584
  ds_read_b64_tr_b16 a[206:207], v26 offset:25608
  ds_read_b64_tr_b16 a[208:209], v26 offset:32776
  ds_read_b64_tr_b16 a[210:211], v26 offset:33800
  ds_read_b64_tr_b16 a[212:213], v26 offset:40968
  ds_read_b64_tr_b16 a[214:215], v26 offset:41992
  ds_read_b64_tr_b16 a[216:217], v26 offset:49160
  ds_read_b64_tr_b16 a[218:219], v26 offset:50184
  ds_read_b64_tr_b16 a[220:221], v26 offset:57352
  ds_read_b64_tr_b16 a[222:223], v26 offset:58376
  ds_read_b64_tr_b16 a[224:225], v27 offset:8
  ds_read_b64_tr_b16 a[226:227], v27 offset:1032
  ds_read_b64_tr_b16 a[228:229], v27 offset:8200
  ds_read_b64_tr_b16 a[230:231], v27 offset:9224
  ds_read_b64_tr_b16 a[232:233], v27 offset:16392
  ds_read_b64_tr_b16 a[234:235], v27 offset:17416
  ds_read_b64_tr_b16 a[236:237], v27 offset:24584
  ds_read_b64_tr_b16 a[238:239], v27 offset:25608
  ds_read_b64_tr_b16 a[240:241], v27 offset:32776
  ds_read_b64_tr_b16 a[242:243], v27 offset:33800
  ds_read_b64_tr_b16 a[244:245], v27 offset:40968
  ds_read_b64_tr_b16 a[246:247], v27 offset:41992
  ds_read_b64_tr_b16 a[248:249], v27 offset:49160
  ds_read_b64_tr_b16 a[250:251], v27 offset:50184
  ds_read_b64_tr_b16 a[252:253], v27 offset:57352
  ds_read_b64_tr_b16 a[254:255], v27 offset:58376
  s_waitcnt lgkmcnt(0)
  s_barrier
  s_load_dwordx2 s[8:9], s[0:1], 56
  s_waitcnt lgkmcnt(0)
  s_mov_b32 s10, 4194304
  s_mov_b32 s11, 0x20000
  s_lshl_b32 s16, s12, 20
  s_lshl_b32 s17, s13, 8
  s_add_u32 s16, s16, s17
  s_lshl_b32 s17, s12, 15
  s_mov_b32 m0, s17
  s_add_u32 s17, s17, 1024
  buffer_load_dwordx4 v24, s[8:11], s16 offen lds
  s_add_u32 s16, s16, 32768
  s_mov_b32 m0, s17
  s_add_u32 s17, s17, 1024
  buffer_load_dwordx4 v24, s[8:11], s16 offen lds
  s_add_u32 s16, s16, 32768
  s_mov_b32 m0, s17
  s_add_u32 s17, s17, 1024
  buffer_load_dwordx4 v25, s[8:11], s16 offen lds
  s_add_u32 s16, s16, 32768
  s_mov_b32 m0, s17
  s_add_u32 s17, s17, 1024
  buffer_load_dwordx4 v25, s[8:11], s16 offen lds
  s_add_u32 s16, s16, 32768
  s_mov_b32 m0, s17
  s_add_u32 s17, s17, 1024
  buffer_load_dwordx4 v24, s[8:11], s16 offen lds
  s_add_u32 s16, s16, 32768
  s_mov_b32 m0, s17
  s_add_u32 s17, s17, 1024
  buffer_load_dwordx4 v24, s[8:11], s16 offen lds
  s_add_u32 s16, s16, 32768
  s_mov_b32 m0, s17
  s_add_u32 s17, s17, 1024
  buffer_load_dwordx4 v25, s[8:11], s16 offen lds
  s_add_u32 s16, s16, 32768
  s_mov_b32 m0, s17
  s_add_u32 s17, s17, 1024
  buffer_load_dwordx4 v25, s[8:11], s16 offen lds
  s_add_u32 s16, s16, 32768
  s_mov_b32 m0, s17
  s_add_u32 s17, s17, 1024
  buffer_load_dwordx4 v24, s[8:11], s16 offen lds
  s_add_u32 s16, s16, 32768
  s_mov_b32 m0, s17
  s_add_u32 s17, s17, 1024
  buffer_load_dwordx4 v24, s[8:11], s16 offen lds
  s_add_u32 s16, s16, 32768
  s_mov_b32 m0, s17
  s_add_u32 s17, s17, 1024
  buffer_load_dwordx4 v25, s[8:11], s16 offen lds
  s_add_u32 s16, s16, 32768
  s_mov_b32 m0, s17
  s_add_u32 s17, s17, 1024
  buffer_load_dwordx4 v25, s[8:11], s16 offen lds
  s_add_u32 s16, s16, 32768
  s_mov_b32 m0, s17
  s_add_u32 s17, s17, 1024
  buffer_load_dwordx4 v24, s[8:11], s16 offen lds
  s_add_u32 s16, s16, 32768
  s_mov_b32 m0, s17
  s_add_u32 s17, s17, 1024
  buffer_load_dwordx4 v24, s[8:11], s16 offen lds
  s_add_u32 s16, s16, 32768
  s_mov_b32 m0, s17
  s_add_u32 s17, s17, 1024
  buffer_load_dwordx4 v25, s[8:11], s16 offen lds
  s_add_u32 s16, s16, 32768
  s_mov_b32 m0, s17
  s_add_u32 s17, s17, 1024
  buffer_load_dwordx4 v25, s[8:11], s16 offen lds
  s_add_u32 s16, s16, 32768
  s_mov_b32 m0, s17
  s_add_u32 s17, s17, 1024
  buffer_load_dwordx4 v24, s[8:11], s16 offen lds
  s_add_u32 s16, s16, 32768
  s_mov_b32 m0, s17
  s_add_u32 s17, s17, 1024
  buffer_load_dwordx4 v24, s[8:11], s16 offen lds
  s_add_u32 s16, s16, 32768
  s_mov_b32 m0, s17
  s_add_u32 s17, s17, 1024
  buffer_load_dwordx4 v25, s[8:11], s16 offen lds
  s_add_u32 s16, s16, 32768
  s_mov_b32 m0, s17
  s_add_u32 s17, s17, 1024
  buffer_load_dwordx4 v25, s[8:11], s16 offen lds
  s_add_u32 s16, s16, 32768
  s_mov_b32 m0, s17
  s_add_u32 s17, s17, 1024
  buffer_load_dwordx4 v24, s[8:11], s16 offen lds
  s_add_u32 s16, s16, 32768
  s_mov_b32 m0, s17
  s_add_u32 s17, s17, 1024
  buffer_load_dwordx4 v24, s[8:11], s16 offen lds
  s_add_u32 s16, s16, 32768
  s_mov_b32 m0, s17
  s_add_u32 s17, s17, 1024
  buffer_load_dwordx4 v25, s[8:11], s16 offen lds
  s_add_u32 s16, s16, 32768
  s_mov_b32 m0, s17
  s_add_u32 s17, s17, 1024
  buffer_load_dwordx4 v25, s[8:11], s16 offen lds
  s_add_u32 s16, s16, 32768
  s_mov_b32 m0, s17
  s_add_u32 s17, s17, 1024
  buffer_load_dwordx4 v24, s[8:11], s16 offen lds
  s_add_u32 s16, s16, 32768
  s_mov_b32 m0, s17
  s_add_u32 s17, s17, 1024
  buffer_load_dwordx4 v24, s[8:11], s16 offen lds
  s_add_u32 s16, s16, 32768
  s_mov_b32 m0, s17
  s_add_u32 s17, s17, 1024
  buffer_load_dwordx4 v25, s[8:11], s16 offen lds
  s_add_u32 s16, s16, 32768
  s_mov_b32 m0, s17
  s_add_u32 s17, s17, 1024
  buffer_load_dwordx4 v25, s[8:11], s16 offen lds
  s_add_u32 s16, s16, 32768
  s_mov_b32 m0, s17
  s_add_u32 s17, s17, 1024
  buffer_load_dwordx4 v24, s[8:11], s16 offen lds
  s_add_u32 s16, s16, 32768
  s_mov_b32 m0, s17
  s_add_u32 s17, s17, 1024
  buffer_load_dwordx4 v24, s[8:11], s16 offen lds
  s_add_u32 s16, s16, 32768
  s_mov_b32 m0, s17
  s_add_u32 s17, s17, 1024
  buffer_load_dwordx4 v25, s[8:11], s16 offen lds
  s_add_u32 s16, s16, 32768
  s_mov_b32 m0, s17
  s_add_u32 s17, s17, 1024
  buffer_load_dwordx4 v25, s[8:11], s16 offen lds
  s_add_u32 s16, s16, 32768
  s_waitcnt vmcnt(0)
  s_barrier
  ds_read_b64_tr_b16 v[128:129], v26 offset:0
  ds_read_b64_tr_b16 v[130:131], v26 offset:1024
  ds_read_b64_tr_b16 v[132:133], v26 offset:8192
  ds_read_b64_tr_b16 v[134:135], v26 offset:9216
  ds_read_b64_tr_b16 v[136:137], v26 offset:16384
  ds_read_b64_tr_b16 v[138:139], v26 offset:17408
  ds_read_b64_tr_b16 v[140:141], v26 offset:24576
  ds_read_b64_tr_b16 v[142:143], v26 offset:25600
  ds_read_b64_tr_b16 v[144:145], v26 offset:32768
  ds_read_b64_tr_b16 v[146:147], v26 offset:33792
  ds_read_b64_tr_b16 v[148:149], v26 offset:40960
  ds_read_b64_tr_b16 v[150:151], v26 offset:41984
  ds_read_b64_tr_b16 v[152:153], v26 offset:49152
  ds_read_b64_tr_b16 v[154:155], v26 offset:50176
  ds_read_b64_tr_b16 v[156:157], v26 offset:57344
  ds_read_b64_tr_b16 v[158:159], v26 offset:58368
  ds_read_b64_tr_b16 v[160:161], v27 offset:0
  ds_read_b64_tr_b16 v[162:163], v27 offset:1024
  ds_read_b64_tr_b16 v[164:165], v27 offset:8192
  ds_read_b64_tr_b16 v[166:167], v27 offset:9216
  ds_read_b64_tr_b16 v[168:169], v27 offset:16384
  ds_read_b64_tr_b16 v[170:171], v27 offset:17408
  ds_read_b64_tr_b16 v[172:173], v27 offset:24576
  ds_read_b64_tr_b16 v[174:175], v27 offset:25600
  ds_read_b64_tr_b16 v[176:177], v27 offset:32768
  ds_read_b64_tr_b16 v[178:179], v27 offset:33792
  ds_read_b64_tr_b16 v[180:181], v27 offset:40960
  ds_read_b64_tr_b16 v[182:183], v27 offset:41984
  ds_read_b64_tr_b16 v[184:185], v27 offset:49152
  ds_read_b64_tr_b16 v[186:187], v27 offset:50176
  ds_read_b64_tr_b16 v[188:189], v27 offset:57344
  ds_read_b64_tr_b16 v[190:191], v27 offset:58368
  ds_read_b64_tr_b16 v[192:193], v26 offset:8
  ds_read_b64_tr_b16 v[194:195], v26 offset:1032
  ds_read_b64_tr_b16 v[196:197], v26 offset:8200
  ds_read_b64_tr_b16 v[198:199], v26 offset:9224
  ds_read_b64_tr_b16 v[200:201], v26 offset:16392
  ds_read_b64_tr_b16 v[202:203], v26 offset:17416
  ds_read_b64_tr_b16 v[204:205], v26 offset:24584
  ds_read_b64_tr_b16 v[206:207], v26 offset:25608
  ds_read_b64_tr_b16 v[208:209], v26 offset:32776
  ds_read_b64_tr_b16 v[210:211], v26 offset:33800
  ds_read_b64_tr_b16 v[212:213], v26 offset:40968
  ds_read_b64_tr_b16 v[214:215], v26 offset:41992
  ds_read_b64_tr_b16 v[216:217], v26 offset:49160
  ds_read_b64_tr_b16 v[218:219], v26 offset:50184
  ds_read_b64_tr_b16 v[220:221], v26 offset:57352
  ds_read_b64_tr_b16 v[222:223], v26 offset:58376
  ds_read_b64_tr_b16 v[224:225], v27 offset:8
  ds_read_b64_tr_b16 v[226:227], v27 offset:1032
  ds_read_b64_tr_b16 v[228:229], v27 offset:8200
  ds_read_b64_tr_b16 v[230:231], v27 offset:9224
  ds_read_b64_tr_b16 v[232:233], v27 offset:16392
  ds_read_b64_tr_b16 v[234:235], v27 offset:17416
  ds_read_b64_tr_b16 v[236:237], v27 offset:24584
  ds_read_b64_tr_b16 v[238:239], v27 offset:25608
  ds_read_b64_tr_b16 v[240:241], v27 offset:32776
  ds_read_b64_tr_b16 v[242:243], v27 offset:33800
  ds_read_b64_tr_b16 v[244:245], v27 offset:40968
  ds_read_b64_tr_b16 v[246:247], v27 offset:41992
  ds_read_b64_tr_b16 v[248:249], v27 offset:49160
  ds_read_b64_tr_b16 v[250:251], v27 offset:50184
  ds_read_b64_tr_b16 v[252:253], v27 offset:57352
  ds_read_b64_tr_b16 v[254:255], v27 offset:58376
  s_waitcnt lgkmcnt(0)
  s_barrier
  s_load_dwordx2 s[8:9], s[0:1], 64
  s_waitcnt lgkmcnt(0)
  s_mov_b32 s10, 4194304
  s_mov_b32 s11, 0x20000
  v_lshlrev_b32 v24, 4, v0
  s_lshl_b32 s16, s13, 17
  s_lshl_b32 s17, s12, 15
  s_add_u32 s16, s16, s17
  s_add_u32 s17, s17, 32768
  v_xor_b32 v25, 0, v24
  s_mov_b32 m0, s17
  s_add_u32 s17, s17, 1024
  buffer_load_dwordx4 v25, s[8:11], s16 offen lds
  s_add_u32 s16, s16, 1024
  v_xor_b32 v25, 32, v24
  s_mov_b32 m0, s17
  s_add_u32 s17, s17, 1024
  buffer_load_dwordx4 v25, s[8:11], s16 offen lds
  s_add_u32 s16, s16, 1024
  v_xor_b32 v25, 64, v24
  s_mov_b32 m0, s17
  s_add_u32 s17, s17, 1024
  buffer_load_dwordx4 v25, s[8:11], s16 offen lds
  s_add_u32 s16, s16, 1024
  v_xor_b32 v25, 96, v24
  s_mov_b32 m0, s17
  s_add_u32 s17, s17, 1024
  buffer_load_dwordx4 v25, s[8:11], s16 offen lds
  s_add_u32 s16, s16, 1024
  v_xor_b32 v25, 0, v24
  s_mov_b32 m0, s17
  s_add_u32 s17, s17, 1024
  buffer_load_dwordx4 v25, s[8:11], s16 offen lds
  s_add_u32 s16, s16, 1024
  v_xor_b32 v25, 32, v24
  s_mov_b32 m0, s17
  s_add_u32 s17, s17, 1024
  buffer_load_dwordx4 v25, s[8:11], s16 offen lds
  s_add_u32 s16, s16, 1024
  v_xor_b32 v25, 64, v24
  s_mov_b32 m0, s17
  s_add_u32 s17, s17, 1024
  buffer_load_dwordx4 v25, s[8:11], s16 offen lds
  s_add_u32 s16, s16, 1024
  v_xor_b32 v25, 96, v24
  s_mov_b32 m0, s17
  s_add_u32 s17, s17, 1024
  buffer_load_dwordx4 v25, s[8:11], s16 offen lds
  s_add_u32 s16, s16, 1024
  v_xor_b32 v25, 128, v24
  s_mov_b32 m0, s17
  s_add_u32 s17, s17, 1024
  buffer_load_dwordx4 v25, s[8:11], s16 offen lds
  s_add_u32 s16, s16, 1024
  v_xor_b32 v25, 160, v24
  s_mov_b32 m0, s17
  s_add_u32 s17, s17, 1024
  buffer_load_dwordx4 v25, s[8:11], s16 offen lds
  s_add_u32 s16, s16, 1024
  v_xor_b32 v25, 192, v24
  s_mov_b32 m0, s17
  s_add_u32 s17, s17, 1024
  buffer_load_dwordx4 v25, s[8:11], s16 offen lds
  s_add_u32 s16, s16, 1024
  v_xor_b32 v25, 224, v24
  s_mov_b32 m0, s17
  s_add_u32 s17, s17, 1024
  buffer_load_dwordx4 v25, s[8:11], s16 offen lds
  s_add_u32 s16, s16, 1024
  v_xor_b32 v25, 128, v24
  s_mov_b32 m0, s17
  s_add_u32 s17, s17, 1024
  buffer_load_dwordx4 v25, s[8:11], s16 offen lds
  s_add_u32 s16, s16, 1024
  v_xor_b32 v25, 160, v24
  s_mov_b32 m0, s17
  s_add_u32 s17, s17, 1024
  buffer_load_dwordx4 v25, s[8:11], s16 offen lds
  s_add_u32 s16, s16, 1024
  v_xor_b32 v25, 192, v24
  s_mov_b32 m0, s17
  s_add_u32 s17, s17, 1024
  buffer_load_dwordx4 v25, s[8:11], s16 offen lds
  s_add_u32 s16, s16, 1024
  v_xor_b32 v25, 224, v24
  s_mov_b32 m0, s17
  s_add_u32 s17, s17, 1024
  buffer_load_dwordx4 v25, s[8:11], s16 offen lds
  s_add_u32 s16, s16, 1024
  v_xor_b32 v25, 0, v24
  s_mov_b32 m0, s17
  s_add_u32 s17, s17, 1024
  buffer_load_dwordx4 v25, s[8:11], s16 offen lds
  s_add_u32 s16, s16, 1024
  v_xor_b32 v25, 32, v24
  s_mov_b32 m0, s17
  s_add_u32 s17, s17, 1024
  buffer_load_dwordx4 v25, s[8:11], s16 offen lds
  s_add_u32 s16, s16, 1024
  v_xor_b32 v25, 64, v24
  s_mov_b32 m0, s17
  s_add_u32 s17, s17, 1024
  buffer_load_dwordx4 v25, s[8:11], s16 offen lds
  s_add_u32 s16, s16, 1024
  v_xor_b32 v25, 96, v24
  s_mov_b32 m0, s17
  s_add_u32 s17, s17, 1024
  buffer_load_dwordx4 v25, s[8:11], s16 offen lds
  s_add_u32 s16, s16, 1024
  v_xor_b32 v25, 0, v24
  s_mov_b32 m0, s17
  s_add_u32 s17, s17, 1024
  buffer_load_dwordx4 v25, s[8:11], s16 offen lds
  s_add_u32 s16, s16, 1024
  v_xor_b32 v25, 32, v24
  s_mov_b32 m0, s17
  s_add_u32 s17, s17, 1024
  buffer_load_dwordx4 v25, s[8:11], s16 offen lds
  s_add_u32 s16, s16, 1024
  v_xor_b32 v25, 64, v24
  s_mov_b32 m0, s17
  s_add_u32 s17, s17, 1024
  buffer_load_dwordx4 v25, s[8:11], s16 offen lds
  s_add_u32 s16, s16, 1024
  v_xor_b32 v25, 96, v24
  s_mov_b32 m0, s17
  s_add_u32 s17, s17, 1024
  buffer_load_dwordx4 v25, s[8:11], s16 offen lds
  s_add_u32 s16, s16, 1024
  v_xor_b32 v25, 128, v24
  s_mov_b32 m0, s17
  s_add_u32 s17, s17, 1024
  buffer_load_dwordx4 v25, s[8:11], s16 offen lds
  s_add_u32 s16, s16, 1024
  v_xor_b32 v25, 160, v24
  s_mov_b32 m0, s17
  s_add_u32 s17, s17, 1024
  buffer_load_dwordx4 v25, s[8:11], s16 offen lds
  s_add_u32 s16, s16, 1024
  v_xor_b32 v25, 192, v24
  s_mov_b32 m0, s17
  s_add_u32 s17, s17, 1024
  buffer_load_dwordx4 v25, s[8:11], s16 offen lds
  s_add_u32 s16, s16, 1024
  v_xor_b32 v25, 224, v24
  s_mov_b32 m0, s17
  s_add_u32 s17, s17, 1024
  buffer_load_dwordx4 v25, s[8:11], s16 offen lds
  s_add_u32 s16, s16, 1024
  v_xor_b32 v25, 128, v24
  s_mov_b32 m0, s17
  s_add_u32 s17, s17, 1024
  buffer_load_dwordx4 v25, s[8:11], s16 offen lds
  s_add_u32 s16, s16, 1024
  v_xor_b32 v25, 160, v24
  s_mov_b32 m0, s17
  s_add_u32 s17, s17, 1024
  buffer_load_dwordx4 v25, s[8:11], s16 offen lds
  s_add_u32 s16, s16, 1024
  v_xor_b32 v25, 192, v24
  s_mov_b32 m0, s17
  s_add_u32 s17, s17, 1024
  buffer_load_dwordx4 v25, s[8:11], s16 offen lds
  s_add_u32 s16, s16, 1024
  v_xor_b32 v25, 224, v24
  s_mov_b32 m0, s17
  s_add_u32 s17, s17, 1024
  buffer_load_dwordx4 v25, s[8:11], s16 offen lds
  s_add_u32 s16, s16, 1024
  v_lshrrev_b32 v26, 4, v0
  v_bfe_u32 v27, v0, 2, 2
  v_lshl_add_u32 v28, v26, 3, v27
  v_lshlrev_b32 v28, 10, v28
  v_and_b32 v26, 1, v26
  v_lshl_add_u32 v27, v26, 2, v27
  v_lshl_add_u32 v28, v27, 5, v28
  v_and_b32 v26, 3, v0
  v_lshl_add_u32 v28, v26, 3, v28
  s_lshl_b32 s16, s12, 8
  v_add_u32 v28, s16, v28
  v_add_u32 v28, 0x8000, v28
  s_lshl_b32 s16, s12, 13
  v_lshlrev_b32 v29, 4, v0
  v_add_u32 v29, s16, v29
  s_add_u32 s16, s13, 0
  s_and_b32 s16, s16, 1
  s_lshl_b32 s16, s16, 2
  s_or_b32 s16, s16, 0
  s_lshl_b32 s24, s16, 5
  s_add_u32 s16, s13, 0
  s_and_b32 s16, s16, 1
  s_lshl_b32 s16, s16, 2
  s_or_b32 s16, s16, 1
  s_lshl_b32 s25, s16, 5
  s_add_u32 s16, s13, 0
  s_and_b32 s16, s16, 1
  s_lshl_b32 s16, s16, 2
  s_or_b32 s16, s16, 2
  s_lshl_b32 s26, s16, 5
  s_add_u32 s16, s13, 0
  s_and_b32 s16, s16, 1
  s_lshl_b32 s16, s16, 2
  s_or_b32 s16, s16, 3
  s_lshl_b32 s27, s16, 5
  s_add_u32 s16, s13, 1
  s_and_b32 s16, s16, 1
  s_lshl_b32 s16, s16, 2
  s_or_b32 s16, s16, 0
  s_lshl_b32 s28, s16, 5
  s_add_u32 s16, s13, 1
  s_and_b32 s16, s16, 1
  s_lshl_b32 s16, s16, 2
  s_or_b32 s16, s16, 1
  s_lshl_b32 s29, s16, 5
  s_add_u32 s16, s13, 1
  s_and_b32 s16, s16, 1
  s_lshl_b32 s16, s16, 2
  s_or_b32 s16, s16, 2
  s_lshl_b32 s30, s16, 5
  s_add_u32 s16, s13, 1
  s_and_b32 s16, s16, 1
  s_lshl_b32 s16, s16, 2
  s_or_b32 s16, s16, 3
  s_lshl_b32 s31, s16, 5
  s_waitcnt vmcnt(0)
  s_barrier
  v_xor_b32 v30, s24, v28
  ds_read_b64_tr_b16 v[32:33], v30 offset:0
  ds_read_b64_tr_b16 v[34:35], v30 offset:4096
  v_xor_b32 v30, s25, v28
  ds_read_b64_tr_b16 v[36:37], v30 offset:0
  ds_read_b64_tr_b16 v[38:39], v30 offset:4096
  v_xor_b32 v30, s26, v28
  ds_read_b64_tr_b16 v[40:41], v30 offset:0
  ds_read_b64_tr_b16 v[42:43], v30 offset:4096
  v_xor_b32 v30, s27, v28
  ds_read_b64_tr_b16 v[44:45], v30 offset:0
  ds_read_b64_tr_b16 v[46:47], v30 offset:4096
  v_xor_b32 v30, s28, v28
  ds_read_b64_tr_b16 v[48:49], v30 offset:0
  ds_read_b64_tr_b16 v[50:51], v30 offset:4096
  v_xor_b32 v30, s29, v28
  ds_read_b64_tr_b16 v[52:53], v30 offset:0
  ds_read_b64_tr_b16 v[54:55], v30 offset:4096
  v_xor_b32 v30, s30, v28
  ds_read_b64_tr_b16 v[56:57], v30 offset:0
  ds_read_b64_tr_b16 v[58:59], v30 offset:4096
  v_xor_b32 v30, s31, v28
  ds_read_b64_tr_b16 v[60:61], v30 offset:0
  ds_read_b64_tr_b16 v[62:63], v30 offset:4096
  s_waitcnt lgkmcnt(0)
  ds_write_b128 v29, v[32:35] offset:0
  ds_write_b128 v29, v[36:39] offset:1024
  ds_write_b128 v29, v[40:43] offset:2048
  ds_write_b128 v29, v[44:47] offset:3072
  ds_write_b128 v29, v[48:51] offset:4096
  ds_write_b128 v29, v[52:55] offset:5120
  ds_write_b128 v29, v[56:59] offset:6144
  ds_write_b128 v29, v[60:63] offset:7168
  v_add_u32 v28, 0x8000, v28
  v_add_u32 v29, 0x8000, v29
  s_waitcnt lgkmcnt(0)
  s_barrier
  v_xor_b32 v30, s24, v28
  ds_read_b64_tr_b16 v[32:33], v30 offset:0
  ds_read_b64_tr_b16 v[34:35], v30 offset:4096
  v_xor_b32 v30, s25, v28
  ds_read_b64_tr_b16 v[36:37], v30 offset:0
  ds_read_b64_tr_b16 v[38:39], v30 offset:4096
  v_xor_b32 v30, s26, v28
  ds_read_b64_tr_b16 v[40:41], v30 offset:0
  ds_read_b64_tr_b16 v[42:43], v30 offset:4096
  v_xor_b32 v30, s27, v28
  ds_read_b64_tr_b16 v[44:45], v30 offset:0
  ds_read_b64_tr_b16 v[46:47], v30 offset:4096
  v_xor_b32 v30, s28, v28
  ds_read_b64_tr_b16 v[48:49], v30 offset:0
  ds_read_b64_tr_b16 v[50:51], v30 offset:4096
  v_xor_b32 v30, s29, v28
  ds_read_b64_tr_b16 v[52:53], v30 offset:0
  ds_read_b64_tr_b16 v[54:55], v30 offset:4096
  v_xor_b32 v30, s30, v28
  ds_read_b64_tr_b16 v[56:57], v30 offset:0
  ds_read_b64_tr_b16 v[58:59], v30 offset:4096
  v_xor_b32 v30, s31, v28
  ds_read_b64_tr_b16 v[60:61], v30 offset:0
  ds_read_b64_tr_b16 v[62:63], v30 offset:4096
  s_waitcnt lgkmcnt(0)
  ds_write_b128 v29, v[32:35] offset:0
  ds_write_b128 v29, v[36:39] offset:1024
  ds_write_b128 v29, v[40:43] offset:2048
  ds_write_b128 v29, v[44:47] offset:3072
  ds_write_b128 v29, v[48:51] offset:4096
  ds_write_b128 v29, v[52:55] offset:5120
  ds_write_b128 v29, v[56:59] offset:6144
  ds_write_b128 v29, v[60:63] offset:7168
  v_add_u32 v28, 0x8000, v28
  v_add_u32 v29, 0x8000, v29
  s_waitcnt lgkmcnt(0)
  s_barrier
  v_xor_b32 v30, s24, v28
  ds_read_b64_tr_b16 v[32:33], v30 offset:0
  ds_read_b64_tr_b16 v[34:35], v30 offset:4096
  v_xor_b32 v30, s25, v28
  ds_read_b64_tr_b16 v[36:37], v30 offset:0
  ds_read_b64_tr_b16 v[38:39], v30 offset:4096
  v_xor_b32 v30, s26, v28
  ds_read_b64_tr_b16 v[40:41], v30 offset:0
  ds_read_b64_tr_b16 v[42:43], v30 offset:4096
  v_xor_b32 v30, s27, v28
  ds_read_b64_tr_b16 v[44:45], v30 offset:0
  ds_read_b64_tr_b16 v[46:47], v30 offset:4096
  v_xor_b32 v30, s28, v28
  ds_read_b64_tr_b16 v[48:49], v30 offset:0
  ds_read_b64_tr_b16 v[50:51], v30 offset:4096
  v_xor_b32 v30, s29, v28
  ds_read_b64_tr_b16 v[52:53], v30 offset:0
  ds_read_b64_tr_b16 v[54:55], v30 offset:4096
  v_xor_b32 v30, s30, v28
  ds_read_b64_tr_b16 v[56:57], v30 offset:0
  ds_read_b64_tr_b16 v[58:59], v30 offset:4096
  v_xor_b32 v30, s31, v28
  ds_read_b64_tr_b16 v[60:61], v30 offset:0
  ds_read_b64_tr_b16 v[62:63], v30 offset:4096
  s_waitcnt lgkmcnt(0)
  ds_write_b128 v29, v[32:35] offset:0
  ds_write_b128 v29, v[36:39] offset:1024
  ds_write_b128 v29, v[40:43] offset:2048
  ds_write_b128 v29, v[44:47] offset:3072
  ds_write_b128 v29, v[48:51] offset:4096
  ds_write_b128 v29, v[52:55] offset:5120
  ds_write_b128 v29, v[56:59] offset:6144
  ds_write_b128 v29, v[60:63] offset:7168
  v_add_u32 v28, 0x8000, v28
  v_add_u32 v29, 0x8000, v29
  s_waitcnt lgkmcnt(0)
  s_barrier
  v_xor_b32 v30, s24, v28
  ds_read_b64_tr_b16 v[32:33], v30 offset:0
  ds_read_b64_tr_b16 v[34:35], v30 offset:4096
  v_xor_b32 v30, s25, v28
  ds_read_b64_tr_b16 v[36:37], v30 offset:0
  ds_read_b64_tr_b16 v[38:39], v30 offset:4096
  v_xor_b32 v30, s26, v28
  ds_read_b64_tr_b16 v[40:41], v30 offset:0
  ds_read_b64_tr_b16 v[42:43], v30 offset:4096
  v_xor_b32 v30, s27, v28
  ds_read_b64_tr_b16 v[44:45], v30 offset:0
  ds_read_b64_tr_b16 v[46:47], v30 offset:4096
  v_xor_b32 v30, s28, v28
  ds_read_b64_tr_b16 v[48:49], v30 offset:0
  ds_read_b64_tr_b16 v[50:51], v30 offset:4096
  v_xor_b32 v30, s29, v28
  ds_read_b64_tr_b16 v[52:53], v30 offset:0
  ds_read_b64_tr_b16 v[54:55], v30 offset:4096
  v_xor_b32 v30, s30, v28
  ds_read_b64_tr_b16 v[56:57], v30 offset:0
  ds_read_b64_tr_b16 v[58:59], v30 offset:4096
  v_xor_b32 v30, s31, v28
  ds_read_b64_tr_b16 v[60:61], v30 offset:0
  ds_read_b64_tr_b16 v[62:63], v30 offset:4096
  s_waitcnt lgkmcnt(0)
  ds_write_b128 v29, v[32:35] offset:0
  ds_write_b128 v29, v[36:39] offset:1024
  ds_write_b128 v29, v[40:43] offset:2048
  ds_write_b128 v29, v[44:47] offset:3072
  ds_write_b128 v29, v[48:51] offset:4096
  ds_write_b128 v29, v[52:55] offset:5120
  ds_write_b128 v29, v[56:59] offset:6144
  ds_write_b128 v29, v[60:63] offset:7168
  v_add_u32 v28, 0x8000, v28
  v_add_u32 v29, 0x8000, v29
  s_waitcnt lgkmcnt(0)
  s_barrier
  v_and_b32 v24, 15, v0
  v_lshrrev_b32 v25, 4, v0
  v_lshlrev_b32 v1, 4, v0
  s_lshl_b32 s16, s12, 13
  v_add_u32 v2, s16, v1
  v_add_u32 v3, 0x10000, v2
  s_lshl_b32 s16, s12, 11
  v_add_u32 v10, s16, v1
  v_add_u32 v11, 131072, v10
  v_add_u32 v8, 147456, v10
  v_add_u32 v1, 131072, v1
  v_mul_u32_u24 v4, 288, v25
  v_lshrrev_b32 v26, 2, v24
  v_lshl_add_u32 v4, v26, 4, v4
  v_and_b32 v26, 3, v24
  v_lshl_add_u32 v4, v26, 1, v4
  s_lshl_b32 s16, s12, 6
  s_add_u32 s16, s16, 155648
  v_add_u32 v4, s16, v4
  v_and_b32 v26, 7, v24
  v_mul_u32_u24 v5, 288, v26
  v_lshl_add_u32 v5, v25, 4, v5
  v_add_u32 v5, 155648, v5
  v_lshrrev_b32 v26, 2, v24
  v_and_b32 v27, 1, v24
  v_lshl_add_u32 v26, v27, 2, v26
  v_mul_u32_u24 v6, 288, v26
  v_lshl_add_u32 v6, v25, 4, v6
  v_add_u32 v6, 157952, v6
  s_lshl_b32 s83, s12, 6
  v_lshrrev_b32 v26, 1, v25
  s_and_b32 s16, s12, 1
  s_lshl_b32 s16, s16, 1
  v_add_u32 v26, s16, v26
  v_lshlrev_b32 v26, 4, v26
  v_and_b32 v27, 3, v24
  v_lshl_add_u32 v26, v27, 2, v26
  v_lshrrev_b32 v27, 2, v24
  v_add_u32 v26, v26, v27
  v_lshlrev_b32 v7, 4, v26
  v_and_b32 v27, 1, v25
  v_lshl_add_u32 v7, v27, 3, v7
  s_lshr_b32 s16, s12, 1
  s_lshl_b32 s16, s16, 10
  s_add_u32 s16, s16, 160256
  v_add_u32 v7, s16, v7
  v_bfe_u32 v26, v24, 1, 1
  v_mul_u32_u24 v26, 0xAAAA, v26
  v_add_u32 v9, 0x4444, v26
  v_lshrrev_b32 v26, 3, v24
  v_lshlrev_b32 v15, 4, v26
  s_lshl_b32 s16, s12, 3
  v_add_u32 v26, s16, v25
  v_lshlrev_b32 v12, 13, v26
  v_lshl_add_u32 v12, v24, 4, v12
  s_lshr_b32 s16, s13, 1
  s_lshl_b32 s16, s16, 8
  v_add_u32 v12, s16, v12
  s_add_u32 s16, s13, 0
  s_and_b32 s16, s16, 1
  s_lshl_b32 s16, s16, 15
  s_add_u32 s76, s16, 0
  s_add_u32 s16, s13, 1
  s_and_b32 s16, s16, 1
  s_lshl_b32 s16, s16, 15
  s_add_u32 s77, s16, 4096
  v_lshrrev_b32 v26, 2, v24
  v_lshl_add_u32 v26, v25, 2, v26
  v_lshlrev_b32 v13, 8, v26
  v_and_b32 v26, 3, v24
  v_lshl_add_u32 v13, v26, 4, v13
  s_lshl_b32 s16, s13, 13
  s_lshl_b32 s17, s12, 6
  s_add_u32 s16, s16, s17
  v_add_u32 v13, s16, v13
  s_lshr_b32 s16, s13, 2
  s_lshl_b32 s16, s16, 6
  s_lshl_b32 s17, s12, 2
  s_add_u32 s16, s16, s17
  v_lshrrev_b32 v26, 1, v24
  v_lshl_add_u32 v26, v26, 4, v25
  v_add_u32 v26, s16, v26
  s_and_b32 s16, s13, 3
  s_lshl_b32 s16, s16, 2
  v_and_b32 v27, 1, v24
  v_add_u32 v27, s16, v27
  v_bfe_u32 v20, v26, 1, 1
  v_lshl_add_u32 v27, v20, 1, v27
  v_bfe_u32 v20, v26, 4, 2
  v_lshl_add_u32 v27, v20, 4, v27
  v_lshlrev_b32 v14, 4, v27
  v_bfe_u32 v20, v26, 2, 2
  v_lshl_add_u32 v14, v20, 2, v14
  v_lshrrev_b32 v20, 6, v26
  v_and_b32 v20, 7, v20
  v_lshl_add_u32 v14, v20, 10, v14
  v_mov_b32 v32, 0
  v_cmp_eq_u32 vcc, 0, v24
  v_mov_b32 v20, 0x3f80
  s_nop 0
  v_cndmask_b32 v32, v32, v20, vcc
  v_cmp_eq_u32 vcc, 1, v24
  v_mov_b32 v20, 0x3f800000
  s_nop 0
  v_cndmask_b32 v32, v32, v20, vcc
  v_mov_b32 v33, 0
  v_cmp_eq_u32 vcc, 2, v24
  v_mov_b32 v20, 0x3f80
  s_nop 0
  v_cndmask_b32 v33, v33, v20, vcc
  v_cmp_eq_u32 vcc, 3, v24
  v_mov_b32 v20, 0x3f800000
  s_nop 0
  v_cndmask_b32 v33, v33, v20, vcc
  v_mov_b32 v34, 0
  v_cmp_eq_u32 vcc, 4, v24
  v_mov_b32 v20, 0x3f80
  s_nop 0
  v_cndmask_b32 v34, v34, v20, vcc
  v_cmp_eq_u32 vcc, 5, v24
  v_mov_b32 v20, 0x3f800000
  s_nop 0
  v_cndmask_b32 v34, v34, v20, vcc
  v_mov_b32 v35, 0
  v_cmp_eq_u32 vcc, 6, v24
  v_mov_b32 v20, 0x3f80
  s_nop 0
  v_cndmask_b32 v35, v35, v20, vcc
  v_cmp_eq_u32 vcc, 7, v24
  v_mov_b32 v20, 0x3f800000
  s_nop 0
  v_cndmask_b32 v35, v35, v20, vcc
  ds_write_b128 v1, v[32:35] offset:31232
  s_mov_b32 s28, 0xFF00FF00
  s_mov_b32 s29, 0xFF00FF00
  s_mov_b32 s30, 0x00FF00FF
  s_mov_b32 s31, 0x00FF00FF
  s_mov_b32 s32, 0x000000FF
  s_mov_b32 s33, 0x000000FF
  s_mov_b32 s96, 0x33333333
  s_mov_b32 s97, 0x33333333
  s_mov_b32 s40, 0x3e0293ee
  s_load_dwordx2 s[8:9], s[0:1], 32
  s_waitcnt lgkmcnt(0)
  s_mov_b32 s10, 8192
  s_mov_b32 s11, 0x20000
  v_lshrrev_b32 v26, 2, v24
  v_and_b32 v27, 1, v24
  v_lshl_add_u32 v26, v27, 2, v26
  v_lshlrev_b32 v26, 10, v26
  v_lshl_add_u32 v26, v25, 5, v26
  v_bfe_u32 v27, v24, 1, 1
  v_lshl_add_u32 v26, v27, 2, v26
  s_lshl_b32 s16, s12, 8
  v_add_u32 v26, s16, v26
  buffer_load_dword v32, v26, s[8:11], 0 offen offset:0
  buffer_load_dword v33, v26, s[8:11], 0 offen offset:8
  buffer_load_dword v34, v26, s[8:11], 0 offen offset:16
  buffer_load_dword v35, v26, s[8:11], 0 offen offset:24
  buffer_load_dword v36, v26, s[8:11], 0 offen offset:128
  buffer_load_dword v37, v26, s[8:11], 0 offen offset:136
  buffer_load_dword v38, v26, s[8:11], 0 offen offset:144
  buffer_load_dword v39, v26, s[8:11], 0 offen offset:152
  s_waitcnt vmcnt(0)
  ds_write_b128 v11, v[32:35]
  ds_write_b128 v11, v[36:39] offset:1024
  s_mul_i32 s34, s14, 16777216
  s_lshl_b32 s16, s13, 13
  s_add_u32 s34, s34, s16
  s_add_u32 s35, s34, 100663296
  s_add_u32 s34, s34, 67108864
  s_mul_i32 s36, s14, 8650752
  s_lshl_b32 s16, s13, 12
  s_add_u32 s36, s36, s16
  s_add_u32 s36, s36, 135135232
  s_lshl_b32 s16, s12, 10
  s_add_u32 s36, s36, s16
  s_mul_i32 s38, s14, 33280
  s_add_u32 s38, s38, 4194304
  s_lshl_b32 s16, s13, 4
  s_add_u32 s38, s38, s16
  s_mul_i32 s80, s14, 524288
  s_add_u32 s80, s80, 1048576
  s_mul_i32 s81, s14, 32768
  s_add_u32 s81, s81, 0
  s_mov_b32 s16, 0
  s_mov_b32 s99, s14
  s_load_dwordx2 s[8:9], s[0:1], 88
  s_waitcnt lgkmcnt(0)
  s_mov_b32 s10, 256
  s_mov_b32 s11, 0x20000
  v_and_b32 v21, 7, v0
  v_lshlrev_b32 v21, 4, v21
census_R:
  buffer_load_dword v20, v21, s[8:11], 0 offen sc1
  s_waitcnt vmcnt(0)
  s_mov_b32 s16, 0
  v_readlane_b32 s17, v20, 0
  s_nop 0
  s_add_u32 s16, s16, s17
  v_readlane_b32 s17, v20, 1
  s_nop 0
  s_add_u32 s16, s16, s17
  v_readlane_b32 s17, v20, 2
  s_nop 0
  s_add_u32 s16, s16, s17
  v_readlane_b32 s17, v20, 3
  s_nop 0
  s_add_u32 s16, s16, s17
  v_readlane_b32 s17, v20, 4
  s_nop 0
  s_add_u32 s16, s16, s17
  v_readlane_b32 s17, v20, 5
  s_nop 0
  s_add_u32 s16, s16, s17
  v_readlane_b32 s17, v20, 6
  s_nop 0
  s_add_u32 s16, s16, s17
  v_readlane_b32 s17, v20, 7
  s_nop 0
  s_add_u32 s16, s16, s17
  s_cmp_ge_u32 s16, 256
  s_cbranch_scc1 census_R_ok
  s_sub_u32 s15, s15, 1
  s_cbranch_scc1 census_R_ok
  s_branch census_R
census_R_ok:
  v_readlane_b32 s17, v20, s99
  s_nop 0
  s_cmp_ge_u32 s17, 32
  s_cselect_b32 s100, 1, 0
  s_mov_b32 s16, 0
  s_cmp_eq_u32 s100, 0
  s_cbranch_scc1 R_nonlocal
  v_bfe_u32 v21, v1, 4, 2
  v_lshlrev_b32 v21, 2, v21
R_tf_Rlfirst:
  buffer_load_dword v20, v21, s[4:7], s38 offen sc1
  s_waitcnt vmcnt(0)
  v_cmp_eq_u32 vcc, 0, v20
  s_cbranch_vccz R_tf_Rlfirst_ok
  s_sub_u32 s15, s15, 1
  s_cbranch_scc1 R_tf_Rlfirst_ok
  s_branch R_tf_Rlfirst
R_tf_Rlfirst_ok:
  s_lshl_b32 s44, s12, 11
  s_add_u32 m0, s44, 139264
  s_nop 0
  buffer_load_dwordx4 v10, s[4:7], s34 offen sc1 lds
  buffer_load_dwordx4 v10, s[4:7], s34 offen offset:1024 sc1 lds
  s_lshl_b32 s44, s12, 11
  s_add_u32 m0, s44, 147456
  s_nop 0
  buffer_load_dwordx4 v10, s[4:7], s35 offen sc1 lds
  buffer_load_dwordx4 v10, s[4:7], s35 offen offset:1024 sc1 lds
  s_add_u32 s34, s34, 262144
  s_add_u32 s35, s35, 262144
  s_add_u32 s38, s38, 512
  v_bfe_u32 v23, v1, 4, 2
  v_lshlrev_b32 v23, 2, v23
  buffer_load_dword v22, v23, s[4:7], s38 offen sc1
  v_mov_b64 v[56:57], 0
  v_mov_b64 v[58:59], 0
  v_mov_b64 v[60:61], 0
  v_mov_b64 v[62:63], 0
  v_mov_b64 v[64:65], 0
  v_mov_b64 v[66:67], 0
  v_mov_b64 v[68:69], 0
  v_mov_b64 v[70:71], 0
  v_mov_b64 v[72:73], 0
  v_mov_b64 v[74:75], 0
  v_mov_b64 v[76:77], 0
  v_mov_b64 v[78:79], 0
  s_and_b32 s44, s16, 1
  s_mul_i32 s44, s44, 262144
  s_add_u32 s44, s44, s80
  s_add_u32 s24, s44, s76
  s_add_u32 s20, s44, 0
  s_add_u32 s25, s44, s77
  s_add_u32 s21, s44, 4096
  s_bfe_u32 s18, s16, 0x10001
  s_waitcnt vmcnt(0) lgkmcnt(0)
  s_barrier
Rl_step:
  ds_read_b128 v[24:27], v1 offset:0
  ds_read_b128 v[28:31], v1 offset:1024
  ds_read_b128 v[32:35], v1 offset:2048
  ds_read_b128 v[36:39], v1 offset:3072
  ds_read_b128 v[40:43], v1 offset:4096
  ds_read_b128 v[44:47], v1 offset:5120
  ds_read_b128 v[48:51], v1 offset:6144
  ds_read_b128 v[52:55], v1 offset:7168
  s_waitcnt lgkmcnt(7)
  v_smfmac_f32_16x16x64_bf16 v[56:59], v[24:27], a[0:7], v9
  v_smfmac_f32_16x16x64_bf16 v[64:67], v[24:27], a[128:135], v9
  ds_read_b128 v[96:99], v1 offset:8192
  v_smfmac_f32_16x16x64_bf16 v[60:63], v[24:27], a[64:71], v9
  v_smfmac_f32_16x16x64_bf16 v[68:71], v[24:27], a[192:199], v9
  s_waitcnt lgkmcnt(7)
  v_smfmac_f32_16x16x64_bf16 v[56:59], v[28:31], a[8:15], v9
  v_smfmac_f32_16x16x64_bf16 v[64:67], v[28:31], a[136:143], v9
  ds_read_b128 v[100:103], v1 offset:9216
  v_smfmac_f32_16x16x64_bf16 v[60:63], v[28:31], a[72:79], v9
  v_smfmac_f32_16x16x64_bf16 v[68:71], v[28:31], a[200:207], v9
  s_waitcnt lgkmcnt(7)
  v_smfmac_f32_16x16x64_bf16 v[56:59], v[32:35], a[16:23], v9
  v_smfmac_f32_16x16x64_bf16 v[64:67], v[32:35], a[144:151], v9
  ds_read_b128 v[104:107], v1 offset:10240
  v_smfmac_f32_16x16x64_bf16 v[60:63], v[32:35], a[80:87], v9
  v_smfmac_f32_16x16x64_bf16 v[68:71], v[32:35], a[208:215], v9
  s_waitcnt lgkmcnt(7)
  v_smfmac_f32_16x16x64_bf16 v[56:59], v[36:39], a[24:31], v9
  v_smfmac_f32_16x16x64_bf16 v[64:67], v[36:39], a[152:159], v9
  ds_read_b128 v[108:111], v1 offset:11264
  v_smfmac_f32_16x16x64_bf16 v[60:63], v[36:39], a[88:95], v9
  v_smfmac_f32_16x16x64_bf16 v[68:71], v[36:39], a[216:223], v9
  s_waitcnt lgkmcnt(7)
  v_smfmac_f32_16x16x64_bf16 v[56:59], v[40:43], a[32:39], v9
  v_smfmac_f32_16x16x64_bf16 v[64:67], v[40:43], a[160:167], v9
  ds_read_b128 v[112:115], v1 offset:12288
  v_smfmac_f32_16x16x64_bf16 v[60:63], v[40:43], a[96:103], v9
  v_smfmac_f32_16x16x64_bf16 v[68:71], v[40:43], a[224:231], v9
  s_waitcnt lgkmcnt(7)
  v_smfmac_f32_16x16x64_bf16 v[56:59], v[44:47], a[40:47], v9
  v_smfmac_f32_16x16x64_bf16 v[64:67], v[44:47], a[168:175], v9
  ds_read_b128 v[116:119], v1 offset:13312
  v_smfmac_f32_16x16x64_bf16 v[60:63], v[44:47], a[104:111], v9
  v_smfmac_f32_16x16x64_bf16 v[68:71], v[44:47], a[232:239], v9
  s_waitcnt lgkmcnt(7)
  v_smfmac_f32_16x16x64_bf16 v[56:59], v[48:51], a[48:55], v9
  v_smfmac_f32_16x16x64_bf16 v[64:67], v[48:51], a[176:183], v9
  ds_read_b128 v[120:123], v1 offset:14336
  v_smfmac_f32_16x16x64_bf16 v[60:63], v[48:51], a[112:119], v9
  v_smfmac_f32_16x16x64_bf16 v[68:71], v[48:51], a[240:247], v9
  s_waitcnt lgkmcnt(7)
  v_smfmac_f32_16x16x64_bf16 v[56:59], v[52:55], a[56:63], v9
  v_smfmac_f32_16x16x64_bf16 v[64:67], v[52:55], a[184:191], v9
  ds_read_b128 v[124:127], v1 offset:15360
  v_smfmac_f32_16x16x64_bf16 v[60:63], v[52:55], a[120:127], v9
  v_smfmac_f32_16x16x64_bf16 v[68:71], v[52:55], a[248:255], v9
  v_pk_add_f32 v[56:57], v[56:57], v[58:59]
  v_cvt_pk_bf16_f32 v56, v56, v57
  ds_write_b16 v4, v56 offset:0
  ds_write_b16_d16_hi v4, v56 offset:1152
  v_pk_add_f32 v[64:65], v[64:65], v[66:67]
  v_cvt_pk_bf16_f32 v64, v64, v65
  ds_write_b16 v4, v64 offset:2304
  ds_write_b16_d16_hi v4, v64 offset:3456
  v_pk_add_f32 v[60:61], v[60:61], v[62:63]
  v_cvt_pk_bf16_f32 v60, v60, v61
  ds_write_b16 v4, v60 offset:8
  ds_write_b16_d16_hi v4, v60 offset:1160
  v_pk_add_f32 v[68:69], v[68:69], v[70:71]
  v_cvt_pk_bf16_f32 v68, v68, v69
  ds_write_b16 v4, v68 offset:2312
  ds_write_b16_d16_hi v4, v68 offset:3464
  v_smfmac_f32_16x16x64_bf16 v[72:75], v[24:27], v[128:135], v9
  v_smfmac_f32_16x16x64_bf16 v[76:79], v[24:27], v[192:199], v9
  v_smfmac_f32_16x16x64_bf16 v[72:75], v[28:31], v[136:143], v9
  v_smfmac_f32_16x16x64_bf16 v[76:79], v[28:31], v[200:207], v9
  s_waitcnt lgkmcnt(0)
  s_barrier
  ds_read_b128 v[80:83], v5 offset:0
  ds_read_b128 v[84:87], v5 offset:64
  ds_read_b128 v[88:91], v5 offset:128
  ds_read_b128 v[92:95], v5 offset:192
  ds_read_b128 v[24:27], v6 offset:0
  ds_read_b128 v[28:31], v6 offset:64
  v_add_u32 v21, s83, v6
  ds_read_b128 v[68:71], v21
  v_smfmac_f32_16x16x64_bf16 v[72:75], v[32:35], v[144:151], v9
  v_smfmac_f32_16x16x64_bf16 v[76:79], v[32:35], v[208:215], v9
  v_smfmac_f32_16x16x64_bf16 v[72:75], v[36:39], v[152:159], v9
  v_smfmac_f32_16x16x64_bf16 v[76:79], v[36:39], v[216:223], v9
  ds_read_b128 v[32:35], v6 offset:128
  ds_read_b128 v[36:39], v6 offset:192
  s_waitcnt lgkmcnt(8)
  v_mfma_f32_16x16x32_bf16 v[56:59], v[96:99], v[80:83], 0
  v_mfma_f32_16x16x32_bf16 v[60:63], v[112:115], v[80:83], 0
  s_waitcnt lgkmcnt(7)
  v_mfma_f32_16x16x32_bf16 v[56:59], v[100:103], v[84:87], v[56:59]
  v_mfma_f32_16x16x32_bf16 v[60:63], v[116:119], v[84:87], v[60:63]
  s_waitcnt lgkmcnt(6)
  v_mfma_f32_16x16x32_bf16 v[56:59], v[104:107], v[88:91], v[56:59]
  v_mfma_f32_16x16x32_bf16 v[60:63], v[120:123], v[88:91], v[60:63]
  s_waitcnt lgkmcnt(5)
  v_mfma_f32_16x16x32_bf16 v[56:59], v[108:111], v[92:95], v[56:59]
  v_mfma_f32_16x16x32_bf16 v[60:63], v[124:127], v[92:95], v[60:63]
  s_waitcnt lgkmcnt(4)
  v_mfma_f32_16x16x32_bf16 v[64:67], v[24:27], v[80:83], 0
  s_waitcnt lgkmcnt(3)
  v_mfma_f32_16x16x32_bf16 v[64:67], v[28:31], v[84:87], v[64:67]
  s_waitcnt lgkmcnt(1)
  v_mfma_f32_16x16x32_bf16 v[64:67], v[32:35], v[88:91], v[64:67]
  s_waitcnt lgkmcnt(0)
  v_mfma_f32_16x16x32_bf16 v[64:67], v[36:39], v[92:95], v[64:67]
  s_waitcnt vmcnt(4)
  s_cmp_eq_u32 s16, 63
  s_cbranch_scc1 Rl_tf_skip
  v_cmp_eq_u32 vcc, 0, v22
  s_cbranch_vccnz Rl_tf_slow
Rl_tf_ok:
  s_lshl_b32 s44, s12, 11
  s_add_u32 m0, s44, 139264
  s_nop 0
  buffer_load_dwordx4 v10, s[4:7], s34 offen sc1 lds
  buffer_load_dwordx4 v10, s[4:7], s34 offen offset:1024 sc1 lds
Rl_tf_skip:
  v_smfmac_f32_16x16x64_bf16 v[72:75], v[40:43], v[160:167], v9
  v_smfmac_f32_16x16x64_bf16 v[76:79], v[40:43], v[224:231], v9
  v_cndmask_b32 v56, v56, v60, s[28:29]
  v_cndmask_b32 v57, v57, v61, s[28:29]
  v_cndmask_b32 v58, v58, v62, s[28:29]
  v_cndmask_b32 v59, v59, v63, s[28:29]
  v_cndmask_b32 v64, v64, v65, s[28:29]
  v_max3_f32 v20, v56, v57, v58
  v_max3_f32 v20, v20, v59, v64
  v_smfmac_f32_16x16x64_bf16 v[72:75], v[44:47], v[168:175], v9
  s_nop 0
  v_max_f32_dpp v20, v20, v20 row_ror:8 row_mask:0xf bank_mask:0xf
  v_mov_b32 v21, v20
  v_smfmac_f32_16x16x64_bf16 v[76:79], v[44:47], v[232:239], v9
  s_nop 0
  v_permlane16_swap_b32 v20, v21
  v_max_f32 v20, v20, v21
  v_mov_b32 v21, v20
  v_smfmac_f32_16x16x64_bf16 v[72:75], v[48:51], v[176:183], v9
  s_nop 0
  v_permlane32_swap_b32 v20, v21
  v_max_f32 v20, v20, v21
  v_mul_f32 v20, s40, v20
  v_smfmac_f32_16x16x64_bf16 v[76:79], v[48:51], v[240:247], v9
  s_waitcnt vmcnt(4)
  ds_read_b64 v[96:97], v8 offset:0
  ds_read_b64 v[100:101], v8 offset:8
  ds_read_b64 v[104:105], v8 offset:1024
  ds_read_b64 v[108:109], v8 offset:1032
  v_fma_f32 v56, v56, s40, -v20
  v_fma_f32 v57, v57, s40, -v20
  v_smfmac_f32_16x16x64_bf16 v[72:75], v[52:55], v[184:191], v9
  v_fma_f32 v58, v58, s40, -v20
  v_fma_f32 v59, v59, s40, -v20
  v_smfmac_f32_16x16x64_bf16 v[76:79], v[52:55], v[248:255], v9
  v_fma_f32 v64, v64, s40, -v20
  v_exp_f32 v56, v56
  ds_read_b128 v[112:115], v2 offset:0
  v_exp_f32 v57, v57
  ds_read_b128 v[120:123], v3 offset:0
  v_exp_f32 v58, v58
  ds_read_b128 v[80:83], v2 offset:1024
  v_exp_f32 v59, v59
  ds_read_b128 v[88:91], v3 offset:1024
  v_exp_f32 v64, v64
  ds_read_b128 v[116:119], v2 offset:32768
  ds_read_b128 v[124:127], v3 offset:32768
  ds_read_b128 v[84:87], v2 offset:33792
  ds_read_b128 v[92:95], v3 offset:33792
  v_pk_add_f32 v[72:73], v[72:73], v[74:75]
  v_pk_add_f32 v[76:77], v[76:77], v[78:79]
  v_cvt_pk_bf16_f32 v62, v64, 0
  v_cvt_pk_bf16_f32 v60, v56, v57
  v_cvt_pk_bf16_f32 v61, v58, v59
  v_mov_b32 v63, 0
  v_lshlrev_b32 v62, v15, v62
  s_waitcnt lgkmcnt(8)
  v_cvt_pk_bf16_f32 v98, v72, v73
  v_cvt_pk_bf16_f32 v102, v72, v73
  v_cvt_pk_bf16_f32 v106, v76, v77
  v_cvt_pk_bf16_f32 v110, v76, v77
  s_nop 0
  v_mfma_f32_16x16x32_bf16 v[24:27], v[96:99], v[60:63], 0
  v_mfma_f32_16x16x32_bf16 v[28:31], v[100:103], v[60:63], 0
  v_mfma_f32_16x16x32_bf16 v[32:35], v[104:107], v[60:63], 0
  v_mfma_f32_16x16x32_bf16 v[36:39], v[108:111], v[60:63], 0
  s_mov_b64 vcc, s[96:97]
  v_cndmask_b32_dpp v16, v98, v68, vcc row_shr:2 row_mask:0xf bank_mask:0xf bound_ctrl:0
  v_cndmask_b32_dpp v17, v106, v69, vcc row_shr:2 row_mask:0xf bank_mask:0xf bound_ctrl:0
  v_cndmask_b32 v18, v98, v70, vcc
  v_cndmask_b32 v19, v106, v71, vcc
  s_cmp_eq_u32 s16, 63
  s_cbranch_scc1 Rl_last
  v_add_f32 v20, v56, v57
  v_add_f32 v21, v58, v59
  v_add_f32 v20, v20, v64
  v_add_f32 v20, v20, v21
  ds_read_b128 v[40:43], v2 offset:3072
  ds_read_b128 v[44:47], v2 offset:35840
  v_add_f32_dpp v20, v20, v20 row_ror:8 row_mask:0xf bank_mask:0xf
  v_mov_b32 v21, v20
  ds_read_b128 v[48:51], v3 offset:3072
  ds_read_b128 v[52:55], v3 offset:35840
  v_permlane16_swap_b32 v20, v21
  v_add_f32 v20, v20, v21
  v_mov_b32 v21, v20
  ds_read_b128 v[96:99], v2 offset:2048
  ds_read_b128 v[100:103], v2 offset:34816
  v_permlane32_swap_b32 v20, v21
  v_add_f32 v20, v20, v21
  v_rcp_f32 v20, v20
  ds_read_b128 v[104:107], v3 offset:2048
  ds_read_b128 v[108:111], v3 offset:34816
  v_add_f32_dpp v24, v28, v24 row_ror:8 row_mask:0xf bank_mask:0xf
  v_add_f32_dpp v25, v29, v25 row_ror:8 row_mask:0xf bank_mask:0xf
  v_add_f32_dpp v26, v30, v26 row_ror:8 row_mask:0xf bank_mask:0xf
  v_add_f32_dpp v27, v31, v27 row_ror:8 row_mask:0xf bank_mask:0xf
  v_add_f32_dpp v32, v36, v32 row_ror:8 row_mask:0xf bank_mask:0xf
  v_add_f32_dpp v33, v37, v33 row_ror:8 row_mask:0xf bank_mask:0xf
  v_add_f32_dpp v34, v38, v34 row_ror:8 row_mask:0xf bank_mask:0xf
  v_add_f32_dpp v35, v39, v35 row_ror:8 row_mask:0xf bank_mask:0xf
  v_mov_b32 v21, v20
  v_pk_mul_f32 v[24:25], v[24:25], v[20:21]
  v_pk_mul_f32 v[26:27], v[26:27], v[20:21]
  v_pk_mul_f32 v[32:33], v[32:33], v[20:21]
  v_pk_mul_f32 v[34:35], v[34:35], v[20:21]
  s_mov_b64 exec, s[30:31]
  v_cvt_pk_bf16_f32 v24, v24, v25
  ds_write_b32 v7, v24 offset:0
  v_cvt_pk_bf16_f32 v26, v26, v27
  ds_write_b32 v7, v26 offset:32
  v_cvt_pk_bf16_f32 v32, v32, v33
  ds_write_b32 v7, v32 offset:4
  v_cvt_pk_bf16_f32 v34, v34, v35
  ds_write_b32 v7, v34 offset:36
  s_mov_b64 exec, -1
  v_mov_b64 v[56:57], 0
  v_mov_b64 v[58:59], 0
  v_mov_b64 v[60:61], 0
  v_mov_b64 v[62:63], 0
  v_mov_b64 v[64:65], 0
  v_mov_b64 v[66:67], 0
  v_mov_b64 v[68:69], 0
  v_mov_b64 v[70:71], 0
  v_mov_b64 v[72:73], 0
  v_mov_b64 v[74:75], 0
  v_mov_b64 v[76:77], 0
  v_mov_b64 v[78:79], 0
  s_waitcnt lgkmcnt(0)
  s_barrier
  ds_read_b128 v[32:35], v1 offset:29184
  ds_read_b128 v[36:39], v1 offset:30208
  v_mov_b64 v[24:25], 0
  v_mov_b64 v[26:27], 0
  v_mov_b64 v[28:29], 0
  v_mov_b64 v[30:31], 0
  s_waitcnt lgkmcnt(0)
  v_smfmac_f32_16x16x64_bf16 v[56:59], v[32:35], v[112:119], v9
  ds_read_b128 v[112:115], v2 offset:4096
  ds_read_b128 v[116:119], v2 offset:36864
  v_smfmac_f32_16x16x64_bf16 v[56:59], v[36:39], v[120:127], v9
  ds_read_b128 v[120:123], v3 offset:4096
  ds_read_b128 v[124:127], v3 offset:36864
  v_smfmac_f32_16x16x64_bf16 v[60:63], v[32:35], v[80:87], v9
  ds_read_b128 v[80:83], v2 offset:5120
  ds_read_b128 v[84:87], v2 offset:37888
  v_smfmac_f32_16x16x64_bf16 v[60:63], v[36:39], v[88:95], v9
  ds_read_b128 v[88:91], v3 offset:5120
  ds_read_b128 v[92:95], v3 offset:37888
  v_smfmac_f32_16x16x64_bf16 v[64:67], v[32:35], v[96:103], v9
  ds_read_b128 v[96:99], v2 offset:6144
  ds_read_b128 v[100:103], v2 offset:38912
  v_smfmac_f32_16x16x64_bf16 v[64:67], v[36:39], v[104:111], v9
  ds_read_b128 v[104:107], v3 offset:6144
  ds_read_b128 v[108:111], v3 offset:38912
  v_smfmac_f32_16x16x64_bf16 v[68:71], v[32:35], v[40:47], v9
  ds_read_b128 v[40:43], v2 offset:7168
  ds_read_b128 v[44:47], v2 offset:39936
  v_smfmac_f32_16x16x64_bf16 v[68:71], v[36:39], v[48:55], v9
  ds_read_b128 v[48:51], v3 offset:7168
  ds_read_b128 v[52:55], v3 offset:39936
  s_waitcnt lgkmcnt(14)
  v_smfmac_f32_16x16x64_bf16 v[72:75], v[32:35], v[112:119], v9
  s_waitcnt lgkmcnt(12)
  v_smfmac_f32_16x16x64_bf16 v[72:75], v[36:39], v[120:127], v9
  v_pk_add_f32 v[56:57], v[56:57], v[58:59]
  v_pk_add_f32 v[60:61], v[60:61], v[62:63]
  v_pk_add_f32 v[64:65], v[64:65], v[66:67]
  v_pk_add_f32 v[68:69], v[68:69], v[70:71]
  v_cvt_pk_bf16_f32 v56, v56, v57
  v_cvt_pk_bf16_f32 v57, v60, v61
  v_cvt_pk_bf16_f32 v58, v64, v65
  v_cvt_pk_bf16_f32 v59, v68, v69
  v_bfi_b32 v56, 1, s18, v56
  buffer_store_dwordx4 v[56:59], v12, s[4:7], s24 offen
  s_waitcnt lgkmcnt(10)
  v_smfmac_f32_16x16x64_bf16 v[76:79], v[32:35], v[80:87], v9
  s_waitcnt lgkmcnt(8)
  v_smfmac_f32_16x16x64_bf16 v[76:79], v[36:39], v[88:95], v9
  s_waitcnt lgkmcnt(6)
  v_smfmac_f32_16x16x64_bf16 v[24:27], v[32:35], v[96:103], v9
  s_waitcnt lgkmcnt(4)
  v_smfmac_f32_16x16x64_bf16 v[24:27], v[36:39], v[104:111], v9
  s_waitcnt lgkmcnt(2)
  v_smfmac_f32_16x16x64_bf16 v[28:31], v[32:35], v[40:47], v9
  s_waitcnt lgkmcnt(0)
  v_smfmac_f32_16x16x64_bf16 v[28:31], v[36:39], v[48:55], v9
  v_pk_add_f32 v[72:73], v[72:73], v[74:75]
  v_pk_add_f32 v[76:77], v[76:77], v[78:79]
  v_pk_add_f32 v[24:25], v[24:25], v[26:27]
  v_cvt_pk_bf16_f32 v72, v72, v73
  v_cvt_pk_bf16_f32 v73, v76, v77
  v_cvt_pk_bf16_f32 v74, v24, v25
  v_bfi_b32 v72, 1, s18, v72
  ds_read_b128 v[80:83], v1 offset:31232
  v_pk_add_f32 v[28:29], v[28:29], v[30:31]
  v_cvt_pk_bf16_f32 v75, v28, v29
  buffer_store_dwordx4 v[72:75], v12, s[4:7], s25 offen
  s_add_u32 s44, s16, 1
  s_and_b32 s44, s44, 3
  s_lshl_b32 s44, s44, 13
  s_add_u32 s41, s44, s81
  s_add_u32 s44, s16, 3
  s_and_b32 s44, s44, 3
  s_lshl_b32 s44, s44, 13
  s_add_u32 s42, s44, s81
  v_mov_b64 v[56:57], 0
  v_mov_b64 v[58:59], 0
  v_mov_b64 v[60:61], 0
  v_mov_b64 v[62:63], 0
  v_mov_b64 v[64:65], 0
  v_mov_b64 v[66:67], 0
  v_mov_b64 v[68:69], 0
  v_mov_b64 v[70:71], 0
  v_mov_b64 v[72:73], 0
  v_mov_b64 v[74:75], 0
  v_mov_b64 v[76:77], 0
  v_mov_b64 v[78:79], 0
  s_waitcnt vmcnt(0)
  buffer_load_dwordx4 v[40:43], v13, s[4:7], s20 offen nt
  buffer_load_dwordx4 v[44:47], v13, s[4:7], s21 offen nt
  s_waitcnt lgkmcnt(0)
  s_waitcnt vmcnt(0)
  v_bitop3_b32 v20, v40, v44, s18 bitop3:0x7E
  v_and_b32 v20, 1, v20
  v_cmp_ne_u32 vcc, 0, v20
  s_cbranch_vccz Rl_in_ok0
Rl_in_retry:
  s_mov_b64 exec, vcc
  buffer_load_dwordx4 v[40:43], v13, s[4:7], s20 offen nt
  buffer_load_dwordx4 v[44:47], v13, s[4:7], s21 offen nt
  s_sub_u32 s15, s15, 1
  s_cbranch_scc1 Rl_in_ok0
  s_waitcnt vmcnt(0)
  v_bitop3_b32 v20, v40, v44, s18 bitop3:0x7E
  v_and_b32 v20, 1, v20
  v_cmp_ne_u32 vcc, 0, v20
  s_cbranch_vccnz Rl_in_retry
Rl_in_ok0:
  s_mov_b64 exec, -1
  s_nop 0
  v_mfma_f32_16x16x32_bf16 v[84:87], v[40:43], v[80:83], 0
  v_mfma_f32_16x16x32_bf16 v[84:87], v[44:47], v[80:83], v[84:87]
  s_nop 7
  v_permlane32_swap_b32 v84, v86
  v_permlane32_swap_b32 v85, v87
  v_add_f32 v84, v84, v86
  v_add_f32 v85, v85, v87
  s_nop 1
  v_permlane16_swap_b32 v84, v85
  v_add_f32 v84, v84, v85
  v_mov_b32 v85, v84
  s_nop 1
  v_permlane16_swap_b32 v84, v85
  v_cvt_pk_bf16_f32 v84, v84, v85
  s_mov_b64 exec, s[32:33]
  buffer_store_dword v84, v14, s[4:7], s41 offen
  s_mov_b64 exec, -1
  s_add_u32 s16, s16, 1
  s_add_u32 s38, s38, 512
  s_add_u32 s34, s34, 262144
  s_and_b32 s44, s16, 1
  s_mul_i32 s44, s44, 262144
  s_add_u32 s44, s44, s80
  s_add_u32 s24, s44, s76
  s_add_u32 s20, s44, 0
  s_add_u32 s25, s44, s77
  s_add_u32 s21, s44, 4096
  s_bfe_u32 s18, s16, 0x10001
  s_waitcnt vmcnt(0)
  buffer_load_dwordx4 v[80:83], v10, s[4:7], s41 offen nt
  buffer_load_dwordx4 v[84:87], v10, s[4:7], s41 offen offset:1024 nt
  s_waitcnt vmcnt(0)
  v_max3_u32 v20, v80, v81, v82
  v_max3_u32 v21, v83, v84, v85
  v_max3_u32 v20, v86, v87, v20
  v_max_u32 v20, v20, v21
  v_cmp_eq_u32 vcc, -1, v20
  s_cbranch_vccz Rl_mp_ok0
Rl_mp_retry:
  s_mov_b64 exec, vcc
  buffer_load_dwordx4 v[80:83], v10, s[4:7], s41 offen nt
  buffer_load_dwordx4 v[84:87], v10, s[4:7], s41 offen offset:1024 nt
  s_sub_u32 s15, s15, 1
  s_cbranch_scc1 Rl_mp_ok0
  s_waitcnt vmcnt(0)
  v_max3_u32 v20, v80, v81, v82
  v_max3_u32 v21, v83, v84, v85
  v_max3_u32 v20, v86, v87, v20
  v_max_u32 v20, v20, v21
  v_cmp_eq_u32 vcc, -1, v20
  s_cbranch_vccnz Rl_mp_retry
Rl_mp_ok0:
  s_mov_b64 exec, -1
  ds_write_b128 v11, v[80:83]
  ds_write_b128 v11, v[84:87] offset:1024
  v_bfe_u32 v23, v1, 4, 2
  v_lshlrev_b32 v23, 2, v23
  buffer_load_dword v22, v23, s[4:7], s38 offen sc1
  s_lshl_b32 s44, s12, 11
  s_add_u32 m0, s44, 147456
  s_nop 0
  buffer_load_dwordx4 v10, s[4:7], s35 offen sc1 lds
  buffer_load_dwordx4 v10, s[4:7], s35 offen offset:1024 sc1 lds
  s_add_u32 s35, s35, 262144
  v_mov_b32 v21, -1
  s_mov_b64 exec, s[32:33]
  buffer_store_dword v21, v14, s[4:7], s42 offen
  s_mov_b64 exec, -1
  buffer_store_dwordx4 v[16:19], v1, s[4:7], s36 offen sc1
  s_add_u32 s36, s36, 131072
  s_waitcnt lgkmcnt(0)
  s_barrier
  s_branch Rl_step
Rl_tf_slow:
  v_bfe_u32 v21, v1, 4, 2
  v_lshlrev_b32 v21, 2, v21
R_tf_Rlslow:
  buffer_load_dword v20, v21, s[4:7], s38 offen sc1
  s_waitcnt vmcnt(0)
  v_cmp_eq_u32 vcc, 0, v20
  s_cbranch_vccz R_tf_Rlslow_ok
  s_sub_u32 s15, s15, 1
  s_cbranch_scc1 R_tf_Rlslow_ok
  s_branch R_tf_Rlslow
R_tf_Rlslow_ok:
  s_branch Rl_tf_ok
Rl_last:
  s_waitcnt vmcnt(0)
  buffer_store_dwordx4 v[16:19], v1, s[4:7], s36 offen sc1
  s_waitcnt vmcnt(0)
  s_add_u32 s36, s36, 131072
  v_mov_b32 v20, 0
  s_mov_b64 exec, 1
  buffer_store_dword v20, v1, s[4:7], s36 offen sc1
  s_mov_b64 exec, -1
  s_waitcnt vmcnt(0)
  s_endpgm
R_nonlocal:
  v_bfe_u32 v21, v1, 4, 2
  v_lshlrev_b32 v21, 2, v21
R_tf_Rnfirst:
  buffer_load_dword v20, v21, s[4:7], s38 offen sc1
  s_waitcnt vmcnt(0)
  v_cmp_eq_u32 vcc, 0, v20
  s_cbranch_vccz R_tf_Rnfirst_ok
  s_sub_u32 s15, s15, 1
  s_cbranch_scc1 R_tf_Rnfirst_ok
  s_branch R_tf_Rnfirst
R_tf_Rnfirst_ok:
  s_lshl_b32 s44, s12, 11
  s_add_u32 m0, s44, 139264
  s_nop 0
  buffer_load_dwordx4 v10, s[4:7], s34 offen sc1 lds
  buffer_load_dwordx4 v10, s[4:7], s34 offen offset:1024 sc1 lds
  s_lshl_b32 s44, s12, 11
  s_add_u32 m0, s44, 147456
  s_nop 0
  buffer_load_dwordx4 v10, s[4:7], s35 offen sc1 lds
  buffer_load_dwordx4 v10, s[4:7], s35 offen offset:1024 sc1 lds
  s_add_u32 s34, s34, 262144
  s_add_u32 s35, s35, 262144
  s_add_u32 s38, s38, 512
  v_bfe_u32 v23, v1, 4, 2
  v_lshlrev_b32 v23, 2, v23
  buffer_load_dword v22, v23, s[4:7], s38 offen sc1
  v_mov_b64 v[56:57], 0
  v_mov_b64 v[58:59], 0
  v_mov_b64 v[60:61], 0
  v_mov_b64 v[62:63], 0
  v_mov_b64 v[64:65], 0
  v_mov_b64 v[66:67], 0
  v_mov_b64 v[68:69], 0
  v_mov_b64 v[70:71], 0
  v_mov_b64 v[72:73], 0
  v_mov_b64 v[74:75], 0
  v_mov_b64 v[76:77], 0
  v_mov_b64 v[78:79], 0
  s_and_b32 s44, s16, 1
  s_mul_i32 s44, s44, 262144
  s_add_u32 s44, s44, s80
  s_add_u32 s24, s44, s76
  s_add_u32 s20, s44, 0
  s_add_u32 s25, s44, s77
  s_add_u32 s21, s44, 4096
  s_bfe_u32 s18, s16, 0x10001
  s_waitcnt vmcnt(0) lgkmcnt(0)
  s_barrier
Rn_step:
  ds_read_b128 v[24:27], v1 offset:0
  ds_read_b128 v[28:31], v1 offset:1024
  ds_read_b128 v[32:35], v1 offset:2048
  ds_read_b128 v[36:39], v1 offset:3072
  ds_read_b128 v[40:43], v1 offset:4096
  ds_read_b128 v[44:47], v1 offset:5120
  ds_read_b128 v[48:51], v1 offset:6144
  ds_read_b128 v[52:55], v1 offset:7168
  s_waitcnt lgkmcnt(7)
  v_smfmac_f32_16x16x64_bf16 v[56:59], v[24:27], a[0:7], v9
  v_smfmac_f32_16x16x64_bf16 v[64:67], v[24:27], a[128:135], v9
  ds_read_b128 v[96:99], v1 offset:8192
  v_smfmac_f32_16x16x64_bf16 v[60:63], v[24:27], a[64:71], v9
  v_smfmac_f32_16x16x64_bf16 v[68:71], v[24:27], a[192:199], v9
  s_waitcnt lgkmcnt(7)
  v_smfmac_f32_16x16x64_bf16 v[56:59], v[28:31], a[8:15], v9
  v_smfmac_f32_16x16x64_bf16 v[64:67], v[28:31], a[136:143], v9
  ds_read_b128 v[100:103], v1 offset:9216
  v_smfmac_f32_16x16x64_bf16 v[60:63], v[28:31], a[72:79], v9
  v_smfmac_f32_16x16x64_bf16 v[68:71], v[28:31], a[200:207], v9
  s_waitcnt lgkmcnt(7)
  v_smfmac_f32_16x16x64_bf16 v[56:59], v[32:35], a[16:23], v9
  v_smfmac_f32_16x16x64_bf16 v[64:67], v[32:35], a[144:151], v9
  ds_read_b128 v[104:107], v1 offset:10240
  v_smfmac_f32_16x16x64_bf16 v[60:63], v[32:35], a[80:87], v9
  v_smfmac_f32_16x16x64_bf16 v[68:71], v[32:35], a[208:215], v9
  s_waitcnt lgkmcnt(7)
  v_smfmac_f32_16x16x64_bf16 v[56:59], v[36:39], a[24:31], v9
  v_smfmac_f32_16x16x64_bf16 v[64:67], v[36:39], a[152:159], v9
  ds_read_b128 v[108:111], v1 offset:11264
  v_smfmac_f32_16x16x64_bf16 v[60:63], v[36:39], a[88:95], v9
  v_smfmac_f32_16x16x64_bf16 v[68:71], v[36:39], a[216:223], v9
  s_waitcnt lgkmcnt(7)
  v_smfmac_f32_16x16x64_bf16 v[56:59], v[40:43], a[32:39], v9
  v_smfmac_f32_16x16x64_bf16 v[64:67], v[40:43], a[160:167], v9
  ds_read_b128 v[112:115], v1 offset:12288
  v_smfmac_f32_16x16x64_bf16 v[60:63], v[40:43], a[96:103], v9
  v_smfmac_f32_16x16x64_bf16 v[68:71], v[40:43], a[224:231], v9
  s_waitcnt lgkmcnt(7)
  v_smfmac_f32_16x16x64_bf16 v[56:59], v[44:47], a[40:47], v9
  v_smfmac_f32_16x16x64_bf16 v[64:67], v[44:47], a[168:175], v9
  ds_read_b128 v[116:119], v1 offset:13312
  v_smfmac_f32_16x16x64_bf16 v[60:63], v[44:47], a[104:111], v9
  v_smfmac_f32_16x16x64_bf16 v[68:71], v[44:47], a[232:239], v9
  s_waitcnt lgkmcnt(7)
  v_smfmac_f32_16x16x64_bf16 v[56:59], v[48:51], a[48:55], v9
  v_smfmac_f32_16x16x64_bf16 v[64:67], v[48:51], a[176:183], v9
  ds_read_b128 v[120:123], v1 offset:14336
  v_smfmac_f32_16x16x64_bf16 v[60:63], v[48:51], a[112:119], v9
  v_smfmac_f32_16x16x64_bf16 v[68:71], v[48:51], a[240:247], v9
  s_waitcnt lgkmcnt(7)
  v_smfmac_f32_16x16x64_bf16 v[56:59], v[52:55], a[56:63], v9
  v_smfmac_f32_16x16x64_bf16 v[64:67], v[52:55], a[184:191], v9
  ds_read_b128 v[124:127], v1 offset:15360
  v_smfmac_f32_16x16x64_bf16 v[60:63], v[52:55], a[120:127], v9
  v_smfmac_f32_16x16x64_bf16 v[68:71], v[52:55], a[248:255], v9
  v_pk_add_f32 v[56:57], v[56:57], v[58:59]
  v_cvt_pk_bf16_f32 v56, v56, v57
  ds_write_b16 v4, v56 offset:0
  ds_write_b16_d16_hi v4, v56 offset:1152
  v_pk_add_f32 v[64:65], v[64:65], v[66:67]
  v_cvt_pk_bf16_f32 v64, v64, v65
  ds_write_b16 v4, v64 offset:2304
  ds_write_b16_d16_hi v4, v64 offset:3456
  v_pk_add_f32 v[60:61], v[60:61], v[62:63]
  v_cvt_pk_bf16_f32 v60, v60, v61
  ds_write_b16 v4, v60 offset:8
  ds_write_b16_d16_hi v4, v60 offset:1160
  v_pk_add_f32 v[68:69], v[68:69], v[70:71]
  v_cvt_pk_bf16_f32 v68, v68, v69
  ds_write_b16 v4, v68 offset:2312
  ds_write_b16_d16_hi v4, v68 offset:3464
  v_smfmac_f32_16x16x64_bf16 v[72:75], v[24:27], v[128:135], v9
  v_smfmac_f32_16x16x64_bf16 v[76:79], v[24:27], v[192:199], v9
  v_smfmac_f32_16x16x64_bf16 v[72:75], v[28:31], v[136:143], v9
  v_smfmac_f32_16x16x64_bf16 v[76:79], v[28:31], v[200:207], v9
  s_waitcnt lgkmcnt(0)
  s_barrier
  ds_read_b128 v[80:83], v5 offset:0
  ds_read_b128 v[84:87], v5 offset:64
  ds_read_b128 v[88:91], v5 offset:128
  ds_read_b128 v[92:95], v5 offset:192
  ds_read_b128 v[24:27], v6 offset:0
  ds_read_b128 v[28:31], v6 offset:64
  v_add_u32 v21, s83, v6
  ds_read_b128 v[68:71], v21
  v_smfmac_f32_16x16x64_bf16 v[72:75], v[32:35], v[144:151], v9
  v_smfmac_f32_16x16x64_bf16 v[76:79], v[32:35], v[208:215], v9
  v_smfmac_f32_16x16x64_bf16 v[72:75], v[36:39], v[152:159], v9
  v_smfmac_f32_16x16x64_bf16 v[76:79], v[36:39], v[216:223], v9
  ds_read_b128 v[32:35], v6 offset:128
  ds_read_b128 v[36:39], v6 offset:192
  s_waitcnt lgkmcnt(8)
  v_mfma_f32_16x16x32_bf16 v[56:59], v[96:99], v[80:83], 0
  v_mfma_f32_16x16x32_bf16 v[60:63], v[112:115], v[80:83], 0
  s_waitcnt lgkmcnt(7)
  v_mfma_f32_16x16x32_bf16 v[56:59], v[100:103], v[84:87], v[56:59]
  v_mfma_f32_16x16x32_bf16 v[60:63], v[116:119], v[84:87], v[60:63]
  s_waitcnt lgkmcnt(6)
  v_mfma_f32_16x16x32_bf16 v[56:59], v[104:107], v[88:91], v[56:59]
  v_mfma_f32_16x16x32_bf16 v[60:63], v[120:123], v[88:91], v[60:63]
  s_waitcnt lgkmcnt(5)
  v_mfma_f32_16x16x32_bf16 v[56:59], v[108:111], v[92:95], v[56:59]
  v_mfma_f32_16x16x32_bf16 v[60:63], v[124:127], v[92:95], v[60:63]
  s_waitcnt lgkmcnt(4)
  v_mfma_f32_16x16x32_bf16 v[64:67], v[24:27], v[80:83], 0
  s_waitcnt lgkmcnt(3)
  v_mfma_f32_16x16x32_bf16 v[64:67], v[28:31], v[84:87], v[64:67]
  s_waitcnt lgkmcnt(1)
  v_mfma_f32_16x16x32_bf16 v[64:67], v[32:35], v[88:91], v[64:67]
  s_waitcnt lgkmcnt(0)
  v_mfma_f32_16x16x32_bf16 v[64:67], v[36:39], v[92:95], v[64:67]
  s_waitcnt vmcnt(4)
  s_cmp_eq_u32 s16, 63
  s_cbranch_scc1 Rn_tf_skip
  v_cmp_eq_u32 vcc, 0, v22
  s_cbranch_vccnz Rn_tf_slow
Rn_tf_ok:
  s_lshl_b32 s44, s12, 11
  s_add_u32 m0, s44, 139264
  s_nop 0
  buffer_load_dwordx4 v10, s[4:7], s34 offen sc1 lds
  buffer_load_dwordx4 v10, s[4:7], s34 offen offset:1024 sc1 lds
Rn_tf_skip:
  v_smfmac_f32_16x16x64_bf16 v[72:75], v[40:43], v[160:167], v9
  v_smfmac_f32_16x16x64_bf16 v[76:79], v[40:43], v[224:231], v9
  v_cndmask_b32 v56, v56, v60, s[28:29]
  v_cndmask_b32 v57, v57, v61, s[28:29]
  v_cndmask_b32 v58, v58, v62, s[28:29]
  v_cndmask_b32 v59, v59, v63, s[28:29]
  v_cndmask_b32 v64, v64, v65, s[28:29]
  v_max3_f32 v20, v56, v57, v58
  v_max3_f32 v20, v20, v59, v64
  v_smfmac_f32_16x16x64_bf16 v[72:75], v[44:47], v[168:175], v9
  s_nop 0
  v_max_f32_dpp v20, v20, v20 row_ror:8 row_mask:0xf bank_mask:0xf
  v_mov_b32 v21, v20
  v_smfmac_f32_16x16x64_bf16 v[76:79], v[44:47], v[232:239], v9
  s_nop 0
  v_permlane16_swap_b32 v20, v21
  v_max_f32 v20, v20, v21
  v_mov_b32 v21, v20
  v_smfmac_f32_16x16x64_bf16 v[72:75], v[48:51], v[176:183], v9
  s_nop 0
  v_permlane32_swap_b32 v20, v21
  v_max_f32 v20, v20, v21
  v_mul_f32 v20, s40, v20
  v_smfmac_f32_16x16x64_bf16 v[76:79], v[48:51], v[240:247], v9
  s_waitcnt vmcnt(4)
  ds_read_b64 v[96:97], v8 offset:0
  ds_read_b64 v[100:101], v8 offset:8
  ds_read_b64 v[104:105], v8 offset:1024
  ds_read_b64 v[108:109], v8 offset:1032
  v_fma_f32 v56, v56, s40, -v20
  v_fma_f32 v57, v57, s40, -v20
  v_smfmac_f32_16x16x64_bf16 v[72:75], v[52:55], v[184:191], v9
  v_fma_f32 v58, v58, s40, -v20
  v_fma_f32 v59, v59, s40, -v20
  v_smfmac_f32_16x16x64_bf16 v[76:79], v[52:55], v[248:255], v9
  v_fma_f32 v64, v64, s40, -v20
  v_exp_f32 v56, v56
  ds_read_b128 v[112:115], v2 offset:0
  v_exp_f32 v57, v57
  ds_read_b128 v[120:123], v3 offset:0
  v_exp_f32 v58, v58
  ds_read_b128 v[80:83], v2 offset:1024
  v_exp_f32 v59, v59
  ds_read_b128 v[88:91], v3 offset:1024
  v_exp_f32 v64, v64
  ds_read_b128 v[116:119], v2 offset:32768
  ds_read_b128 v[124:127], v3 offset:32768
  ds_read_b128 v[84:87], v2 offset:33792
  ds_read_b128 v[92:95], v3 offset:33792
  v_pk_add_f32 v[72:73], v[72:73], v[74:75]
  v_pk_add_f32 v[76:77], v[76:77], v[78:79]
  v_cvt_pk_bf16_f32 v62, v64, 0
  v_cvt_pk_bf16_f32 v60, v56, v57
  v_cvt_pk_bf16_f32 v61, v58, v59
  v_mov_b32 v63, 0
  v_lshlrev_b32 v62, v15, v62
  s_waitcnt lgkmcnt(8)
  v_cvt_pk_bf16_f32 v98, v72, v73
  v_cvt_pk_bf16_f32 v102, v72, v73
  v_cvt_pk_bf16_f32 v106, v76, v77
  v_cvt_pk_bf16_f32 v110, v76, v77
  s_nop 0
  v_mfma_f32_16x16x32_bf16 v[24:27], v[96:99], v[60:63], 0
  v_mfma_f32_16x16x32_bf16 v[28:31], v[100:103], v[60:63], 0
  v_mfma_f32_16x16x32_bf16 v[32:35], v[104:107], v[60:63], 0
  v_mfma_f32_16x16x32_bf16 v[36:39], v[108:111], v[60:63], 0
  s_mov_b64 vcc, s[96:97]
  v_cndmask_b32_dpp v16, v98, v68, vcc row_shr:2 row_mask:0xf bank_mask:0xf bound_ctrl:0
  v_cndmask_b32_dpp v17, v106, v69, vcc row_shr:2 row_mask:0xf bank_mask:0xf bound_ctrl:0
  v_cndmask_b32 v18, v98, v70, vcc
  v_cndmask_b32 v19, v106, v71, vcc
  s_cmp_eq_u32 s16, 63
  s_cbranch_scc1 Rn_last
  v_add_f32 v20, v56, v57
  v_add_f32 v21, v58, v59
  v_add_f32 v20, v20, v64
  v_add_f32 v20, v20, v21
  ds_read_b128 v[40:43], v2 offset:3072
  ds_read_b128 v[44:47], v2 offset:35840
  v_add_f32_dpp v20, v20, v20 row_ror:8 row_mask:0xf bank_mask:0xf
  v_mov_b32 v21, v20
  ds_read_b128 v[48:51], v3 offset:3072
  ds_read_b128 v[52:55], v3 offset:35840
  v_permlane16_swap_b32 v20, v21
  v_add_f32 v20, v20, v21
  v_mov_b32 v21, v20
  ds_read_b128 v[96:99], v2 offset:2048
  ds_read_b128 v[100:103], v2 offset:34816
  v_permlane32_swap_b32 v20, v21
  v_add_f32 v20, v20, v21
  v_rcp_f32 v20, v20
  ds_read_b128 v[104:107], v3 offset:2048
  ds_read_b128 v[108:111], v3 offset:34816
  v_add_f32_dpp v24, v28, v24 row_ror:8 row_mask:0xf bank_mask:0xf
  v_add_f32_dpp v25, v29, v25 row_ror:8 row_mask:0xf bank_mask:0xf
  v_add_f32_dpp v26, v30, v26 row_ror:8 row_mask:0xf bank_mask:0xf
  v_add_f32_dpp v27, v31, v27 row_ror:8 row_mask:0xf bank_mask:0xf
  v_add_f32_dpp v32, v36, v32 row_ror:8 row_mask:0xf bank_mask:0xf
  v_add_f32_dpp v33, v37, v33 row_ror:8 row_mask:0xf bank_mask:0xf
  v_add_f32_dpp v34, v38, v34 row_ror:8 row_mask:0xf bank_mask:0xf
  v_add_f32_dpp v35, v39, v35 row_ror:8 row_mask:0xf bank_mask:0xf
  v_mov_b32 v21, v20
  v_pk_mul_f32 v[24:25], v[24:25], v[20:21]
  v_pk_mul_f32 v[26:27], v[26:27], v[20:21]
  v_pk_mul_f32 v[32:33], v[32:33], v[20:21]
  v_pk_mul_f32 v[34:35], v[34:35], v[20:21]
  s_mov_b64 exec, s[30:31]
  v_cvt_pk_bf16_f32 v24, v24, v25
  ds_write_b32 v7, v24 offset:0
  v_cvt_pk_bf16_f32 v26, v26, v27
  ds_write_b32 v7, v26 offset:32
  v_cvt_pk_bf16_f32 v32, v32, v33
  ds_write_b32 v7, v32 offset:4
  v_cvt_pk_bf16_f32 v34, v34, v35
  ds_write_b32 v7, v34 offset:36
  s_mov_b64 exec, -1
  v_mov_b64 v[56:57], 0
  v_mov_b64 v[58:59], 0
  v_mov_b64 v[60:61], 0
  v_mov_b64 v[62:63], 0
  v_mov_b64 v[64:65], 0
  v_mov_b64 v[66:67], 0
  v_mov_b64 v[68:69], 0
  v_mov_b64 v[70:71], 0
  v_mov_b64 v[72:73], 0
  v_mov_b64 v[74:75], 0
  v_mov_b64 v[76:77], 0
  v_mov_b64 v[78:79], 0
  s_waitcnt lgkmcnt(0)
  s_barrier
  ds_read_b128 v[32:35], v1 offset:29184
  ds_read_b128 v[36:39], v1 offset:30208
  v_mov_b64 v[24:25], 0
  v_mov_b64 v[26:27], 0
  v_mov_b64 v[28:29], 0
  v_mov_b64 v[30:31], 0
  s_waitcnt lgkmcnt(0)
  v_smfmac_f32_16x16x64_bf16 v[56:59], v[32:35], v[112:119], v9
  ds_read_b128 v[112:115], v2 offset:4096
  ds_read_b128 v[116:119], v2 offset:36864
  v_smfmac_f32_16x16x64_bf16 v[56:59], v[36:39], v[120:127], v9
  ds_read_b128 v[120:123], v3 offset:4096
  ds_read_b128 v[124:127], v3 offset:36864
  v_smfmac_f32_16x16x64_bf16 v[60:63], v[32:35], v[80:87], v9
  ds_read_b128 v[80:83], v2 offset:5120
  ds_read_b128 v[84:87], v2 offset:37888
  v_smfmac_f32_16x16x64_bf16 v[60:63], v[36:39], v[88:95], v9
  ds_read_b128 v[88:91], v3 offset:5120
  ds_read_b128 v[92:95], v3 offset:37888
  v_smfmac_f32_16x16x64_bf16 v[64:67], v[32:35], v[96:103], v9
  ds_read_b128 v[96:99], v2 offset:6144
  ds_read_b128 v[100:103], v2 offset:38912
  v_smfmac_f32_16x16x64_bf16 v[64:67], v[36:39], v[104:111], v9
  ds_read_b128 v[104:107], v3 offset:6144
  ds_read_b128 v[108:111], v3 offset:38912
  v_smfmac_f32_16x16x64_bf16 v[68:71], v[32:35], v[40:47], v9
  ds_read_b128 v[40:43], v2 offset:7168
  ds_read_b128 v[44:47], v2 offset:39936
  v_smfmac_f32_16x16x64_bf16 v[68:71], v[36:39], v[48:55], v9
  ds_read_b128 v[48:51], v3 offset:7168
  ds_read_b128 v[52:55], v3 offset:39936
  s_waitcnt lgkmcnt(14)
  v_smfmac_f32_16x16x64_bf16 v[72:75], v[32:35], v[112:119], v9
  s_waitcnt lgkmcnt(12)
  v_smfmac_f32_16x16x64_bf16 v[72:75], v[36:39], v[120:127], v9
  v_pk_add_f32 v[56:57], v[56:57], v[58:59]
  v_pk_add_f32 v[60:61], v[60:61], v[62:63]
  v_pk_add_f32 v[64:65], v[64:65], v[66:67]
  v_pk_add_f32 v[68:69], v[68:69], v[70:71]
  v_cvt_pk_bf16_f32 v56, v56, v57
  v_cvt_pk_bf16_f32 v57, v60, v61
  v_cvt_pk_bf16_f32 v58, v64, v65
  v_cvt_pk_bf16_f32 v59, v68, v69
  v_bfi_b32 v56, 1, s18, v56
  buffer_store_dwordx4 v[56:59], v12, s[4:7], s24 offen sc1
  s_waitcnt lgkmcnt(10)
  v_smfmac_f32_16x16x64_bf16 v[76:79], v[32:35], v[80:87], v9
  s_waitcnt lgkmcnt(8)
  v_smfmac_f32_16x16x64_bf16 v[76:79], v[36:39], v[88:95], v9
  s_waitcnt lgkmcnt(6)
  v_smfmac_f32_16x16x64_bf16 v[24:27], v[32:35], v[96:103], v9
  s_waitcnt lgkmcnt(4)
  v_smfmac_f32_16x16x64_bf16 v[24:27], v[36:39], v[104:111], v9
  s_waitcnt lgkmcnt(2)
  v_smfmac_f32_16x16x64_bf16 v[28:31], v[32:35], v[40:47], v9
  s_waitcnt lgkmcnt(0)
  v_smfmac_f32_16x16x64_bf16 v[28:31], v[36:39], v[48:55], v9
  v_pk_add_f32 v[72:73], v[72:73], v[74:75]
  v_pk_add_f32 v[76:77], v[76:77], v[78:79]
  v_pk_add_f32 v[24:25], v[24:25], v[26:27]
  v_cvt_pk_bf16_f32 v72, v72, v73
  v_cvt_pk_bf16_f32 v73, v76, v77
  v_cvt_pk_bf16_f32 v74, v24, v25
  v_bfi_b32 v72, 1, s18, v72
  ds_read_b128 v[80:83], v1 offset:31232
  v_pk_add_f32 v[28:29], v[28:29], v[30:31]
  v_cvt_pk_bf16_f32 v75, v28, v29
  buffer_store_dwordx4 v[72:75], v12, s[4:7], s25 offen sc1
  s_add_u32 s44, s16, 1
  s_and_b32 s44, s44, 3
  s_lshl_b32 s44, s44, 13
  s_add_u32 s41, s44, s81
  s_add_u32 s44, s16, 3
  s_and_b32 s44, s44, 3
  s_lshl_b32 s44, s44, 13
  s_add_u32 s42, s44, s81
  v_mov_b64 v[56:57], 0
  v_mov_b64 v[58:59], 0
  v_mov_b64 v[60:61], 0
  v_mov_b64 v[62:63], 0
  v_mov_b64 v[64:65], 0
  v_mov_b64 v[66:67], 0
  v_mov_b64 v[68:69], 0
  v_mov_b64 v[70:71], 0
  v_mov_b64 v[72:73], 0
  v_mov_b64 v[74:75], 0
  v_mov_b64 v[76:77], 0
  v_mov_b64 v[78:79], 0
  s_waitcnt vmcnt(0)
  buffer_load_dwordx4 v[40:43], v13, s[4:7], s20 offen sc1
  buffer_load_dwordx4 v[44:47], v13, s[4:7], s21 offen sc1
  s_waitcnt lgkmcnt(0)
  s_waitcnt vmcnt(0)
  v_bitop3_b32 v20, v40, v44, s18 bitop3:0x7E
  v_and_b32 v20, 1, v20
  v_cmp_ne_u32 vcc, 0, v20
  s_cbranch_vccz Rn_in_ok0
Rn_in_retry:
  s_mov_b64 exec, vcc
  buffer_load_dwordx4 v[40:43], v13, s[4:7], s20 offen sc1
  buffer_load_dwordx4 v[44:47], v13, s[4:7], s21 offen sc1
  s_sub_u32 s15, s15, 1
  s_cbranch_scc1 Rn_in_ok0
  s_waitcnt vmcnt(0)
  v_bitop3_b32 v20, v40, v44, s18 bitop3:0x7E
  v_and_b32 v20, 1, v20
  v_cmp_ne_u32 vcc, 0, v20
  s_cbranch_vccnz Rn_in_retry
Rn_in_ok0:
  s_mov_b64 exec, -1
  s_nop 0
  v_mfma_f32_16x16x32_bf16 v[84:87], v[40:43], v[80:83], 0
  v_mfma_f32_16x16x32_bf16 v[84:87], v[44:47], v[80:83], v[84:87]
  s_nop 7
  v_permlane32_swap_b32 v84, v86
  v_permlane32_swap_b32 v85, v87
  v_add_f32 v84, v84, v86
  v_add_f32 v85, v85, v87
  s_nop 1
  v_permlane16_swap_b32 v84, v85
  v_add_f32 v84, v84, v85
  v_mov_b32 v85, v84
  s_nop 1
  v_permlane16_swap_b32 v84, v85
  v_cvt_pk_bf16_f32 v84, v84, v85
  s_mov_b64 exec, s[32:33]
  buffer_store_dword v84, v14, s[4:7], s41 offen sc1
  s_mov_b64 exec, -1
  s_add_u32 s16, s16, 1
  s_add_u32 s38, s38, 512
  s_add_u32 s34, s34, 262144
  s_and_b32 s44, s16, 1
  s_mul_i32 s44, s44, 262144
  s_add_u32 s44, s44, s80
  s_add_u32 s24, s44, s76
  s_add_u32 s20, s44, 0
  s_add_u32 s25, s44, s77
  s_add_u32 s21, s44, 4096
  s_bfe_u32 s18, s16, 0x10001
  s_waitcnt vmcnt(0)
  buffer_load_dwordx4 v[80:83], v10, s[4:7], s41 offen sc1
  buffer_load_dwordx4 v[84:87], v10, s[4:7], s41 offen offset:1024 sc1
  s_waitcnt vmcnt(0)
  v_max3_u32 v20, v80, v81, v82
  v_max3_u32 v21, v83, v84, v85
  v_max3_u32 v20, v86, v87, v20
  v_max_u32 v20, v20, v21
  v_cmp_eq_u32 vcc, -1, v20
  s_cbranch_vccz Rn_mp_ok0
Rn_mp_retry:
  s_mov_b64 exec, vcc
  buffer_load_dwordx4 v[80:83], v10, s[4:7], s41 offen sc1
  buffer_load_dwordx4 v[84:87], v10, s[4:7], s41 offen offset:1024 sc1
  s_sub_u32 s15, s15, 1
  s_cbranch_scc1 Rn_mp_ok0
  s_waitcnt vmcnt(0)
  v_max3_u32 v20, v80, v81, v82
  v_max3_u32 v21, v83, v84, v85
  v_max3_u32 v20, v86, v87, v20
  v_max_u32 v20, v20, v21
  v_cmp_eq_u32 vcc, -1, v20
  s_cbranch_vccnz Rn_mp_retry
Rn_mp_ok0:
  s_mov_b64 exec, -1
  ds_write_b128 v11, v[80:83]
  ds_write_b128 v11, v[84:87] offset:1024
  v_bfe_u32 v23, v1, 4, 2
  v_lshlrev_b32 v23, 2, v23
  buffer_load_dword v22, v23, s[4:7], s38 offen sc1
  s_lshl_b32 s44, s12, 11
  s_add_u32 m0, s44, 147456
  s_nop 0
  buffer_load_dwordx4 v10, s[4:7], s35 offen sc1 lds
  buffer_load_dwordx4 v10, s[4:7], s35 offen offset:1024 sc1 lds
  s_add_u32 s35, s35, 262144
  v_mov_b32 v21, -1
  s_mov_b64 exec, s[32:33]
  buffer_store_dword v21, v14, s[4:7], s42 offen sc1
  s_mov_b64 exec, -1
  buffer_store_dwordx4 v[16:19], v1, s[4:7], s36 offen sc1
  s_add_u32 s36, s36, 131072
  s_waitcnt lgkmcnt(0)
  s_barrier
  s_branch Rn_step
Rn_tf_slow:
  v_bfe_u32 v21, v1, 4, 2
  v_lshlrev_b32 v21, 2, v21
R_tf_Rnslow:
  buffer_load_dword v20, v21, s[4:7], s38 offen sc1
  s_waitcnt vmcnt(0)
  v_cmp_eq_u32 vcc, 0, v20
  s_cbranch_vccz R_tf_Rnslow_ok
  s_sub_u32 s15, s15, 1
  s_cbranch_scc1 R_tf_Rnslow_ok
  s_branch R_tf_Rnslow
R_tf_Rnslow_ok:
  s_branch Rn_tf_ok
Rn_last:
  s_waitcnt vmcnt(0)
  buffer_store_dwordx4 v[16:19], v1, s[4:7], s36 offen sc1
  s_waitcnt vmcnt(0)
  s_add_u32 s36, s36, 131072
  v_mov_b32 v20, 0
  s_mov_b64 exec, 1
  buffer_store_dword v20, v1, s[4:7], s36 offen sc1
  s_mov_b64 exec, -1
  s_waitcnt vmcnt(0)
  s_endpgm
T_entry:
  v_lshrrev_b32 v28, 4, v0
  v_and_b32 v29, 15, v0
  v_lshrrev_b32 v29, 1, v29
  v_xor_b32 v24, v29, v28
  v_xor_b32 v25, 4, v24
  v_lshlrev_b32 v24, 5, v24
  v_lshlrev_b32 v25, 5, v25
  v_lshlrev_b32 v28, 13, v28
  v_and_b32 v29, 1, v0
  v_lshlrev_b32 v29, 4, v29
  v_add3_u32 v24, v24, v28, v29
  v_add3_u32 v25, v25, v28, v29
  v_lshrrev_b32 v28, 4, v0
  v_bfe_u32 v29, v0, 2, 2
  v_lshlrev_b32 v26, 3, v28
  v_add_u32 v26, v26, v29
  v_lshlrev_b32 v26, 8, v26
  v_and_b32 v28, 1, v28
  v_lshl_add_u32 v29, v28, 2, v29
  v_bfe_u32 v28, v0, 1, 1
  s_lshl_b32 s16, s12, 1
  v_add_u32 v28, s16, v28
  v_xor_b32 v28, v28, v29
  v_lshl_add_u32 v26, v28, 5, v26
  v_and_b32 v28, 1, v0
  v_lshl_add_u32 v26, v28, 4, v26
  v_add_u32 v27, 0x10000, v26
  s_load_dwordx2 s[8:9], s[0:1], 40
  s_waitcnt lgkmcnt(0)
  s_mov_b32 s10, 4194304
  s_mov_b32 s11, 0x20000
  s_lshl_b32 s16, s12, 20
  s_lshl_b32 s17, s13, 8
  s_add_u32 s16, s16, s17
  s_lshl_b32 s17, s12, 15
  s_mov_b32 m0, s17
  s_add_u32 s17, s17, 1024
  buffer_load_dwordx4 v24, s[8:11], s16 offen lds
  s_add_u32 s16, s16, 32768
  s_mov_b32 m0, s17
  s_add_u32 s17, s17, 1024
  buffer_load_dwordx4 v24, s[8:11], s16 offen lds
  s_add_u32 s16, s16, 32768
  s_mov_b32 m0, s17
  s_add_u32 s17, s17, 1024
  buffer_load_dwordx4 v25, s[8:11], s16 offen lds
  s_add_u32 s16, s16, 32768
  s_mov_b32 m0, s17
  s_add_u32 s17, s17, 1024
  buffer_load_dwordx4 v25, s[8:11], s16 offen lds
  s_add_u32 s16, s16, 32768
  s_mov_b32 m0, s17
  s_add_u32 s17, s17, 1024
  buffer_load_dwordx4 v24, s[8:11], s16 offen lds
  s_add_u32 s16, s16, 32768
  s_mov_b32 m0, s17
  s_add_u32 s17, s17, 1024
  buffer_load_dwordx4 v24, s[8:11], s16 offen lds
  s_add_u32 s16, s16, 32768
  s_mov_b32 m0, s17
  s_add_u32 s17, s17, 1024
  buffer_load_dwordx4 v25, s[8:11], s16 offen lds
  s_add_u32 s16, s16, 32768
  s_mov_b32 m0, s17
  s_add_u32 s17, s17, 1024
  buffer_load_dwordx4 v25, s[8:11], s16 offen lds
  s_add_u32 s16, s16, 32768
  s_mov_b32 m0, s17
  s_add_u32 s17, s17, 1024
  buffer_load_dwordx4 v24, s[8:11], s16 offen lds
  s_add_u32 s16, s16, 32768
  s_mov_b32 m0, s17
  s_add_u32 s17, s17, 1024
  buffer_load_dwordx4 v24, s[8:11], s16 offen lds
  s_add_u32 s16, s16, 32768
  s_mov_b32 m0, s17
  s_add_u32 s17, s17, 1024
  buffer_load_dwordx4 v25, s[8:11], s16 offen lds
  s_add_u32 s16, s16, 32768
  s_mov_b32 m0, s17
  s_add_u32 s17, s17, 1024
  buffer_load_dwordx4 v25, s[8:11], s16 offen lds
  s_add_u32 s16, s16, 32768
  s_mov_b32 m0, s17
  s_add_u32 s17, s17, 1024
  buffer_load_dwordx4 v24, s[8:11], s16 offen lds
  s_add_u32 s16, s16, 32768
  s_mov_b32 m0, s17
  s_add_u32 s17, s17, 1024
  buffer_load_dwordx4 v24, s[8:11], s16 offen lds
  s_add_u32 s16, s16, 32768
  s_mov_b32 m0, s17
  s_add_u32 s17, s17, 1024
  buffer_load_dwordx4 v25, s[8:11], s16 offen lds
  s_add_u32 s16, s16, 32768
  s_mov_b32 m0, s17
  s_add_u32 s17, s17, 1024
  buffer_load_dwordx4 v25, s[8:11], s16 offen lds
  s_add_u32 s16, s16, 32768
  s_mov_b32 m0, s17
  s_add_u32 s17, s17, 1024
  buffer_load_dwordx4 v24, s[8:11], s16 offen lds
  s_add_u32 s16, s16, 32768
  s_mov_b32 m0, s17
  s_add_u32 s17, s17, 1024
  buffer_load_dwordx4 v24, s[8:11], s16 offen lds
  s_add_u32 s16, s16, 32768
  s_mov_b32 m0, s17
  s_add_u32 s17, s17, 1024
  buffer_load_dwordx4 v25, s[8:11], s16 offen lds
  s_add_u32 s16, s16, 32768
  s_mov_b32 m0, s17
  s_add_u32 s17, s17, 1024
  buffer_load_dwordx4 v25, s[8:11], s16 offen lds
  s_add_u32 s16, s16, 32768
  s_mov_b32 m0, s17
  s_add_u32 s17, s17, 1024
  buffer_load_dwordx4 v24, s[8:11], s16 offen lds
  s_add_u32 s16, s16, 32768
  s_mov_b32 m0, s17
  s_add_u32 s17, s17, 1024
  buffer_load_dwordx4 v24, s[8:11], s16 offen lds
  s_add_u32 s16, s16, 32768
  s_mov_b32 m0, s17
  s_add_u32 s17, s17, 1024
  buffer_load_dwordx4 v25, s[8:11], s16 offen lds
  s_add_u32 s16, s16, 32768
  s_mov_b32 m0, s17
  s_add_u32 s17, s17, 1024
  buffer_load_dwordx4 v25, s[8:11], s16 offen lds
  s_add_u32 s16, s16, 32768
  s_mov_b32 m0, s17
  s_add_u32 s17, s17, 1024
  buffer_load_dwordx4 v24, s[8:11], s16 offen lds
  s_add_u32 s16, s16, 32768
  s_mov_b32 m0, s17
  s_add_u32 s17, s17, 1024
  buffer_load_dwordx4 v24, s[8:11], s16 offen lds
  s_add_u32 s16, s16, 32768
  s_mov_b32 m0, s17
  s_add_u32 s17, s17, 1024
  buffer_load_dwordx4 v25, s[8:11], s16 offen lds
  s_add_u32 s16, s16, 32768
  s_mov_b32 m0, s17
  s_add_u32 s17, s17, 1024
  buffer_load_dwordx4 v25, s[8:11], s16 offen lds
  s_add_u32 s16, s16, 32768
  s_mov_b32 m0, s17
  s_add_u32 s17, s17, 1024
  buffer_load_dwordx4 v24, s[8:11], s16 offen lds
  s_add_u32 s16, s16, 32768
  s_mov_b32 m0, s17
  s_add_u32 s17, s17, 1024
  buffer_load_dwordx4 v24, s[8:11], s16 offen lds
  s_add_u32 s16, s16, 32768
  s_mov_b32 m0, s17
  s_add_u32 s17, s17, 1024
  buffer_load_dwordx4 v25, s[8:11], s16 offen lds
  s_add_u32 s16, s16, 32768
  s_mov_b32 m0, s17
  s_add_u32 s17, s17, 1024
  buffer_load_dwordx4 v25, s[8:11], s16 offen lds
  s_add_u32 s16, s16, 32768
  s_waitcnt vmcnt(0)
  s_barrier
  ds_read_b64_tr_b16 a[0:1], v26 offset:0
  ds_read_b64_tr_b16 a[2:3], v26 offset:1024
  ds_read_b64_tr_b16 a[4:5], v26 offset:8192
  ds_read_b64_tr_b16 a[6:7], v26 offset:9216
  ds_read_b64_tr_b16 a[8:9], v26 offset:16384
  ds_read_b64_tr_b16 a[10:11], v26 offset:17408
  ds_read_b64_tr_b16 a[12:13], v26 offset:24576
  ds_read_b64_tr_b16 a[14:15], v26 offset:25600
  ds_read_b64_tr_b16 a[16:17], v26 offset:32768
  ds_read_b64_tr_b16 a[18:19], v26 offset:33792
  ds_read_b64_tr_b16 a[20:21], v26 offset:40960
  ds_read_b64_tr_b16 a[22:23], v26 offset:41984
  ds_read_b64_tr_b16 a[24:25], v26 offset:49152
  ds_read_b64_tr_b16 a[26:27], v26 offset:50176
  ds_read_b64_tr_b16 a[28:29], v26 offset:57344
  ds_read_b64_tr_b16 a[30:31], v26 offset:58368
  ds_read_b64_tr_b16 a[32:33], v27 offset:0
  ds_read_b64_tr_b16 a[34:35], v27 offset:1024
  ds_read_b64_tr_b16 a[36:37], v27 offset:8192
  ds_read_b64_tr_b16 a[38:39], v27 offset:9216
  ds_read_b64_tr_b16 a[40:41], v27 offset:16384
  ds_read_b64_tr_b16 a[42:43], v27 offset:17408
  ds_read_b64_tr_b16 a[44:45], v27 offset:24576
  ds_read_b64_tr_b16 a[46:47], v27 offset:25600
  ds_read_b64_tr_b16 a[48:49], v27 offset:32768
  ds_read_b64_tr_b16 a[50:51], v27 offset:33792
  ds_read_b64_tr_b16 a[52:53], v27 offset:40960
  ds_read_b64_tr_b16 a[54:55], v27 offset:41984
  ds_read_b64_tr_b16 a[56:57], v27 offset:49152
  ds_read_b64_tr_b16 a[58:59], v27 offset:50176
  ds_read_b64_tr_b16 a[60:61], v27 offset:57344
  ds_read_b64_tr_b16 a[62:63], v27 offset:58368
  ds_read_b64_tr_b16 a[64:65], v26 offset:8
  ds_read_b64_tr_b16 a[66:67], v26 offset:1032
  ds_read_b64_tr_b16 a[68:69], v26 offset:8200
  ds_read_b64_tr_b16 a[70:71], v26 offset:9224
  ds_read_b64_tr_b16 a[72:73], v26 offset:16392
  ds_read_b64_tr_b16 a[74:75], v26 offset:17416
  ds_read_b64_tr_b16 a[76:77], v26 offset:24584
  ds_read_b64_tr_b16 a[78:79], v26 offset:25608
  ds_read_b64_tr_b16 a[80:81], v26 offset:32776
  ds_read_b64_tr_b16 a[82:83], v26 offset:33800
  ds_read_b64_tr_b16 a[84:85], v26 offset:40968
  ds_read_b64_tr_b16 a[86:87], v26 offset:41992
  ds_read_b64_tr_b16 a[88:89], v26 offset:49160
  ds_read_b64_tr_b16 a[90:91], v26 offset:50184
  ds_read_b64_tr_b16 a[92:93], v26 offset:57352
  ds_read_b64_tr_b16 a[94:95], v26 offset:58376
  ds_read_b64_tr_b16 a[96:97], v27 offset:8
  ds_read_b64_tr_b16 a[98:99], v27 offset:1032
  ds_read_b64_tr_b16 a[100:101], v27 offset:8200
  ds_read_b64_tr_b16 a[102:103], v27 offset:9224
  ds_read_b64_tr_b16 a[104:105], v27 offset:16392
  ds_read_b64_tr_b16 a[106:107], v27 offset:17416
  ds_read_b64_tr_b16 a[108:109], v27 offset:24584
  ds_read_b64_tr_b16 a[110:111], v27 offset:25608
  ds_read_b64_tr_b16 a[112:113], v27 offset:32776
  ds_read_b64_tr_b16 a[114:115], v27 offset:33800
  ds_read_b64_tr_b16 a[116:117], v27 offset:40968
  ds_read_b64_tr_b16 a[118:119], v27 offset:41992
  ds_read_b64_tr_b16 a[120:121], v27 offset:49160
  ds_read_b64_tr_b16 a[122:123], v27 offset:50184
  ds_read_b64_tr_b16 a[124:125], v27 offset:57352
  ds_read_b64_tr_b16 a[126:127], v27 offset:58376
  s_waitcnt lgkmcnt(0)
  s_barrier
  s_load_dwordx2 s[8:9], s[0:1], 48
  s_waitcnt lgkmcnt(0)
  s_mov_b32 s10, 4194304
  s_mov_b32 s11, 0x20000
  s_lshl_b32 s16, s12, 20
  s_lshl_b32 s17, s13, 8
  s_add_u32 s16, s16, s17
  s_lshl_b32 s17, s12, 15
  s_mov_b32 m0, s17
  s_add_u32 s17, s17, 1024
  buffer_load_dwordx4 v24, s[8:11], s16 offen lds
  s_add_u32 s16, s16, 32768
  s_mov_b32 m0, s17
  s_add_u32 s17, s17, 1024
  buffer_load_dwordx4 v24, s[8:11], s16 offen lds
  s_add_u32 s16, s16, 32768
  s_mov_b32 m0, s17
  s_add_u32 s17, s17, 1024
  buffer_load_dwordx4 v25, s[8:11], s16 offen lds
  s_add_u32 s16, s16, 32768
  s_mov_b32 m0, s17
  s_add_u32 s17, s17, 1024
  buffer_load_dwordx4 v25, s[8:11], s16 offen lds
  s_add_u32 s16, s16, 32768
  s_mov_b32 m0, s17
  s_add_u32 s17, s17, 1024
  buffer_load_dwordx4 v24, s[8:11], s16 offen lds
  s_add_u32 s16, s16, 32768
  s_mov_b32 m0, s17
  s_add_u32 s17, s17, 1024
  buffer_load_dwordx4 v24, s[8:11], s16 offen lds
  s_add_u32 s16, s16, 32768
  s_mov_b32 m0, s17
  s_add_u32 s17, s17, 1024
  buffer_load_dwordx4 v25, s[8:11], s16 offen lds
  s_add_u32 s16, s16, 32768
  s_mov_b32 m0, s17
  s_add_u32 s17, s17, 1024
  buffer_load_dwordx4 v25, s[8:11], s16 offen lds
  s_add_u32 s16, s16, 32768
  s_mov_b32 m0, s17
  s_add_u32 s17, s17, 1024
  buffer_load_dwordx4 v24, s[8:11], s16 offen lds
  s_add_u32 s16, s16, 32768
  s_mov_b32 m0, s17
  s_add_u32 s17, s17, 1024
  buffer_load_dwordx4 v24, s[8:11], s16 offen lds
  s_add_u32 s16, s16, 32768
  s_mov_b32 m0, s17
  s_add_u32 s17, s17, 1024
  buffer_load_dwordx4 v25, s[8:11], s16 offen lds
  s_add_u32 s16, s16, 32768
  s_mov_b32 m0, s17
  s_add_u32 s17, s17, 1024
  buffer_load_dwordx4 v25, s[8:11], s16 offen lds
  s_add_u32 s16, s16, 32768
  s_mov_b32 m0, s17
  s_add_u32 s17, s17, 1024
  buffer_load_dwordx4 v24, s[8:11], s16 offen lds
  s_add_u32 s16, s16, 32768
  s_mov_b32 m0, s17
  s_add_u32 s17, s17, 1024
  buffer_load_dwordx4 v24, s[8:11], s16 offen lds
  s_add_u32 s16, s16, 32768
  s_mov_b32 m0, s17
  s_add_u32 s17, s17, 1024
  buffer_load_dwordx4 v25, s[8:11], s16 offen lds
  s_add_u32 s16, s16, 32768
  s_mov_b32 m0, s17
  s_add_u32 s17, s17, 1024
  buffer_load_dwordx4 v25, s[8:11], s16 offen lds
  s_add_u32 s16, s16, 32768
  s_mov_b32 m0, s17
  s_add_u32 s17, s17, 1024
  buffer_load_dwordx4 v24, s[8:11], s16 offen lds
  s_add_u32 s16, s16, 32768
  s_mov_b32 m0, s17
  s_add_u32 s17, s17, 1024
  buffer_load_dwordx4 v24, s[8:11], s16 offen lds
  s_add_u32 s16, s16, 32768
  s_mov_b32 m0, s17
  s_add_u32 s17, s17, 1024
  buffer_load_dwordx4 v25, s[8:11], s16 offen lds
  s_add_u32 s16, s16, 32768
  s_mov_b32 m0, s17
  s_add_u32 s17, s17, 1024
  buffer_load_dwordx4 v25, s[8:11], s16 offen lds
  s_add_u32 s16, s16, 32768
  s_mov_b32 m0, s17
  s_add_u32 s17, s17, 1024
  buffer_load_dwordx4 v24, s[8:11], s16 offen lds
  s_add_u32 s16, s16, 32768
  s_mov_b32 m0, s17
  s_add_u32 s17, s17, 1024
  buffer_load_dwordx4 v24, s[8:11], s16 offen lds
  s_add_u32 s16, s16, 32768
  s_mov_b32 m0, s17
  s_add_u32 s17, s17, 1024
  buffer_load_dwordx4 v25, s[8:11], s16 offen lds
  s_add_u32 s16, s16, 32768
  s_mov_b32 m0, s17
  s_add_u32 s17, s17, 1024
  buffer_load_dwordx4 v25, s[8:11], s16 offen lds
  s_add_u32 s16, s16, 32768
  s_mov_b32 m0, s17
  s_add_u32 s17, s17, 1024
  buffer_load_dwordx4 v24, s[8:11], s16 offen lds
  s_add_u32 s16, s16, 32768
  s_mov_b32 m0, s17
  s_add_u32 s17, s17, 1024
  buffer_load_dwordx4 v24, s[8:11], s16 offen lds
  s_add_u32 s16, s16, 32768
  s_mov_b32 m0, s17
  s_add_u32 s17, s17, 1024
  buffer_load_dwordx4 v25, s[8:11], s16 offen lds
  s_add_u32 s16, s16, 32768
  s_mov_b32 m0, s17
  s_add_u32 s17, s17, 1024
  buffer_load_dwordx4 v25, s[8:11], s16 offen lds
  s_add_u32 s16, s16, 32768
  s_mov_b32 m0, s17
  s_add_u32 s17, s17, 1024
  buffer_load_dwordx4 v24, s[8:11], s16 offen lds
  s_add_u32 s16, s16, 32768
  s_mov_b32 m0, s17
  s_add_u32 s17, s17, 1024
  buffer_load_dwordx4 v24, s[8:11], s16 offen lds
  s_add_u32 s16, s16, 32768
  s_mov_b32 m0, s17
  s_add_u32 s17, s17, 1024
  buffer_load_dwordx4 v25, s[8:11], s16 offen lds
  s_add_u32 s16, s16, 32768
  s_mov_b32 m0, s17
  s_add_u32 s17, s17, 1024
  buffer_load_dwordx4 v25, s[8:11], s16 offen lds
  s_add_u32 s16, s16, 32768
  s_waitcnt vmcnt(0)
  s_barrier
  ds_read_b64_tr_b16 a[128:129], v26 offset:0
  ds_read_b64_tr_b16 a[130:131], v26 offset:1024
  ds_read_b64_tr_b16 a[132:133], v26 offset:8192
  ds_read_b64_tr_b16 a[134:135], v26 offset:9216
  ds_read_b64_tr_b16 a[136:137], v26 offset:16384
  ds_read_b64_tr_b16 a[138:139], v26 offset:17408
  ds_read_b64_tr_b16 a[140:141], v26 offset:24576
  ds_read_b64_tr_b16 a[142:143], v26 offset:25600
  ds_read_b64_tr_b16 a[144:145], v26 offset:32768
  ds_read_b64_tr_b16 a[146:147], v26 offset:33792
  ds_read_b64_tr_b16 a[148:149], v26 offset:40960
  ds_read_b64_tr_b16 a[150:151], v26 offset:41984
  ds_read_b64_tr_b16 a[152:153], v26 offset:49152
  ds_read_b64_tr_b16 a[154:155], v26 offset:50176
  ds_read_b64_tr_b16 a[156:157], v26 offset:57344
  ds_read_b64_tr_b16 a[158:159], v26 offset:58368
  ds_read_b64_tr_b16 a[160:161], v27 offset:0
  ds_read_b64_tr_b16 a[162:163], v27 offset:1024
  ds_read_b64_tr_b16 a[164:165], v27 offset:8192
  ds_read_b64_tr_b16 a[166:167], v27 offset:9216
  ds_read_b64_tr_b16 a[168:169], v27 offset:16384
  ds_read_b64_tr_b16 a[170:171], v27 offset:17408
  ds_read_b64_tr_b16 a[172:173], v27 offset:24576
  ds_read_b64_tr_b16 a[174:175], v27 offset:25600
  ds_read_b64_tr_b16 a[176:177], v27 offset:32768
  ds_read_b64_tr_b16 a[178:179], v27 offset:33792
  ds_read_b64_tr_b16 a[180:181], v27 offset:40960
  ds_read_b64_tr_b16 a[182:183], v27 offset:41984
  ds_read_b64_tr_b16 a[184:185], v27 offset:49152
  ds_read_b64_tr_b16 a[186:187], v27 offset:50176
  ds_read_b64_tr_b16 a[188:189], v27 offset:57344
  ds_read_b64_tr_b16 a[190:191], v27 offset:58368
  ds_read_b64_tr_b16 a[192:193], v26 offset:8
  ds_read_b64_tr_b16 a[194:195], v26 offset:1032
  ds_read_b64_tr_b16 a[196:197], v26 offset:8200
  ds_read_b64_tr_b16 a[198:199], v26 offset:9224
  ds_read_b64_tr_b16 a[200:201], v26 offset:16392
  ds_read_b64_tr_b16 a[202:203], v26 offset:17416
  ds_read_b64_tr_b16 a[204:205], v26 offset:24584
  ds_read_b64_tr_b16 a[206:207], v26 offset:25608
  ds_read_b64_tr_b16 a[208:209], v26 offset:32776
  ds_read_b64_tr_b16 a[210:211], v26 offset:33800
  ds_read_b64_tr_b16 a[212:213], v26 offset:40968
  ds_read_b64_tr_b16 a[214:215], v26 offset:41992
  ds_read_b64_tr_b16 a[216:217], v26 offset:49160
  ds_read_b64_tr_b16 a[218:219], v26 offset:50184
  ds_read_b64_tr_b16 a[220:221], v26 offset:57352
  ds_read_b64_tr_b16 a[222:223], v26 offset:58376
  ds_read_b64_tr_b16 a[224:225], v27 offset:8
  ds_read_b64_tr_b16 a[226:227], v27 offset:1032
  ds_read_b64_tr_b16 a[228:229], v27 offset:8200
  ds_read_b64_tr_b16 a[230:231], v27 offset:9224
  ds_read_b64_tr_b16 a[232:233], v27 offset:16392
  ds_read_b64_tr_b16 a[234:235], v27 offset:17416
  ds_read_b64_tr_b16 a[236:237], v27 offset:24584
  ds_read_b64_tr_b16 a[238:239], v27 offset:25608
  ds_read_b64_tr_b16 a[240:241], v27 offset:32776
  ds_read_b64_tr_b16 a[242:243], v27 offset:33800
  ds_read_b64_tr_b16 a[244:245], v27 offset:40968
  ds_read_b64_tr_b16 a[246:247], v27 offset:41992
  ds_read_b64_tr_b16 a[248:249], v27 offset:49160
  ds_read_b64_tr_b16 a[250:251], v27 offset:50184
  ds_read_b64_tr_b16 a[252:253], v27 offset:57352
  ds_read_b64_tr_b16 a[254:255], v27 offset:58376
  s_waitcnt lgkmcnt(0)
  s_barrier
  s_load_dwordx2 s[8:9], s[0:1], 56
  s_waitcnt lgkmcnt(0)
  s_mov_b32 s10, 4194304
  s_mov_b32 s11, 0x20000
  s_lshl_b32 s16, s12, 20
  s_lshl_b32 s17, s13, 8
  s_add_u32 s16, s16, s17
  s_lshl_b32 s17, s12, 15
  s_mov_b32 m0, s17
  s_add_u32 s17, s17, 1024
  buffer_load_dwordx4 v24, s[8:11], s16 offen lds
  s_add_u32 s16, s16, 32768
  s_mov_b32 m0, s17
  s_add_u32 s17, s17, 1024
  buffer_load_dwordx4 v24, s[8:11], s16 offen lds
  s_add_u32 s16, s16, 32768
  s_mov_b32 m0, s17
  s_add_u32 s17, s17, 1024
  buffer_load_dwordx4 v25, s[8:11], s16 offen lds
  s_add_u32 s16, s16, 32768
  s_mov_b32 m0, s17
  s_add_u32 s17, s17, 1024
  buffer_load_dwordx4 v25, s[8:11], s16 offen lds
  s_add_u32 s16, s16, 32768
  s_mov_b32 m0, s17
  s_add_u32 s17, s17, 1024
  buffer_load_dwordx4 v24, s[8:11], s16 offen lds
  s_add_u32 s16, s16, 32768
  s_mov_b32 m0, s17
  s_add_u32 s17, s17, 1024
  buffer_load_dwordx4 v24, s[8:11], s16 offen lds
  s_add_u32 s16, s16, 32768
  s_mov_b32 m0, s17
  s_add_u32 s17, s17, 1024
  buffer_load_dwordx4 v25, s[8:11], s16 offen lds
  s_add_u32 s16, s16, 32768
  s_mov_b32 m0, s17
  s_add_u32 s17, s17, 1024
  buffer_load_dwordx4 v25, s[8:11], s16 offen lds
  s_add_u32 s16, s16, 32768
  s_mov_b32 m0, s17
  s_add_u32 s17, s17, 1024
  buffer_load_dwordx4 v24, s[8:11], s16 offen lds
  s_add_u32 s16, s16, 32768
  s_mov_b32 m0, s17
  s_add_u32 s17, s17, 1024
  buffer_load_dwordx4 v24, s[8:11], s16 offen lds
  s_add_u32 s16, s16, 32768
  s_mov_b32 m0, s17
  s_add_u32 s17, s17, 1024
  buffer_load_dwordx4 v25, s[8:11], s16 offen lds
  s_add_u32 s16, s16, 32768
  s_mov_b32 m0, s17
  s_add_u32 s17, s17, 1024
  buffer_load_dwordx4 v25, s[8:11], s16 offen lds
  s_add_u32 s16, s16, 32768
  s_mov_b32 m0, s17
  s_add_u32 s17, s17, 1024
  buffer_load_dwordx4 v24, s[8:11], s16 offen lds
  s_add_u32 s16, s16, 32768
  s_mov_b32 m0, s17
  s_add_u32 s17, s17, 1024
  buffer_load_dwordx4 v24, s[8:11], s16 offen lds
  s_add_u32 s16, s16, 32768
  s_mov_b32 m0, s17
  s_add_u32 s17, s17, 1024
  buffer_load_dwordx4 v25, s[8:11], s16 offen lds
  s_add_u32 s16, s16, 32768
  s_mov_b32 m0, s17
  s_add_u32 s17, s17, 1024
  buffer_load_dwordx4 v25, s[8:11], s16 offen lds
  s_add_u32 s16, s16, 32768
  s_mov_b32 m0, s17
  s_add_u32 s17, s17, 1024
  buffer_load_dwordx4 v24, s[8:11], s16 offen lds
  s_add_u32 s16, s16, 32768
  s_mov_b32 m0, s17
  s_add_u32 s17, s17, 1024
  buffer_load_dwordx4 v24, s[8:11], s16 offen lds
  s_add_u32 s16, s16, 32768
  s_mov_b32 m0, s17
  s_add_u32 s17, s17, 1024
  buffer_load_dwordx4 v25, s[8:11], s16 offen lds
  s_add_u32 s16, s16, 32768
  s_mov_b32 m0, s17
  s_add_u32 s17, s17, 1024
  buffer_load_dwordx4 v25, s[8:11], s16 offen lds
  s_add_u32 s16, s16, 32768
  s_mov_b32 m0, s17
  s_add_u32 s17, s17, 1024
  buffer_load_dwordx4 v24, s[8:11], s16 offen lds
  s_add_u32 s16, s16, 32768
  s_mov_b32 m0, s17
  s_add_u32 s17, s17, 1024
  buffer_load_dwordx4 v24, s[8:11], s16 offen lds
  s_add_u32 s16, s16, 32768
  s_mov_b32 m0, s17
  s_add_u32 s17, s17, 1024
  buffer_load_dwordx4 v25, s[8:11], s16 offen lds
  s_add_u32 s16, s16, 32768
  s_mov_b32 m0, s17
  s_add_u32 s17, s17, 1024
  buffer_load_dwordx4 v25, s[8:11], s16 offen lds
  s_add_u32 s16, s16, 32768
  s_mov_b32 m0, s17
  s_add_u32 s17, s17, 1024
  buffer_load_dwordx4 v24, s[8:11], s16 offen lds
  s_add_u32 s16, s16, 32768
  s_mov_b32 m0, s17
  s_add_u32 s17, s17, 1024
  buffer_load_dwordx4 v24, s[8:11], s16 offen lds
  s_add_u32 s16, s16, 32768
  s_mov_b32 m0, s17
  s_add_u32 s17, s17, 1024
  buffer_load_dwordx4 v25, s[8:11], s16 offen lds
  s_add_u32 s16, s16, 32768
  s_mov_b32 m0, s17
  s_add_u32 s17, s17, 1024
  buffer_load_dwordx4 v25, s[8:11], s16 offen lds
  s_add_u32 s16, s16, 32768
  s_mov_b32 m0, s17
  s_add_u32 s17, s17, 1024
  buffer_load_dwordx4 v24, s[8:11], s16 offen lds
  s_add_u32 s16, s16, 32768
  s_mov_b32 m0, s17
  s_add_u32 s17, s17, 1024
  buffer_load_dwordx4 v24, s[8:11], s16 offen lds
  s_add_u32 s16, s16, 32768
  s_mov_b32 m0, s17
  s_add_u32 s17, s17, 1024
  buffer_load_dwordx4 v25, s[8:11], s16 offen lds
  s_add_u32 s16, s16, 32768
  s_mov_b32 m0, s17
  s_add_u32 s17, s17, 1024
  buffer_load_dwordx4 v25, s[8:11], s16 offen lds
  s_add_u32 s16, s16, 32768
  s_waitcnt vmcnt(0)
  s_barrier
  ds_read_b64_tr_b16 v[128:129], v26 offset:0
  ds_read_b64_tr_b16 v[130:131], v26 offset:1024
  ds_read_b64_tr_b16 v[132:133], v26 offset:8192
  ds_read_b64_tr_b16 v[134:135], v26 offset:9216
  ds_read_b64_tr_b16 v[136:137], v26 offset:16384
  ds_read_b64_tr_b16 v[138:139], v26 offset:17408
  ds_read_b64_tr_b16 v[140:141], v26 offset:24576
  ds_read_b64_tr_b16 v[142:143], v26 offset:25600
  ds_read_b64_tr_b16 v[144:145], v26 offset:32768
  ds_read_b64_tr_b16 v[146:147], v26 offset:33792
  ds_read_b64_tr_b16 v[148:149], v26 offset:40960
  ds_read_b64_tr_b16 v[150:151], v26 offset:41984
  ds_read_b64_tr_b16 v[152:153], v26 offset:49152
  ds_read_b64_tr_b16 v[154:155], v26 offset:50176
  ds_read_b64_tr_b16 v[156:157], v26 offset:57344
  ds_read_b64_tr_b16 v[158:159], v26 offset:58368
  ds_read_b64_tr_b16 v[160:161], v27 offset:0
  ds_read_b64_tr_b16 v[162:163], v27 offset:1024
  ds_read_b64_tr_b16 v[164:165], v27 offset:8192
  ds_read_b64_tr_b16 v[166:167], v27 offset:9216
  ds_read_b64_tr_b16 v[168:169], v27 offset:16384
  ds_read_b64_tr_b16 v[170:171], v27 offset:17408
  ds_read_b64_tr_b16 v[172:173], v27 offset:24576
  ds_read_b64_tr_b16 v[174:175], v27 offset:25600
  ds_read_b64_tr_b16 v[176:177], v27 offset:32768
  ds_read_b64_tr_b16 v[178:179], v27 offset:33792
  ds_read_b64_tr_b16 v[180:181], v27 offset:40960
  ds_read_b64_tr_b16 v[182:183], v27 offset:41984
  ds_read_b64_tr_b16 v[184:185], v27 offset:49152
  ds_read_b64_tr_b16 v[186:187], v27 offset:50176
  ds_read_b64_tr_b16 v[188:189], v27 offset:57344
  ds_read_b64_tr_b16 v[190:191], v27 offset:58368
  ds_read_b64_tr_b16 v[192:193], v26 offset:8
  ds_read_b64_tr_b16 v[194:195], v26 offset:1032
  ds_read_b64_tr_b16 v[196:197], v26 offset:8200
  ds_read_b64_tr_b16 v[198:199], v26 offset:9224
  ds_read_b64_tr_b16 v[200:201], v26 offset:16392
  ds_read_b64_tr_b16 v[202:203], v26 offset:17416
  ds_read_b64_tr_b16 v[204:205], v26 offset:24584
  ds_read_b64_tr_b16 v[206:207], v26 offset:25608
  ds_read_b64_tr_b16 v[208:209], v26 offset:32776
  ds_read_b64_tr_b16 v[210:211], v26 offset:33800
  ds_read_b64_tr_b16 v[212:213], v26 offset:40968
  ds_read_b64_tr_b16 v[214:215], v26 offset:41992
  ds_read_b64_tr_b16 v[216:217], v26 offset:49160
  ds_read_b64_tr_b16 v[218:219], v26 offset:50184
  ds_read_b64_tr_b16 v[220:221], v26 offset:57352
  ds_read_b64_tr_b16 v[222:223], v26 offset:58376
  ds_read_b64_tr_b16 v[224:225], v27 offset:8
  ds_read_b64_tr_b16 v[226:227], v27 offset:1032
  ds_read_b64_tr_b16 v[228:229], v27 offset:8200
  ds_read_b64_tr_b16 v[230:231], v27 offset:9224
  ds_read_b64_tr_b16 v[232:233], v27 offset:16392
  ds_read_b64_tr_b16 v[234:235], v27 offset:17416
  ds_read_b64_tr_b16 v[236:237], v27 offset:24584
  ds_read_b64_tr_b16 v[238:239], v27 offset:25608
  ds_read_b64_tr_b16 v[240:241], v27 offset:32776
  ds_read_b64_tr_b16 v[242:243], v27 offset:33800
  ds_read_b64_tr_b16 v[244:245], v27 offset:40968
  ds_read_b64_tr_b16 v[246:247], v27 offset:41992
  ds_read_b64_tr_b16 v[248:249], v27 offset:49160
  ds_read_b64_tr_b16 v[250:251], v27 offset:50184
  ds_read_b64_tr_b16 v[252:253], v27 offset:57352
  ds_read_b64_tr_b16 v[254:255], v27 offset:58376
  s_waitcnt lgkmcnt(0)
  s_barrier
  v_and_b32 v24, 15, v0
  v_lshrrev_b32 v25, 4, v0
  v_mul_u32_u24 v1, 1056, v24
  v_lshl_add_u32 v1, v25, 4, v1
  v_lshlrev_b32 v2, 4, v0
  s_lshl_b32 s16, s12, 10
  v_add_u32 v3, s16, v2
  v_add_u32 v4, 4096, v3
  s_lshl_b32 s16, s12, 11
  v_add_u32 v5, s16, v2
  v_lshlrev_b32 v6, 2, v0
  s_mov_b32 s30, -1
  s_mov_b32 s31, 0
  s_mov_b32 s32, 0
  s_mov_b32 s33, -1
  s_mov_b32 s29, 0
  s_mov_b32 s34, 0
  s_lshl_b32 s16, s13, 4
  s_lshl_b32 s17, s12, 2
  s_add_u32 s16, s16, s17
  v_mov_b32 v7, s16
  s_lshl_b32 s16, s14, 1
  s_add_u32 s16, s16, 1
  s_mul_i32 s19, s16, 2097152
  s_add_u32 s19, s19, 8388608
  s_mul_i32 s20, s16, 8192
  s_add_u32 s20, s20, 4489216
  s_mul_i32 s21, s14, 16777216
  s_lshl_b32 s16, s13, 13
  s_add_u32 s21, s21, s16
  s_add_u32 s22, s21, 100663296
  s_add_u32 s23, s21, 33554432
  s_add_u32 s21, s21, 67108864
  s_mul_i32 s24, s14, 33280
  s_add_u32 s25, s24, 4325376
  s_add_u32 s24, s24, 4194304
  s_mov_b32 s18, 0
  s_mov_b32 s27, 0
  s_mov_b32 s28, 0
hfw_T0:
  buffer_load_dword v20, v6, s[4:7], s20 offen sc1
  s_waitcnt vmcnt(0)
  v_cmp_eq_u32 vcc, 0, v20
  s_cmp_eq_u32 vcc_lo, 0
  s_cbranch_scc1 hfw_T0_ok
  s_sub_u32 s15, s15, 1
  s_cbranch_scc1 hfw_T0_ok
  s_sleep 24
  s_branch hfw_T0
hfw_T0_ok:
  s_lshl_b32 s44, s12, 13
  s_add_u32 s44, s44, s19
  s_mul_i32 s45, s12, 8448
  s_add_u32 s45, s45, s27
  s_mov_b32 m0, s45
  s_add_u32 s45, s45, 1056
  buffer_load_dwordx4 v2, s[4:7], s44 offen sc1 lds
  s_add_u32 s44, s44, 1024
  s_mov_b32 m0, s45
  s_add_u32 s45, s45, 1056
  buffer_load_dwordx4 v2, s[4:7], s44 offen sc1 lds
  s_add_u32 s44, s44, 1024
  s_mov_b32 m0, s45
  s_add_u32 s45, s45, 1056
  buffer_load_dwordx4 v2, s[4:7], s44 offen sc1 lds
  s_add_u32 s44, s44, 1024
  s_mov_b32 m0, s45
  s_add_u32 s45, s45, 1056
  buffer_load_dwordx4 v2, s[4:7], s44 offen sc1 lds
  s_add_u32 s44, s44, 1024
  s_mov_b32 m0, s45
  s_add_u32 s45, s45, 1056
  buffer_load_dwordx4 v2, s[4:7], s44 offen sc1 lds
  s_add_u32 s44, s44, 1024
  s_mov_b32 m0, s45
  s_add_u32 s45, s45, 1056
  buffer_load_dwordx4 v2, s[4:7], s44 offen sc1 lds
  s_add_u32 s44, s44, 1024
  s_mov_b32 m0, s45
  s_add_u32 s45, s45, 1056
  buffer_load_dwordx4 v2, s[4:7], s44 offen sc1 lds
  s_add_u32 s44, s44, 1024
  s_mov_b32 m0, s45
  s_add_u32 s45, s45, 1056
  buffer_load_dwordx4 v2, s[4:7], s44 offen sc1 lds
  s_add_u32 s44, s44, 1024
  s_waitcnt vmcnt(0)
  s_barrier
T_item:
  s_add_u32 s20, s20, 128
  s_add_u32 s19, s19, 32768
  s_cmp_lg_u32 s29, 0
  s_cbranch_scc1 T_early
  ds_read_b128 v[24:27], v1 offset:0
  ds_read_b128 v[28:31], v1 offset:16896
  ds_read_b128 v[32:35], v1 offset:64
  ds_read_b128 v[36:39], v1 offset:16960
  ds_read_b128 v[40:43], v1 offset:128
  ds_read_b128 v[44:47], v1 offset:17024
  s_waitcnt lgkmcnt(4)
  v_mfma_f32_16x16x32_bf16 v[56:59], a[128:131], v[24:27], 0
  ds_read_b128 v[48:51], v1 offset:192
  v_mfma_f32_16x16x32_bf16 v[60:63], a[128:131], v[28:31], 0
  ds_read_b128 v[52:55], v1 offset:17088
  v_mfma_f32_16x16x32_bf16 v[64:67], a[192:195], v[24:27], 0
  v_mfma_f32_16x16x32_bf16 v[68:71], a[192:195], v[28:31], 0
  v_mfma_f32_16x16x32_bf16 v[72:75], v[24:27], v[128:131], 0
  v_mfma_f32_16x16x32_bf16 v[76:79], v[28:31], v[128:131], 0
  v_mfma_f32_16x16x32_bf16 v[80:83], v[24:27], v[192:195], 0
  s_waitcnt lgkmcnt(4)
  v_mfma_f32_16x16x32_bf16 v[84:87], v[28:31], v[192:195], 0
  v_mfma_f32_16x16x32_bf16 v[56:59], a[132:135], v[32:35], v[56:59]
  ds_read_b128 v[24:27], v1 offset:256
  v_mfma_f32_16x16x32_bf16 v[60:63], a[132:135], v[36:39], v[60:63]
  ds_read_b128 v[28:31], v1 offset:17152
  v_mfma_f32_16x16x32_bf16 v[64:67], a[196:199], v[32:35], v[64:67]
  v_mfma_f32_16x16x32_bf16 v[68:71], a[196:199], v[36:39], v[68:71]
  v_mfma_f32_16x16x32_bf16 v[72:75], v[32:35], v[132:135], v[72:75]
  v_mfma_f32_16x16x32_bf16 v[76:79], v[36:39], v[132:135], v[76:79]
  v_mfma_f32_16x16x32_bf16 v[80:83], v[32:35], v[196:199], v[80:83]
  s_waitcnt lgkmcnt(4)
  v_mfma_f32_16x16x32_bf16 v[84:87], v[36:39], v[196:199], v[84:87]
  s_cmp_eq_u32 s34, 0
  s_cbranch_scc1 Tl_kvp
  s_waitcnt vmcnt(2)
  s_sub_u32 s47, s24, 512
  v_mov_b32 v8, 1
  s_mov_b64 exec, 1
  buffer_store_dword v8, v7, s[4:7], s47 offen sc1
  s_mov_b64 exec, -1
  s_mov_b32 s34, 0
Tl_kvp:
  v_mfma_f32_16x16x32_bf16 v[56:59], a[136:139], v[40:43], v[56:59]
  ds_read_b128 v[32:35], v1 offset:320
  v_mfma_f32_16x16x32_bf16 v[60:63], a[136:139], v[44:47], v[60:63]
  ds_read_b128 v[36:39], v1 offset:17216
  v_mfma_f32_16x16x32_bf16 v[64:67], a[200:203], v[40:43], v[64:67]
  v_mfma_f32_16x16x32_bf16 v[68:71], a[200:203], v[44:47], v[68:71]
  v_mfma_f32_16x16x32_bf16 v[72:75], v[40:43], v[136:139], v[72:75]
  v_mfma_f32_16x16x32_bf16 v[76:79], v[44:47], v[136:139], v[76:79]
  v_mfma_f32_16x16x32_bf16 v[80:83], v[40:43], v[200:203], v[80:83]
  s_waitcnt lgkmcnt(4)
  v_mfma_f32_16x16x32_bf16 v[84:87], v[44:47], v[200:203], v[84:87]
  v_mfma_f32_16x16x32_bf16 v[56:59], a[140:143], v[48:51], v[56:59]
  ds_read_b128 v[40:43], v1 offset:384
  v_mfma_f32_16x16x32_bf16 v[60:63], a[140:143], v[52:55], v[60:63]
  ds_read_b128 v[44:47], v1 offset:17280
  v_mfma_f32_16x16x32_bf16 v[64:67], a[204:207], v[48:51], v[64:67]
  v_mfma_f32_16x16x32_bf16 v[68:71], a[204:207], v[52:55], v[68:71]
  v_mfma_f32_16x16x32_bf16 v[72:75], v[48:51], v[140:143], v[72:75]
  v_mfma_f32_16x16x32_bf16 v[76:79], v[52:55], v[140:143], v[76:79]
  v_mfma_f32_16x16x32_bf16 v[80:83], v[48:51], v[204:207], v[80:83]
  s_waitcnt lgkmcnt(4)
  v_mfma_f32_16x16x32_bf16 v[84:87], v[52:55], v[204:207], v[84:87]
  v_mfma_f32_16x16x32_bf16 v[56:59], a[144:147], v[24:27], v[56:59]
  ds_read_b128 v[48:51], v1 offset:448
  v_mfma_f32_16x16x32_bf16 v[60:63], a[144:147], v[28:31], v[60:63]
  ds_read_b128 v[52:55], v1 offset:17344
  v_mfma_f32_16x16x32_bf16 v[64:67], a[208:211], v[24:27], v[64:67]
  v_mfma_f32_16x16x32_bf16 v[68:71], a[208:211], v[28:31], v[68:71]
  v_mfma_f32_16x16x32_bf16 v[72:75], v[24:27], v[144:147], v[72:75]
  v_mfma_f32_16x16x32_bf16 v[76:79], v[28:31], v[144:147], v[76:79]
  v_mfma_f32_16x16x32_bf16 v[80:83], v[24:27], v[208:211], v[80:83]
  s_waitcnt lgkmcnt(4)
  v_mfma_f32_16x16x32_bf16 v[84:87], v[28:31], v[208:211], v[84:87]
  v_mfma_f32_16x16x32_bf16 v[56:59], a[148:151], v[32:35], v[56:59]
  ds_read_b128 v[24:27], v1 offset:512
  v_mfma_f32_16x16x32_bf16 v[60:63], a[148:151], v[36:39], v[60:63]
  ds_read_b128 v[28:31], v1 offset:17408
  v_mfma_f32_16x16x32_bf16 v[64:67], a[212:215], v[32:35], v[64:67]
  v_mfma_f32_16x16x32_bf16 v[68:71], a[212:215], v[36:39], v[68:71]
  v_mfma_f32_16x16x32_bf16 v[72:75], v[32:35], v[148:151], v[72:75]
  v_mfma_f32_16x16x32_bf16 v[76:79], v[36:39], v[148:151], v[76:79]
  v_mfma_f32_16x16x32_bf16 v[80:83], v[32:35], v[212:215], v[80:83]
  s_waitcnt lgkmcnt(4)
  v_mfma_f32_16x16x32_bf16 v[84:87], v[36:39], v[212:215], v[84:87]
  v_mfma_f32_16x16x32_bf16 v[56:59], a[152:155], v[40:43], v[56:59]
  ds_read_b128 v[32:35], v1 offset:576
  v_mfma_f32_16x16x32_bf16 v[60:63], a[152:155], v[44:47], v[60:63]
  ds_read_b128 v[36:39], v1 offset:17472
  v_mfma_f32_16x16x32_bf16 v[64:67], a[216:219], v[40:43], v[64:67]
  v_mfma_f32_16x16x32_bf16 v[68:71], a[216:219], v[44:47], v[68:71]
  v_mfma_f32_16x16x32_bf16 v[72:75], v[40:43], v[152:155], v[72:75]
  v_mfma_f32_16x16x32_bf16 v[76:79], v[44:47], v[152:155], v[76:79]
  v_mfma_f32_16x16x32_bf16 v[80:83], v[40:43], v[216:219], v[80:83]
  s_waitcnt lgkmcnt(4)
  v_mfma_f32_16x16x32_bf16 v[84:87], v[44:47], v[216:219], v[84:87]
  v_mfma_f32_16x16x32_bf16 v[56:59], a[156:159], v[48:51], v[56:59]
  ds_read_b128 v[40:43], v1 offset:640
  v_mfma_f32_16x16x32_bf16 v[60:63], a[156:159], v[52:55], v[60:63]
  ds_read_b128 v[44:47], v1 offset:17536
  v_mfma_f32_16x16x32_bf16 v[64:67], a[220:223], v[48:51], v[64:67]
  v_mfma_f32_16x16x32_bf16 v[68:71], a[220:223], v[52:55], v[68:71]
  v_mfma_f32_16x16x32_bf16 v[72:75], v[48:51], v[156:159], v[72:75]
  v_mfma_f32_16x16x32_bf16 v[76:79], v[52:55], v[156:159], v[76:79]
  v_mfma_f32_16x16x32_bf16 v[80:83], v[48:51], v[220:223], v[80:83]
  s_waitcnt lgkmcnt(4)
  v_mfma_f32_16x16x32_bf16 v[84:87], v[52:55], v[220:223], v[84:87]
  v_mfma_f32_16x16x32_bf16 v[56:59], a[160:163], v[24:27], v[56:59]
  ds_read_b128 v[48:51], v1 offset:704
  v_mfma_f32_16x16x32_bf16 v[60:63], a[160:163], v[28:31], v[60:63]
  ds_read_b128 v[52:55], v1 offset:17600
  v_mfma_f32_16x16x32_bf16 v[64:67], a[224:227], v[24:27], v[64:67]
  v_mfma_f32_16x16x32_bf16 v[68:71], a[224:227], v[28:31], v[68:71]
  v_mfma_f32_16x16x32_bf16 v[72:75], v[24:27], v[160:163], v[72:75]
  v_mfma_f32_16x16x32_bf16 v[76:79], v[28:31], v[160:163], v[76:79]
  v_mfma_f32_16x16x32_bf16 v[80:83], v[24:27], v[224:227], v[80:83]
  s_waitcnt lgkmcnt(4)
  v_mfma_f32_16x16x32_bf16 v[84:87], v[28:31], v[224:227], v[84:87]
  v_mfma_f32_16x16x32_bf16 v[56:59], a[164:167], v[32:35], v[56:59]
  ds_read_b128 v[24:27], v1 offset:768
  v_mfma_f32_16x16x32_bf16 v[60:63], a[164:167], v[36:39], v[60:63]
  ds_read_b128 v[28:31], v1 offset:17664
  v_mfma_f32_16x16x32_bf16 v[64:67], a[228:231], v[32:35], v[64:67]
  v_mfma_f32_16x16x32_bf16 v[68:71], a[228:231], v[36:39], v[68:71]
  v_mfma_f32_16x16x32_bf16 v[72:75], v[32:35], v[164:167], v[72:75]
  v_mfma_f32_16x16x32_bf16 v[76:79], v[36:39], v[164:167], v[76:79]
  v_mfma_f32_16x16x32_bf16 v[80:83], v[32:35], v[228:231], v[80:83]
  s_waitcnt lgkmcnt(4)
  v_mfma_f32_16x16x32_bf16 v[84:87], v[36:39], v[228:231], v[84:87]
  v_mfma_f32_16x16x32_bf16 v[56:59], a[168:171], v[40:43], v[56:59]
  ds_read_b128 v[32:35], v1 offset:832
  v_mfma_f32_16x16x32_bf16 v[60:63], a[168:171], v[44:47], v[60:63]
  ds_read_b128 v[36:39], v1 offset:17728
  v_mfma_f32_16x16x32_bf16 v[64:67], a[232:235], v[40:43], v[64:67]
  v_mfma_f32_16x16x32_bf16 v[68:71], a[232:235], v[44:47], v[68:71]
  v_mfma_f32_16x16x32_bf16 v[72:75], v[40:43], v[168:171], v[72:75]
  v_mfma_f32_16x16x32_bf16 v[76:79], v[44:47], v[168:171], v[76:79]
  v_mfma_f32_16x16x32_bf16 v[80:83], v[40:43], v[232:235], v[80:83]
  s_waitcnt lgkmcnt(4)
  v_mfma_f32_16x16x32_bf16 v[84:87], v[44:47], v[232:235], v[84:87]
  v_mfma_f32_16x16x32_bf16 v[56:59], a[172:175], v[48:51], v[56:59]
  ds_read_b128 v[40:43], v1 offset:896
  v_mfma_f32_16x16x32_bf16 v[60:63], a[172:175], v[52:55], v[60:63]
  ds_read_b128 v[44:47], v1 offset:17792
  v_mfma_f32_16x16x32_bf16 v[64:67], a[236:239], v[48:51], v[64:67]
  v_mfma_f32_16x16x32_bf16 v[68:71], a[236:239], v[52:55], v[68:71]
  v_mfma_f32_16x16x32_bf16 v[72:75], v[48:51], v[172:175], v[72:75]
  v_mfma_f32_16x16x32_bf16 v[76:79], v[52:55], v[172:175], v[76:79]
  v_mfma_f32_16x16x32_bf16 v[80:83], v[48:51], v[236:239], v[80:83]
  s_waitcnt lgkmcnt(4)
  v_mfma_f32_16x16x32_bf16 v[84:87], v[52:55], v[236:239], v[84:87]
  s_cmp_eq_u32 s28, 0
  s_cbranch_scc1 Tl_qf
  s_waitcnt vmcnt(0)
  s_sub_u32 s47, s25, 512
  v_mov_b32 v8, 1
  s_mov_b64 exec, 1
  buffer_store_dword v8, v7, s[4:7], s47 offen sc1
  s_mov_b64 exec, -1
Tl_qf:
  v_mfma_f32_16x16x32_bf16 v[56:59], a[176:179], v[24:27], v[56:59]
  ds_read_b128 v[48:51], v1 offset:960
  v_mfma_f32_16x16x32_bf16 v[60:63], a[176:179], v[28:31], v[60:63]
  ds_read_b128 v[52:55], v1 offset:17856
  v_mfma_f32_16x16x32_bf16 v[64:67], a[240:243], v[24:27], v[64:67]
  v_mfma_f32_16x16x32_bf16 v[68:71], a[240:243], v[28:31], v[68:71]
  v_mfma_f32_16x16x32_bf16 v[72:75], v[24:27], v[176:179], v[72:75]
  v_mfma_f32_16x16x32_bf16 v[76:79], v[28:31], v[176:179], v[76:79]
  v_mfma_f32_16x16x32_bf16 v[80:83], v[24:27], v[240:243], v[80:83]
  s_waitcnt lgkmcnt(4)
  v_mfma_f32_16x16x32_bf16 v[84:87], v[28:31], v[240:243], v[84:87]
  v_mfma_f32_16x16x32_bf16 v[56:59], a[180:183], v[32:35], v[56:59]
  v_mfma_f32_16x16x32_bf16 v[60:63], a[180:183], v[36:39], v[60:63]
  v_mfma_f32_16x16x32_bf16 v[64:67], a[244:247], v[32:35], v[64:67]
  v_mfma_f32_16x16x32_bf16 v[68:71], a[244:247], v[36:39], v[68:71]
  v_mfma_f32_16x16x32_bf16 v[72:75], v[32:35], v[180:183], v[72:75]
  v_mfma_f32_16x16x32_bf16 v[76:79], v[36:39], v[180:183], v[76:79]
  v_mfma_f32_16x16x32_bf16 v[80:83], v[32:35], v[244:247], v[80:83]
  s_waitcnt lgkmcnt(2)
  v_mfma_f32_16x16x32_bf16 v[84:87], v[36:39], v[244:247], v[84:87]
  v_mfma_f32_16x16x32_bf16 v[56:59], a[184:187], v[40:43], v[56:59]
  v_mfma_f32_16x16x32_bf16 v[60:63], a[184:187], v[44:47], v[60:63]
  v_mfma_f32_16x16x32_bf16 v[64:67], a[248:251], v[40:43], v[64:67]
  v_mfma_f32_16x16x32_bf16 v[68:71], a[248:251], v[44:47], v[68:71]
  v_mfma_f32_16x16x32_bf16 v[72:75], v[40:43], v[184:187], v[72:75]
  v_mfma_f32_16x16x32_bf16 v[76:79], v[44:47], v[184:187], v[76:79]
  v_mfma_f32_16x16x32_bf16 v[80:83], v[40:43], v[248:251], v[80:83]
  s_waitcnt lgkmcnt(0)
  v_mfma_f32_16x16x32_bf16 v[84:87], v[44:47], v[248:251], v[84:87]
  v_mfma_f32_16x16x32_bf16 v[56:59], a[188:191], v[48:51], v[56:59]
  v_mfma_f32_16x16x32_bf16 v[60:63], a[188:191], v[52:55], v[60:63]
  v_mfma_f32_16x16x32_bf16 v[64:67], a[252:255], v[48:51], v[64:67]
  v_mfma_f32_16x16x32_bf16 v[68:71], a[252:255], v[52:55], v[68:71]
  v_mfma_f32_16x16x32_bf16 v[72:75], v[48:51], v[188:191], v[72:75]
  v_mfma_f32_16x16x32_bf16 v[76:79], v[52:55], v[188:191], v[76:79]
  v_mfma_f32_16x16x32_bf16 v[80:83], v[48:51], v[252:255], v[80:83]
  v_mfma_f32_16x16x32_bf16 v[84:87], v[52:55], v[252:255], v[84:87]
  buffer_load_dword v20, v6, s[4:7], s20 offen sc1
  ds_read_b128 v[24:27], v1 offset:0
  ds_read_b128 v[28:31], v1 offset:16896
  ds_read_b128 v[32:35], v1 offset:64
  ds_read_b128 v[36:39], v1 offset:16960
  ds_read_b128 v[40:43], v1 offset:128
  ds_read_b128 v[44:47], v1 offset:17024
  s_waitcnt lgkmcnt(4)
  v_mfma_f32_16x16x32_bf16 v[88:91], a[0:3], v[24:27], 0
  ds_read_b128 v[48:51], v1 offset:192
  v_mfma_f32_16x16x32_bf16 v[92:95], a[0:3], v[28:31], 0
  ds_read_b128 v[52:55], v1 offset:17088
  v_mfma_f32_16x16x32_bf16 v[96:99], a[64:67], v[24:27], 0
  s_waitcnt lgkmcnt(4)
  v_mfma_f32_16x16x32_bf16 v[100:103], a[64:67], v[28:31], 0
  v_mfma_f32_16x16x32_bf16 v[88:91], a[4:7], v[32:35], v[88:91]
  ds_read_b128 v[24:27], v1 offset:256
  v_mfma_f32_16x16x32_bf16 v[92:95], a[4:7], v[36:39], v[92:95]
  ds_read_b128 v[28:31], v1 offset:17152
  v_cvt_pk_bf16_f32 v104, v56, v57
  v_mfma_f32_16x16x32_bf16 v[96:99], a[68:71], v[32:35], v[96:99]
  v_cvt_pk_bf16_f32 v105, v58, v59
  s_waitcnt lgkmcnt(4)
  v_mfma_f32_16x16x32_bf16 v[100:103], a[68:71], v[36:39], v[100:103]
  v_cvt_pk_bf16_f32 v106, v64, v65
  v_mfma_f32_16x16x32_bf16 v[88:91], a[8:11], v[40:43], v[88:91]
  ds_read_b128 v[32:35], v1 offset:320
  v_mfma_f32_16x16x32_bf16 v[92:95], a[8:11], v[44:47], v[92:95]
  ds_read_b128 v[36:39], v1 offset:17216
  v_cvt_pk_bf16_f32 v107, v66, v67
  buffer_store_dwordx4 v[104:107], v3, s[4:7], s21 offen sc1
  v_mfma_f32_16x16x32_bf16 v[96:99], a[72:75], v[40:43], v[96:99]
  v_cvt_pk_bf16_f32 v108, v60, v61
  s_waitcnt lgkmcnt(4)
  v_mfma_f32_16x16x32_bf16 v[100:103], a[72:75], v[44:47], v[100:103]
  v_cvt_pk_bf16_f32 v109, v62, v63
  v_mfma_f32_16x16x32_bf16 v[88:91], a[12:15], v[48:51], v[88:91]
  ds_read_b128 v[40:43], v1 offset:384
  v_mfma_f32_16x16x32_bf16 v[92:95], a[12:15], v[52:55], v[92:95]
  ds_read_b128 v[44:47], v1 offset:17280
  v_cvt_pk_bf16_f32 v110, v68, v69
  v_mfma_f32_16x16x32_bf16 v[96:99], a[76:79], v[48:51], v[96:99]
  v_cvt_pk_bf16_f32 v111, v70, v71
  buffer_store_dwordx4 v[108:111], v4, s[4:7], s21 offen sc1
  s_waitcnt lgkmcnt(4)
  v_mfma_f32_16x16x32_bf16 v[100:103], a[76:79], v[52:55], v[100:103]
  v_cvt_pk_bf16_f32 v112, v72, v73
  v_mfma_f32_16x16x32_bf16 v[88:91], a[16:19], v[24:27], v[88:91]
  ds_read_b128 v[48:51], v1 offset:448
  v_mfma_f32_16x16x32_bf16 v[92:95], a[16:19], v[28:31], v[92:95]
  ds_read_b128 v[52:55], v1 offset:17344
  v_cvt_pk_bf16_f32 v113, v74, v75
  v_mfma_f32_16x16x32_bf16 v[96:99], a[80:83], v[24:27], v[96:99]
  v_cvt_pk_bf16_f32 v114, v76, v77
  s_waitcnt lgkmcnt(4)
  v_mfma_f32_16x16x32_bf16 v[100:103], a[80:83], v[28:31], v[100:103]
  v_cvt_pk_bf16_f32 v115, v78, v79
  buffer_store_dwordx4 v[112:115], v5, s[4:7], s22 offen offset:0 sc1
  v_mfma_f32_16x16x32_bf16 v[88:91], a[20:23], v[32:35], v[88:91]
  ds_read_b128 v[24:27], v1 offset:512
  v_mfma_f32_16x16x32_bf16 v[92:95], a[20:23], v[36:39], v[92:95]
  ds_read_b128 v[28:31], v1 offset:17408
  v_cvt_pk_bf16_f32 v116, v80, v81
  v_mfma_f32_16x16x32_bf16 v[96:99], a[84:87], v[32:35], v[96:99]
  v_cvt_pk_bf16_f32 v117, v82, v83
  s_waitcnt lgkmcnt(4)
  v_mfma_f32_16x16x32_bf16 v[100:103], a[84:87], v[36:39], v[100:103]
  v_cvt_pk_bf16_f32 v118, v84, v85
  v_mfma_f32_16x16x32_bf16 v[88:91], a[24:27], v[40:43], v[88:91]
  ds_read_b128 v[32:35], v1 offset:576
  v_mfma_f32_16x16x32_bf16 v[92:95], a[24:27], v[44:47], v[92:95]
  ds_read_b128 v[36:39], v1 offset:17472
  v_cvt_pk_bf16_f32 v119, v86, v87
  buffer_store_dwordx4 v[116:119], v5, s[4:7], s22 offen offset:1024 sc1
  v_mfma_f32_16x16x32_bf16 v[96:99], a[88:91], v[40:43], v[96:99]
  s_waitcnt lgkmcnt(4)
  v_mfma_f32_16x16x32_bf16 v[100:103], a[88:91], v[44:47], v[100:103]
  v_mfma_f32_16x16x32_bf16 v[88:91], a[28:31], v[48:51], v[88:91]
  ds_read_b128 v[40:43], v1 offset:640
  v_mfma_f32_16x16x32_bf16 v[92:95], a[28:31], v[52:55], v[92:95]
  ds_read_b128 v[44:47], v1 offset:17536
  v_mfma_f32_16x16x32_bf16 v[96:99], a[92:95], v[48:51], v[96:99]
  s_waitcnt lgkmcnt(4)
  v_mfma_f32_16x16x32_bf16 v[100:103], a[92:95], v[52:55], v[100:103]
  v_mfma_f32_16x16x32_bf16 v[88:91], a[32:35], v[24:27], v[88:91]
  ds_read_b128 v[48:51], v1 offset:704
  v_mfma_f32_16x16x32_bf16 v[92:95], a[32:35], v[28:31], v[92:95]
  ds_read_b128 v[52:55], v1 offset:17600
  v_mfma_f32_16x16x32_bf16 v[96:99], a[96:99], v[24:27], v[96:99]
  s_waitcnt lgkmcnt(4)
  v_mfma_f32_16x16x32_bf16 v[100:103], a[96:99], v[28:31], v[100:103]
  v_mfma_f32_16x16x32_bf16 v[88:91], a[36:39], v[32:35], v[88:91]
  ds_read_b128 v[24:27], v1 offset:768
  v_mfma_f32_16x16x32_bf16 v[92:95], a[36:39], v[36:39], v[92:95]
  ds_read_b128 v[28:31], v1 offset:17664
  v_mfma_f32_16x16x32_bf16 v[96:99], a[100:103], v[32:35], v[96:99]
  s_waitcnt lgkmcnt(4)
  v_mfma_f32_16x16x32_bf16 v[100:103], a[100:103], v[36:39], v[100:103]
  s_waitcnt vmcnt(4)
  v_cmp_eq_u32 vcc, 0, v20
  s_nop 0
  s_cmp_eq_u32 vcc_hi, 0
  s_cselect_b32 s29, 1, 0
  s_cmp_ge_u32 s18, 62
  s_cselect_b32 s29, 0, s29
  s_cmp_eq_u32 vcc_lo, 0
  s_cselect_b32 s44, 1, 0
  s_cmp_eq_u32 s18, 63
  s_cselect_b32 s26, 0, s44
  s_sub_u32 s47, s19, 32768
  s_cmp_lg_u32 s26, 0
  s_cselect_b32 s47, s19, s47
  s_sub_u32 s46, 33792, s27
  s_lshl_b32 s44, s12, 13
  s_add_u32 s44, s44, s47
  s_mul_i32 s45, s12, 8448
  s_add_u32 s45, s45, s46
  v_mfma_f32_16x16x32_bf16 v[88:91], a[40:43], v[40:43], v[88:91]
  ds_read_b128 v[32:35], v1 offset:832
  v_mfma_f32_16x16x32_bf16 v[92:95], a[40:43], v[44:47], v[92:95]
  ds_read_b128 v[36:39], v1 offset:17728
  s_mov_b32 m0, s45
  s_add_u32 s45, s45, 1056
  buffer_load_dwordx4 v2, s[4:7], s44 offen sc1 lds
  s_add_u32 s44, s44, 1024
  v_mfma_f32_16x16x32_bf16 v[96:99], a[104:107], v[40:43], v[96:99]
  s_waitcnt lgkmcnt(4)
  v_mfma_f32_16x16x32_bf16 v[100:103], a[104:107], v[44:47], v[100:103]
  s_mov_b32 m0, s45
  s_add_u32 s45, s45, 1056
  buffer_load_dwordx4 v2, s[4:7], s44 offen sc1 lds
  s_add_u32 s44, s44, 1024
  v_mfma_f32_16x16x32_bf16 v[88:91], a[44:47], v[48:51], v[88:91]
  ds_read_b128 v[40:43], v1 offset:896
  v_mfma_f32_16x16x32_bf16 v[92:95], a[44:47], v[52:55], v[92:95]
  ds_read_b128 v[44:47], v1 offset:17792
  s_mov_b32 m0, s45
  s_add_u32 s45, s45, 1056
  buffer_load_dwordx4 v2, s[4:7], s44 offen sc1 lds
  s_add_u32 s44, s44, 1024
  v_mfma_f32_16x16x32_bf16 v[96:99], a[108:111], v[48:51], v[96:99]
  s_waitcnt lgkmcnt(4)
  v_mfma_f32_16x16x32_bf16 v[100:103], a[108:111], v[52:55], v[100:103]
  s_mov_b32 m0, s45
  s_add_u32 s45, s45, 1056
  buffer_load_dwordx4 v2, s[4:7], s44 offen sc1 lds
  s_add_u32 s44, s44, 1024
  v_mfma_f32_16x16x32_bf16 v[88:91], a[48:51], v[24:27], v[88:91]
  ds_read_b128 v[48:51], v1 offset:960
  v_mfma_f32_16x16x32_bf16 v[92:95], a[48:51], v[28:31], v[92:95]
  ds_read_b128 v[52:55], v1 offset:17856
  s_mov_b32 m0, s45
  s_add_u32 s45, s45, 1056
  buffer_load_dwordx4 v2, s[4:7], s44 offen sc1 lds
  s_add_u32 s44, s44, 1024
  v_mfma_f32_16x16x32_bf16 v[96:99], a[112:115], v[24:27], v[96:99]
  s_waitcnt lgkmcnt(4)
  v_mfma_f32_16x16x32_bf16 v[100:103], a[112:115], v[28:31], v[100:103]
  s_mov_b32 m0, s45
  s_add_u32 s45, s45, 1056
  buffer_load_dwordx4 v2, s[4:7], s44 offen sc1 lds
  s_add_u32 s44, s44, 1024
  v_mfma_f32_16x16x32_bf16 v[88:91], a[52:55], v[32:35], v[88:91]
  s_mov_b32 m0, s45
  s_add_u32 s45, s45, 1056
  buffer_load_dwordx4 v2, s[4:7], s44 offen sc1 lds
  s_add_u32 s44, s44, 1024
  v_mfma_f32_16x16x32_bf16 v[92:95], a[52:55], v[36:39], v[92:95]
  s_mov_b32 m0, s45
  s_add_u32 s45, s45, 1056
  buffer_load_dwordx4 v2, s[4:7], s44 offen sc1 lds
  s_add_u32 s44, s44, 1024
  v_mfma_f32_16x16x32_bf16 v[96:99], a[116:119], v[32:35], v[96:99]
  s_waitcnt lgkmcnt(2)
  v_mfma_f32_16x16x32_bf16 v[100:103], a[116:119], v[36:39], v[100:103]
  v_mfma_f32_16x16x32_bf16 v[88:91], a[56:59], v[40:43], v[88:91]
  v_mfma_f32_16x16x32_bf16 v[92:95], a[56:59], v[44:47], v[92:95]
  v_mfma_f32_16x16x32_bf16 v[96:99], a[120:123], v[40:43], v[96:99]
  s_waitcnt lgkmcnt(0)
  v_mfma_f32_16x16x32_bf16 v[100:103], a[120:123], v[44:47], v[100:103]
  v_mfma_f32_16x16x32_bf16 v[88:91], a[60:63], v[48:51], v[88:91]
  v_mfma_f32_16x16x32_bf16 v[92:95], a[60:63], v[52:55], v[92:95]
  v_mfma_f32_16x16x32_bf16 v[96:99], a[124:127], v[48:51], v[96:99]
  v_mfma_f32_16x16x32_bf16 v[100:103], a[124:127], v[52:55], v[100:103]
  s_nop 5
  v_cvt_pk_bf16_f32 v104, v88, v89
  v_cvt_pk_bf16_f32 v105, v90, v91
  v_cvt_pk_bf16_f32 v106, v96, v97
  v_cvt_pk_bf16_f32 v107, v98, v99
  buffer_store_dwordx4 v[104:107], v3, s[4:7], s23 offen sc1
  v_cvt_pk_bf16_f32 v108, v92, v93
  v_cvt_pk_bf16_f32 v109, v94, v95
  v_cvt_pk_bf16_f32 v110, v100, v101
  v_cvt_pk_bf16_f32 v111, v102, v103
  buffer_store_dwordx4 v[108:111], v4, s[4:7], s23 offen sc1
  s_mov_b32 s34, 1
  s_mov_b32 s28, 1
  s_cmp_eq_u32 s18, 63
  s_cbranch_scc1 T_end
  s_cmp_lg_u32 s26, 0
  s_cbranch_scc1 Tl_have
  buffer_load_dword v20, v6, s[4:7], s20 offen sc1
  s_waitcnt vmcnt(3)
  v_mov_b32 v8, 1
  s_mov_b64 exec, 1
  buffer_store_dword v8, v7, s[4:7], s24 offen sc1
  s_mov_b64 exec, -1
  s_mov_b32 s34, 0
  s_waitcnt vmcnt(1)
  v_cmp_eq_u32 vcc, 0, v20
  s_nop 0
  s_cmp_eq_u32 vcc_lo, 0
  s_cbranch_scc1 Tl_rdy
hfw_Tl1:
  buffer_load_dword v20, v6, s[4:7], s20 offen sc1
  s_waitcnt vmcnt(0)
  v_cmp_eq_u32 vcc, 0, v20
  s_cmp_eq_u32 vcc_lo, 0
  s_cbranch_scc1 hfw_Tl1_ok
  s_sub_u32 s15, s15, 1
  s_cbranch_scc1 hfw_Tl1_ok
  s_sleep 24
  s_branch hfw_Tl1
hfw_Tl1_ok:
Tl_rdy:
  v_cmp_eq_u32 vcc, 0, v20
  s_nop 0
  s_cmp_eq_u32 vcc_hi, 0
  s_cselect_b32 s29, 1, 0
  s_cmp_ge_u32 s18, 62
  s_cselect_b32 s29, 0, s29
  s_cmp_eq_u32 vcc_lo, 0
  s_cselect_b32 s44, 1, 0
  s_sub_u32 s46, 33792, s27
  s_lshl_b32 s44, s12, 13
  s_add_u32 s44, s44, s19
  s_mul_i32 s45, s12, 8448
  s_add_u32 s45, s45, s46
  s_mov_b32 m0, s45
  s_add_u32 s45, s45, 1056
  buffer_load_dwordx4 v2, s[4:7], s44 offen sc1 lds
  s_add_u32 s44, s44, 1024
  s_mov_b32 m0, s45
  s_add_u32 s45, s45, 1056
  buffer_load_dwordx4 v2, s[4:7], s44 offen sc1 lds
  s_add_u32 s44, s44, 1024
  s_mov_b32 m0, s45
  s_add_u32 s45, s45, 1056
  buffer_load_dwordx4 v2, s[4:7], s44 offen sc1 lds
  s_add_u32 s44, s44, 1024
  s_mov_b32 m0, s45
  s_add_u32 s45, s45, 1056
  buffer_load_dwordx4 v2, s[4:7], s44 offen sc1 lds
  s_add_u32 s44, s44, 1024
  s_mov_b32 m0, s45
  s_add_u32 s45, s45, 1056
  buffer_load_dwordx4 v2, s[4:7], s44 offen sc1 lds
  s_add_u32 s44, s44, 1024
  s_mov_b32 m0, s45
  s_add_u32 s45, s45, 1056
  buffer_load_dwordx4 v2, s[4:7], s44 offen sc1 lds
  s_add_u32 s44, s44, 1024
  s_mov_b32 m0, s45
  s_add_u32 s45, s45, 1056
  buffer_load_dwordx4 v2, s[4:7], s44 offen sc1 lds
  s_add_u32 s44, s44, 1024
  s_mov_b32 m0, s45
  s_add_u32 s45, s45, 1056
  buffer_load_dwordx4 v2, s[4:7], s44 offen sc1 lds
  s_add_u32 s44, s44, 1024
  s_waitcnt vmcnt(0)
  s_branch T_go
Tl_have:
  s_waitcnt vmcnt(2)
  s_branch T_go
T_early:
  ds_read_b128 v[24:27], v1 offset:0
  ds_read_b128 v[28:31], v1 offset:16896
  ds_read_b128 v[32:35], v1 offset:64
  ds_read_b128 v[36:39], v1 offset:16960
  ds_read_b128 v[40:43], v1 offset:128
  ds_read_b128 v[44:47], v1 offset:17024
  s_sub_u32 s46, 33792, s27
  s_waitcnt lgkmcnt(4)
  v_mfma_f32_16x16x32_bf16 v[56:59], a[128:131], v[24:27], 0
  ds_read_b128 v[48:51], v1 offset:192
  v_mfma_f32_16x16x32_bf16 v[60:63], a[128:131], v[28:31], 0
  ds_read_b128 v[52:55], v1 offset:17088
  v_mfma_f32_16x16x32_bf16 v[64:67], a[192:195], v[24:27], 0
  v_mfma_f32_16x16x32_bf16 v[68:71], a[192:195], v[28:31], 0
  s_lshl_b32 s44, s12, 13
  s_add_u32 s44, s44, s19
  s_mul_i32 s45, s12, 8448
  s_add_u32 s45, s45, s46
  v_mfma_f32_16x16x32_bf16 v[72:75], v[24:27], v[128:131], 0
  v_mfma_f32_16x16x32_bf16 v[76:79], v[28:31], v[128:131], 0
  v_mfma_f32_16x16x32_bf16 v[80:83], v[24:27], v[192:195], 0
  s_waitcnt lgkmcnt(4)
  v_mfma_f32_16x16x32_bf16 v[84:87], v[28:31], v[192:195], 0
  v_mfma_f32_16x16x32_bf16 v[56:59], a[132:135], v[32:35], v[56:59]
  ds_read_b128 v[24:27], v1 offset:256
  v_mfma_f32_16x16x32_bf16 v[60:63], a[132:135], v[36:39], v[60:63]
  ds_read_b128 v[28:31], v1 offset:17152
  v_mfma_f32_16x16x32_bf16 v[64:67], a[196:199], v[32:35], v[64:67]
  v_mfma_f32_16x16x32_bf16 v[68:71], a[196:199], v[36:39], v[68:71]
  s_mov_b32 m0, s45
  s_add_u32 s45, s45, 1056
  buffer_load_dwordx4 v2, s[4:7], s44 offen sc1 lds
  s_add_u32 s44, s44, 1024
  v_mfma_f32_16x16x32_bf16 v[72:75], v[32:35], v[132:135], v[72:75]
  v_mfma_f32_16x16x32_bf16 v[76:79], v[36:39], v[132:135], v[76:79]
  v_mfma_f32_16x16x32_bf16 v[80:83], v[32:35], v[196:199], v[80:83]
  s_waitcnt lgkmcnt(4)
  v_mfma_f32_16x16x32_bf16 v[84:87], v[36:39], v[196:199], v[84:87]
  s_cmp_eq_u32 s34, 0
  s_cbranch_scc1 Te_kvp
  s_waitcnt vmcnt(3)
  s_sub_u32 s47, s24, 512
  v_mov_b32 v8, 1
  s_mov_b64 exec, 1
  buffer_store_dword v8, v7, s[4:7], s47 offen sc1
  s_mov_b64 exec, -1
  s_mov_b32 s34, 0
Te_kvp:
  v_mfma_f32_16x16x32_bf16 v[56:59], a[136:139], v[40:43], v[56:59]
  ds_read_b128 v[32:35], v1 offset:320
  v_mfma_f32_16x16x32_bf16 v[60:63], a[136:139], v[44:47], v[60:63]
  ds_read_b128 v[36:39], v1 offset:17216
  v_mfma_f32_16x16x32_bf16 v[64:67], a[200:203], v[40:43], v[64:67]
  v_mfma_f32_16x16x32_bf16 v[68:71], a[200:203], v[44:47], v[68:71]
  s_mov_b32 m0, s45
  s_add_u32 s45, s45, 1056
  buffer_load_dwordx4 v2, s[4:7], s44 offen sc1 lds
  s_add_u32 s44, s44, 1024
  v_mfma_f32_16x16x32_bf16 v[72:75], v[40:43], v[136:139], v[72:75]
  v_mfma_f32_16x16x32_bf16 v[76:79], v[44:47], v[136:139], v[76:79]
  v_mfma_f32_16x16x32_bf16 v[80:83], v[40:43], v[200:203], v[80:83]
  s_waitcnt lgkmcnt(4)
  v_mfma_f32_16x16x32_bf16 v[84:87], v[44:47], v[200:203], v[84:87]
  v_mfma_f32_16x16x32_bf16 v[56:59], a[140:143], v[48:51], v[56:59]
  ds_read_b128 v[40:43], v1 offset:384
  v_mfma_f32_16x16x32_bf16 v[60:63], a[140:143], v[52:55], v[60:63]
  ds_read_b128 v[44:47], v1 offset:17280
  v_mfma_f32_16x16x32_bf16 v[64:67], a[204:207], v[48:51], v[64:67]
  v_mfma_f32_16x16x32_bf16 v[68:71], a[204:207], v[52:55], v[68:71]
  s_mov_b32 m0, s45
  s_add_u32 s45, s45, 1056
  buffer_load_dwordx4 v2, s[4:7], s44 offen sc1 lds
  s_add_u32 s44, s44, 1024
  v_mfma_f32_16x16x32_bf16 v[72:75], v[48:51], v[140:143], v[72:75]
  v_mfma_f32_16x16x32_bf16 v[76:79], v[52:55], v[140:143], v[76:79]
  v_mfma_f32_16x16x32_bf16 v[80:83], v[48:51], v[204:207], v[80:83]
  s_waitcnt lgkmcnt(4)
  v_mfma_f32_16x16x32_bf16 v[84:87], v[52:55], v[204:207], v[84:87]
  v_mfma_f32_16x16x32_bf16 v[56:59], a[144:147], v[24:27], v[56:59]
  ds_read_b128 v[48:51], v1 offset:448
  v_mfma_f32_16x16x32_bf16 v[60:63], a[144:147], v[28:31], v[60:63]
  ds_read_b128 v[52:55], v1 offset:17344
  v_mfma_f32_16x16x32_bf16 v[64:67], a[208:211], v[24:27], v[64:67]
  v_mfma_f32_16x16x32_bf16 v[68:71], a[208:211], v[28:31], v[68:71]
  s_mov_b32 m0, s45
  s_add_u32 s45, s45, 1056
  buffer_load_dwordx4 v2, s[4:7], s44 offen sc1 lds
  s_add_u32 s44, s44, 1024
  v_mfma_f32_16x16x32_bf16 v[72:75], v[24:27], v[144:147], v[72:75]
  v_mfma_f32_16x16x32_bf16 v[76:79], v[28:31], v[144:147], v[76:79]
  v_mfma_f32_16x16x32_bf16 v[80:83], v[24:27], v[208:211], v[80:83]
  s_waitcnt lgkmcnt(4)
  v_mfma_f32_16x16x32_bf16 v[84:87], v[28:31], v[208:211], v[84:87]
  v_mfma_f32_16x16x32_bf16 v[56:59], a[148:151], v[32:35], v[56:59]
  ds_read_b128 v[24:27], v1 offset:512
  v_mfma_f32_16x16x32_bf16 v[60:63], a[148:151], v[36:39], v[60:63]
  ds_read_b128 v[28:31], v1 offset:17408
  v_mfma_f32_16x16x32_bf16 v[64:67], a[212:215], v[32:35], v[64:67]
  v_mfma_f32_16x16x32_bf16 v[68:71], a[212:215], v[36:39], v[68:71]
  s_mov_b32 m0, s45
  s_add_u32 s45, s45, 1056
  buffer_load_dwordx4 v2, s[4:7], s44 offen sc1 lds
  s_add_u32 s44, s44, 1024
  v_mfma_f32_16x16x32_bf16 v[72:75], v[32:35], v[148:151], v[72:75]
  v_mfma_f32_16x16x32_bf16 v[76:79], v[36:39], v[148:151], v[76:79]
  v_mfma_f32_16x16x32_bf16 v[80:83], v[32:35], v[212:215], v[80:83]
  s_waitcnt lgkmcnt(4)
  v_mfma_f32_16x16x32_bf16 v[84:87], v[36:39], v[212:215], v[84:87]
  v_mfma_f32_16x16x32_bf16 v[56:59], a[152:155], v[40:43], v[56:59]
  ds_read_b128 v[32:35], v1 offset:576
  v_mfma_f32_16x16x32_bf16 v[60:63], a[152:155], v[44:47], v[60:63]
  ds_read_b128 v[36:39], v1 offset:17472
  v_mfma_f32_16x16x32_bf16 v[64:67], a[216:219], v[40:43], v[64:67]
  v_mfma_f32_16x16x32_bf16 v[68:71], a[216:219], v[44:47], v[68:71]
  s_mov_b32 m0, s45
  s_add_u32 s45, s45, 1056
  buffer_load_dwordx4 v2, s[4:7], s44 offen sc1 lds
  s_add_u32 s44, s44, 1024
  v_mfma_f32_16x16x32_bf16 v[72:75], v[40:43], v[152:155], v[72:75]
  v_mfma_f32_16x16x32_bf16 v[76:79], v[44:47], v[152:155], v[76:79]
  v_mfma_f32_16x16x32_bf16 v[80:83], v[40:43], v[216:219], v[80:83]
  s_waitcnt lgkmcnt(4)
  v_mfma_f32_16x16x32_bf16 v[84:87], v[44:47], v[216:219], v[84:87]
  v_mfma_f32_16x16x32_bf16 v[56:59], a[156:159], v[48:51], v[56:59]
  ds_read_b128 v[40:43], v1 offset:640
  v_mfma_f32_16x16x32_bf16 v[60:63], a[156:159], v[52:55], v[60:63]
  ds_read_b128 v[44:47], v1 offset:17536
  v_mfma_f32_16x16x32_bf16 v[64:67], a[220:223], v[48:51], v[64:67]
  v_mfma_f32_16x16x32_bf16 v[68:71], a[220:223], v[52:55], v[68:71]
  s_mov_b32 m0, s45
  s_add_u32 s45, s45, 1056
  buffer_load_dwordx4 v2, s[4:7], s44 offen sc1 lds
  s_add_u32 s44, s44, 1024
  v_mfma_f32_16x16x32_bf16 v[72:75], v[48:51], v[156:159], v[72:75]
  v_mfma_f32_16x16x32_bf16 v[76:79], v[52:55], v[156:159], v[76:79]
  v_mfma_f32_16x16x32_bf16 v[80:83], v[48:51], v[220:223], v[80:83]
  s_waitcnt lgkmcnt(4)
  v_mfma_f32_16x16x32_bf16 v[84:87], v[52:55], v[220:223], v[84:87]
  v_mfma_f32_16x16x32_bf16 v[56:59], a[160:163], v[24:27], v[56:59]
  ds_read_b128 v[48:51], v1 offset:704
  v_mfma_f32_16x16x32_bf16 v[60:63], a[160:163], v[28:31], v[60:63]
  ds_read_b128 v[52:55], v1 offset:17600
  v_mfma_f32_16x16x32_bf16 v[64:67], a[224:227], v[24:27], v[64:67]
  v_mfma_f32_16x16x32_bf16 v[68:71], a[224:227], v[28:31], v[68:71]
  s_mov_b32 m0, s45
  s_add_u32 s45, s45, 1056
  buffer_load_dwordx4 v2, s[4:7], s44 offen sc1 lds
  s_add_u32 s44, s44, 1024
  v_mfma_f32_16x16x32_bf16 v[72:75], v[24:27], v[160:163], v[72:75]
  v_mfma_f32_16x16x32_bf16 v[76:79], v[28:31], v[160:163], v[76:79]
  v_mfma_f32_16x16x32_bf16 v[80:83], v[24:27], v[224:227], v[80:83]
  s_waitcnt lgkmcnt(4)
  v_mfma_f32_16x16x32_bf16 v[84:87], v[28:31], v[224:227], v[84:87]
  v_mfma_f32_16x16x32_bf16 v[56:59], a[164:167], v[32:35], v[56:59]
  ds_read_b128 v[24:27], v1 offset:768
  v_mfma_f32_16x16x32_bf16 v[60:63], a[164:167], v[36:39], v[60:63]
  ds_read_b128 v[28:31], v1 offset:17664
  v_mfma_f32_16x16x32_bf16 v[64:67], a[228:231], v[32:35], v[64:67]
  v_mfma_f32_16x16x32_bf16 v[68:71], a[228:231], v[36:39], v[68:71]
  v_mfma_f32_16x16x32_bf16 v[72:75], v[32:35], v[164:167], v[72:75]
  v_mfma_f32_16x16x32_bf16 v[76:79], v[36:39], v[164:167], v[76:79]
  v_mfma_f32_16x16x32_bf16 v[80:83], v[32:35], v[228:231], v[80:83]
  s_waitcnt lgkmcnt(4)
  v_mfma_f32_16x16x32_bf16 v[84:87], v[36:39], v[228:231], v[84:87]
  v_mfma_f32_16x16x32_bf16 v[56:59], a[168:171], v[40:43], v[56:59]
  ds_read_b128 v[32:35], v1 offset:832
  v_mfma_f32_16x16x32_bf16 v[60:63], a[168:171], v[44:47], v[60:63]
  ds_read_b128 v[36:39], v1 offset:17728
  v_mfma_f32_16x16x32_bf16 v[64:67], a[232:235], v[40:43], v[64:67]
  v_mfma_f32_16x16x32_bf16 v[68:71], a[232:235], v[44:47], v[68:71]
  v_mfma_f32_16x16x32_bf16 v[72:75], v[40:43], v[168:171], v[72:75]
  v_mfma_f32_16x16x32_bf16 v[76:79], v[44:47], v[168:171], v[76:79]
  v_mfma_f32_16x16x32_bf16 v[80:83], v[40:43], v[232:235], v[80:83]
  s_waitcnt lgkmcnt(4)
  v_mfma_f32_16x16x32_bf16 v[84:87], v[44:47], v[232:235], v[84:87]
  v_mfma_f32_16x16x32_bf16 v[56:59], a[172:175], v[48:51], v[56:59]
  ds_read_b128 v[40:43], v1 offset:896
  v_mfma_f32_16x16x32_bf16 v[60:63], a[172:175], v[52:55], v[60:63]
  ds_read_b128 v[44:47], v1 offset:17792
  v_mfma_f32_16x16x32_bf16 v[64:67], a[236:239], v[48:51], v[64:67]
  v_mfma_f32_16x16x32_bf16 v[68:71], a[236:239], v[52:55], v[68:71]
  v_mfma_f32_16x16x32_bf16 v[72:75], v[48:51], v[172:175], v[72:75]
  v_mfma_f32_16x16x32_bf16 v[76:79], v[52:55], v[172:175], v[76:79]
  v_mfma_f32_16x16x32_bf16 v[80:83], v[48:51], v[236:239], v[80:83]
  s_waitcnt lgkmcnt(4)
  v_mfma_f32_16x16x32_bf16 v[84:87], v[52:55], v[236:239], v[84:87]
  s_cmp_eq_u32 s28, 0
  s_cbranch_scc1 Te_qf
  s_waitcnt vmcnt(8)
  s_sub_u32 s47, s25, 512
  v_mov_b32 v8, 1
  s_mov_b64 exec, 1
  buffer_store_dword v8, v7, s[4:7], s47 offen sc1
  s_mov_b64 exec, -1
Te_qf:
  v_mfma_f32_16x16x32_bf16 v[56:59], a[176:179], v[24:27], v[56:59]
  ds_read_b128 v[48:51], v1 offset:960
  v_mfma_f32_16x16x32_bf16 v[60:63], a[176:179], v[28:31], v[60:63]
  ds_read_b128 v[52:55], v1 offset:17856
  v_mfma_f32_16x16x32_bf16 v[64:67], a[240:243], v[24:27], v[64:67]
  v_mfma_f32_16x16x32_bf16 v[68:71], a[240:243], v[28:31], v[68:71]
  v_mfma_f32_16x16x32_bf16 v[72:75], v[24:27], v[176:179], v[72:75]
  v_mfma_f32_16x16x32_bf16 v[76:79], v[28:31], v[176:179], v[76:79]
  v_mfma_f32_16x16x32_bf16 v[80:83], v[24:27], v[240:243], v[80:83]
  s_waitcnt lgkmcnt(4)
  v_mfma_f32_16x16x32_bf16 v[84:87], v[28:31], v[240:243], v[84:87]
  v_mfma_f32_16x16x32_bf16 v[56:59], a[180:183], v[32:35], v[56:59]
  v_mfma_f32_16x16x32_bf16 v[60:63], a[180:183], v[36:39], v[60:63]
  v_mfma_f32_16x16x32_bf16 v[64:67], a[244:247], v[32:35], v[64:67]
  v_mfma_f32_16x16x32_bf16 v[68:71], a[244:247], v[36:39], v[68:71]
  v_mfma_f32_16x16x32_bf16 v[72:75], v[32:35], v[180:183], v[72:75]
  v_mfma_f32_16x16x32_bf16 v[76:79], v[36:39], v[180:183], v[76:79]
  v_mfma_f32_16x16x32_bf16 v[80:83], v[32:35], v[244:247], v[80:83]
  s_waitcnt lgkmcnt(2)
  v_mfma_f32_16x16x32_bf16 v[84:87], v[36:39], v[244:247], v[84:87]
  v_mfma_f32_16x16x32_bf16 v[56:59], a[184:187], v[40:43], v[56:59]
  v_mfma_f32_16x16x32_bf16 v[60:63], a[184:187], v[44:47], v[60:63]
  v_mfma_f32_16x16x32_bf16 v[64:67], a[248:251], v[40:43], v[64:67]
  v_mfma_f32_16x16x32_bf16 v[68:71], a[248:251], v[44:47], v[68:71]
  v_mfma_f32_16x16x32_bf16 v[72:75], v[40:43], v[184:187], v[72:75]
  v_mfma_f32_16x16x32_bf16 v[76:79], v[44:47], v[184:187], v[76:79]
  v_mfma_f32_16x16x32_bf16 v[80:83], v[40:43], v[248:251], v[80:83]
  s_waitcnt lgkmcnt(0)
  v_mfma_f32_16x16x32_bf16 v[84:87], v[44:47], v[248:251], v[84:87]
  v_mfma_f32_16x16x32_bf16 v[56:59], a[188:191], v[48:51], v[56:59]
  v_mfma_f32_16x16x32_bf16 v[60:63], a[188:191], v[52:55], v[60:63]
  v_mfma_f32_16x16x32_bf16 v[64:67], a[252:255], v[48:51], v[64:67]
  v_mfma_f32_16x16x32_bf16 v[68:71], a[252:255], v[52:55], v[68:71]
  v_mfma_f32_16x16x32_bf16 v[72:75], v[48:51], v[188:191], v[72:75]
  v_mfma_f32_16x16x32_bf16 v[76:79], v[52:55], v[188:191], v[76:79]
  v_mfma_f32_16x16x32_bf16 v[80:83], v[48:51], v[252:255], v[80:83]
  v_mfma_f32_16x16x32_bf16 v[84:87], v[52:55], v[252:255], v[84:87]
  buffer_load_dword v20, v6, s[4:7], s20 offen sc1
  ds_read_b128 v[24:27], v1 offset:0
  ds_read_b128 v[28:31], v1 offset:16896
  ds_read_b128 v[32:35], v1 offset:64
  ds_read_b128 v[36:39], v1 offset:16960
  ds_read_b128 v[40:43], v1 offset:128
  ds_read_b128 v[44:47], v1 offset:17024
  s_waitcnt lgkmcnt(4)
  v_mfma_f32_16x16x32_bf16 v[88:91], a[0:3], v[24:27], 0
  ds_read_b128 v[48:51], v1 offset:192
  v_mfma_f32_16x16x32_bf16 v[92:95], a[0:3], v[28:31], 0
  ds_read_b128 v[52:55], v1 offset:17088
  v_mfma_f32_16x16x32_bf16 v[96:99], a[64:67], v[24:27], 0
  s_waitcnt lgkmcnt(4)
  v_mfma_f32_16x16x32_bf16 v[100:103], a[64:67], v[28:31], 0
  v_mfma_f32_16x16x32_bf16 v[88:91], a[4:7], v[32:35], v[88:91]
  ds_read_b128 v[24:27], v1 offset:256
  v_mfma_f32_16x16x32_bf16 v[92:95], a[4:7], v[36:39], v[92:95]
  ds_read_b128 v[28:31], v1 offset:17152
  v_cvt_pk_bf16_f32 v104, v56, v57
  v_mfma_f32_16x16x32_bf16 v[96:99], a[68:71], v[32:35], v[96:99]
  v_cvt_pk_bf16_f32 v105, v58, v59
  s_waitcnt lgkmcnt(4)
  v_mfma_f32_16x16x32_bf16 v[100:103], a[68:71], v[36:39], v[100:103]
  v_cvt_pk_bf16_f32 v106, v64, v65
  v_mfma_f32_16x16x32_bf16 v[88:91], a[8:11], v[40:43], v[88:91]
  ds_read_b128 v[32:35], v1 offset:320
  v_mfma_f32_16x16x32_bf16 v[92:95], a[8:11], v[44:47], v[92:95]
  ds_read_b128 v[36:39], v1 offset:17216
  v_cvt_pk_bf16_f32 v107, v66, v67
  buffer_store_dwordx4 v[104:107], v3, s[4:7], s21 offen sc1
  v_mfma_f32_16x16x32_bf16 v[96:99], a[72:75], v[40:43], v[96:99]
  v_cvt_pk_bf16_f32 v108, v60, v61
  s_waitcnt lgkmcnt(4)
  v_mfma_f32_16x16x32_bf16 v[100:103], a[72:75], v[44:47], v[100:103]
  v_cvt_pk_bf16_f32 v109, v62, v63
  v_mfma_f32_16x16x32_bf16 v[88:91], a[12:15], v[48:51], v[88:91]
  ds_read_b128 v[40:43], v1 offset:384
  v_mfma_f32_16x16x32_bf16 v[92:95], a[12:15], v[52:55], v[92:95]
  ds_read_b128 v[44:47], v1 offset:17280
  v_cvt_pk_bf16_f32 v110, v68, v69
  v_mfma_f32_16x16x32_bf16 v[96:99], a[76:79], v[48:51], v[96:99]
  v_cvt_pk_bf16_f32 v111, v70, v71
  buffer_store_dwordx4 v[108:111], v4, s[4:7], s21 offen sc1
  s_waitcnt lgkmcnt(4)
  v_mfma_f32_16x16x32_bf16 v[100:103], a[76:79], v[52:55], v[100:103]
  v_cvt_pk_bf16_f32 v112, v72, v73
  v_mfma_f32_16x16x32_bf16 v[88:91], a[16:19], v[24:27], v[88:91]
  ds_read_b128 v[48:51], v1 offset:448
  v_mfma_f32_16x16x32_bf16 v[92:95], a[16:19], v[28:31], v[92:95]
  ds_read_b128 v[52:55], v1 offset:17344
  v_cvt_pk_bf16_f32 v113, v74, v75
  v_mfma_f32_16x16x32_bf16 v[96:99], a[80:83], v[24:27], v[96:99]
  v_cvt_pk_bf16_f32 v114, v76, v77
  s_waitcnt lgkmcnt(4)
  v_mfma_f32_16x16x32_bf16 v[100:103], a[80:83], v[28:31], v[100:103]
  v_cvt_pk_bf16_f32 v115, v78, v79
  buffer_store_dwordx4 v[112:115], v5, s[4:7], s22 offen offset:0 sc1
  v_mfma_f32_16x16x32_bf16 v[88:91], a[20:23], v[32:35], v[88:91]
  ds_read_b128 v[24:27], v1 offset:512
  v_mfma_f32_16x16x32_bf16 v[92:95], a[20:23], v[36:39], v[92:95]
  ds_read_b128 v[28:31], v1 offset:17408
  v_cvt_pk_bf16_f32 v116, v80, v81
  v_mfma_f32_16x16x32_bf16 v[96:99], a[84:87], v[32:35], v[96:99]
  v_cvt_pk_bf16_f32 v117, v82, v83
  s_waitcnt lgkmcnt(4)
  v_mfma_f32_16x16x32_bf16 v[100:103], a[84:87], v[36:39], v[100:103]
  v_cvt_pk_bf16_f32 v118, v84, v85
  v_mfma_f32_16x16x32_bf16 v[88:91], a[24:27], v[40:43], v[88:91]
  ds_read_b128 v[32:35], v1 offset:576
  v_mfma_f32_16x16x32_bf16 v[92:95], a[24:27], v[44:47], v[92:95]
  ds_read_b128 v[36:39], v1 offset:17472
  v_cvt_pk_bf16_f32 v119, v86, v87
  buffer_store_dwordx4 v[116:119], v5, s[4:7], s22 offen offset:1024 sc1
  v_mfma_f32_16x16x32_bf16 v[96:99], a[88:91], v[40:43], v[96:99]
  s_waitcnt lgkmcnt(4)
  v_mfma_f32_16x16x32_bf16 v[100:103], a[88:91], v[44:47], v[100:103]
  v_mfma_f32_16x16x32_bf16 v[88:91], a[28:31], v[48:51], v[88:91]
  ds_read_b128 v[40:43], v1 offset:640
  v_mfma_f32_16x16x32_bf16 v[92:95], a[28:31], v[52:55], v[92:95]
  ds_read_b128 v[44:47], v1 offset:17536
  v_mfma_f32_16x16x32_bf16 v[96:99], a[92:95], v[48:51], v[96:99]
  s_waitcnt lgkmcnt(4)
  v_mfma_f32_16x16x32_bf16 v[100:103], a[92:95], v[52:55], v[100:103]
  v_mfma_f32_16x16x32_bf16 v[88:91], a[32:35], v[24:27], v[88:91]
  ds_read_b128 v[48:51], v1 offset:704
  v_mfma_f32_16x16x32_bf16 v[92:95], a[32:35], v[28:31], v[92:95]
  ds_read_b128 v[52:55], v1 offset:17600
  v_mfma_f32_16x16x32_bf16 v[96:99], a[96:99], v[24:27], v[96:99]
  s_waitcnt lgkmcnt(4)
  v_mfma_f32_16x16x32_bf16 v[100:103], a[96:99], v[28:31], v[100:103]
  v_mfma_f32_16x16x32_bf16 v[88:91], a[36:39], v[32:35], v[88:91]
  ds_read_b128 v[24:27], v1 offset:768
  v_mfma_f32_16x16x32_bf16 v[92:95], a[36:39], v[36:39], v[92:95]
  ds_read_b128 v[28:31], v1 offset:17664
  v_mfma_f32_16x16x32_bf16 v[96:99], a[100:103], v[32:35], v[96:99]
  s_waitcnt lgkmcnt(4)
  v_mfma_f32_16x16x32_bf16 v[100:103], a[100:103], v[36:39], v[100:103]
  s_waitcnt vmcnt(4)
  v_cmp_eq_u32 vcc, 0, v20
  s_nop 0
  s_cmp_eq_u32 vcc_hi, 0
  s_cselect_b32 s29, 1, 0
  s_cmp_ge_u32 s18, 62
  s_cselect_b32 s29, 0, s29
  s_cmp_eq_u32 vcc_lo, 0
  s_cselect_b32 s44, 1, 0
  s_mov_b32 s26, 1
  v_mfma_f32_16x16x32_bf16 v[88:91], a[40:43], v[40:43], v[88:91]
  ds_read_b128 v[32:35], v1 offset:832
  v_mfma_f32_16x16x32_bf16 v[92:95], a[40:43], v[44:47], v[92:95]
  ds_read_b128 v[36:39], v1 offset:17728
  v_mfma_f32_16x16x32_bf16 v[96:99], a[104:107], v[40:43], v[96:99]
  s_waitcnt lgkmcnt(4)
  v_mfma_f32_16x16x32_bf16 v[100:103], a[104:107], v[44:47], v[100:103]
  v_mfma_f32_16x16x32_bf16 v[88:91], a[44:47], v[48:51], v[88:91]
  ds_read_b128 v[40:43], v1 offset:896
  v_mfma_f32_16x16x32_bf16 v[92:95], a[44:47], v[52:55], v[92:95]
  ds_read_b128 v[44:47], v1 offset:17792
  v_mfma_f32_16x16x32_bf16 v[96:99], a[108:111], v[48:51], v[96:99]
  s_waitcnt lgkmcnt(4)
  v_mfma_f32_16x16x32_bf16 v[100:103], a[108:111], v[52:55], v[100:103]
  v_mfma_f32_16x16x32_bf16 v[88:91], a[48:51], v[24:27], v[88:91]
  ds_read_b128 v[48:51], v1 offset:960
  v_mfma_f32_16x16x32_bf16 v[92:95], a[48:51], v[28:31], v[92:95]
  ds_read_b128 v[52:55], v1 offset:17856
  v_mfma_f32_16x16x32_bf16 v[96:99], a[112:115], v[24:27], v[96:99]
  s_waitcnt lgkmcnt(4)
  v_mfma_f32_16x16x32_bf16 v[100:103], a[112:115], v[28:31], v[100:103]
  v_mfma_f32_16x16x32_bf16 v[88:91], a[52:55], v[32:35], v[88:91]
  v_mfma_f32_16x16x32_bf16 v[92:95], a[52:55], v[36:39], v[92:95]
  v_mfma_f32_16x16x32_bf16 v[96:99], a[116:119], v[32:35], v[96:99]
  s_waitcnt lgkmcnt(2)
  v_mfma_f32_16x16x32_bf16 v[100:103], a[116:119], v[36:39], v[100:103]
  v_mfma_f32_16x16x32_bf16 v[88:91], a[56:59], v[40:43], v[88:91]
  v_mfma_f32_16x16x32_bf16 v[92:95], a[56:59], v[44:47], v[92:95]
  v_mfma_f32_16x16x32_bf16 v[96:99], a[120:123], v[40:43], v[96:99]
  s_waitcnt lgkmcnt(0)
  v_mfma_f32_16x16x32_bf16 v[100:103], a[120:123], v[44:47], v[100:103]
  v_mfma_f32_16x16x32_bf16 v[88:91], a[60:63], v[48:51], v[88:91]
  v_mfma_f32_16x16x32_bf16 v[92:95], a[60:63], v[52:55], v[92:95]
  v_mfma_f32_16x16x32_bf16 v[96:99], a[124:127], v[48:51], v[96:99]
  v_mfma_f32_16x16x32_bf16 v[100:103], a[124:127], v[52:55], v[100:103]
  s_nop 5
  v_cvt_pk_bf16_f32 v104, v88, v89
  v_cvt_pk_bf16_f32 v105, v90, v91
  v_cvt_pk_bf16_f32 v106, v96, v97
  v_cvt_pk_bf16_f32 v107, v98, v99
  buffer_store_dwordx4 v[104:107], v3, s[4:7], s23 offen sc1
  v_cvt_pk_bf16_f32 v108, v92, v93
  v_cvt_pk_bf16_f32 v109, v94, v95
  v_cvt_pk_bf16_f32 v110, v100, v101
  v_cvt_pk_bf16_f32 v111, v102, v103
  buffer_store_dwordx4 v[108:111], v4, s[4:7], s23 offen sc1
  s_mov_b32 s34, 1
  s_mov_b32 s28, 1
  s_cmp_eq_u32 s18, 63
  s_cbranch_scc1 T_end
T_go:
  s_sub_u32 s46, 33792, s27
  s_sub_u32 s44, s46, s27
  v_add_u32 v1, s44, v1
  s_mov_b32 s27, s46
  s_add_u32 s18, s18, 1
  s_add_u32 s21, s21, 262144
  s_add_u32 s22, s22, 262144
  s_add_u32 s23, s23, 262144
  s_add_u32 s24, s24, 512
  s_add_u32 s25, s25, 512
  s_barrier
  s_branch T_item
T_end:
  s_waitcnt vmcnt(0)
  v_mov_b32 v8, 1
  s_mov_b64 exec, 1
  buffer_store_dword v8, v7, s[4:7], s24 offen sc1
  s_mov_b64 exec, -1
  v_mov_b32 v8, 1
  s_mov_b64 exec, 1
  buffer_store_dword v8, v7, s[4:7], s25 offen sc1
  s_mov_b64 exec, -1
  s_waitcnt vmcnt(0)
  s_endpgm
Aq_entry:
  s_lshr_b32 s19, s13, 4
  s_and_b32 s18, s13, 15
  s_load_dwordx2 s[8:9], s[0:1], 8
  s_waitcnt lgkmcnt(0)
  s_mov_b32 s10, 1572864
  s_mov_b32 s11, 0x20000
  v_lshrrev_b32 v16, 2, v0
  v_mul_u32_u24 v16, 3072, v16
  v_and_b32 v17, 3, v0
  v_lshl_add_u32 v16, v17, 4, v16
  s_lshl_b32 s16, s18, 6
  s_mul_i32 s17, s12, 393216
  s_add_u32 s16, s16, s17
  s_lshl_b32 s17, s12, 13
  s_add_u32 s20, s17, 0
  s_mov_b32 m0, s20
  s_add_u32 s21, s16, 0
  buffer_load_dwordx4 v16, s[8:11], s21 offen lds
  s_add_u32 s20, s17, 1024
  s_mov_b32 m0, s20
  s_add_u32 s21, s16, 49152
  buffer_load_dwordx4 v16, s[8:11], s21 offen lds
  s_add_u32 s20, s17, 2048
  s_mov_b32 m0, s20
  s_add_u32 s21, s16, 98304
  buffer_load_dwordx4 v16, s[8:11], s21 offen lds
  s_add_u32 s20, s17, 3072
  s_mov_b32 m0, s20
  s_add_u32 s21, s16, 147456
  buffer_load_dwordx4 v16, s[8:11], s21 offen lds
  s_add_u32 s20, s17, 4096
  s_mov_b32 m0, s20
  s_add_u32 s21, s16, 196608
  buffer_load_dwordx4 v16, s[8:11], s21 offen lds
  s_add_u32 s20, s17, 5120
  s_mov_b32 m0, s20
  s_add_u32 s21, s16, 245760
  buffer_load_dwordx4 v16, s[8:11], s21 offen lds
  s_add_u32 s20, s17, 6144
  s_mov_b32 m0, s20
  s_add_u32 s21, s16, 294912
  buffer_load_dwordx4 v16, s[8:11], s21 offen lds
  s_add_u32 s20, s17, 7168
  s_mov_b32 m0, s20
  s_add_u32 s21, s16, 344064
  buffer_load_dwordx4 v16, s[8:11], s21 offen lds
  s_add_u32 s20, s17, 32768
  s_mov_b32 m0, s20
  s_add_u32 s21, s16, 1024
  buffer_load_dwordx4 v16, s[8:11], s21 offen lds
  s_add_u32 s20, s17, 33792
  s_mov_b32 m0, s20
  s_add_u32 s21, s16, 50176
  buffer_load_dwordx4 v16, s[8:11], s21 offen lds
  s_add_u32 s20, s17, 34816
  s_mov_b32 m0, s20
  s_add_u32 s21, s16, 99328
  buffer_load_dwordx4 v16, s[8:11], s21 offen lds
  s_add_u32 s20, s17, 35840
  s_mov_b32 m0, s20
  s_add_u32 s21, s16, 148480
  buffer_load_dwordx4 v16, s[8:11], s21 offen lds
  s_add_u32 s20, s17, 36864
  s_mov_b32 m0, s20
  s_add_u32 s21, s16, 197632
  buffer_load_dwordx4 v16, s[8:11], s21 offen lds
  s_add_u32 s20, s17, 37888
  s_mov_b32 m0, s20
  s_add_u32 s21, s16, 246784
  buffer_load_dwordx4 v16, s[8:11], s21 offen lds
  s_add_u32 s20, s17, 38912
  s_mov_b32 m0, s20
  s_add_u32 s21, s16, 295936
  buffer_load_dwordx4 v16, s[8:11], s21 offen lds
  s_add_u32 s20, s17, 39936
  s_mov_b32 m0, s20
  s_add_u32 s21, s16, 345088
  buffer_load_dwordx4 v16, s[8:11], s21 offen lds
  s_add_u32 s20, s17, 65536
  s_mov_b32 m0, s20
  s_add_u32 s21, s16, 2048
  buffer_load_dwordx4 v16, s[8:11], s21 offen lds
  s_add_u32 s20, s17, 66560
  s_mov_b32 m0, s20
  s_add_u32 s21, s16, 51200
  buffer_load_dwordx4 v16, s[8:11], s21 offen lds
  s_add_u32 s20, s17, 67584
  s_mov_b32 m0, s20
  s_add_u32 s21, s16, 100352
  buffer_load_dwordx4 v16, s[8:11], s21 offen lds
  s_add_u32 s20, s17, 68608
  s_mov_b32 m0, s20
  s_add_u32 s21, s16, 149504
  buffer_load_dwordx4 v16, s[8:11], s21 offen lds
  s_add_u32 s20, s17, 69632
  s_mov_b32 m0, s20
  s_add_u32 s21, s16, 198656
  buffer_load_dwordx4 v16, s[8:11], s21 offen lds
  s_add_u32 s20, s17, 70656
  s_mov_b32 m0, s20
  s_add_u32 s21, s16, 247808
  buffer_load_dwordx4 v16, s[8:11], s21 offen lds
  s_add_u32 s20, s17, 71680
  s_mov_b32 m0, s20
  s_add_u32 s21, s16, 296960
  buffer_load_dwordx4 v16, s[8:11], s21 offen lds
  s_add_u32 s20, s17, 72704
  s_mov_b32 m0, s20
  s_add_u32 s21, s16, 346112
  buffer_load_dwordx4 v16, s[8:11], s21 offen lds
  v_lshrrev_b32 v17, 4, v0
  v_bfe_u32 v18, v0, 2, 2
  v_lshl_add_u32 v17, v17, 3, v18
  v_lshlrev_b32 v17, 6, v17
  v_and_b32 v18, 3, v0
  v_lshl_add_u32 v17, v18, 3, v17
  s_lshr_b32 s16, s12, 1
  s_lshl_b32 s16, s16, 5
  v_add_u32 v17, s16, v17
  v_add_u32 v18, 0x10000, v17
  s_waitcnt vmcnt(0)
  s_barrier
  ds_read_b64_tr_b16 a[0:1], v17 offset:0
  ds_read_b64_tr_b16 a[2:3], v17 offset:256
  ds_read_b64_tr_b16 a[4:5], v17 offset:2048
  ds_read_b64_tr_b16 a[6:7], v17 offset:2304
  ds_read_b64_tr_b16 a[8:9], v17 offset:4096
  ds_read_b64_tr_b16 a[10:11], v17 offset:4352
  ds_read_b64_tr_b16 a[12:13], v17 offset:6144
  ds_read_b64_tr_b16 a[14:15], v17 offset:6400
  ds_read_b64_tr_b16 a[16:17], v17 offset:8192
  ds_read_b64_tr_b16 a[18:19], v17 offset:8448
  ds_read_b64_tr_b16 a[20:21], v17 offset:10240
  ds_read_b64_tr_b16 a[22:23], v17 offset:10496
  ds_read_b64_tr_b16 a[24:25], v17 offset:12288
  ds_read_b64_tr_b16 a[26:27], v17 offset:12544
  ds_read_b64_tr_b16 a[28:29], v17 offset:14336
  ds_read_b64_tr_b16 a[30:31], v17 offset:14592
  ds_read_b64_tr_b16 a[32:33], v17 offset:16384
  ds_read_b64_tr_b16 a[34:35], v17 offset:16640
  ds_read_b64_tr_b16 a[36:37], v17 offset:18432
  ds_read_b64_tr_b16 a[38:39], v17 offset:18688
  ds_read_b64_tr_b16 a[40:41], v17 offset:20480
  ds_read_b64_tr_b16 a[42:43], v17 offset:20736
  ds_read_b64_tr_b16 a[44:45], v17 offset:22528
  ds_read_b64_tr_b16 a[46:47], v17 offset:22784
  ds_read_b64_tr_b16 a[48:49], v17 offset:24576
  ds_read_b64_tr_b16 a[50:51], v17 offset:24832
  ds_read_b64_tr_b16 a[52:53], v17 offset:26624
  ds_read_b64_tr_b16 a[54:55], v17 offset:26880
  ds_read_b64_tr_b16 a[56:57], v17 offset:28672
  ds_read_b64_tr_b16 a[58:59], v17 offset:28928
  ds_read_b64_tr_b16 a[60:61], v17 offset:30720
  ds_read_b64_tr_b16 a[62:63], v17 offset:30976
  ds_read_b64_tr_b16 a[64:65], v17 offset:32768
  ds_read_b64_tr_b16 a[66:67], v17 offset:33024
  ds_read_b64_tr_b16 a[68:69], v17 offset:34816
  ds_read_b64_tr_b16 a[70:71], v17 offset:35072
  ds_read_b64_tr_b16 a[72:73], v17 offset:36864
  ds_read_b64_tr_b16 a[74:75], v17 offset:37120
  ds_read_b64_tr_b16 a[76:77], v17 offset:38912
  ds_read_b64_tr_b16 a[78:79], v17 offset:39168
  ds_read_b64_tr_b16 a[80:81], v17 offset:40960
  ds_read_b64_tr_b16 a[82:83], v17 offset:41216
  ds_read_b64_tr_b16 a[84:85], v17 offset:43008
  ds_read_b64_tr_b16 a[86:87], v17 offset:43264
  ds_read_b64_tr_b16 a[88:89], v17 offset:45056
  ds_read_b64_tr_b16 a[90:91], v17 offset:45312
  ds_read_b64_tr_b16 a[92:93], v17 offset:47104
  ds_read_b64_tr_b16 a[94:95], v17 offset:47360
  ds_read_b64_tr_b16 a[96:97], v17 offset:49152
  ds_read_b64_tr_b16 a[98:99], v17 offset:49408
  ds_read_b64_tr_b16 a[100:101], v17 offset:51200
  ds_read_b64_tr_b16 a[102:103], v17 offset:51456
  ds_read_b64_tr_b16 a[104:105], v17 offset:53248
  ds_read_b64_tr_b16 a[106:107], v17 offset:53504
  ds_read_b64_tr_b16 a[108:109], v17 offset:55296
  ds_read_b64_tr_b16 a[110:111], v17 offset:55552
  ds_read_b64_tr_b16 a[112:113], v17 offset:57344
  ds_read_b64_tr_b16 a[114:115], v17 offset:57600
  ds_read_b64_tr_b16 a[116:117], v17 offset:59392
  ds_read_b64_tr_b16 a[118:119], v17 offset:59648
  ds_read_b64_tr_b16 a[120:121], v17 offset:61440
  ds_read_b64_tr_b16 a[122:123], v17 offset:61696
  ds_read_b64_tr_b16 a[124:125], v17 offset:63488
  ds_read_b64_tr_b16 a[126:127], v17 offset:63744
  ds_read_b64_tr_b16 a[128:129], v18 offset:0
  ds_read_b64_tr_b16 a[130:131], v18 offset:256
  ds_read_b64_tr_b16 a[132:133], v18 offset:2048
  ds_read_b64_tr_b16 a[134:135], v18 offset:2304
  ds_read_b64_tr_b16 a[136:137], v18 offset:4096
  ds_read_b64_tr_b16 a[138:139], v18 offset:4352
  ds_read_b64_tr_b16 a[140:141], v18 offset:6144
  ds_read_b64_tr_b16 a[142:143], v18 offset:6400
  ds_read_b64_tr_b16 a[144:145], v18 offset:8192
  ds_read_b64_tr_b16 a[146:147], v18 offset:8448
  ds_read_b64_tr_b16 a[148:149], v18 offset:10240
  ds_read_b64_tr_b16 a[150:151], v18 offset:10496
  ds_read_b64_tr_b16 a[152:153], v18 offset:12288
  ds_read_b64_tr_b16 a[154:155], v18 offset:12544
  ds_read_b64_tr_b16 a[156:157], v18 offset:14336
  ds_read_b64_tr_b16 a[158:159], v18 offset:14592
  ds_read_b64_tr_b16 a[160:161], v18 offset:16384
  ds_read_b64_tr_b16 a[162:163], v18 offset:16640
  ds_read_b64_tr_b16 a[164:165], v18 offset:18432
  ds_read_b64_tr_b16 a[166:167], v18 offset:18688
  ds_read_b64_tr_b16 a[168:169], v18 offset:20480
  ds_read_b64_tr_b16 a[170:171], v18 offset:20736
  ds_read_b64_tr_b16 a[172:173], v18 offset:22528
  ds_read_b64_tr_b16 a[174:175], v18 offset:22784
  ds_read_b64_tr_b16 a[176:177], v18 offset:24576
  ds_read_b64_tr_b16 a[178:179], v18 offset:24832
  ds_read_b64_tr_b16 a[180:181], v18 offset:26624
  ds_read_b64_tr_b16 a[182:183], v18 offset:26880
  ds_read_b64_tr_b16 a[184:185], v18 offset:28672
  ds_read_b64_tr_b16 a[186:187], v18 offset:28928
  ds_read_b64_tr_b16 a[188:189], v18 offset:30720
  ds_read_b64_tr_b16 a[190:191], v18 offset:30976
  s_waitcnt lgkmcnt(0)
  s_barrier
  v_and_b32 v16, 15, v0
  v_lshrrev_b32 v17, 4, v0
  v_lshlrev_b32 v1, 4, v0
  s_and_b32 s19, s12, 1
  s_lshl_b32 s29, s19, 3
  s_lshl_b32 s16, s19, 14
  s_add_u32 s16, s16, 40960
  v_add_u32 v18, 0, v17
  v_xor_b32 v18, v18, v16
  v_lshlrev_b32 v58, 4, v18
  v_lshl_add_u32 v58, v16, 10, v58
  v_add_u32 v58, s16, v58
  v_add_u32 v18, 4, v17
  v_xor_b32 v18, v18, v16
  v_lshlrev_b32 v59, 4, v18
  v_lshl_add_u32 v59, v16, 10, v59
  v_add_u32 v59, s16, v59
  v_add_u32 v18, 8, v17
  v_xor_b32 v18, v18, v16
  v_lshlrev_b32 v60, 4, v18
  v_lshl_add_u32 v60, v16, 10, v60
  v_add_u32 v60, s16, v60
  v_add_u32 v18, 12, v17
  v_xor_b32 v18, v18, v16
  v_lshlrev_b32 v61, 4, v18
  v_lshl_add_u32 v61, v16, 10, v61
  v_add_u32 v61, s16, v61
  s_lshl_b32 s16, s19, 3
  s_add_u32 s17, s16, 0
  v_xor_b32 v18, s17, v0
  v_lshlrev_b32 v62, 4, v18
  s_add_u32 s17, s16, 1
  v_xor_b32 v18, s17, v0
  v_lshlrev_b32 v63, 4, v18
  s_add_u32 s17, s16, 2
  v_xor_b32 v18, s17, v0
  v_lshlrev_b32 v64, 4, v18
  s_add_u32 s17, s16, 3
  v_xor_b32 v18, s17, v0
  v_lshlrev_b32 v65, 4, v18
  s_add_u32 s17, s16, 4
  v_xor_b32 v18, s17, v0
  v_lshlrev_b32 v66, 4, v18
  s_add_u32 s17, s16, 5
  v_xor_b32 v18, s17, v0
  v_lshlrev_b32 v67, 4, v18
  s_add_u32 s17, s16, 6
  v_xor_b32 v18, s17, v0
  v_lshlrev_b32 v68, 4, v18
  s_add_u32 s17, s16, 7
  v_xor_b32 v18, s17, v0
  v_lshlrev_b32 v69, 4, v18
  v_lshlrev_b32 v2, 2, v0
  v_mov_b32 v6, 0
  v_lshrrev_b32 v18, 3, v16
  v_lshlrev_b32 v5, 13, v18
  v_and_b32 v18, 3, v16
  v_lshl_add_u32 v5, v18, 6, v5
  v_bfe_u32 v18, v16, 2, 1
  v_lshl_add_u32 v5, v18, 4, v5
  v_lshl_add_u32 v5, v17, 2, v5
  s_lshl_b32 s16, s19, 14
  s_lshl_b32 s17, s18, 1
  s_lshr_b32 s20, s12, 1
  s_add_u32 s17, s17, s20
  s_lshl_b32 s20, s17, 8
  s_add_u32 s16, s16, s20
  v_add_u32 v5, s16, v5
  s_lshl_b32 s17, s17, 1
  s_add_u32 s17, s17, s19
  s_lshl_b32 s17, s17, 2
  v_mov_b32 v7, s17
  v_lshlrev_b32 v18, 2, v17
  v_sub_u32 v18, v16, v18
  s_lshl_b32 s16, s19, 4
  v_add_u32 v18, s16, v18
  v_cmp_gt_i32 s[30:31], 0, v18
  v_cmp_gt_i32 s[32:33], 1, v18
  v_cmp_gt_i32 s[34:35], 2, v18
  v_cmp_gt_i32 s[36:37], 3, v18
  v_cmp_gt_i32 s[38:39], 16, v18
  v_cmp_gt_i32 s[40:41], 17, v18
  v_cmp_gt_i32 s[42:43], 18, v18
  v_cmp_gt_i32 s[44:45], 19, v18
  s_lshr_b32 s16, s12, 1
  s_mul_i32 s16, s16, 9216
  s_add_u32 s17, s16, 0
  v_add_u32 v48, s17, v1
  s_add_u32 s17, s16, 1024
  v_add_u32 v49, s17, v1
  s_add_u32 s17, s16, 2048
  v_add_u32 v50, s17, v1
  s_add_u32 s17, s16, 3072
  v_add_u32 v51, s17, v1
  s_add_u32 s17, s16, 4096
  v_add_u32 v52, s17, v1
  s_add_u32 s17, s16, 5120
  v_add_u32 v53, s17, v1
  s_add_u32 s17, s16, 6144
  v_add_u32 v54, s17, v1
  s_add_u32 s17, s16, 7168
  v_add_u32 v55, s17, v1
  s_add_u32 s17, s16, 8192
  v_add_u32 v56, s17, v1
  v_mov_b32 v20, 0
  v_mov_b32 v21, 0
  v_mov_b32 v22, 0
  v_mov_b32 v23, 0
  s_lshl_b32 s16, s12, 10
  v_add_u32 v18, s16, v1
  ds_write_b128 v18, v[20:23] offset:0
  ds_write_b128 v18, v[20:23] offset:4096
  ds_write_b128 v18, v[20:23] offset:8192
  ds_write_b128 v18, v[20:23] offset:12288
  ds_write_b128 v18, v[20:23] offset:16384
  ds_write_b128 v18, v[20:23] offset:20480
  ds_write_b128 v18, v[20:23] offset:24576
  ds_write_b128 v18, v[20:23] offset:28672
  ds_write_b128 v18, v[20:23] offset:32768
  s_mov_b32 s25, 0x3eb8aa3b
  s_lshr_b32 s19, s13, 4
  s_mul_i32 s20, s19, 4194304
  s_add_u32 s20, s20, 8388608
  s_mov_b32 s21, 4505600
  s_mul_i32 s22, s19, 2097152
  s_add_u32 s22, s22, 25165824
  s_mul_i32 s23, s19, 16384
  s_add_u32 s23, s23, 4456448
  s_mov_b32 s18, 0
  s_mov_b32 s24, 40960
  s_mov_b32 s27, 0
  s_waitcnt lgkmcnt(0)
  s_barrier
  s_mov_b32 s76, 0
  s_cmp_eq_u32 s19, 0
  s_cbranch_scc1 Aq_f0
Aq_w0:
  buffer_load_dword v15, v2, s[4:7], s21 offen sc1
  s_waitcnt vmcnt(0)
  v_cmp_eq_u32 vcc, 0, v15
  s_nop 0
  s_cmp_eq_u32 vcc_lo, 0
  s_cbranch_scc1 Aq_f0
  s_sleep 24
  s_sub_u32 s15, s15, 1
  s_cbranch_scc0 Aq_w0
Aq_f0:
  s_lshl_b32 s46, s12, 13
  s_add_u32 s47, s46, s24
  s_add_u32 s46, s46, s20
  s_mov_b32 m0, s47
  s_nop 0
  buffer_load_dwordx4 v62, s[4:7], s46 offen offset:0 sc1 lds
  buffer_load_dwordx4 v63, s[4:7], s46 offen offset:1024 sc1 lds
  buffer_load_dwordx4 v64, s[4:7], s46 offen offset:2048 sc1 lds
  buffer_load_dwordx4 v65, s[4:7], s46 offen offset:3072 sc1 lds
  s_add_u32 m0, s47, 4096
  s_add_u32 s46, s46, 4096
  buffer_load_dwordx4 v66, s[4:7], s46 offen offset:0 sc1 lds
  buffer_load_dwordx4 v67, s[4:7], s46 offen offset:1024 sc1 lds
  buffer_load_dwordx4 v68, s[4:7], s46 offen offset:2048 sc1 lds
  buffer_load_dwordx4 v69, s[4:7], s46 offen offset:3072 sc1 lds
  s_waitcnt vmcnt(0)
  s_barrier
Aq_item:
  s_cmp_lg_u32 s76, 0
  s_cbranch_scc1 Aq_early
  ds_read_b128 v[16:19], v58 offset:0
  ds_read_b128 v[20:23], v59 offset:0
  ds_read_b128 v[24:27], v60 offset:0
  s_waitcnt lgkmcnt(2)
  v_mfma_f32_16x16x32_bf16 v[32:35], a[64:67], v[16:19], 0
  ds_read_b128 v[28:31], v61 offset:0
  v_mfma_f32_16x16x32_bf16 v[40:43], v[16:19], a[128:131], 0
  s_waitcnt lgkmcnt(2)
  s_add_u32 s21, s21, 128
  v_mfma_f32_16x16x32_bf16 v[36:39], a[0:3], v[16:19], 0
  s_mov_b32 s28, s20
  v_mfma_f32_16x16x32_bf16 v[32:35], a[68:71], v[20:23], v[32:35]
  ds_read_b128 v[16:19], v58 offset:256
  v_mfma_f32_16x16x32_bf16 v[40:43], v[20:23], a[132:135], v[40:43]
  s_waitcnt lgkmcnt(2)
  s_add_u32 s20, s20, 32768
  v_mfma_f32_16x16x32_bf16 v[36:39], a[4:7], v[20:23], v[36:39]
  v_mov_b32 v57, v48
  v_mfma_f32_16x16x32_bf16 v[32:35], a[72:75], v[24:27], v[32:35]
  ds_read_b128 v[20:23], v59 offset:256
  v_mfma_f32_16x16x32_bf16 v[40:43], v[24:27], a[136:139], v[40:43]
  s_waitcnt lgkmcnt(2)
  v_mov_b32 v48, v49
  v_mfma_f32_16x16x32_bf16 v[36:39], a[8:11], v[24:27], v[36:39]
  v_mov_b32 v49, v50
  v_mfma_f32_16x16x32_bf16 v[32:35], a[76:79], v[28:31], v[32:35]
  ds_read_b128 v[24:27], v60 offset:256
  v_mfma_f32_16x16x32_bf16 v[40:43], v[28:31], a[140:143], v[40:43]
  s_waitcnt lgkmcnt(2)
  v_mov_b32 v50, v51
  v_mfma_f32_16x16x32_bf16 v[36:39], a[12:15], v[28:31], v[36:39]
  v_mov_b32 v51, v52
  v_mfma_f32_16x16x32_bf16 v[32:35], a[80:83], v[16:19], v[32:35]
  ds_read_b128 v[28:31], v61 offset:256
  v_mfma_f32_16x16x32_bf16 v[40:43], v[16:19], a[144:147], v[40:43]
  s_waitcnt lgkmcnt(2)
  v_mov_b32 v52, v53
  v_mfma_f32_16x16x32_bf16 v[36:39], a[16:19], v[16:19], v[36:39]
  v_mov_b32 v53, v54
  v_mfma_f32_16x16x32_bf16 v[32:35], a[84:87], v[20:23], v[32:35]
  ds_read_b128 v[16:19], v58 offset:512
  v_mfma_f32_16x16x32_bf16 v[40:43], v[20:23], a[148:151], v[40:43]
  s_waitcnt lgkmcnt(2)
  v_mov_b32 v54, v55
  v_mfma_f32_16x16x32_bf16 v[36:39], a[20:23], v[20:23], v[36:39]
  v_mov_b32 v55, v56
  v_mfma_f32_16x16x32_bf16 v[32:35], a[88:91], v[24:27], v[32:35]
  ds_read_b128 v[20:23], v59 offset:512
  v_mfma_f32_16x16x32_bf16 v[40:43], v[24:27], a[152:155], v[40:43]
  s_waitcnt lgkmcnt(2)
  v_mov_b32 v56, v57
  v_mfma_f32_16x16x32_bf16 v[36:39], a[24:27], v[24:27], v[36:39]
  v_add_u32 v57, s29, v57
  v_mfma_f32_16x16x32_bf16 v[32:35], a[92:95], v[28:31], v[32:35]
  ds_read_b128 v[24:27], v60 offset:512
  v_mfma_f32_16x16x32_bf16 v[40:43], v[28:31], a[156:159], v[40:43]
  s_waitcnt lgkmcnt(2)
  ds_read_b128 v[72:75], v48 offset:0
  v_mfma_f32_16x16x32_bf16 v[36:39], a[28:31], v[28:31], v[36:39]
  ds_read_b128 v[76:79], v49 offset:0
  v_mfma_f32_16x16x32_bf16 v[32:35], a[96:99], v[16:19], v[32:35]
  ds_read_b128 v[28:31], v61 offset:512
  v_mfma_f32_16x16x32_bf16 v[40:43], v[16:19], a[160:163], v[40:43]
  s_waitcnt lgkmcnt(4)
  ds_read_b128 v[80:83], v50 offset:0
  v_mfma_f32_16x16x32_bf16 v[36:39], a[32:35], v[16:19], v[36:39]
  ds_read_b128 v[84:87], v51 offset:0
  v_mfma_f32_16x16x32_bf16 v[32:35], a[100:103], v[20:23], v[32:35]
  ds_read_b128 v[16:19], v58 offset:768
  v_mfma_f32_16x16x32_bf16 v[40:43], v[20:23], a[164:167], v[40:43]
  s_waitcnt lgkmcnt(6)
  ds_read_b128 v[88:91], v52 offset:0
  v_mfma_f32_16x16x32_bf16 v[36:39], a[36:39], v[20:23], v[36:39]
  ds_read_b128 v[92:95], v53 offset:0
  v_mfma_f32_16x16x32_bf16 v[32:35], a[104:107], v[24:27], v[32:35]
  ds_read_b128 v[20:23], v59 offset:768
  v_mfma_f32_16x16x32_bf16 v[40:43], v[24:27], a[168:171], v[40:43]
  s_waitcnt lgkmcnt(6)
  ds_read_b128 v[96:99], v54 offset:0
  v_mfma_f32_16x16x32_bf16 v[36:39], a[40:43], v[24:27], v[36:39]
  ds_read_b128 v[100:103], v55 offset:0
  v_mfma_f32_16x16x32_bf16 v[32:35], a[108:111], v[28:31], v[32:35]
  ds_read_b128 v[24:27], v60 offset:768
  v_mfma_f32_16x16x32_bf16 v[40:43], v[28:31], a[172:175], v[40:43]
  s_waitcnt lgkmcnt(6)
  ds_read_b128 v[108:111], v48 offset:18432
  v_mfma_f32_16x16x32_bf16 v[36:39], a[44:47], v[28:31], v[36:39]
  ds_read_b128 v[112:115], v49 offset:18432
  v_mfma_f32_16x16x32_bf16 v[32:35], a[112:115], v[16:19], v[32:35]
  ds_read_b128 v[28:31], v61 offset:768
  v_mfma_f32_16x16x32_bf16 v[40:43], v[16:19], a[176:179], v[40:43]
  s_waitcnt lgkmcnt(6)
  ds_read_b128 v[116:119], v50 offset:18432
  v_mfma_f32_16x16x32_bf16 v[36:39], a[48:51], v[16:19], v[36:39]
  ds_read_b128 v[120:123], v51 offset:18432
  v_mfma_f32_16x16x32_bf16 v[32:35], a[116:119], v[20:23], v[32:35]
  v_mfma_f32_16x16x32_bf16 v[40:43], v[20:23], a[180:183], v[40:43]
  s_waitcnt lgkmcnt(5)
  ds_read_b128 v[124:127], v52 offset:18432
  v_mfma_f32_16x16x32_bf16 v[36:39], a[52:55], v[20:23], v[36:39]
  ds_read_b128 v[128:131], v53 offset:18432
  v_mfma_f32_16x16x32_bf16 v[32:35], a[120:123], v[24:27], v[32:35]
  v_mfma_f32_16x16x32_bf16 v[40:43], v[24:27], a[184:187], v[40:43]
  s_waitcnt lgkmcnt(4)
  ds_read_b128 v[132:135], v54 offset:18432
  v_mfma_f32_16x16x32_bf16 v[36:39], a[56:59], v[24:27], v[36:39]
  ds_read_b128 v[136:139], v55 offset:18432
  v_mfma_f32_16x16x32_bf16 v[32:35], a[124:127], v[28:31], v[32:35]
  v_mfma_f32_16x16x32_bf16 v[40:43], v[28:31], a[188:191], v[40:43]
  v_mfma_f32_16x16x32_bf16 v[36:39], a[60:63], v[28:31], v[36:39]
  s_nop 4
  v_cvt_pk_bf16_f32 v10, v32, v33
  v_cvt_pk_bf16_f32 v11, v34, v35
  ds_write_b64 v57, v[10:11] offset:0
  v_cvt_pk_bf16_f32 v12, v40, v41
  v_cvt_pk_bf16_f32 v13, v42, v43
  ds_write_b64 v57, v[12:13] offset:18432
  v_cvt_pk_bf16_f32 v44, v36, v37
  v_cvt_pk_bf16_f32 v45, v38, v39
  s_cmp_eq_u32 s27, 0
  s_cbranch_scc1 Aql_mid
  s_waitcnt vmcnt(0)
  v_mov_b32 v8, 1
  s_sub_u32 s48, s23, 256
  s_mov_b64 exec, 1
  buffer_store_dword v8, v7, s[4:7], s48 offen sc1
  s_mov_b64 exec, -1
  s_mov_b32 s27, 0
Aql_mid:
  v_mov_b32 v9, 0xff800000
  s_cmp_lt_u32 s18, 8
  s_cbranch_scc1 Aql_start
  v_mfma_f32_16x16x16_bf16 v[144:147], v[72:73], v[44:45], 0
  v_mfma_f32_16x16x16_bf16 v[148:151], v[74:75], v[44:45], 0
  v_mfma_f32_16x16x16_bf16 v[152:155], v[76:77], v[44:45], 0
  v_mfma_f32_16x16x16_bf16 v[156:159], v[78:79], v[44:45], 0
  v_mfma_f32_16x16x16_bf16 v[160:163], v[80:81], v[44:45], 0
  v_mfma_f32_16x16x16_bf16 v[164:167], v[82:83], v[44:45], 0
  v_mfma_f32_16x16x16_bf16 v[168:171], v[84:85], v[44:45], 0
  v_mfma_f32_16x16x16_bf16 v[172:175], v[86:87], v[44:45], 0
  v_mfma_f32_16x16x16_bf16 v[176:179], v[88:89], v[44:45], 0
  v_max3_f32 v11, v152, v153, v154
  v_max3_f32 v12, v155, v156, v157
  v_mfma_f32_16x16x16_bf16 v[180:183], v[90:91], v[44:45], 0
  v_max3_f32 v11, v11, v158, v159
  v_mfma_f32_16x16x16_bf16 v[184:187], v[92:93], v[44:45], 0
  v_max3_f32 v11, v11, v160, v161
  v_max3_f32 v12, v12, v162, v163
  v_mfma_f32_16x16x16_bf16 v[188:191], v[94:95], v[44:45], 0
  v_max3_f32 v11, v11, v164, v165
  v_max3_f32 v12, v12, v166, v167
  v_mfma_f32_16x16x16_bf16 v[192:195], v[96:97], v[44:45], 0
  v_max3_f32 v11, v11, v168, v169
  v_max3_f32 v12, v12, v170, v171
  v_mfma_f32_16x16x16_bf16 v[196:199], v[98:99], v[44:45], 0
  v_max3_f32 v11, v11, v172, v173
  v_max3_f32 v12, v12, v174, v175
  v_mfma_f32_16x16x16_bf16 v[200:203], v[100:101], v[44:45], 0
  v_max3_f32 v11, v11, v176, v177
  v_max3_f32 v12, v12, v178, v179
  v_mfma_f32_16x16x16_bf16 v[204:207], v[102:103], v[44:45], 0
  v_max3_f32 v11, v11, v180, v181
  v_max3_f32 v12, v12, v182, v183
  s_nop 3
  v_cndmask_b32 v144, v9, v144, s[30:31]
  v_cndmask_b32 v145, v9, v145, s[32:33]
  v_cndmask_b32 v146, v9, v146, s[34:35]
  v_cndmask_b32 v147, v9, v147, s[36:37]
  v_cndmask_b32 v148, v9, v148, s[38:39]
  v_cndmask_b32 v149, v9, v149, s[40:41]
  v_cndmask_b32 v150, v9, v150, s[42:43]
  v_cndmask_b32 v151, v9, v151, s[44:45]
  v_max3_f32 v11, v11, v184, v185
  v_max3_f32 v12, v12, v186, v187
  v_max3_f32 v11, v11, v188, v189
  v_max3_f32 v12, v12, v190, v191
  v_max3_f32 v11, v11, v192, v193
  v_max3_f32 v12, v12, v194, v195
  v_max3_f32 v11, v11, v196, v197
  v_max3_f32 v12, v12, v198, v199
  v_max3_f32 v11, v11, v200, v201
  v_max3_f32 v12, v12, v202, v203
  v_max3_f32 v11, v11, v204, v205
  v_max3_f32 v12, v12, v206, v207
Aql_mxdone:
  v_max3_f32 v11, v11, v144, v145
  v_max3_f32 v12, v12, v146, v147
  v_max3_f32 v11, v11, v148, v149
  v_max3_f32 v12, v12, v150, v151
  s_waitcnt lgkmcnt(0)
  s_barrier
  ds_read_b128 v[104:107], v56 offset:0
  ds_read_b128 v[140:143], v56 offset:18432
  s_waitcnt lgkmcnt(1)
  v_mfma_f32_16x16x16_bf16 v[208:211], v[104:105], v[44:45], 0
  v_mfma_f32_16x16x16_bf16 v[212:215], v[106:107], v[44:45], 0
  s_nop 7
  v_cndmask_b32 v208, v208, v9, s[30:31]
  v_cndmask_b32 v209, v209, v9, s[32:33]
  v_cndmask_b32 v210, v210, v9, s[34:35]
  v_cndmask_b32 v211, v211, v9, s[36:37]
  v_cndmask_b32 v212, v212, v9, s[38:39]
  v_cndmask_b32 v213, v213, v9, s[40:41]
  v_cndmask_b32 v214, v214, v9, s[42:43]
  v_cndmask_b32 v215, v215, v9, s[44:45]
  v_max3_f32 v11, v11, v208, v209
  v_max3_f32 v12, v12, v210, v211
  v_max3_f32 v11, v11, v212, v213
  v_max3_f32 v12, v12, v214, v215
  v_max_f32 v11, v11, v12
  v_mov_b32 v12, v11
  s_nop 1
  v_permlane16_swap_b32 v11, v12
  v_max_f32 v11, v11, v12
  v_mov_b32 v12, v11
  s_nop 1
  v_permlane32_swap_b32 v11, v12
  v_max_f32 v11, v11, v12
  v_mul_f32 v12, s25, v11
  v_mov_b32 v13, v12
  v_mov_b32 v14, s25
  v_mov_b32 v15, s25
  s_waitcnt lgkmcnt(0)
  buffer_load_dword v226, v2, s[4:7], s21 offen sc1
  v_pk_fma_f32 v[144:145], v[144:145], v[14:15], v[12:13] neg_lo:[0,0,1] neg_hi:[0,0,1]
  v_pk_fma_f32 v[146:147], v[146:147], v[14:15], v[12:13] neg_lo:[0,0,1] neg_hi:[0,0,1]
  v_pk_fma_f32 v[148:149], v[148:149], v[14:15], v[12:13] neg_lo:[0,0,1] neg_hi:[0,0,1]
  v_pk_fma_f32 v[150:151], v[150:151], v[14:15], v[12:13] neg_lo:[0,0,1] neg_hi:[0,0,1]
  v_exp_f32 v144, v144
  v_exp_f32 v145, v145
  v_exp_f32 v146, v146
  v_exp_f32 v147, v147
  v_exp_f32 v148, v148
  v_exp_f32 v149, v149
  v_exp_f32 v150, v150
  v_exp_f32 v151, v151
  s_nop 0
  v_pk_add_f32 v[224:225], v[144:145], v[146:147]
  v_cvt_pk_bf16_f32 v216, v144, v145
  v_cvt_pk_bf16_f32 v217, v146, v147
  v_cvt_pk_bf16_f32 v218, v148, v149
  v_cvt_pk_bf16_f32 v219, v150, v151
  v_pk_add_f32 v[224:225], v[224:225], v[148:149]
  v_pk_add_f32 v[224:225], v[224:225], v[150:151]
  v_mfma_f32_16x16x32_bf16 v[220:223], v[108:111], v[216:219], 0
  v_pk_fma_f32 v[152:153], v[152:153], v[14:15], v[12:13] neg_lo:[0,0,1] neg_hi:[0,0,1]
  v_pk_fma_f32 v[154:155], v[154:155], v[14:15], v[12:13] neg_lo:[0,0,1] neg_hi:[0,0,1]
  v_pk_fma_f32 v[156:157], v[156:157], v[14:15], v[12:13] neg_lo:[0,0,1] neg_hi:[0,0,1]
  v_pk_fma_f32 v[158:159], v[158:159], v[14:15], v[12:13] neg_lo:[0,0,1] neg_hi:[0,0,1]
  v_exp_f32 v152, v152
  v_exp_f32 v153, v153
  v_exp_f32 v154, v154
  v_exp_f32 v155, v155
  v_exp_f32 v156, v156
  v_exp_f32 v157, v157
  v_exp_f32 v158, v158
  v_exp_f32 v159, v159
  s_nop 0
  v_pk_add_f32 v[224:225], v[224:225], v[152:153]
  v_pk_add_f32 v[224:225], v[224:225], v[154:155]
  v_cvt_pk_bf16_f32 v216, v152, v153
  v_cvt_pk_bf16_f32 v217, v154, v155
  v_cvt_pk_bf16_f32 v218, v156, v157
  v_cvt_pk_bf16_f32 v219, v158, v159
  v_pk_add_f32 v[224:225], v[224:225], v[156:157]
  v_pk_add_f32 v[224:225], v[224:225], v[158:159]
  v_mfma_f32_16x16x32_bf16 v[220:223], v[112:115], v[216:219], v[220:223]
  v_pk_fma_f32 v[160:161], v[160:161], v[14:15], v[12:13] neg_lo:[0,0,1] neg_hi:[0,0,1]
  v_pk_fma_f32 v[162:163], v[162:163], v[14:15], v[12:13] neg_lo:[0,0,1] neg_hi:[0,0,1]
  v_pk_fma_f32 v[164:165], v[164:165], v[14:15], v[12:13] neg_lo:[0,0,1] neg_hi:[0,0,1]
  v_pk_fma_f32 v[166:167], v[166:167], v[14:15], v[12:13] neg_lo:[0,0,1] neg_hi:[0,0,1]
  v_exp_f32 v160, v160
  v_exp_f32 v161, v161
  v_exp_f32 v162, v162
  v_exp_f32 v163, v163
  v_exp_f32 v164, v164
  v_exp_f32 v165, v165
  v_exp_f32 v166, v166
  v_exp_f32 v167, v167
  s_nop 0
  v_pk_add_f32 v[224:225], v[224:225], v[160:161]
  v_pk_add_f32 v[224:225], v[224:225], v[162:163]
  v_cvt_pk_bf16_f32 v216, v160, v161
  v_cvt_pk_bf16_f32 v217, v162, v163
  v_cvt_pk_bf16_f32 v218, v164, v165
  v_cvt_pk_bf16_f32 v219, v166, v167
  v_pk_add_f32 v[224:225], v[224:225], v[164:165]
  v_pk_add_f32 v[224:225], v[224:225], v[166:167]
  v_mfma_f32_16x16x32_bf16 v[220:223], v[116:119], v[216:219], v[220:223]
  v_pk_fma_f32 v[168:169], v[168:169], v[14:15], v[12:13] neg_lo:[0,0,1] neg_hi:[0,0,1]
  v_pk_fma_f32 v[170:171], v[170:171], v[14:15], v[12:13] neg_lo:[0,0,1] neg_hi:[0,0,1]
  v_pk_fma_f32 v[172:173], v[172:173], v[14:15], v[12:13] neg_lo:[0,0,1] neg_hi:[0,0,1]
  v_pk_fma_f32 v[174:175], v[174:175], v[14:15], v[12:13] neg_lo:[0,0,1] neg_hi:[0,0,1]
  v_exp_f32 v168, v168
  v_exp_f32 v169, v169
  v_exp_f32 v170, v170
  v_exp_f32 v171, v171
  v_exp_f32 v172, v172
  v_exp_f32 v173, v173
  v_exp_f32 v174, v174
  v_exp_f32 v175, v175
  s_waitcnt vmcnt(0)
  v_cmp_eq_u32 vcc, 0, v226
  s_nop 0
  s_cmp_eq_u32 vcc_hi, 0
  s_cselect_b32 s76, 1, 0
  s_cmp_eq_u32 s19, 0
  s_cselect_b32 s76, 1, s76
  s_cmp_ge_u32 s18, 62
  s_cselect_b32 s76, 0, s76
  s_sub_u32 s49, 114688, s24
  s_cmp_eq_u32 vcc_lo, 0
  s_cselect_b32 s26, 1, 0
  s_cmp_eq_u32 s19, 0
  s_cselect_b32 s26, 1, s26
  s_cmp_eq_u32 s18, 63
  s_cselect_b32 s26, 0, s26
  s_cmp_lg_u32 s26, 0
  s_cselect_b32 s28, s20, s28
  s_lshl_b32 s46, s12, 13
  s_add_u32 s47, s46, s49
  s_add_u32 s46, s46, s28
  s_mov_b32 m0, s47
  s_nop 0
  v_pk_add_f32 v[224:225], v[224:225], v[168:169]
  v_pk_add_f32 v[224:225], v[224:225], v[170:171]
  v_cvt_pk_bf16_f32 v216, v168, v169
  v_cvt_pk_bf16_f32 v217, v170, v171
  v_cvt_pk_bf16_f32 v218, v172, v173
  v_cvt_pk_bf16_f32 v219, v174, v175
  v_pk_add_f32 v[224:225], v[224:225], v[172:173]
  v_pk_add_f32 v[224:225], v[224:225], v[174:175]
  v_mfma_f32_16x16x32_bf16 v[220:223], v[120:123], v[216:219], v[220:223]
  v_pk_fma_f32 v[176:177], v[176:177], v[14:15], v[12:13] neg_lo:[0,0,1] neg_hi:[0,0,1]
  v_pk_fma_f32 v[178:179], v[178:179], v[14:15], v[12:13] neg_lo:[0,0,1] neg_hi:[0,0,1]
  v_pk_fma_f32 v[180:181], v[180:181], v[14:15], v[12:13] neg_lo:[0,0,1] neg_hi:[0,0,1]
  v_pk_fma_f32 v[182:183], v[182:183], v[14:15], v[12:13] neg_lo:[0,0,1] neg_hi:[0,0,1]
  v_exp_f32 v176, v176
  v_exp_f32 v177, v177
  v_exp_f32 v178, v178
  buffer_load_dwordx4 v62, s[4:7], s46 offen offset:0 sc1 lds
  v_exp_f32 v179, v179
  v_exp_f32 v180, v180
  v_exp_f32 v181, v181
  v_exp_f32 v182, v182
  buffer_load_dwordx4 v63, s[4:7], s46 offen offset:1024 sc1 lds
  v_exp_f32 v183, v183
  s_nop 0
  v_pk_add_f32 v[224:225], v[224:225], v[176:177]
  v_pk_add_f32 v[224:225], v[224:225], v[178:179]
  v_cvt_pk_bf16_f32 v216, v176, v177
  v_cvt_pk_bf16_f32 v217, v178, v179
  v_cvt_pk_bf16_f32 v218, v180, v181
  v_cvt_pk_bf16_f32 v219, v182, v183
  v_pk_add_f32 v[224:225], v[224:225], v[180:181]
  v_pk_add_f32 v[224:225], v[224:225], v[182:183]
  v_mfma_f32_16x16x32_bf16 v[220:223], v[124:127], v[216:219], v[220:223]
  v_pk_fma_f32 v[184:185], v[184:185], v[14:15], v[12:13] neg_lo:[0,0,1] neg_hi:[0,0,1]
  v_pk_fma_f32 v[186:187], v[186:187], v[14:15], v[12:13] neg_lo:[0,0,1] neg_hi:[0,0,1]
  v_pk_fma_f32 v[188:189], v[188:189], v[14:15], v[12:13] neg_lo:[0,0,1] neg_hi:[0,0,1]
  v_pk_fma_f32 v[190:191], v[190:191], v[14:15], v[12:13] neg_lo:[0,0,1] neg_hi:[0,0,1]
  v_exp_f32 v184, v184
  v_exp_f32 v185, v185
  v_exp_f32 v186, v186
  buffer_load_dwordx4 v64, s[4:7], s46 offen offset:2048 sc1 lds
  v_exp_f32 v187, v187
  v_exp_f32 v188, v188
  v_exp_f32 v189, v189
  v_exp_f32 v190, v190
  buffer_load_dwordx4 v65, s[4:7], s46 offen offset:3072 sc1 lds
  v_exp_f32 v191, v191
  s_nop 0
  v_pk_add_f32 v[224:225], v[224:225], v[184:185]
  v_pk_add_f32 v[224:225], v[224:225], v[186:187]
  v_cvt_pk_bf16_f32 v216, v184, v185
  v_cvt_pk_bf16_f32 v217, v186, v187
  v_cvt_pk_bf16_f32 v218, v188, v189
  v_cvt_pk_bf16_f32 v219, v190, v191
  v_pk_add_f32 v[224:225], v[224:225], v[188:189]
  v_pk_add_f32 v[224:225], v[224:225], v[190:191]
  v_mfma_f32_16x16x32_bf16 v[220:223], v[128:131], v[216:219], v[220:223]
  v_pk_fma_f32 v[192:193], v[192:193], v[14:15], v[12:13] neg_lo:[0,0,1] neg_hi:[0,0,1]
  v_pk_fma_f32 v[194:195], v[194:195], v[14:15], v[12:13] neg_lo:[0,0,1] neg_hi:[0,0,1]
  v_pk_fma_f32 v[196:197], v[196:197], v[14:15], v[12:13] neg_lo:[0,0,1] neg_hi:[0,0,1]
  v_pk_fma_f32 v[198:199], v[198:199], v[14:15], v[12:13] neg_lo:[0,0,1] neg_hi:[0,0,1]
  v_exp_f32 v192, v192
  v_exp_f32 v193, v193
  v_exp_f32 v194, v194
  s_add_u32 m0, s47, 4096
  s_add_u32 s46, s46, 4096
  v_exp_f32 v195, v195
  v_exp_f32 v196, v196
  v_exp_f32 v197, v197
  v_exp_f32 v198, v198
  buffer_load_dwordx4 v66, s[4:7], s46 offen offset:0 sc1 lds
  v_exp_f32 v199, v199
  s_nop 0
  v_pk_add_f32 v[224:225], v[224:225], v[192:193]
  v_pk_add_f32 v[224:225], v[224:225], v[194:195]
  v_cvt_pk_bf16_f32 v216, v192, v193
  v_cvt_pk_bf16_f32 v217, v194, v195
  v_cvt_pk_bf16_f32 v218, v196, v197
  v_cvt_pk_bf16_f32 v219, v198, v199
  v_pk_add_f32 v[224:225], v[224:225], v[196:197]
  v_pk_add_f32 v[224:225], v[224:225], v[198:199]
  v_mfma_f32_16x16x32_bf16 v[220:223], v[132:135], v[216:219], v[220:223]
  v_pk_fma_f32 v[200:201], v[200:201], v[14:15], v[12:13] neg_lo:[0,0,1] neg_hi:[0,0,1]
  v_pk_fma_f32 v[202:203], v[202:203], v[14:15], v[12:13] neg_lo:[0,0,1] neg_hi:[0,0,1]
  v_pk_fma_f32 v[204:205], v[204:205], v[14:15], v[12:13] neg_lo:[0,0,1] neg_hi:[0,0,1]
  v_pk_fma_f32 v[206:207], v[206:207], v[14:15], v[12:13] neg_lo:[0,0,1] neg_hi:[0,0,1]
  v_exp_f32 v200, v200
  v_exp_f32 v201, v201
  v_exp_f32 v202, v202
  buffer_load_dwordx4 v67, s[4:7], s46 offen offset:1024 sc1 lds
  v_exp_f32 v203, v203
  v_exp_f32 v204, v204
  v_exp_f32 v205, v205
  v_exp_f32 v206, v206
  buffer_load_dwordx4 v68, s[4:7], s46 offen offset:2048 sc1 lds
  v_exp_f32 v207, v207
  s_nop 0
  v_pk_add_f32 v[224:225], v[224:225], v[200:201]
  v_pk_add_f32 v[224:225], v[224:225], v[202:203]
  v_cvt_pk_bf16_f32 v216, v200, v201
  v_cvt_pk_bf16_f32 v217, v202, v203
  v_cvt_pk_bf16_f32 v218, v204, v205
  v_cvt_pk_bf16_f32 v219, v206, v207
  v_pk_add_f32 v[224:225], v[224:225], v[204:205]
  v_pk_add_f32 v[224:225], v[224:225], v[206:207]
  v_mfma_f32_16x16x32_bf16 v[220:223], v[136:139], v[216:219], v[220:223]
  v_pk_fma_f32 v[208:209], v[208:209], v[14:15], v[12:13] neg_lo:[0,0,1] neg_hi:[0,0,1]
  v_pk_fma_f32 v[210:211], v[210:211], v[14:15], v[12:13] neg_lo:[0,0,1] neg_hi:[0,0,1]
  v_pk_fma_f32 v[212:213], v[212:213], v[14:15], v[12:13] neg_lo:[0,0,1] neg_hi:[0,0,1]
  v_pk_fma_f32 v[214:215], v[214:215], v[14:15], v[12:13] neg_lo:[0,0,1] neg_hi:[0,0,1]
  v_exp_f32 v208, v208
  v_exp_f32 v209, v209
  v_exp_f32 v210, v210
  buffer_load_dwordx4 v69, s[4:7], s46 offen offset:3072 sc1 lds
  v_exp_f32 v211, v211
  v_exp_f32 v212, v212
  v_exp_f32 v213, v213
  v_exp_f32 v214, v214
  v_exp_f32 v215, v215
  s_nop 0
  v_pk_add_f32 v[224:225], v[224:225], v[208:209]
  v_pk_add_f32 v[224:225], v[224:225], v[210:211]
  v_cvt_pk_bf16_f32 v216, v208, v209
  v_cvt_pk_bf16_f32 v217, v210, v211
  v_cvt_pk_bf16_f32 v218, v212, v213
  v_cvt_pk_bf16_f32 v219, v214, v215
  v_pk_add_f32 v[224:225], v[224:225], v[212:213]
  v_pk_add_f32 v[224:225], v[224:225], v[214:215]
  v_mfma_f32_16x16x32_bf16 v[220:223], v[140:143], v[216:219], v[220:223]
  v_add_f32 v224, v224, v225
  v_mov_b32 v14, v224
  s_nop 1
  v_permlane16_swap_b32 v224, v14
  v_add_f32 v224, v224, v14
  v_mov_b32 v14, v224
  s_nop 1
  v_permlane32_swap_b32 v224, v14
  v_add_f32 v224, v224, v14
  v_rcp_f32 v224, v224
  s_nop 0
  v_mul_f32 v220, v220, v224
  v_mul_f32 v221, v221, v224
  v_mul_f32 v222, v222, v224
  v_mul_f32 v223, v223, v224
  v_cvt_pk_bf16_f32 v220, v220, v221
  v_cvt_pk_bf16_f32 v221, v222, v223
  s_lshl_b32 s48, s18, 15
  s_add_u32 s48, s48, s22
  s_add_u32 s23, s23, 256
  buffer_store_dword v220, v5, s[4:7], s48 offen sc1
  buffer_store_dword v221, v5, s[4:7], s48 offen offset:32 sc1
  s_mov_b32 s27, 1
  s_cmp_eq_u32 s18, 63
  s_cbranch_scc1 Aq_end
  s_cmp_lg_u32 s26, 0
  s_cbranch_scc1 Aql_have
  buffer_load_dword v15, v2, s[4:7], s21 offen sc1
  s_waitcnt vmcnt(0)
  v_mov_b32 v8, 1
  s_sub_u32 s48, s23, 256
  s_mov_b64 exec, 1
  buffer_store_dword v8, v7, s[4:7], s48 offen sc1
  s_mov_b64 exec, -1
  s_mov_b32 s27, 0
Aql_w:
  v_cmp_eq_u32 vcc, 0, v15
  s_nop 0
  s_cmp_eq_u32 vcc_lo, 0
  s_cbranch_scc1 Aql_w_ok
  s_sub_u32 s15, s15, 1
  s_cbranch_scc1 Aql_w_ok
  s_sleep 24
  buffer_load_dword v15, v2, s[4:7], s21 offen sc1
  s_waitcnt vmcnt(0)
  s_branch Aql_w
Aql_w_ok:
  s_sub_u32 s49, 114688, s24
  s_lshl_b32 s46, s12, 13
  s_add_u32 s47, s46, s49
  s_add_u32 s46, s46, s20
  s_mov_b32 m0, s47
  s_nop 0
  buffer_load_dwordx4 v62, s[4:7], s46 offen offset:0 sc1 lds
  buffer_load_dwordx4 v63, s[4:7], s46 offen offset:1024 sc1 lds
  buffer_load_dwordx4 v64, s[4:7], s46 offen offset:2048 sc1 lds
  buffer_load_dwordx4 v65, s[4:7], s46 offen offset:3072 sc1 lds
  s_add_u32 m0, s47, 4096
  s_add_u32 s46, s46, 4096
  buffer_load_dwordx4 v66, s[4:7], s46 offen offset:0 sc1 lds
  buffer_load_dwordx4 v67, s[4:7], s46 offen offset:1024 sc1 lds
  buffer_load_dwordx4 v68, s[4:7], s46 offen offset:2048 sc1 lds
  buffer_load_dwordx4 v69, s[4:7], s46 offen offset:3072 sc1 lds
  s_waitcnt vmcnt(0)
  s_branch Aq_go
Aql_have:
  s_waitcnt vmcnt(2)
  s_branch Aq_go
Aq_early:
  ds_read_b128 v[16:19], v58 offset:0
  ds_read_b128 v[20:23], v59 offset:0
  ds_read_b128 v[24:27], v60 offset:0
  s_waitcnt lgkmcnt(2)
  v_mfma_f32_16x16x32_bf16 v[32:35], a[64:67], v[16:19], 0
  ds_read_b128 v[28:31], v61 offset:0
  v_mfma_f32_16x16x32_bf16 v[40:43], v[16:19], a[128:131], 0
  s_waitcnt lgkmcnt(2)
  s_add_u32 s21, s21, 128
  v_mfma_f32_16x16x32_bf16 v[36:39], a[0:3], v[16:19], 0
  s_mov_b32 s28, s20
  v_mfma_f32_16x16x32_bf16 v[32:35], a[68:71], v[20:23], v[32:35]
  ds_read_b128 v[16:19], v58 offset:256
  v_mfma_f32_16x16x32_bf16 v[40:43], v[20:23], a[132:135], v[40:43]
  s_waitcnt lgkmcnt(2)
  s_add_u32 s20, s20, 32768
  v_mfma_f32_16x16x32_bf16 v[36:39], a[4:7], v[20:23], v[36:39]
  s_sub_u32 s49, 114688, s24
  v_mfma_f32_16x16x32_bf16 v[32:35], a[72:75], v[24:27], v[32:35]
  ds_read_b128 v[20:23], v59 offset:256
  v_mfma_f32_16x16x32_bf16 v[40:43], v[24:27], a[136:139], v[40:43]
  s_waitcnt lgkmcnt(2)
  s_lshl_b32 s46, s12, 13
  s_add_u32 s47, s46, s49
  s_add_u32 s46, s46, s20
  s_mov_b32 m0, s47
  s_nop 0
  v_mfma_f32_16x16x32_bf16 v[36:39], a[8:11], v[24:27], v[36:39]
  v_mov_b32 v57, v48
  v_mfma_f32_16x16x32_bf16 v[32:35], a[76:79], v[28:31], v[32:35]
  ds_read_b128 v[24:27], v60 offset:256
  v_mfma_f32_16x16x32_bf16 v[40:43], v[28:31], a[140:143], v[40:43]
  s_waitcnt lgkmcnt(2)
  v_mov_b32 v48, v49
  v_mfma_f32_16x16x32_bf16 v[36:39], a[12:15], v[28:31], v[36:39]
  v_mov_b32 v49, v50
  v_mfma_f32_16x16x32_bf16 v[32:35], a[80:83], v[16:19], v[32:35]
  ds_read_b128 v[28:31], v61 offset:256
  v_mfma_f32_16x16x32_bf16 v[40:43], v[16:19], a[144:147], v[40:43]
  s_waitcnt lgkmcnt(2)
  v_mov_b32 v50, v51
  v_mfma_f32_16x16x32_bf16 v[36:39], a[16:19], v[16:19], v[36:39]
  v_mov_b32 v51, v52
  v_mfma_f32_16x16x32_bf16 v[32:35], a[84:87], v[20:23], v[32:35]
  ds_read_b128 v[16:19], v58 offset:512
  v_mfma_f32_16x16x32_bf16 v[40:43], v[20:23], a[148:151], v[40:43]
  s_waitcnt lgkmcnt(2)
  v_mov_b32 v52, v53
  v_mfma_f32_16x16x32_bf16 v[36:39], a[20:23], v[20:23], v[36:39]
  v_mov_b32 v53, v54
  v_mfma_f32_16x16x32_bf16 v[32:35], a[88:91], v[24:27], v[32:35]
  ds_read_b128 v[20:23], v59 offset:512
  v_mfma_f32_16x16x32_bf16 v[40:43], v[24:27], a[152:155], v[40:43]
  s_waitcnt lgkmcnt(2)
  v_mov_b32 v54, v55
  v_mfma_f32_16x16x32_bf16 v[36:39], a[24:27], v[24:27], v[36:39]
  v_mov_b32 v55, v56
  v_mfma_f32_16x16x32_bf16 v[32:35], a[92:95], v[28:31], v[32:35]
  ds_read_b128 v[24:27], v60 offset:512
  v_mfma_f32_16x16x32_bf16 v[40:43], v[28:31], a[156:159], v[40:43]
  s_waitcnt lgkmcnt(2)
  v_mov_b32 v56, v57
  v_mfma_f32_16x16x32_bf16 v[36:39], a[28:31], v[28:31], v[36:39]
  v_add_u32 v57, s29, v57
  v_mfma_f32_16x16x32_bf16 v[32:35], a[96:99], v[16:19], v[32:35]
  ds_read_b128 v[28:31], v61 offset:512
  v_mfma_f32_16x16x32_bf16 v[40:43], v[16:19], a[160:163], v[40:43]
  s_waitcnt lgkmcnt(2)
  ds_read_b128 v[72:75], v48 offset:0
  v_mfma_f32_16x16x32_bf16 v[36:39], a[32:35], v[16:19], v[36:39]
  ds_read_b128 v[76:79], v49 offset:0
  v_mfma_f32_16x16x32_bf16 v[32:35], a[100:103], v[20:23], v[32:35]
  ds_read_b128 v[16:19], v58 offset:768
  v_mfma_f32_16x16x32_bf16 v[40:43], v[20:23], a[164:167], v[40:43]
  s_waitcnt lgkmcnt(4)
  ds_read_b128 v[80:83], v50 offset:0
  v_mfma_f32_16x16x32_bf16 v[36:39], a[36:39], v[20:23], v[36:39]
  ds_read_b128 v[84:87], v51 offset:0
  buffer_load_dwordx4 v62, s[4:7], s46 offen offset:0 sc1 lds
  v_mfma_f32_16x16x32_bf16 v[32:35], a[104:107], v[24:27], v[32:35]
  ds_read_b128 v[20:23], v59 offset:768
  v_mfma_f32_16x16x32_bf16 v[40:43], v[24:27], a[168:171], v[40:43]
  s_waitcnt lgkmcnt(6)
  ds_read_b128 v[88:91], v52 offset:0
  v_mfma_f32_16x16x32_bf16 v[36:39], a[40:43], v[24:27], v[36:39]
  ds_read_b128 v[92:95], v53 offset:0
  v_mfma_f32_16x16x32_bf16 v[32:35], a[108:111], v[28:31], v[32:35]
  ds_read_b128 v[24:27], v60 offset:768
  v_mfma_f32_16x16x32_bf16 v[40:43], v[28:31], a[172:175], v[40:43]
  s_waitcnt lgkmcnt(6)
  ds_read_b128 v[96:99], v54 offset:0
  v_mfma_f32_16x16x32_bf16 v[36:39], a[44:47], v[28:31], v[36:39]
  ds_read_b128 v[100:103], v55 offset:0
  v_mfma_f32_16x16x32_bf16 v[32:35], a[112:115], v[16:19], v[32:35]
  ds_read_b128 v[28:31], v61 offset:768
  v_mfma_f32_16x16x32_bf16 v[40:43], v[16:19], a[176:179], v[40:43]
  s_waitcnt lgkmcnt(6)
  ds_read_b128 v[108:111], v48 offset:18432
  v_mfma_f32_16x16x32_bf16 v[36:39], a[48:51], v[16:19], v[36:39]
  ds_read_b128 v[112:115], v49 offset:18432
  v_mfma_f32_16x16x32_bf16 v[32:35], a[116:119], v[20:23], v[32:35]
  v_mfma_f32_16x16x32_bf16 v[40:43], v[20:23], a[180:183], v[40:43]
  s_waitcnt lgkmcnt(5)
  ds_read_b128 v[116:119], v50 offset:18432
  v_mfma_f32_16x16x32_bf16 v[36:39], a[52:55], v[20:23], v[36:39]
  ds_read_b128 v[120:123], v51 offset:18432
  v_mfma_f32_16x16x32_bf16 v[32:35], a[120:123], v[24:27], v[32:35]
  v_mfma_f32_16x16x32_bf16 v[40:43], v[24:27], a[184:187], v[40:43]
  s_waitcnt lgkmcnt(4)
  ds_read_b128 v[124:127], v52 offset:18432
  v_mfma_f32_16x16x32_bf16 v[36:39], a[56:59], v[24:27], v[36:39]
  ds_read_b128 v[128:131], v53 offset:18432
  buffer_load_dwordx4 v63, s[4:7], s46 offen offset:1024 sc1 lds
  v_mfma_f32_16x16x32_bf16 v[32:35], a[124:127], v[28:31], v[32:35]
  v_mfma_f32_16x16x32_bf16 v[40:43], v[28:31], a[188:191], v[40:43]
  ds_read_b128 v[132:135], v54 offset:18432
  v_mfma_f32_16x16x32_bf16 v[36:39], a[60:63], v[28:31], v[36:39]
  ds_read_b128 v[136:139], v55 offset:18432
  s_nop 4
  v_cvt_pk_bf16_f32 v10, v32, v33
  v_cvt_pk_bf16_f32 v11, v34, v35
  ds_write_b64 v57, v[10:11] offset:0
  v_cvt_pk_bf16_f32 v12, v40, v41
  v_cvt_pk_bf16_f32 v13, v42, v43
  ds_write_b64 v57, v[12:13] offset:18432
  v_cvt_pk_bf16_f32 v44, v36, v37
  v_cvt_pk_bf16_f32 v45, v38, v39
  s_cmp_eq_u32 s27, 0
  s_cbranch_scc1 Aqe_mid
  s_waitcnt vmcnt(2)
  v_mov_b32 v8, 1
  s_sub_u32 s48, s23, 256
  s_mov_b64 exec, 1
  buffer_store_dword v8, v7, s[4:7], s48 offen sc1
  s_mov_b64 exec, -1
  s_mov_b32 s27, 0
Aqe_mid:
  v_mov_b32 v9, 0xff800000
  s_cmp_lt_u32 s18, 8
  s_cbranch_scc1 Aqe_start
  v_mfma_f32_16x16x16_bf16 v[144:147], v[72:73], v[44:45], 0
  v_mfma_f32_16x16x16_bf16 v[148:151], v[74:75], v[44:45], 0
  v_mfma_f32_16x16x16_bf16 v[152:155], v[76:77], v[44:45], 0
  v_mfma_f32_16x16x16_bf16 v[156:159], v[78:79], v[44:45], 0
  v_mfma_f32_16x16x16_bf16 v[160:163], v[80:81], v[44:45], 0
  v_mfma_f32_16x16x16_bf16 v[164:167], v[82:83], v[44:45], 0
  v_mfma_f32_16x16x16_bf16 v[168:171], v[84:85], v[44:45], 0
  v_mfma_f32_16x16x16_bf16 v[172:175], v[86:87], v[44:45], 0
  v_mfma_f32_16x16x16_bf16 v[176:179], v[88:89], v[44:45], 0
  v_max3_f32 v11, v152, v153, v154
  v_max3_f32 v12, v155, v156, v157
  v_mfma_f32_16x16x16_bf16 v[180:183], v[90:91], v[44:45], 0
  v_max3_f32 v11, v11, v158, v159
  v_mfma_f32_16x16x16_bf16 v[184:187], v[92:93], v[44:45], 0
  v_max3_f32 v11, v11, v160, v161
  v_max3_f32 v12, v12, v162, v163
  v_mfma_f32_16x16x16_bf16 v[188:191], v[94:95], v[44:45], 0
  v_max3_f32 v11, v11, v164, v165
  v_max3_f32 v12, v12, v166, v167
  v_mfma_f32_16x16x16_bf16 v[192:195], v[96:97], v[44:45], 0
  v_max3_f32 v11, v11, v168, v169
  v_max3_f32 v12, v12, v170, v171
  v_mfma_f32_16x16x16_bf16 v[196:199], v[98:99], v[44:45], 0
  v_max3_f32 v11, v11, v172, v173
  v_max3_f32 v12, v12, v174, v175
  v_mfma_f32_16x16x16_bf16 v[200:203], v[100:101], v[44:45], 0
  v_max3_f32 v11, v11, v176, v177
  v_max3_f32 v12, v12, v178, v179
  v_mfma_f32_16x16x16_bf16 v[204:207], v[102:103], v[44:45], 0
  v_max3_f32 v11, v11, v180, v181
  v_max3_f32 v12, v12, v182, v183
  s_nop 3
  v_cndmask_b32 v144, v9, v144, s[30:31]
  v_cndmask_b32 v145, v9, v145, s[32:33]
  v_cndmask_b32 v146, v9, v146, s[34:35]
  v_cndmask_b32 v147, v9, v147, s[36:37]
  v_cndmask_b32 v148, v9, v148, s[38:39]
  v_cndmask_b32 v149, v9, v149, s[40:41]
  v_cndmask_b32 v150, v9, v150, s[42:43]
  v_cndmask_b32 v151, v9, v151, s[44:45]
  v_max3_f32 v11, v11, v184, v185
  v_max3_f32 v12, v12, v186, v187
  v_max3_f32 v11, v11, v188, v189
  v_max3_f32 v12, v12, v190, v191
  v_max3_f32 v11, v11, v192, v193
  v_max3_f32 v12, v12, v194, v195
  v_max3_f32 v11, v11, v196, v197
  v_max3_f32 v12, v12, v198, v199
  v_max3_f32 v11, v11, v200, v201
  v_max3_f32 v12, v12, v202, v203
  v_max3_f32 v11, v11, v204, v205
  v_max3_f32 v12, v12, v206, v207
Aqe_mxdone:
  v_max3_f32 v11, v11, v144, v145
  v_max3_f32 v12, v12, v146, v147
  v_max3_f32 v11, v11, v148, v149
  v_max3_f32 v12, v12, v150, v151
  buffer_load_dwordx4 v64, s[4:7], s46 offen offset:2048 sc1 lds
  s_waitcnt lgkmcnt(0)
  s_barrier
  ds_read_b128 v[104:107], v56 offset:0
  ds_read_b128 v[140:143], v56 offset:18432
  s_waitcnt lgkmcnt(1)
  v_mfma_f32_16x16x16_bf16 v[208:211], v[104:105], v[44:45], 0
  v_mfma_f32_16x16x16_bf16 v[212:215], v[106:107], v[44:45], 0
  s_nop 7
  v_cndmask_b32 v208, v208, v9, s[30:31]
  v_cndmask_b32 v209, v209, v9, s[32:33]
  v_cndmask_b32 v210, v210, v9, s[34:35]
  v_cndmask_b32 v211, v211, v9, s[36:37]
  v_cndmask_b32 v212, v212, v9, s[38:39]
  v_cndmask_b32 v213, v213, v9, s[40:41]
  v_cndmask_b32 v214, v214, v9, s[42:43]
  v_cndmask_b32 v215, v215, v9, s[44:45]
  v_max3_f32 v11, v11, v208, v209
  v_max3_f32 v12, v12, v210, v211
  v_max3_f32 v11, v11, v212, v213
  v_max3_f32 v12, v12, v214, v215
  v_max_f32 v11, v11, v12
  v_mov_b32 v12, v11
  s_nop 1
  v_permlane16_swap_b32 v11, v12
  v_max_f32 v11, v11, v12
  v_mov_b32 v12, v11
  s_nop 1
  v_permlane32_swap_b32 v11, v12
  v_max_f32 v11, v11, v12
  v_mul_f32 v12, s25, v11
  v_mov_b32 v13, v12
  v_mov_b32 v14, s25
  v_mov_b32 v15, s25
  s_waitcnt lgkmcnt(0)
  buffer_load_dword v226, v2, s[4:7], s21 offen sc1
  v_pk_fma_f32 v[144:145], v[144:145], v[14:15], v[12:13] neg_lo:[0,0,1] neg_hi:[0,0,1]
  v_pk_fma_f32 v[146:147], v[146:147], v[14:15], v[12:13] neg_lo:[0,0,1] neg_hi:[0,0,1]
  v_pk_fma_f32 v[148:149], v[148:149], v[14:15], v[12:13] neg_lo:[0,0,1] neg_hi:[0,0,1]
  v_pk_fma_f32 v[150:151], v[150:151], v[14:15], v[12:13] neg_lo:[0,0,1] neg_hi:[0,0,1]
  v_exp_f32 v144, v144
  v_exp_f32 v145, v145
  v_exp_f32 v146, v146
  v_exp_f32 v147, v147
  v_exp_f32 v148, v148
  v_exp_f32 v149, v149
  buffer_load_dwordx4 v65, s[4:7], s46 offen offset:3072 sc1 lds
  v_exp_f32 v150, v150
  v_exp_f32 v151, v151
  s_nop 0
  v_pk_add_f32 v[224:225], v[144:145], v[146:147]
  v_cvt_pk_bf16_f32 v216, v144, v145
  v_cvt_pk_bf16_f32 v217, v146, v147
  v_cvt_pk_bf16_f32 v218, v148, v149
  v_cvt_pk_bf16_f32 v219, v150, v151
  v_pk_add_f32 v[224:225], v[224:225], v[148:149]
  v_pk_add_f32 v[224:225], v[224:225], v[150:151]
  v_mfma_f32_16x16x32_bf16 v[220:223], v[108:111], v[216:219], 0
  v_pk_fma_f32 v[152:153], v[152:153], v[14:15], v[12:13] neg_lo:[0,0,1] neg_hi:[0,0,1]
  v_pk_fma_f32 v[154:155], v[154:155], v[14:15], v[12:13] neg_lo:[0,0,1] neg_hi:[0,0,1]
  v_pk_fma_f32 v[156:157], v[156:157], v[14:15], v[12:13] neg_lo:[0,0,1] neg_hi:[0,0,1]
  v_pk_fma_f32 v[158:159], v[158:159], v[14:15], v[12:13] neg_lo:[0,0,1] neg_hi:[0,0,1]
  v_exp_f32 v152, v152
  v_exp_f32 v153, v153
  v_exp_f32 v154, v154
  v_exp_f32 v155, v155
  v_exp_f32 v156, v156
  v_exp_f32 v157, v157
  s_add_u32 m0, s47, 4096
  s_add_u32 s46, s46, 4096
  v_exp_f32 v158, v158
  v_exp_f32 v159, v159
  s_nop 0
  v_pk_add_f32 v[224:225], v[224:225], v[152:153]
  v_pk_add_f32 v[224:225], v[224:225], v[154:155]
  v_cvt_pk_bf16_f32 v216, v152, v153
  v_cvt_pk_bf16_f32 v217, v154, v155
  v_cvt_pk_bf16_f32 v218, v156, v157
  v_cvt_pk_bf16_f32 v219, v158, v159
  v_pk_add_f32 v[224:225], v[224:225], v[156:157]
  v_pk_add_f32 v[224:225], v[224:225], v[158:159]
  v_mfma_f32_16x16x32_bf16 v[220:223], v[112:115], v[216:219], v[220:223]
  v_pk_fma_f32 v[160:161], v[160:161], v[14:15], v[12:13] neg_lo:[0,0,1] neg_hi:[0,0,1]
  v_pk_fma_f32 v[162:163], v[162:163], v[14:15], v[12:13] neg_lo:[0,0,1] neg_hi:[0,0,1]
  v_pk_fma_f32 v[164:165], v[164:165], v[14:15], v[12:13] neg_lo:[0,0,1] neg_hi:[0,0,1]
  v_pk_fma_f32 v[166:167], v[166:167], v[14:15], v[12:13] neg_lo:[0,0,1] neg_hi:[0,0,1]
  v_exp_f32 v160, v160
  v_exp_f32 v161, v161
  v_exp_f32 v162, v162
  v_exp_f32 v163, v163
  v_exp_f32 v164, v164
  v_exp_f32 v165, v165
  buffer_load_dwordx4 v66, s[4:7], s46 offen offset:0 sc1 lds
  v_exp_f32 v166, v166
  v_exp_f32 v167, v167
  s_nop 0
  v_pk_add_f32 v[224:225], v[224:225], v[160:161]
  v_pk_add_f32 v[224:225], v[224:225], v[162:163]
  v_cvt_pk_bf16_f32 v216, v160, v161
  v_cvt_pk_bf16_f32 v217, v162, v163
  v_cvt_pk_bf16_f32 v218, v164, v165
  v_cvt_pk_bf16_f32 v219, v166, v167
  v_pk_add_f32 v[224:225], v[224:225], v[164:165]
  v_pk_add_f32 v[224:225], v[224:225], v[166:167]
  v_mfma_f32_16x16x32_bf16 v[220:223], v[116:119], v[216:219], v[220:223]
  v_pk_fma_f32 v[168:169], v[168:169], v[14:15], v[12:13] neg_lo:[0,0,1] neg_hi:[0,0,1]
  v_pk_fma_f32 v[170:171], v[170:171], v[14:15], v[12:13] neg_lo:[0,0,1] neg_hi:[0,0,1]
  v_pk_fma_f32 v[172:173], v[172:173], v[14:15], v[12:13] neg_lo:[0,0,1] neg_hi:[0,0,1]
  v_pk_fma_f32 v[174:175], v[174:175], v[14:15], v[12:13] neg_lo:[0,0,1] neg_hi:[0,0,1]
  v_exp_f32 v168, v168
  v_exp_f32 v169, v169
  v_exp_f32 v170, v170
  v_exp_f32 v171, v171
  v_exp_f32 v172, v172
  v_exp_f32 v173, v173
  buffer_load_dwordx4 v67, s[4:7], s46 offen offset:1024 sc1 lds
  v_exp_f32 v174, v174
  v_exp_f32 v175, v175
  s_waitcnt vmcnt(3)
  v_cmp_eq_u32 vcc, 0, v226
  s_nop 0
  s_cmp_eq_u32 vcc_hi, 0
  s_cselect_b32 s76, 1, 0
  s_cmp_eq_u32 s19, 0
  s_cselect_b32 s76, 1, s76
  s_cmp_ge_u32 s18, 62
  s_cselect_b32 s76, 0, s76
  s_mov_b32 s26, 1
  v_pk_add_f32 v[224:225], v[224:225], v[168:169]
  v_pk_add_f32 v[224:225], v[224:225], v[170:171]
  v_cvt_pk_bf16_f32 v216, v168, v169
  v_cvt_pk_bf16_f32 v217, v170, v171
  v_cvt_pk_bf16_f32 v218, v172, v173
  v_cvt_pk_bf16_f32 v219, v174, v175
  v_pk_add_f32 v[224:225], v[224:225], v[172:173]
  v_pk_add_f32 v[224:225], v[224:225], v[174:175]
  v_mfma_f32_16x16x32_bf16 v[220:223], v[120:123], v[216:219], v[220:223]
  v_pk_fma_f32 v[176:177], v[176:177], v[14:15], v[12:13] neg_lo:[0,0,1] neg_hi:[0,0,1]
  v_pk_fma_f32 v[178:179], v[178:179], v[14:15], v[12:13] neg_lo:[0,0,1] neg_hi:[0,0,1]
  v_pk_fma_f32 v[180:181], v[180:181], v[14:15], v[12:13] neg_lo:[0,0,1] neg_hi:[0,0,1]
  v_pk_fma_f32 v[182:183], v[182:183], v[14:15], v[12:13] neg_lo:[0,0,1] neg_hi:[0,0,1]
  v_exp_f32 v176, v176
  v_exp_f32 v177, v177
  v_exp_f32 v178, v178
  v_exp_f32 v179, v179
  v_exp_f32 v180, v180
  v_exp_f32 v181, v181
  buffer_load_dwordx4 v68, s[4:7], s46 offen offset:2048 sc1 lds
  v_exp_f32 v182, v182
  v_exp_f32 v183, v183
  s_nop 0
  v_pk_add_f32 v[224:225], v[224:225], v[176:177]
  v_pk_add_f32 v[224:225], v[224:225], v[178:179]
  v_cvt_pk_bf16_f32 v216, v176, v177
  v_cvt_pk_bf16_f32 v217, v178, v179
  v_cvt_pk_bf16_f32 v218, v180, v181
  v_cvt_pk_bf16_f32 v219, v182, v183
  v_pk_add_f32 v[224:225], v[224:225], v[180:181]
  v_pk_add_f32 v[224:225], v[224:225], v[182:183]
  v_mfma_f32_16x16x32_bf16 v[220:223], v[124:127], v[216:219], v[220:223]
  v_pk_fma_f32 v[184:185], v[184:185], v[14:15], v[12:13] neg_lo:[0,0,1] neg_hi:[0,0,1]
  v_pk_fma_f32 v[186:187], v[186:187], v[14:15], v[12:13] neg_lo:[0,0,1] neg_hi:[0,0,1]
  v_pk_fma_f32 v[188:189], v[188:189], v[14:15], v[12:13] neg_lo:[0,0,1] neg_hi:[0,0,1]
  v_pk_fma_f32 v[190:191], v[190:191], v[14:15], v[12:13] neg_lo:[0,0,1] neg_hi:[0,0,1]
  v_exp_f32 v184, v184
  v_exp_f32 v185, v185
  v_exp_f32 v186, v186
  v_exp_f32 v187, v187
  v_exp_f32 v188, v188
  v_exp_f32 v189, v189
  buffer_load_dwordx4 v69, s[4:7], s46 offen offset:3072 sc1 lds
  v_exp_f32 v190, v190
  v_exp_f32 v191, v191
  s_nop 0
  v_pk_add_f32 v[224:225], v[224:225], v[184:185]
  v_pk_add_f32 v[224:225], v[224:225], v[186:187]
  v_cvt_pk_bf16_f32 v216, v184, v185
  v_cvt_pk_bf16_f32 v217, v186, v187
  v_cvt_pk_bf16_f32 v218, v188, v189
  v_cvt_pk_bf16_f32 v219, v190, v191
  v_pk_add_f32 v[224:225], v[224:225], v[188:189]
  v_pk_add_f32 v[224:225], v[224:225], v[190:191]
  v_mfma_f32_16x16x32_bf16 v[220:223], v[128:131], v[216:219], v[220:223]
  v_pk_fma_f32 v[192:193], v[192:193], v[14:15], v[12:13] neg_lo:[0,0,1] neg_hi:[0,0,1]
  v_pk_fma_f32 v[194:195], v[194:195], v[14:15], v[12:13] neg_lo:[0,0,1] neg_hi:[0,0,1]
  v_pk_fma_f32 v[196:197], v[196:197], v[14:15], v[12:13] neg_lo:[0,0,1] neg_hi:[0,0,1]
  v_pk_fma_f32 v[198:199], v[198:199], v[14:15], v[12:13] neg_lo:[0,0,1] neg_hi:[0,0,1]
  v_exp_f32 v192, v192
  v_exp_f32 v193, v193
  v_exp_f32 v194, v194
  v_exp_f32 v195, v195
  v_exp_f32 v196, v196
  v_exp_f32 v197, v197
  v_exp_f32 v198, v198
  v_exp_f32 v199, v199
  s_nop 0
  v_pk_add_f32 v[224:225], v[224:225], v[192:193]
  v_pk_add_f32 v[224:225], v[224:225], v[194:195]
  v_cvt_pk_bf16_f32 v216, v192, v193
  v_cvt_pk_bf16_f32 v217, v194, v195
  v_cvt_pk_bf16_f32 v218, v196, v197
  v_cvt_pk_bf16_f32 v219, v198, v199
  v_pk_add_f32 v[224:225], v[224:225], v[196:197]
  v_pk_add_f32 v[224:225], v[224:225], v[198:199]
  v_mfma_f32_16x16x32_bf16 v[220:223], v[132:135], v[216:219], v[220:223]
  v_pk_fma_f32 v[200:201], v[200:201], v[14:15], v[12:13] neg_lo:[0,0,1] neg_hi:[0,0,1]
  v_pk_fma_f32 v[202:203], v[202:203], v[14:15], v[12:13] neg_lo:[0,0,1] neg_hi:[0,0,1]
  v_pk_fma_f32 v[204:205], v[204:205], v[14:15], v[12:13] neg_lo:[0,0,1] neg_hi:[0,0,1]
  v_pk_fma_f32 v[206:207], v[206:207], v[14:15], v[12:13] neg_lo:[0,0,1] neg_hi:[0,0,1]
  v_exp_f32 v200, v200
  v_exp_f32 v201, v201
  v_exp_f32 v202, v202
  v_exp_f32 v203, v203
  v_exp_f32 v204, v204
  v_exp_f32 v205, v205
  v_exp_f32 v206, v206
  v_exp_f32 v207, v207
  s_nop 0
  v_pk_add_f32 v[224:225], v[224:225], v[200:201]
  v_pk_add_f32 v[224:225], v[224:225], v[202:203]
  v_cvt_pk_bf16_f32 v216, v200, v201
  v_cvt_pk_bf16_f32 v217, v202, v203
  v_cvt_pk_bf16_f32 v218, v204, v205
  v_cvt_pk_bf16_f32 v219, v206, v207
  v_pk_add_f32 v[224:225], v[224:225], v[204:205]
  v_pk_add_f32 v[224:225], v[224:225], v[206:207]
  v_mfma_f32_16x16x32_bf16 v[220:223], v[136:139], v[216:219], v[220:223]
  v_pk_fma_f32 v[208:209], v[208:209], v[14:15], v[12:13] neg_lo:[0,0,1] neg_hi:[0,0,1]
  v_pk_fma_f32 v[210:211], v[210:211], v[14:15], v[12:13] neg_lo:[0,0,1] neg_hi:[0,0,1]
  v_pk_fma_f32 v[212:213], v[212:213], v[14:15], v[12:13] neg_lo:[0,0,1] neg_hi:[0,0,1]
  v_pk_fma_f32 v[214:215], v[214:215], v[14:15], v[12:13] neg_lo:[0,0,1] neg_hi:[0,0,1]
  v_exp_f32 v208, v208
  v_exp_f32 v209, v209
  v_exp_f32 v210, v210
  v_exp_f32 v211, v211
  v_exp_f32 v212, v212
  v_exp_f32 v213, v213
  v_exp_f32 v214, v214
  v_exp_f32 v215, v215
  s_nop 0
  v_pk_add_f32 v[224:225], v[224:225], v[208:209]
  v_pk_add_f32 v[224:225], v[224:225], v[210:211]
  v_cvt_pk_bf16_f32 v216, v208, v209
  v_cvt_pk_bf16_f32 v217, v210, v211
  v_cvt_pk_bf16_f32 v218, v212, v213
  v_cvt_pk_bf16_f32 v219, v214, v215
  v_pk_add_f32 v[224:225], v[224:225], v[212:213]
  v_pk_add_f32 v[224:225], v[224:225], v[214:215]
  v_mfma_f32_16x16x32_bf16 v[220:223], v[140:143], v[216:219], v[220:223]
  v_add_f32 v224, v224, v225
  v_mov_b32 v14, v224
  s_nop 1
  v_permlane16_swap_b32 v224, v14
  v_add_f32 v224, v224, v14
  v_mov_b32 v14, v224
  s_nop 1
  v_permlane32_swap_b32 v224, v14
  v_add_f32 v224, v224, v14
  v_rcp_f32 v224, v224
  s_nop 0
  v_mul_f32 v220, v220, v224
  v_mul_f32 v221, v221, v224
  v_mul_f32 v222, v222, v224
  v_mul_f32 v223, v223, v224
  v_cvt_pk_bf16_f32 v220, v220, v221
  v_cvt_pk_bf16_f32 v221, v222, v223
  s_lshl_b32 s48, s18, 15
  s_add_u32 s48, s48, s22
  s_add_u32 s23, s23, 256
  buffer_store_dword v220, v5, s[4:7], s48 offen sc1
  buffer_store_dword v221, v5, s[4:7], s48 offen offset:32 sc1
  s_mov_b32 s27, 1
  s_cmp_eq_u32 s18, 63
  s_cbranch_scc1 Aq_end
  s_waitcnt vmcnt(2)
Aq_go:
  s_sub_u32 s49, 114688, s24
  s_sub_u32 s48, s49, s24
  v_add_u32 v58, s48, v58
  v_add_u32 v59, s48, v59
  v_add_u32 v60, s48, v60
  v_add_u32 v61, s48, v61
  s_mov_b32 s24, s49
  s_add_u32 s18, s18, 1
  s_barrier
  s_branch Aq_item
Aql_start:
  v_mfma_f32_16x16x16_bf16 v[144:147], v[72:73], v[44:45], 0
  v_mfma_f32_16x16x16_bf16 v[148:151], v[74:75], v[44:45], 0
  v_mfma_f32_16x16x16_bf16 v[152:155], v[76:77], v[44:45], 0
  v_mfma_f32_16x16x16_bf16 v[156:159], v[78:79], v[44:45], 0
  v_mfma_f32_16x16x16_bf16 v[160:163], v[80:81], v[44:45], 0
  v_mfma_f32_16x16x16_bf16 v[164:167], v[82:83], v[44:45], 0
  v_mfma_f32_16x16x16_bf16 v[168:171], v[84:85], v[44:45], 0
  v_mfma_f32_16x16x16_bf16 v[172:175], v[86:87], v[44:45], 0
  v_mfma_f32_16x16x16_bf16 v[176:179], v[88:89], v[44:45], 0
  v_mfma_f32_16x16x16_bf16 v[180:183], v[90:91], v[44:45], 0
  v_mfma_f32_16x16x16_bf16 v[184:187], v[92:93], v[44:45], 0
  v_mfma_f32_16x16x16_bf16 v[188:191], v[94:95], v[44:45], 0
  v_mfma_f32_16x16x16_bf16 v[192:195], v[96:97], v[44:45], 0
  v_mfma_f32_16x16x16_bf16 v[196:199], v[98:99], v[44:45], 0
  v_mfma_f32_16x16x16_bf16 v[200:203], v[100:101], v[44:45], 0
  v_mfma_f32_16x16x16_bf16 v[204:207], v[102:103], v[44:45], 0
  s_nop 7
  s_add_u32 s48, s18, 0
  s_cmp_ge_u32 s48, 8
  s_cbranch_scc1 Aql_nv0
  v_mov_b32 v144, v9
  v_mov_b32 v145, v9
  v_mov_b32 v146, v9
  v_mov_b32 v147, v9
  v_mov_b32 v148, v9
  v_mov_b32 v149, v9
  v_mov_b32 v150, v9
  v_mov_b32 v151, v9
Aql_nv0:
  s_add_u32 s48, s18, 1
  s_cmp_ge_u32 s48, 8
  s_cbranch_scc1 Aql_nv1
  v_mov_b32 v152, v9
  v_mov_b32 v153, v9
  v_mov_b32 v154, v9
  v_mov_b32 v155, v9
  v_mov_b32 v156, v9
  v_mov_b32 v157, v9
  v_mov_b32 v158, v9
  v_mov_b32 v159, v9
Aql_nv1:
  s_add_u32 s48, s18, 2
  s_cmp_ge_u32 s48, 8
  s_cbranch_scc1 Aql_nv2
  v_mov_b32 v160, v9
  v_mov_b32 v161, v9
  v_mov_b32 v162, v9
  v_mov_b32 v163, v9
  v_mov_b32 v164, v9
  v_mov_b32 v165, v9
  v_mov_b32 v166, v9
  v_mov_b32 v167, v9
Aql_nv2:
  s_add_u32 s48, s18, 3
  s_cmp_ge_u32 s48, 8
  s_cbranch_scc1 Aql_nv3
  v_mov_b32 v168, v9
  v_mov_b32 v169, v9
  v_mov_b32 v170, v9
  v_mov_b32 v171, v9
  v_mov_b32 v172, v9
  v_mov_b32 v173, v9
  v_mov_b32 v174, v9
  v_mov_b32 v175, v9
Aql_nv3:
  s_add_u32 s48, s18, 4
  s_cmp_ge_u32 s48, 8
  s_cbranch_scc1 Aql_nv4
  v_mov_b32 v176, v9
  v_mov_b32 v177, v9
  v_mov_b32 v178, v9
  v_mov_b32 v179, v9
  v_mov_b32 v180, v9
  v_mov_b32 v181, v9
  v_mov_b32 v182, v9
  v_mov_b32 v183, v9
Aql_nv4:
  s_add_u32 s48, s18, 5
  s_cmp_ge_u32 s48, 8
  s_cbranch_scc1 Aql_nv5
  v_mov_b32 v184, v9
  v_mov_b32 v185, v9
  v_mov_b32 v186, v9
  v_mov_b32 v187, v9
  v_mov_b32 v188, v9
  v_mov_b32 v189, v9
  v_mov_b32 v190, v9
  v_mov_b32 v191, v9
Aql_nv5:
  s_add_u32 s48, s18, 6
  s_cmp_ge_u32 s48, 8
  s_cbranch_scc1 Aql_nv6
  v_mov_b32 v192, v9
  v_mov_b32 v193, v9
  v_mov_b32 v194, v9
  v_mov_b32 v195, v9
  v_mov_b32 v196, v9
  v_mov_b32 v197, v9
  v_mov_b32 v198, v9
  v_mov_b32 v199, v9
Aql_nv6:
  s_add_u32 s48, s18, 7
  s_cmp_ge_u32 s48, 8
  s_cbranch_scc1 Aql_nv7
  v_mov_b32 v200, v9
  v_mov_b32 v201, v9
  v_mov_b32 v202, v9
  v_mov_b32 v203, v9
  v_mov_b32 v204, v9
  v_mov_b32 v205, v9
  v_mov_b32 v206, v9
  v_mov_b32 v207, v9
Aql_nv7:
  v_cndmask_b32 v144, v9, v144, s[30:31]
  v_cndmask_b32 v145, v9, v145, s[32:33]
  v_cndmask_b32 v146, v9, v146, s[34:35]
  v_cndmask_b32 v147, v9, v147, s[36:37]
  v_cndmask_b32 v148, v9, v148, s[38:39]
  v_cndmask_b32 v149, v9, v149, s[40:41]
  v_cndmask_b32 v150, v9, v150, s[42:43]
  v_cndmask_b32 v151, v9, v151, s[44:45]
  v_max3_f32 v11, v152, v153, v154
  v_max3_f32 v12, v155, v156, v157
  v_max3_f32 v11, v11, v158, v159
  v_max3_f32 v11, v11, v160, v161
  v_max3_f32 v12, v12, v162, v163
  v_max3_f32 v11, v11, v164, v165
  v_max3_f32 v12, v12, v166, v167
  v_max3_f32 v11, v11, v168, v169
  v_max3_f32 v12, v12, v170, v171
  v_max3_f32 v11, v11, v172, v173
  v_max3_f32 v12, v12, v174, v175
  v_max3_f32 v11, v11, v176, v177
  v_max3_f32 v12, v12, v178, v179
  v_max3_f32 v11, v11, v180, v181
  v_max3_f32 v12, v12, v182, v183
  v_max3_f32 v11, v11, v184, v185
  v_max3_f32 v12, v12, v186, v187
  v_max3_f32 v11, v11, v188, v189
  v_max3_f32 v12, v12, v190, v191
  v_max3_f32 v11, v11, v192, v193
  v_max3_f32 v12, v12, v194, v195
  v_max3_f32 v11, v11, v196, v197
  v_max3_f32 v12, v12, v198, v199
  v_max3_f32 v11, v11, v200, v201
  v_max3_f32 v12, v12, v202, v203
  v_max3_f32 v11, v11, v204, v205
  v_max3_f32 v12, v12, v206, v207
  s_branch Aql_mxdone
Aqe_start:
  v_mfma_f32_16x16x16_bf16 v[144:147], v[72:73], v[44:45], 0
  v_mfma_f32_16x16x16_bf16 v[148:151], v[74:75], v[44:45], 0
  v_mfma_f32_16x16x16_bf16 v[152:155], v[76:77], v[44:45], 0
  v_mfma_f32_16x16x16_bf16 v[156:159], v[78:79], v[44:45], 0
  v_mfma_f32_16x16x16_bf16 v[160:163], v[80:81], v[44:45], 0
  v_mfma_f32_16x16x16_bf16 v[164:167], v[82:83], v[44:45], 0
  v_mfma_f32_16x16x16_bf16 v[168:171], v[84:85], v[44:45], 0
  v_mfma_f32_16x16x16_bf16 v[172:175], v[86:87], v[44:45], 0
  v_mfma_f32_16x16x16_bf16 v[176:179], v[88:89], v[44:45], 0
  v_mfma_f32_16x16x16_bf16 v[180:183], v[90:91], v[44:45], 0
  v_mfma_f32_16x16x16_bf16 v[184:187], v[92:93], v[44:45], 0
  v_mfma_f32_16x16x16_bf16 v[188:191], v[94:95], v[44:45], 0
  v_mfma_f32_16x16x16_bf16 v[192:195], v[96:97], v[44:45], 0
  v_mfma_f32_16x16x16_bf16 v[196:199], v[98:99], v[44:45], 0
  v_mfma_f32_16x16x16_bf16 v[200:203], v[100:101], v[44:45], 0
  v_mfma_f32_16x16x16_bf16 v[204:207], v[102:103], v[44:45], 0
  s_nop 7
  s_add_u32 s48, s18, 0
  s_cmp_ge_u32 s48, 8
  s_cbranch_scc1 Aqe_nv0
  v_mov_b32 v144, v9
  v_mov_b32 v145, v9
  v_mov_b32 v146, v9
  v_mov_b32 v147, v9
  v_mov_b32 v148, v9
  v_mov_b32 v149, v9
  v_mov_b32 v150, v9
  v_mov_b32 v151, v9
Aqe_nv0:
  s_add_u32 s48, s18, 1
  s_cmp_ge_u32 s48, 8
  s_cbranch_scc1 Aqe_nv1
  v_mov_b32 v152, v9
  v_mov_b32 v153, v9
  v_mov_b32 v154, v9
  v_mov_b32 v155, v9
  v_mov_b32 v156, v9
  v_mov_b32 v157, v9
  v_mov_b32 v158, v9
  v_mov_b32 v159, v9
Aqe_nv1:
  s_add_u32 s48, s18, 2
  s_cmp_ge_u32 s48, 8
  s_cbranch_scc1 Aqe_nv2
  v_mov_b32 v160, v9
  v_mov_b32 v161, v9
  v_mov_b32 v162, v9
  v_mov_b32 v163, v9
  v_mov_b32 v164, v9
  v_mov_b32 v165, v9
  v_mov_b32 v166, v9
  v_mov_b32 v167, v9
Aqe_nv2:
  s_add_u32 s48, s18, 3
  s_cmp_ge_u32 s48, 8
  s_cbranch_scc1 Aqe_nv3
  v_mov_b32 v168, v9
  v_mov_b32 v169, v9
  v_mov_b32 v170, v9
  v_mov_b32 v171, v9
  v_mov_b32 v172, v9
  v_mov_b32 v173, v9
  v_mov_b32 v174, v9
  v_mov_b32 v175, v9
Aqe_nv3:
  s_add_u32 s48, s18, 4
  s_cmp_ge_u32 s48, 8
  s_cbranch_scc1 Aqe_nv4
  v_mov_b32 v176, v9
  v_mov_b32 v177, v9
  v_mov_b32 v178, v9
  v_mov_b32 v179, v9
  v_mov_b32 v180, v9
  v_mov_b32 v181, v9
  v_mov_b32 v182, v9
  v_mov_b32 v183, v9
Aqe_nv4:
  s_add_u32 s48, s18, 5
  s_cmp_ge_u32 s48, 8
  s_cbranch_scc1 Aqe_nv5
  v_mov_b32 v184, v9
  v_mov_b32 v185, v9
  v_mov_b32 v186, v9
  v_mov_b32 v187, v9
  v_mov_b32 v188, v9
  v_mov_b32 v189, v9
  v_mov_b32 v190, v9
  v_mov_b32 v191, v9
Aqe_nv5:
  s_add_u32 s48, s18, 6
  s_cmp_ge_u32 s48, 8
  s_cbranch_scc1 Aqe_nv6
  v_mov_b32 v192, v9
  v_mov_b32 v193, v9
  v_mov_b32 v194, v9
  v_mov_b32 v195, v9
  v_mov_b32 v196, v9
  v_mov_b32 v197, v9
  v_mov_b32 v198, v9
  v_mov_b32 v199, v9
Aqe_nv6:
  s_add_u32 s48, s18, 7
  s_cmp_ge_u32 s48, 8
  s_cbranch_scc1 Aqe_nv7
  v_mov_b32 v200, v9
  v_mov_b32 v201, v9
  v_mov_b32 v202, v9
  v_mov_b32 v203, v9
  v_mov_b32 v204, v9
  v_mov_b32 v205, v9
  v_mov_b32 v206, v9
  v_mov_b32 v207, v9
Aqe_nv7:
  v_cndmask_b32 v144, v9, v144, s[30:31]
  v_cndmask_b32 v145, v9, v145, s[32:33]
  v_cndmask_b32 v146, v9, v146, s[34:35]
  v_cndmask_b32 v147, v9, v147, s[36:37]
  v_cndmask_b32 v148, v9, v148, s[38:39]
  v_cndmask_b32 v149, v9, v149, s[40:41]
  v_cndmask_b32 v150, v9, v150, s[42:43]
  v_cndmask_b32 v151, v9, v151, s[44:45]
  v_max3_f32 v11, v152, v153, v154
  v_max3_f32 v12, v155, v156, v157
  v_max3_f32 v11, v11, v158, v159
  v_max3_f32 v11, v11, v160, v161
  v_max3_f32 v12, v12, v162, v163
  v_max3_f32 v11, v11, v164, v165
  v_max3_f32 v12, v12, v166, v167
  v_max3_f32 v11, v11, v168, v169
  v_max3_f32 v12, v12, v170, v171
  v_max3_f32 v11, v11, v172, v173
  v_max3_f32 v12, v12, v174, v175
  v_max3_f32 v11, v11, v176, v177
  v_max3_f32 v12, v12, v178, v179
  v_max3_f32 v11, v11, v180, v181
  v_max3_f32 v12, v12, v182, v183
  v_max3_f32 v11, v11, v184, v185
  v_max3_f32 v12, v12, v186, v187
  v_max3_f32 v11, v11, v188, v189
  v_max3_f32 v12, v12, v190, v191
  v_max3_f32 v11, v11, v192, v193
  v_max3_f32 v12, v12, v194, v195
  v_max3_f32 v11, v11, v196, v197
  v_max3_f32 v12, v12, v198, v199
  v_max3_f32 v11, v11, v200, v201
  v_max3_f32 v12, v12, v202, v203
  v_max3_f32 v11, v11, v204, v205
  v_max3_f32 v12, v12, v206, v207
  s_branch Aqe_mxdone
Aq_end:
  s_waitcnt vmcnt(0)
  v_mov_b32 v8, 1
  s_sub_u32 s48, s23, 256
  s_mov_b64 exec, 1
  buffer_store_dword v8, v7, s[4:7], s48 offen sc1
  s_mov_b64 exec, -1
  s_mov_b32 s27, 0
  s_waitcnt vmcnt(0)
  s_endpgm
O_entry:
  s_lshr_b32 s18, s13, 2
  s_lshl_b32 s18, s18, 19
  s_and_b32 s19, s13, 3
  s_lshl_b32 s19, s19, 8
  s_add_u32 s18, s18, s19
  v_lshrrev_b32 v28, 4, v0
  v_and_b32 v29, 15, v0
  v_lshrrev_b32 v29, 1, v29
  v_xor_b32 v24, v29, v28
  v_xor_b32 v25, 4, v24
  v_lshlrev_b32 v24, 5, v24
  v_lshlrev_b32 v25, 5, v25
  v_lshlrev_b32 v28, 10, v28
  v_and_b32 v29, 1, v0
  v_lshlrev_b32 v29, 4, v29
  v_add3_u32 v24, v24, v28, v29
  v_add3_u32 v25, v25, v28, v29
  v_lshrrev_b32 v28, 4, v0
  v_bfe_u32 v29, v0, 2, 2
  v_lshlrev_b32 v26, 3, v28
  v_add_u32 v26, v26, v29
  v_lshlrev_b32 v26, 8, v26
  v_and_b32 v28, 1, v28
  v_lshl_add_u32 v29, v28, 2, v29
  v_bfe_u32 v28, v0, 1, 1
  s_lshl_b32 s16, s12, 1
  v_add_u32 v28, s16, v28
  v_xor_b32 v28, v28, v29
  v_lshl_add_u32 v26, v28, 5, v26
  v_and_b32 v28, 1, v0
  v_lshl_add_u32 v26, v28, 4, v26
  v_add_u32 v27, 0x10000, v26
  s_load_dwordx2 s[8:9], s[0:1], 64
  s_waitcnt lgkmcnt(0)
  s_mov_b32 s10, 4194304
  s_mov_b32 s11, 0x20000
  s_lshl_b32 s16, s12, 17
  s_add_u32 s16, s16, s18
  s_lshl_b32 s17, s12, 15
  s_mov_b32 m0, s17
  s_add_u32 s17, s17, 1024
  buffer_load_dwordx4 v24, s[8:11], s16 offen lds
  s_add_u32 s16, s16, 4096
  s_mov_b32 m0, s17
  s_add_u32 s17, s17, 1024
  buffer_load_dwordx4 v24, s[8:11], s16 offen lds
  s_add_u32 s16, s16, 4096
  s_mov_b32 m0, s17
  s_add_u32 s17, s17, 1024
  buffer_load_dwordx4 v25, s[8:11], s16 offen lds
  s_add_u32 s16, s16, 4096
  s_mov_b32 m0, s17
  s_add_u32 s17, s17, 1024
  buffer_load_dwordx4 v25, s[8:11], s16 offen lds
  s_add_u32 s16, s16, 4096
  s_mov_b32 m0, s17
  s_add_u32 s17, s17, 1024
  buffer_load_dwordx4 v24, s[8:11], s16 offen lds
  s_add_u32 s16, s16, 4096
  s_mov_b32 m0, s17
  s_add_u32 s17, s17, 1024
  buffer_load_dwordx4 v24, s[8:11], s16 offen lds
  s_add_u32 s16, s16, 4096
  s_mov_b32 m0, s17
  s_add_u32 s17, s17, 1024
  buffer_load_dwordx4 v25, s[8:11], s16 offen lds
  s_add_u32 s16, s16, 4096
  s_mov_b32 m0, s17
  s_add_u32 s17, s17, 1024
  buffer_load_dwordx4 v25, s[8:11], s16 offen lds
  s_add_u32 s16, s16, 4096
  s_mov_b32 m0, s17
  s_add_u32 s17, s17, 1024
  buffer_load_dwordx4 v24, s[8:11], s16 offen lds
  s_add_u32 s16, s16, 4096
  s_mov_b32 m0, s17
  s_add_u32 s17, s17, 1024
  buffer_load_dwordx4 v24, s[8:11], s16 offen lds
  s_add_u32 s16, s16, 4096
  s_mov_b32 m0, s17
  s_add_u32 s17, s17, 1024
  buffer_load_dwordx4 v25, s[8:11], s16 offen lds
  s_add_u32 s16, s16, 4096
  s_mov_b32 m0, s17
  s_add_u32 s17, s17, 1024
  buffer_load_dwordx4 v25, s[8:11], s16 offen lds
  s_add_u32 s16, s16, 4096
  s_mov_b32 m0, s17
  s_add_u32 s17, s17, 1024
  buffer_load_dwordx4 v24, s[8:11], s16 offen lds
  s_add_u32 s16, s16, 4096
  s_mov_b32 m0, s17
  s_add_u32 s17, s17, 1024
  buffer_load_dwordx4 v24, s[8:11], s16 offen lds
  s_add_u32 s16, s16, 4096
  s_mov_b32 m0, s17
  s_add_u32 s17, s17, 1024
  buffer_load_dwordx4 v25, s[8:11], s16 offen lds
  s_add_u32 s16, s16, 4096
  s_mov_b32 m0, s17
  s_add_u32 s17, s17, 1024
  buffer_load_dwordx4 v25, s[8:11], s16 offen lds
  s_add_u32 s16, s16, 4096
  s_mov_b32 m0, s17
  s_add_u32 s17, s17, 1024
  buffer_load_dwordx4 v24, s[8:11], s16 offen lds
  s_add_u32 s16, s16, 4096
  s_mov_b32 m0, s17
  s_add_u32 s17, s17, 1024
  buffer_load_dwordx4 v24, s[8:11], s16 offen lds
  s_add_u32 s16, s16, 4096
  s_mov_b32 m0, s17
  s_add_u32 s17, s17, 1024
  buffer_load_dwordx4 v25, s[8:11], s16 offen lds
  s_add_u32 s16, s16, 4096
  s_mov_b32 m0, s17
  s_add_u32 s17, s17, 1024
  buffer_load_dwordx4 v25, s[8:11], s16 offen lds
  s_add_u32 s16, s16, 4096
  s_mov_b32 m0, s17
  s_add_u32 s17, s17, 1024
  buffer_load_dwordx4 v24, s[8:11], s16 offen lds
  s_add_u32 s16, s16, 4096
  s_mov_b32 m0, s17
  s_add_u32 s17, s17, 1024
  buffer_load_dwordx4 v24, s[8:11], s16 offen lds
  s_add_u32 s16, s16, 4096
  s_mov_b32 m0, s17
  s_add_u32 s17, s17, 1024
  buffer_load_dwordx4 v25, s[8:11], s16 offen lds
  s_add_u32 s16, s16, 4096
  s_mov_b32 m0, s17
  s_add_u32 s17, s17, 1024
  buffer_load_dwordx4 v25, s[8:11], s16 offen lds
  s_add_u32 s16, s16, 4096
  s_mov_b32 m0, s17
  s_add_u32 s17, s17, 1024
  buffer_load_dwordx4 v24, s[8:11], s16 offen lds
  s_add_u32 s16, s16, 4096
  s_mov_b32 m0, s17
  s_add_u32 s17, s17, 1024
  buffer_load_dwordx4 v24, s[8:11], s16 offen lds
  s_add_u32 s16, s16, 4096
  s_mov_b32 m0, s17
  s_add_u32 s17, s17, 1024
  buffer_load_dwordx4 v25, s[8:11], s16 offen lds
  s_add_u32 s16, s16, 4096
  s_mov_b32 m0, s17
  s_add_u32 s17, s17, 1024
  buffer_load_dwordx4 v25, s[8:11], s16 offen lds
  s_add_u32 s16, s16, 4096
  s_mov_b32 m0, s17
  s_add_u32 s17, s17, 1024
  buffer_load_dwordx4 v24, s[8:11], s16 offen lds
  s_add_u32 s16, s16, 4096
  s_mov_b32 m0, s17
  s_add_u32 s17, s17, 1024
  buffer_load_dwordx4 v24, s[8:11], s16 offen lds
  s_add_u32 s16, s16, 4096
  s_mov_b32 m0, s17
  s_add_u32 s17, s17, 1024
  buffer_load_dwordx4 v25, s[8:11], s16 offen lds
  s_add_u32 s16, s16, 4096
  s_mov_b32 m0, s17
  s_add_u32 s17, s17, 1024
  buffer_load_dwordx4 v25, s[8:11], s16 offen lds
  s_add_u32 s16, s16, 4096
  s_waitcnt vmcnt(0)
  s_barrier
  ds_read_b64_tr_b16 a[0:1], v26 offset:0
  ds_read_b64_tr_b16 a[2:3], v26 offset:1024
  ds_read_b64_tr_b16 a[4:5], v26 offset:8192
  ds_read_b64_tr_b16 a[6:7], v26 offset:9216
  ds_read_b64_tr_b16 a[8:9], v26 offset:16384
  ds_read_b64_tr_b16 a[10:11], v26 offset:17408
  ds_read_b64_tr_b16 a[12:13], v26 offset:24576
  ds_read_b64_tr_b16 a[14:15], v26 offset:25600
  ds_read_b64_tr_b16 a[16:17], v26 offset:32768
  ds_read_b64_tr_b16 a[18:19], v26 offset:33792
  ds_read_b64_tr_b16 a[20:21], v26 offset:40960
  ds_read_b64_tr_b16 a[22:23], v26 offset:41984
  ds_read_b64_tr_b16 a[24:25], v26 offset:49152
  ds_read_b64_tr_b16 a[26:27], v26 offset:50176
  ds_read_b64_tr_b16 a[28:29], v26 offset:57344
  ds_read_b64_tr_b16 a[30:31], v26 offset:58368
  ds_read_b64_tr_b16 a[32:33], v27 offset:0
  ds_read_b64_tr_b16 a[34:35], v27 offset:1024
  ds_read_b64_tr_b16 a[36:37], v27 offset:8192
  ds_read_b64_tr_b16 a[38:39], v27 offset:9216
  ds_read_b64_tr_b16 a[40:41], v27 offset:16384
  ds_read_b64_tr_b16 a[42:43], v27 offset:17408
  ds_read_b64_tr_b16 a[44:45], v27 offset:24576
  ds_read_b64_tr_b16 a[46:47], v27 offset:25600
  ds_read_b64_tr_b16 a[48:49], v27 offset:32768
  ds_read_b64_tr_b16 a[50:51], v27 offset:33792
  ds_read_b64_tr_b16 a[52:53], v27 offset:40960
  ds_read_b64_tr_b16 a[54:55], v27 offset:41984
  ds_read_b64_tr_b16 a[56:57], v27 offset:49152
  ds_read_b64_tr_b16 a[58:59], v27 offset:50176
  ds_read_b64_tr_b16 a[60:61], v27 offset:57344
  ds_read_b64_tr_b16 a[62:63], v27 offset:58368
  ds_read_b64_tr_b16 a[64:65], v26 offset:8
  ds_read_b64_tr_b16 a[66:67], v26 offset:1032
  ds_read_b64_tr_b16 a[68:69], v26 offset:8200
  ds_read_b64_tr_b16 a[70:71], v26 offset:9224
  ds_read_b64_tr_b16 a[72:73], v26 offset:16392
  ds_read_b64_tr_b16 a[74:75], v26 offset:17416
  ds_read_b64_tr_b16 a[76:77], v26 offset:24584
  ds_read_b64_tr_b16 a[78:79], v26 offset:25608
  ds_read_b64_tr_b16 a[80:81], v26 offset:32776
  ds_read_b64_tr_b16 a[82:83], v26 offset:33800
  ds_read_b64_tr_b16 a[84:85], v26 offset:40968
  ds_read_b64_tr_b16 a[86:87], v26 offset:41992
  ds_read_b64_tr_b16 a[88:89], v26 offset:49160
  ds_read_b64_tr_b16 a[90:91], v26 offset:50184
  ds_read_b64_tr_b16 a[92:93], v26 offset:57352
  ds_read_b64_tr_b16 a[94:95], v26 offset:58376
  ds_read_b64_tr_b16 a[96:97], v27 offset:8
  ds_read_b64_tr_b16 a[98:99], v27 offset:1032
  ds_read_b64_tr_b16 a[100:101], v27 offset:8200
  ds_read_b64_tr_b16 a[102:103], v27 offset:9224
  ds_read_b64_tr_b16 a[104:105], v27 offset:16392
  ds_read_b64_tr_b16 a[106:107], v27 offset:17416
  ds_read_b64_tr_b16 a[108:109], v27 offset:24584
  ds_read_b64_tr_b16 a[110:111], v27 offset:25608
  ds_read_b64_tr_b16 a[112:113], v27 offset:32776
  ds_read_b64_tr_b16 a[114:115], v27 offset:33800
  ds_read_b64_tr_b16 a[116:117], v27 offset:40968
  ds_read_b64_tr_b16 a[118:119], v27 offset:41992
  ds_read_b64_tr_b16 a[120:121], v27 offset:49160
  ds_read_b64_tr_b16 a[122:123], v27 offset:50184
  ds_read_b64_tr_b16 a[124:125], v27 offset:57352
  ds_read_b64_tr_b16 a[126:127], v27 offset:58376
  s_waitcnt lgkmcnt(0)
  s_barrier
  v_and_b32 v24, 15, v0
  v_lshrrev_b32 v25, 4, v0
  v_lshlrev_b32 v1, 4, v0
  v_mov_b32 v2, v1
  v_mov_b32 v8, 0
  v_and_b32 v26, 7, v0
  v_lshlrev_b32 v3, 2, v26
  v_bfe_u32 v26, v0, 3, 1
  v_lshl_add_u32 v3, v26, 8, v3
  s_lshr_b32 s16, s13, 2
  s_lshl_b32 s16, s16, 5
  v_add_u32 v3, s16, v3
  v_lshlrev_b32 v4, 13, v24
  v_lshl_add_u32 v4, v25, 4, v4
  s_lshr_b32 s16, s13, 2
  s_lshl_b32 s16, s16, 10
  s_and_b32 s17, s13, 3
  s_lshl_b32 s17, s17, 8
  s_add_u32 s16, s16, s17
  s_lshl_b32 s17, s12, 6
  s_add_u32 s16, s16, s17
  v_add_u32 v4, s16, v4
  v_lshlrev_b32 v5, 10, v25
  v_lshl_add_u32 v5, v24, 4, v5
  s_lshl_b32 s16, s13, 13
  s_lshl_b32 s17, s12, 8
  s_add_u32 s16, s16, s17
  v_add_u32 v5, s16, v5
  v_lshl_add_u32 v26, v25, 5, v24
  s_lshl_b32 s16, s12, 7
  v_add_u32 v26, s16, v26
  v_lshlrev_b32 v6, 2, v26
  v_add_u32 v6, 65536, v6
  v_lshlrev_b32 v7, 5, v0
  v_add_u32 v7, 65536, v7
  v_mov_b32 v12, 0
  v_cmp_eq_u32 vcc, 0, v24
  v_mov_b32 v26, 0x3f80
  s_nop 0
  v_cndmask_b32 v12, v12, v26, vcc
  v_cmp_eq_u32 vcc, 1, v24
  v_mov_b32 v26, 0x3f800000
  s_nop 0
  v_cndmask_b32 v12, v12, v26, vcc
  v_mov_b32 v13, 0
  v_cmp_eq_u32 vcc, 2, v24
  v_mov_b32 v26, 0x3f80
  s_nop 0
  v_cndmask_b32 v13, v13, v26, vcc
  v_cmp_eq_u32 vcc, 3, v24
  v_mov_b32 v26, 0x3f800000
  s_nop 0
  v_cndmask_b32 v13, v13, v26, vcc
  v_mov_b32 v14, 0
  v_cmp_eq_u32 vcc, 4, v24
  v_mov_b32 v26, 0x3f80
  s_nop 0
  v_cndmask_b32 v14, v14, v26, vcc
  v_cmp_eq_u32 vcc, 5, v24
  v_mov_b32 v26, 0x3f800000
  s_nop 0
  v_cndmask_b32 v14, v14, v26, vcc
  v_mov_b32 v15, 0
  v_cmp_eq_u32 vcc, 6, v24
  v_mov_b32 v26, 0x3f80
  s_nop 0
  v_cndmask_b32 v15, v15, v26, vcc
  v_cmp_eq_u32 vcc, 7, v24
  v_mov_b32 v26, 0x3f800000
  s_nop 0
  v_cndmask_b32 v15, v15, v26, vcc
  s_mov_b32 s32, 0x00FF00FF
  s_mov_b32 s33, 0x00FF00FF
  s_mov_b32 s40, 0x00FF00FF
  s_mov_b32 s41, 0x00FF00FF
  s_mov_b32 s42, 0xFF00FF00
  s_mov_b32 s43, 0xFF00FF00
  s_mov_b32 s31, 0
  s_mul_i32 s19, s14, 16777216
  s_lshr_b32 s16, s13, 2
  s_lshl_b32 s16, s16, 15
  s_add_u32 s19, s19, s16
  s_add_u32 s19, s19, 167772160
  s_mul_i32 s20, s14, 16384
  s_add_u32 s20, s20, 4521984
  s_mul_i32 s30, s14, 524288
  s_add_u32 s30, s30, 2097152
  s_lshl_b32 s16, s14, 1
  s_add_u32 s16, s16, 1
  s_mul_i32 s25, s16, 2097152
  s_lshl_b32 s17, s13, 10
  s_add_u32 s25, s25, s17
  s_add_u32 s25, s25, 16777216
  s_add_u32 s26, s17, 20971520
  s_add_u32 s27, s17, 12582912
  s_lshl_b32 s28, s13, 2
  s_add_u32 s28, s28, 4505600
  s_load_dwordx2 s[36:37], s[0:1], 80
  s_waitcnt lgkmcnt(0)
  s_mov_b32 s38, 2097152
  s_mov_b32 s39, 0x20000
  s_mov_b32 s18, 0
  s_mov_b32 s34, 0
  s_mov_b32 s21, 0
  s_mov_b32 s29, 0
  s_mov_b32 s99, 5
  s_load_dwordx2 s[8:9], s[0:1], 88
  s_waitcnt lgkmcnt(0)
  s_mov_b32 s10, 256
  s_mov_b32 s11, 0x20000
  v_and_b32 v21, 7, v0
  v_lshlrev_b32 v21, 4, v21
census_O:
  buffer_load_dword v20, v21, s[8:11], 0 offen sc1
  s_waitcnt vmcnt(0)
  s_mov_b32 s16, 0
  v_readlane_b32 s17, v20, 0
  s_nop 0
  s_add_u32 s16, s16, s17
  v_readlane_b32 s17, v20, 1
  s_nop 0
  s_add_u32 s16, s16, s17
  v_readlane_b32 s17, v20, 2
  s_nop 0
  s_add_u32 s16, s16, s17
  v_readlane_b32 s17, v20, 3
  s_nop 0
  s_add_u32 s16, s16, s17
  v_readlane_b32 s17, v20, 4
  s_nop 0
  s_add_u32 s16, s16, s17
  v_readlane_b32 s17, v20, 5
  s_nop 0
  s_add_u32 s16, s16, s17
  v_readlane_b32 s17, v20, 6
  s_nop 0
  s_add_u32 s16, s16, s17
  v_readlane_b32 s17, v20, 7
  s_nop 0
  s_add_u32 s16, s16, s17
  s_cmp_ge_u32 s16, 256
  s_cbranch_scc1 census_O_ok
  s_sub_u32 s15, s15, 1
  s_cbranch_scc1 census_O_ok
  s_branch census_O
census_O_ok:
  v_readlane_b32 s17, v20, s99
  s_nop 0
  s_cmp_ge_u32 s17, 32
  s_cselect_b32 s100, 1, 0
  s_mov_b32 s18, 0
  s_cmp_eq_u32 s100, 0
  s_cbranch_scc1 O_l0n
  s_cmp_eq_u32 s12, 0
  s_cbranch_scc1 O0l_first
ofw_O0l0:
  buffer_load_dword v20, v3, s[4:7], s20 offen sc1
  s_waitcnt vmcnt(0)
  v_cmp_eq_u32 vcc, 0, v20
  s_and_b64 vcc, vcc, s[40:41]
  s_cbranch_scc0 ofw_O0l0_ok
  s_sub_u32 s15, s15, 1
  s_cbranch_scc1 ofw_O0l0_ok
  s_sleep 24
  s_branch ofw_O0l0
ofw_O0l0_ok:
  s_sub_u32 s44, s12, 1
  s_lshl_b32 s44, s44, 10
  s_add_u32 s45, s44, s21
  s_add_u32 s44, s44, s19
  s_mov_b32 m0, s45
  s_add_u32 s45, s45, 3072
  buffer_load_dwordx4 v1, s[4:7], s44 offen sc1 lds
  s_add_u32 s44, s44, 3072
  s_mov_b32 m0, s45
  s_add_u32 s45, s45, 3072
  buffer_load_dwordx4 v1, s[4:7], s44 offen sc1 lds
  s_add_u32 s44, s44, 3072
  s_mov_b32 m0, s45
  s_add_u32 s45, s45, 3072
  buffer_load_dwordx4 v1, s[4:7], s44 offen sc1 lds
  s_add_u32 s44, s44, 3072
  s_mov_b32 m0, s45
  s_add_u32 s45, s45, 3072
  buffer_load_dwordx4 v1, s[4:7], s44 offen sc1 lds
  s_add_u32 s44, s44, 3072
  s_mov_b32 m0, s45
  s_add_u32 s45, s45, 3072
  buffer_load_dwordx4 v1, s[4:7], s44 offen sc1 lds
  s_add_u32 s44, s44, 3072
  s_mov_b32 m0, s45
  s_add_u32 s45, s45, 3072
  buffer_load_dwordx4 v1, s[4:7], s44 offen sc1 lds
  s_add_u32 s44, s44, 3072
  s_mov_b32 m0, s45
  s_add_u32 s45, s45, 3072
  buffer_load_dwordx4 v1, s[4:7], s44 offen sc1 lds
  s_add_u32 s44, s44, 3072
  s_mov_b32 m0, s45
  s_add_u32 s45, s45, 3072
  buffer_load_dwordx4 v1, s[4:7], s44 offen sc1 lds
  s_add_u32 s44, s44, 3072
  s_mov_b32 m0, s45
  s_add_u32 s45, s45, 3072
  buffer_load_dwordx4 v1, s[4:7], s44 offen sc1 lds
  s_add_u32 s44, s44, 3072
  s_mov_b32 m0, s45
  s_add_u32 s45, s45, 3072
  buffer_load_dwordx4 v1, s[4:7], s44 offen sc1 lds
  s_add_u32 s44, s44, 3072
  s_cmp_eq_u32 s12, 3
  s_cselect_b32 s47, 1024, 0
  s_sub_u32 s44, s44, s47
  s_sub_u32 s45, s45, s47
  s_mov_b32 m0, s45
  s_add_u32 s45, s45, 3072
  buffer_load_dwordx4 v1, s[4:7], s44 offen sc1 lds
  s_add_u32 s44, s44, 3072
  s_waitcnt vmcnt(0)
O0l_first:
  s_barrier
O0l_item:
  s_add_u32 s20, s20, 256
  s_add_u32 s19, s19, 262144
  buffer_load_dwordx4 v[104:107], v1, s[4:7], s25 offen sc1
  buffer_load_dword v22, v3, s[4:7], s20 offen sc1
  s_and_b32 s44, s18, 1
  s_mul_i32 s44, s44, 262144
  s_add_u32 s23, s44, s30
  s_bfe_u32 s24, s18, 0x10001
  ds_read_b128 v[24:27], v2 offset:0
  ds_read_b128 v[28:31], v2 offset:4096
  ds_read_b128 v[32:35], v2 offset:1024
  ds_read_b128 v[36:39], v2 offset:5120
  ds_read_b128 v[40:43], v2 offset:2048
  ds_read_b128 v[44:47], v2 offset:6144
  s_mov_b32 s22, s31
  s_cmp_lg_u32 s31, 0
  s_cbranch_scc1 O0l_mearly
  s_waitcnt lgkmcnt(4)
  v_mfma_f32_16x16x32_bf16 v[56:59], a[0:3], v[24:27], 0
  ds_read_b128 v[48:51], v2 offset:3072
  v_mfma_f32_16x16x32_bf16 v[60:63], a[0:3], v[28:31], 0
  ds_read_b128 v[52:55], v2 offset:7168
  v_mfma_f32_16x16x32_bf16 v[64:67], a[64:67], v[24:27], 0
  s_waitcnt lgkmcnt(4)
  v_mfma_f32_16x16x32_bf16 v[68:71], a[64:67], v[28:31], 0
  v_mfma_f32_16x16x32_bf16 v[56:59], a[4:7], v[32:35], v[56:59]
  ds_read_b128 v[24:27], v2 offset:8192
  v_mfma_f32_16x16x32_bf16 v[60:63], a[4:7], v[36:39], v[60:63]
  ds_read_b128 v[28:31], v2 offset:12288
  v_mfma_f32_16x16x32_bf16 v[64:67], a[68:71], v[32:35], v[64:67]
  s_waitcnt lgkmcnt(4)
  v_mfma_f32_16x16x32_bf16 v[68:71], a[68:71], v[36:39], v[68:71]
  v_mfma_f32_16x16x32_bf16 v[56:59], a[8:11], v[40:43], v[56:59]
  ds_read_b128 v[32:35], v2 offset:9216
  v_mfma_f32_16x16x32_bf16 v[60:63], a[8:11], v[44:47], v[60:63]
  ds_read_b128 v[36:39], v2 offset:13312
  v_mfma_f32_16x16x32_bf16 v[64:67], a[72:75], v[40:43], v[64:67]
  s_waitcnt lgkmcnt(4)
  v_mfma_f32_16x16x32_bf16 v[68:71], a[72:75], v[44:47], v[68:71]
  v_mfma_f32_16x16x32_bf16 v[56:59], a[12:15], v[48:51], v[56:59]
  ds_read_b128 v[40:43], v2 offset:10240
  v_mfma_f32_16x16x32_bf16 v[60:63], a[12:15], v[52:55], v[60:63]
  ds_read_b128 v[44:47], v2 offset:14336
  v_mfma_f32_16x16x32_bf16 v[64:67], a[76:79], v[48:51], v[64:67]
  s_waitcnt lgkmcnt(4)
  v_mfma_f32_16x16x32_bf16 v[68:71], a[76:79], v[52:55], v[68:71]
  v_mfma_f32_16x16x32_bf16 v[56:59], a[16:19], v[24:27], v[56:59]
  ds_read_b128 v[48:51], v2 offset:11264
  v_mfma_f32_16x16x32_bf16 v[60:63], a[16:19], v[28:31], v[60:63]
  ds_read_b128 v[52:55], v2 offset:15360
  v_mfma_f32_16x16x32_bf16 v[64:67], a[80:83], v[24:27], v[64:67]
  s_waitcnt lgkmcnt(4)
  v_mfma_f32_16x16x32_bf16 v[68:71], a[80:83], v[28:31], v[68:71]
  v_mfma_f32_16x16x32_bf16 v[56:59], a[20:23], v[32:35], v[56:59]
  ds_read_b128 v[24:27], v2 offset:16384
  v_mfma_f32_16x16x32_bf16 v[60:63], a[20:23], v[36:39], v[60:63]
  ds_read_b128 v[28:31], v2 offset:20480
  v_mfma_f32_16x16x32_bf16 v[64:67], a[84:87], v[32:35], v[64:67]
  s_waitcnt lgkmcnt(4)
  v_mfma_f32_16x16x32_bf16 v[68:71], a[84:87], v[36:39], v[68:71]
  v_mfma_f32_16x16x32_bf16 v[56:59], a[24:27], v[40:43], v[56:59]
  ds_read_b128 v[32:35], v2 offset:17408
  v_mfma_f32_16x16x32_bf16 v[60:63], a[24:27], v[44:47], v[60:63]
  ds_read_b128 v[36:39], v2 offset:21504
  v_mfma_f32_16x16x32_bf16 v[64:67], a[88:91], v[40:43], v[64:67]
  s_waitcnt lgkmcnt(4)
  v_mfma_f32_16x16x32_bf16 v[68:71], a[88:91], v[44:47], v[68:71]
  v_mfma_f32_16x16x32_bf16 v[56:59], a[28:31], v[48:51], v[56:59]
  ds_read_b128 v[40:43], v2 offset:18432
  v_mfma_f32_16x16x32_bf16 v[60:63], a[28:31], v[52:55], v[60:63]
  ds_read_b128 v[44:47], v2 offset:22528
  v_mfma_f32_16x16x32_bf16 v[64:67], a[92:95], v[48:51], v[64:67]
  s_waitcnt lgkmcnt(4)
  v_mfma_f32_16x16x32_bf16 v[68:71], a[92:95], v[52:55], v[68:71]
  v_mfma_f32_16x16x32_bf16 v[56:59], a[32:35], v[24:27], v[56:59]
  ds_read_b128 v[48:51], v2 offset:19456
  v_mfma_f32_16x16x32_bf16 v[60:63], a[32:35], v[28:31], v[60:63]
  ds_read_b128 v[52:55], v2 offset:23552
  v_mfma_f32_16x16x32_bf16 v[64:67], a[96:99], v[24:27], v[64:67]
  s_waitcnt lgkmcnt(4)
  v_mfma_f32_16x16x32_bf16 v[68:71], a[96:99], v[28:31], v[68:71]
  v_mfma_f32_16x16x32_bf16 v[56:59], a[36:39], v[32:35], v[56:59]
  ds_read_b128 v[24:27], v2 offset:24576
  v_mfma_f32_16x16x32_bf16 v[60:63], a[36:39], v[36:39], v[60:63]
  ds_read_b128 v[28:31], v2 offset:28672
  v_mfma_f32_16x16x32_bf16 v[64:67], a[100:103], v[32:35], v[64:67]
  s_waitcnt lgkmcnt(4)
  v_mfma_f32_16x16x32_bf16 v[68:71], a[100:103], v[36:39], v[68:71]
  v_mfma_f32_16x16x32_bf16 v[56:59], a[40:43], v[40:43], v[56:59]
  ds_read_b128 v[32:35], v2 offset:25600
  v_mfma_f32_16x16x32_bf16 v[60:63], a[40:43], v[44:47], v[60:63]
  ds_read_b128 v[36:39], v2 offset:29696
  v_mfma_f32_16x16x32_bf16 v[64:67], a[104:107], v[40:43], v[64:67]
  s_waitcnt lgkmcnt(4)
  v_mfma_f32_16x16x32_bf16 v[68:71], a[104:107], v[44:47], v[68:71]
  v_mfma_f32_16x16x32_bf16 v[56:59], a[44:47], v[48:51], v[56:59]
  ds_read_b128 v[40:43], v2 offset:26624
  v_mfma_f32_16x16x32_bf16 v[60:63], a[44:47], v[52:55], v[60:63]
  ds_read_b128 v[44:47], v2 offset:30720
  v_mfma_f32_16x16x32_bf16 v[64:67], a[108:111], v[48:51], v[64:67]
  s_waitcnt lgkmcnt(4)
  v_mfma_f32_16x16x32_bf16 v[68:71], a[108:111], v[52:55], v[68:71]
  v_mfma_f32_16x16x32_bf16 v[56:59], a[48:51], v[24:27], v[56:59]
  ds_read_b128 v[48:51], v2 offset:27648
  v_mfma_f32_16x16x32_bf16 v[60:63], a[48:51], v[28:31], v[60:63]
  ds_read_b128 v[52:55], v2 offset:31744
  v_mfma_f32_16x16x32_bf16 v[64:67], a[112:115], v[24:27], v[64:67]
  s_waitcnt lgkmcnt(4)
  v_mfma_f32_16x16x32_bf16 v[68:71], a[112:115], v[28:31], v[68:71]
  v_mfma_f32_16x16x32_bf16 v[56:59], a[52:55], v[32:35], v[56:59]
  v_mfma_f32_16x16x32_bf16 v[60:63], a[52:55], v[36:39], v[60:63]
  v_mfma_f32_16x16x32_bf16 v[64:67], a[116:119], v[32:35], v[64:67]
  s_waitcnt lgkmcnt(2)
  v_mfma_f32_16x16x32_bf16 v[68:71], a[116:119], v[36:39], v[68:71]
  v_mfma_f32_16x16x32_bf16 v[56:59], a[56:59], v[40:43], v[56:59]
  v_mfma_f32_16x16x32_bf16 v[60:63], a[56:59], v[44:47], v[60:63]
  v_mfma_f32_16x16x32_bf16 v[64:67], a[120:123], v[40:43], v[64:67]
  s_waitcnt lgkmcnt(0)
  v_mfma_f32_16x16x32_bf16 v[68:71], a[120:123], v[44:47], v[68:71]
  v_mfma_f32_16x16x32_bf16 v[56:59], a[60:63], v[48:51], v[56:59]
  v_mfma_f32_16x16x32_bf16 v[60:63], a[60:63], v[52:55], v[60:63]
  v_mfma_f32_16x16x32_bf16 v[64:67], a[124:127], v[48:51], v[64:67]
  v_mfma_f32_16x16x32_bf16 v[68:71], a[124:127], v[52:55], v[68:71]
  s_branch O0l_mdone
O0l_mearly:
  s_sub_u32 s46, 32768, s21
  s_waitcnt lgkmcnt(4)
  v_mfma_f32_16x16x32_bf16 v[56:59], a[0:3], v[24:27], 0
  ds_read_b128 v[48:51], v2 offset:3072
  v_mfma_f32_16x16x32_bf16 v[60:63], a[0:3], v[28:31], 0
  ds_read_b128 v[52:55], v2 offset:7168
  v_mfma_f32_16x16x32_bf16 v[64:67], a[64:67], v[24:27], 0
  s_waitcnt lgkmcnt(4)
  v_mfma_f32_16x16x32_bf16 v[68:71], a[64:67], v[28:31], 0
  s_sub_u32 s44, s12, 1
  s_lshl_b32 s44, s44, 10
  s_add_u32 s45, s44, s46
  s_add_u32 s44, s44, s19
  v_mfma_f32_16x16x32_bf16 v[56:59], a[4:7], v[32:35], v[56:59]
  ds_read_b128 v[24:27], v2 offset:8192
  v_mfma_f32_16x16x32_bf16 v[60:63], a[4:7], v[36:39], v[60:63]
  ds_read_b128 v[28:31], v2 offset:12288
  v_mfma_f32_16x16x32_bf16 v[64:67], a[68:71], v[32:35], v[64:67]
  s_waitcnt lgkmcnt(4)
  v_mfma_f32_16x16x32_bf16 v[68:71], a[68:71], v[36:39], v[68:71]
  s_mov_b32 m0, s45
  s_add_u32 s45, s45, 3072
  buffer_load_dwordx4 v1, s[4:7], s44 offen sc1 lds
  s_add_u32 s44, s44, 3072
  v_mfma_f32_16x16x32_bf16 v[56:59], a[8:11], v[40:43], v[56:59]
  ds_read_b128 v[32:35], v2 offset:9216
  v_mfma_f32_16x16x32_bf16 v[60:63], a[8:11], v[44:47], v[60:63]
  ds_read_b128 v[36:39], v2 offset:13312
  v_mfma_f32_16x16x32_bf16 v[64:67], a[72:75], v[40:43], v[64:67]
  s_waitcnt lgkmcnt(4)
  v_mfma_f32_16x16x32_bf16 v[68:71], a[72:75], v[44:47], v[68:71]
  s_mov_b32 m0, s45
  s_add_u32 s45, s45, 3072
  buffer_load_dwordx4 v1, s[4:7], s44 offen sc1 lds
  s_add_u32 s44, s44, 3072
  v_mfma_f32_16x16x32_bf16 v[56:59], a[12:15], v[48:51], v[56:59]
  ds_read_b128 v[40:43], v2 offset:10240
  v_mfma_f32_16x16x32_bf16 v[60:63], a[12:15], v[52:55], v[60:63]
  ds_read_b128 v[44:47], v2 offset:14336
  v_mfma_f32_16x16x32_bf16 v[64:67], a[76:79], v[48:51], v[64:67]
  s_waitcnt lgkmcnt(4)
  v_mfma_f32_16x16x32_bf16 v[68:71], a[76:79], v[52:55], v[68:71]
  s_mov_b32 m0, s45
  s_add_u32 s45, s45, 3072
  buffer_load_dwordx4 v1, s[4:7], s44 offen sc1 lds
  s_add_u32 s44, s44, 3072
  v_mfma_f32_16x16x32_bf16 v[56:59], a[16:19], v[24:27], v[56:59]
  ds_read_b128 v[48:51], v2 offset:11264
  v_mfma_f32_16x16x32_bf16 v[60:63], a[16:19], v[28:31], v[60:63]
  ds_read_b128 v[52:55], v2 offset:15360
  v_mfma_f32_16x16x32_bf16 v[64:67], a[80:83], v[24:27], v[64:67]
  s_waitcnt lgkmcnt(4)
  v_mfma_f32_16x16x32_bf16 v[68:71], a[80:83], v[28:31], v[68:71]
  s_mov_b32 m0, s45
  s_add_u32 s45, s45, 3072
  buffer_load_dwordx4 v1, s[4:7], s44 offen sc1 lds
  s_add_u32 s44, s44, 3072
  v_mfma_f32_16x16x32_bf16 v[56:59], a[20:23], v[32:35], v[56:59]
  ds_read_b128 v[24:27], v2 offset:16384
  v_mfma_f32_16x16x32_bf16 v[60:63], a[20:23], v[36:39], v[60:63]
  ds_read_b128 v[28:31], v2 offset:20480
  v_mfma_f32_16x16x32_bf16 v[64:67], a[84:87], v[32:35], v[64:67]
  s_waitcnt lgkmcnt(4)
  v_mfma_f32_16x16x32_bf16 v[68:71], a[84:87], v[36:39], v[68:71]
  s_mov_b32 m0, s45
  s_add_u32 s45, s45, 3072
  buffer_load_dwordx4 v1, s[4:7], s44 offen sc1 lds
  s_add_u32 s44, s44, 3072
  v_mfma_f32_16x16x32_bf16 v[56:59], a[24:27], v[40:43], v[56:59]
  ds_read_b128 v[32:35], v2 offset:17408
  v_mfma_f32_16x16x32_bf16 v[60:63], a[24:27], v[44:47], v[60:63]
  ds_read_b128 v[36:39], v2 offset:21504
  v_mfma_f32_16x16x32_bf16 v[64:67], a[88:91], v[40:43], v[64:67]
  s_waitcnt lgkmcnt(4)
  v_mfma_f32_16x16x32_bf16 v[68:71], a[88:91], v[44:47], v[68:71]
  s_mov_b32 m0, s45
  s_add_u32 s45, s45, 3072
  buffer_load_dwordx4 v1, s[4:7], s44 offen sc1 lds
  s_add_u32 s44, s44, 3072
  v_mfma_f32_16x16x32_bf16 v[56:59], a[28:31], v[48:51], v[56:59]
  ds_read_b128 v[40:43], v2 offset:18432
  v_mfma_f32_16x16x32_bf16 v[60:63], a[28:31], v[52:55], v[60:63]
  ds_read_b128 v[44:47], v2 offset:22528
  v_mfma_f32_16x16x32_bf16 v[64:67], a[92:95], v[48:51], v[64:67]
  s_waitcnt lgkmcnt(4)
  v_mfma_f32_16x16x32_bf16 v[68:71], a[92:95], v[52:55], v[68:71]
  s_mov_b32 m0, s45
  s_add_u32 s45, s45, 3072
  buffer_load_dwordx4 v1, s[4:7], s44 offen sc1 lds
  s_add_u32 s44, s44, 3072
  v_mfma_f32_16x16x32_bf16 v[56:59], a[32:35], v[24:27], v[56:59]
  ds_read_b128 v[48:51], v2 offset:19456
  v_mfma_f32_16x16x32_bf16 v[60:63], a[32:35], v[28:31], v[60:63]
  ds_read_b128 v[52:55], v2 offset:23552
  v_mfma_f32_16x16x32_bf16 v[64:67], a[96:99], v[24:27], v[64:67]
  s_waitcnt lgkmcnt(4)
  v_mfma_f32_16x16x32_bf16 v[68:71], a[96:99], v[28:31], v[68:71]
  s_mov_b32 m0, s45
  s_add_u32 s45, s45, 3072
  buffer_load_dwordx4 v1, s[4:7], s44 offen sc1 lds
  s_add_u32 s44, s44, 3072
  v_mfma_f32_16x16x32_bf16 v[56:59], a[36:39], v[32:35], v[56:59]
  ds_read_b128 v[24:27], v2 offset:24576
  v_mfma_f32_16x16x32_bf16 v[60:63], a[36:39], v[36:39], v[60:63]
  ds_read_b128 v[28:31], v2 offset:28672
  v_mfma_f32_16x16x32_bf16 v[64:67], a[100:103], v[32:35], v[64:67]
  s_waitcnt lgkmcnt(4)
  v_mfma_f32_16x16x32_bf16 v[68:71], a[100:103], v[36:39], v[68:71]
  s_mov_b32 m0, s45
  s_add_u32 s45, s45, 3072
  buffer_load_dwordx4 v1, s[4:7], s44 offen sc1 lds
  s_add_u32 s44, s44, 3072
  v_mfma_f32_16x16x32_bf16 v[56:59], a[40:43], v[40:43], v[56:59]
  ds_read_b128 v[32:35], v2 offset:25600
  v_mfma_f32_16x16x32_bf16 v[60:63], a[40:43], v[44:47], v[60:63]
  ds_read_b128 v[36:39], v2 offset:29696
  v_mfma_f32_16x16x32_bf16 v[64:67], a[104:107], v[40:43], v[64:67]
  s_waitcnt lgkmcnt(4)
  v_mfma_f32_16x16x32_bf16 v[68:71], a[104:107], v[44:47], v[68:71]
  s_mov_b32 m0, s45
  s_add_u32 s45, s45, 3072
  buffer_load_dwordx4 v1, s[4:7], s44 offen sc1 lds
  s_add_u32 s44, s44, 3072
  v_mfma_f32_16x16x32_bf16 v[56:59], a[44:47], v[48:51], v[56:59]
  ds_read_b128 v[40:43], v2 offset:26624
  v_mfma_f32_16x16x32_bf16 v[60:63], a[44:47], v[52:55], v[60:63]
  ds_read_b128 v[44:47], v2 offset:30720
  v_mfma_f32_16x16x32_bf16 v[64:67], a[108:111], v[48:51], v[64:67]
  s_waitcnt lgkmcnt(4)
  v_mfma_f32_16x16x32_bf16 v[68:71], a[108:111], v[52:55], v[68:71]
  s_cmp_eq_u32 s12, 3
  s_cselect_b32 s47, 1024, 0
  s_sub_u32 s44, s44, s47
  s_sub_u32 s45, s45, s47
  s_mov_b32 m0, s45
  s_add_u32 s45, s45, 3072
  buffer_load_dwordx4 v1, s[4:7], s44 offen sc1 lds
  s_add_u32 s44, s44, 3072
  v_mfma_f32_16x16x32_bf16 v[56:59], a[48:51], v[24:27], v[56:59]
  ds_read_b128 v[48:51], v2 offset:27648
  v_mfma_f32_16x16x32_bf16 v[60:63], a[48:51], v[28:31], v[60:63]
  ds_read_b128 v[52:55], v2 offset:31744
  v_mfma_f32_16x16x32_bf16 v[64:67], a[112:115], v[24:27], v[64:67]
  s_waitcnt lgkmcnt(4)
  v_mfma_f32_16x16x32_bf16 v[68:71], a[112:115], v[28:31], v[68:71]
  v_mfma_f32_16x16x32_bf16 v[56:59], a[52:55], v[32:35], v[56:59]
  v_mfma_f32_16x16x32_bf16 v[60:63], a[52:55], v[36:39], v[60:63]
  v_mfma_f32_16x16x32_bf16 v[64:67], a[116:119], v[32:35], v[64:67]
  s_waitcnt lgkmcnt(2)
  v_mfma_f32_16x16x32_bf16 v[68:71], a[116:119], v[36:39], v[68:71]
  v_mfma_f32_16x16x32_bf16 v[56:59], a[56:59], v[40:43], v[56:59]
  v_mfma_f32_16x16x32_bf16 v[60:63], a[56:59], v[44:47], v[60:63]
  v_mfma_f32_16x16x32_bf16 v[64:67], a[120:123], v[40:43], v[64:67]
  s_waitcnt lgkmcnt(0)
  v_mfma_f32_16x16x32_bf16 v[68:71], a[120:123], v[44:47], v[68:71]
  v_mfma_f32_16x16x32_bf16 v[56:59], a[60:63], v[48:51], v[56:59]
  v_mfma_f32_16x16x32_bf16 v[60:63], a[60:63], v[52:55], v[60:63]
  v_mfma_f32_16x16x32_bf16 v[64:67], a[124:127], v[48:51], v[64:67]
  v_mfma_f32_16x16x32_bf16 v[68:71], a[124:127], v[52:55], v[68:71]
O0l_mdone:
  s_nop 5
  v_cvt_pk_bf16_f32 v72, v56, v57
  v_cvt_pk_bf16_f32 v73, v58, v59
  v_cvt_pk_bf16_f32 v74, v64, v65
  v_cvt_pk_bf16_f32 v75, v66, v67
  v_bfi_b32 v72, 1, s24, v72
  s_add_u32 s44, s23, 0
  buffer_store_dwordx4 v[72:75], v4, s[4:7], s44 offen
  v_cvt_pk_bf16_f32 v76, v60, v61
  v_cvt_pk_bf16_f32 v77, v62, v63
  v_cvt_pk_bf16_f32 v78, v68, v69
  v_cvt_pk_bf16_f32 v79, v70, v71
  v_bfi_b32 v76, 1, s24, v76
  s_add_u32 s44, s23, 131072
  buffer_store_dwordx4 v[76:79], v4, s[4:7], s44 offen
  s_waitcnt vmcnt(0)
  buffer_load_dwordx4 v[80:83], v5, s[4:7], s23 offen nt
  s_add_u32 s44, s23, 4096
  buffer_load_dwordx4 v[84:87], v5, s[4:7], s44 offen nt
  s_waitcnt vmcnt(0)
  v_bitop3_b32 v21, v80, v84, s24 bitop3:0x7E
  v_and_b32 v21, 1, v21
  v_cmp_ne_u32 vcc, 0, v21
  s_cbranch_vccz O0l_in_ok
O0l_in:
  s_mov_b64 exec, vcc
  buffer_load_dwordx4 v[80:83], v5, s[4:7], s23 offen nt
  s_add_u32 s44, s23, 4096
  buffer_load_dwordx4 v[84:87], v5, s[4:7], s44 offen nt
  s_sub_u32 s15, s15, 1
  s_cbranch_scc1 O0l_in_ok
  s_waitcnt vmcnt(0)
  v_bitop3_b32 v21, v80, v84, s24 bitop3:0x7E
  v_and_b32 v21, 1, v21
  v_cmp_ne_u32 vcc, 0, v21
  s_cbranch_vccnz O0l_in
O0l_in_ok:
  s_mov_b64 exec, -1
  buffer_load_dword v20, v3, s[4:7], s20 offen sc1
  s_nop 2
  v_mfma_f32_16x16x32_bf16 v[88:91], v[80:83], v[12:15], 0
  v_mfma_f32_16x16x32_bf16 v[88:91], v[84:87], v[12:15], v[88:91]
  s_nop 7
  s_mov_b64 exec, s[32:33]
  ds_write_b32 v6, v88 offset:0
  ds_write_b32 v6, v89 offset:32
  ds_write_b32 v6, v90 offset:64
  ds_write_b32 v6, v91 offset:96
  s_mov_b64 exec, -1
  s_waitcnt lgkmcnt(0)
  s_barrier
  s_cmp_lg_u32 s12, 0
  s_cbranch_scc1 O0l_fin
  ds_read_b128 v[96:99], v7
  ds_read_b128 v[100:103], v7 offset:16
  s_waitcnt lgkmcnt(0)
  v_cvt_pk_bf16_f32 v108, v96, v97
  v_cvt_pk_bf16_f32 v109, v98, v99
  v_cvt_pk_bf16_f32 v110, v100, v101
  v_cvt_pk_bf16_f32 v111, v102, v103
  v_lshlrev_b32 v96, 16, v108
  v_and_b32 v97, 0xffff0000, v108
  v_lshlrev_b32 v98, 16, v109
  v_and_b32 v99, 0xffff0000, v109
  v_lshlrev_b32 v100, 16, v110
  v_and_b32 v101, 0xffff0000, v110
  v_lshlrev_b32 v102, 16, v111
  v_and_b32 v103, 0xffff0000, v111
  v_lshlrev_b32 v112, 16, v104
  v_and_b32 v113, 0xffff0000, v104
  v_lshlrev_b32 v114, 16, v105
  v_and_b32 v115, 0xffff0000, v105
  v_lshlrev_b32 v116, 16, v106
  v_and_b32 v117, 0xffff0000, v106
  v_lshlrev_b32 v118, 16, v107
  v_and_b32 v119, 0xffff0000, v107
  v_pk_add_f32 v[96:97], v[96:97], v[112:113]
  v_pk_add_f32 v[98:99], v[98:99], v[114:115]
  v_pk_add_f32 v[100:101], v[100:101], v[116:117]
  v_pk_add_f32 v[102:103], v[102:103], v[118:119]
  v_cvt_pk_bf16_f32 v104, v96, v97
  v_cvt_pk_bf16_f32 v105, v98, v99
  v_cvt_pk_bf16_f32 v106, v100, v101
  v_cvt_pk_bf16_f32 v107, v102, v103
  v_lshlrev_b32 v96, 16, v104
  v_and_b32 v97, 0xffff0000, v104
  v_lshlrev_b32 v98, 16, v105
  v_and_b32 v99, 0xffff0000, v105
  v_lshlrev_b32 v100, 16, v106
  v_and_b32 v101, 0xffff0000, v106
  v_lshlrev_b32 v102, 16, v107
  v_and_b32 v103, 0xffff0000, v107
  v_pk_add_f32 v[108:109], v[96:97], v[98:99]
  v_pk_add_f32 v[110:111], v[100:101], v[102:103]
  v_pk_add_f32 v[108:109], v[108:109], v[110:111]
  v_add_f32 v112, v108, v109
  s_nop 1
  v_add_f32_dpp v112, v112, v112 quad_perm:[1,0,3,2] row_mask:0xf bank_mask:0xf
  s_nop 1
  v_add_f32_dpp v112, v112, v112 quad_perm:[2,3,0,1] row_mask:0xf bank_mask:0xf
  s_nop 1
  v_add_f32_dpp v112, v112, v112 row_ror:4 row_mask:0xf bank_mask:0xf
  s_nop 1
  v_add_f32_dpp v112, v112, v112 row_ror:8 row_mask:0xf bank_mask:0xf
  v_mov_b32 v113, v112
  s_nop 1
  v_permlane16_swap_b32 v112, v113
  v_add_f32 v112, v112, v113
  v_mov_b32 v113, v112
  s_nop 1
  v_permlane32_swap_b32 v112, v113
  v_add_f32 v112, v112, v113
  v_mul_f32 v112, 0xbb000000, v112
  v_mov_b32 v113, v112
  v_pk_add_f32 v[96:97], v[96:97], v[112:113]
  v_pk_add_f32 v[98:99], v[98:99], v[112:113]
  v_pk_add_f32 v[100:101], v[100:101], v[112:113]
  v_pk_add_f32 v[102:103], v[102:103], v[112:113]
  v_pk_mul_f32 v[108:109], v[96:97], v[96:97]
  v_pk_fma_f32 v[108:109], v[98:99], v[98:99], v[108:109]
  v_pk_fma_f32 v[108:109], v[100:101], v[100:101], v[108:109]
  v_pk_fma_f32 v[108:109], v[102:103], v[102:103], v[108:109]
  v_add_f32 v114, v108, v109
  s_nop 1
  v_add_f32_dpp v114, v114, v114 quad_perm:[1,0,3,2] row_mask:0xf bank_mask:0xf
  s_nop 1
  v_add_f32_dpp v114, v114, v114 quad_perm:[2,3,0,1] row_mask:0xf bank_mask:0xf
  s_nop 1
  v_add_f32_dpp v114, v114, v114 row_ror:4 row_mask:0xf bank_mask:0xf
  s_nop 1
  v_add_f32_dpp v114, v114, v114 row_ror:8 row_mask:0xf bank_mask:0xf
  v_mov_b32 v115, v114
  s_nop 1
  v_permlane16_swap_b32 v114, v115
  v_add_f32 v114, v114, v115
  v_mov_b32 v115, v114
  s_nop 1
  v_permlane32_swap_b32 v114, v115
  v_add_f32 v114, v114, v115
  v_mov_b32 v115, 0x3727c5ac
  v_fmac_f32 v115, 0x3b000000, v114
  v_rsq_f32 v114, v115
  s_nop 0
  v_mov_b32 v115, v114
  v_pk_mul_f32 v[96:97], v[96:97], v[114:115]
  v_pk_mul_f32 v[98:99], v[98:99], v[114:115]
  v_pk_mul_f32 v[100:101], v[100:101], v[114:115]
  v_pk_mul_f32 v[102:103], v[102:103], v[114:115]
  v_cvt_pk_bf16_f32 v108, v96, v97
  v_cvt_pk_bf16_f32 v109, v98, v99
  v_cvt_pk_bf16_f32 v110, v100, v101
  v_cvt_pk_bf16_f32 v111, v102, v103
  buffer_store_dwordx4 v[108:111], v1, s[4:7], s27 offen sc1
  buffer_store_dwordx4 v[104:107], v1, s[4:7], s26 offen sc1
  s_waitcnt vmcnt(0)
  v_mov_b32 v21, 1
  s_mov_b64 exec, 1
  buffer_store_dword v21, v8, s[4:7], s28 offen sc1
  s_mov_b64 exec, -1
  s_cmp_eq_u32 s34, 63
  s_cbranch_scc1 O0l_end
  s_branch O0l_go
O0l_fin:
  s_cmp_eq_u32 s34, 63
  s_cbranch_scc1 O0l_end
  s_cmp_eq_u32 s22, 0
  s_cbranch_scc1 O0l_late
  v_cmp_eq_u32 vcc, 0, v22
  s_and_b64 s[44:45], vcc, s[42:43]
  s_cselect_b32 s31, 0, 1
  s_cmp_ge_u32 s34, 62
  s_cselect_b32 s31, 0, s31
  s_branch O0l_go
O0l_late:
  s_waitcnt vmcnt(0)
  v_cmp_eq_u32 vcc, 0, v20
  s_and_b64 s[44:45], vcc, s[42:43]
  s_cselect_b32 s31, 0, 1
  s_cmp_ge_u32 s34, 62
  s_cselect_b32 s31, 0, s31
  s_and_b64 vcc, vcc, s[40:41]
  s_cbranch_scc0 O0l_chk
ofw_O0l1:
  buffer_load_dword v20, v3, s[4:7], s20 offen sc1
  s_waitcnt vmcnt(0)
  v_cmp_eq_u32 vcc, 0, v20
  s_and_b64 vcc, vcc, s[40:41]
  s_cbranch_scc0 ofw_O0l1_ok
  s_sub_u32 s15, s15, 1
  s_cbranch_scc1 ofw_O0l1_ok
  s_sleep 24
  s_branch ofw_O0l1
ofw_O0l1_ok:
  v_cmp_eq_u32 vcc, 0, v20
  s_and_b64 s[44:45], vcc, s[42:43]
  s_cselect_b32 s31, 0, 1
  s_cmp_ge_u32 s34, 62
  s_cselect_b32 s31, 0, s31
  s_and_b64 vcc, vcc, s[40:41]
  s_branch O0l_copy
O0l_chk:
  s_cmp_lg_u32 s22, 0
  s_cbranch_scc1 O0l_go
O0l_copy:
  s_sub_u32 s46, 32768, s21
  s_sub_u32 s44, s12, 1
  s_lshl_b32 s44, s44, 10
  s_add_u32 s45, s44, s46
  s_add_u32 s44, s44, s19
  s_mov_b32 m0, s45
  s_add_u32 s45, s45, 3072
  buffer_load_dwordx4 v1, s[4:7], s44 offen sc1 lds
  s_add_u32 s44, s44, 3072
  s_mov_b32 m0, s45
  s_add_u32 s45, s45, 3072
  buffer_load_dwordx4 v1, s[4:7], s44 offen sc1 lds
  s_add_u32 s44, s44, 3072
  s_mov_b32 m0, s45
  s_add_u32 s45, s45, 3072
  buffer_load_dwordx4 v1, s[4:7], s44 offen sc1 lds
  s_add_u32 s44, s44, 3072
  s_mov_b32 m0, s45
  s_add_u32 s45, s45, 3072
  buffer_load_dwordx4 v1, s[4:7], s44 offen sc1 lds
  s_add_u32 s44, s44, 3072
  s_mov_b32 m0, s45
  s_add_u32 s45, s45, 3072
  buffer_load_dwordx4 v1, s[4:7], s44 offen sc1 lds
  s_add_u32 s44, s44, 3072
  s_mov_b32 m0, s45
  s_add_u32 s45, s45, 3072
  buffer_load_dwordx4 v1, s[4:7], s44 offen sc1 lds
  s_add_u32 s44, s44, 3072
  s_mov_b32 m0, s45
  s_add_u32 s45, s45, 3072
  buffer_load_dwordx4 v1, s[4:7], s44 offen sc1 lds
  s_add_u32 s44, s44, 3072
  s_mov_b32 m0, s45
  s_add_u32 s45, s45, 3072
  buffer_load_dwordx4 v1, s[4:7], s44 offen sc1 lds
  s_add_u32 s44, s44, 3072
  s_mov_b32 m0, s45
  s_add_u32 s45, s45, 3072
  buffer_load_dwordx4 v1, s[4:7], s44 offen sc1 lds
  s_add_u32 s44, s44, 3072
  s_mov_b32 m0, s45
  s_add_u32 s45, s45, 3072
  buffer_load_dwordx4 v1, s[4:7], s44 offen sc1 lds
  s_add_u32 s44, s44, 3072
  s_cmp_eq_u32 s12, 3
  s_cselect_b32 s47, 1024, 0
  s_sub_u32 s44, s44, s47
  s_sub_u32 s45, s45, s47
  s_mov_b32 m0, s45
  s_add_u32 s45, s45, 3072
  buffer_load_dwordx4 v1, s[4:7], s44 offen sc1 lds
  s_add_u32 s44, s44, 3072
  s_waitcnt vmcnt(0)
O0l_go:
  s_sub_u32 s46, 32768, s21
  s_sub_u32 s44, s46, s21
  v_add_u32 v2, s44, v2
  s_mov_b32 s21, s46
  s_add_u32 s18, s18, 1
  s_add_u32 s34, s34, 1
  s_add_u32 s25, s25, 32768
  s_add_u32 s26, s26, 32768
  s_add_u32 s27, s27, 32768
  s_add_u32 s28, s28, 128
  s_barrier
  s_branch O0l_item
O0l_end:
  s_waitcnt vmcnt(0)
  s_barrier
  s_mov_b32 s18, 64
  s_mov_b32 s34, 52
  s_mov_b32 s31, 0
  s_lshr_b32 s16, s13, 2
  s_lshl_b32 s16, s16, 15
  s_add_u32 s19, s16, 198180864
  s_mov_b32 s20, 4551680
  s_lshl_b32 s17, s13, 10
  s_add_u32 s25, s17, 24772608
  s_cmp_eq_u32 s12, 0
  s_cbranch_scc1 O2l_first
ofw_O2l0:
  buffer_load_dword v20, v3, s[4:7], s20 offen sc1
  s_waitcnt vmcnt(0)
  v_cmp_eq_u32 vcc, 0, v20
  s_and_b64 vcc, vcc, s[40:41]
  s_cbranch_scc0 ofw_O2l0_ok
  s_sub_u32 s15, s15, 1
  s_cbranch_scc1 ofw_O2l0_ok
  s_sleep 24
  s_branch ofw_O2l0
ofw_O2l0_ok:
  s_sub_u32 s44, s12, 1
  s_lshl_b32 s44, s44, 10
  s_add_u32 s45, s44, s21
  s_add_u32 s44, s44, s19
  s_mov_b32 m0, s45
  s_add_u32 s45, s45, 3072
  buffer_load_dwordx4 v1, s[4:7], s44 offen sc1 lds
  s_add_u32 s44, s44, 3072
  s_mov_b32 m0, s45
  s_add_u32 s45, s45, 3072
  buffer_load_dwordx4 v1, s[4:7], s44 offen sc1 lds
  s_add_u32 s44, s44, 3072
  s_mov_b32 m0, s45
  s_add_u32 s45, s45, 3072
  buffer_load_dwordx4 v1, s[4:7], s44 offen sc1 lds
  s_add_u32 s44, s44, 3072
  s_mov_b32 m0, s45
  s_add_u32 s45, s45, 3072
  buffer_load_dwordx4 v1, s[4:7], s44 offen sc1 lds
  s_add_u32 s44, s44, 3072
  s_mov_b32 m0, s45
  s_add_u32 s45, s45, 3072
  buffer_load_dwordx4 v1, s[4:7], s44 offen sc1 lds
  s_add_u32 s44, s44, 3072
  s_mov_b32 m0, s45
  s_add_u32 s45, s45, 3072
  buffer_load_dwordx4 v1, s[4:7], s44 offen sc1 lds
  s_add_u32 s44, s44, 3072
  s_mov_b32 m0, s45
  s_add_u32 s45, s45, 3072
  buffer_load_dwordx4 v1, s[4:7], s44 offen sc1 lds
  s_add_u32 s44, s44, 3072
  s_mov_b32 m0, s45
  s_add_u32 s45, s45, 3072
  buffer_load_dwordx4 v1, s[4:7], s44 offen sc1 lds
  s_add_u32 s44, s44, 3072
  s_mov_b32 m0, s45
  s_add_u32 s45, s45, 3072
  buffer_load_dwordx4 v1, s[4:7], s44 offen sc1 lds
  s_add_u32 s44, s44, 3072
  s_mov_b32 m0, s45
  s_add_u32 s45, s45, 3072
  buffer_load_dwordx4 v1, s[4:7], s44 offen sc1 lds
  s_add_u32 s44, s44, 3072
  s_cmp_eq_u32 s12, 3
  s_cselect_b32 s47, 1024, 0
  s_sub_u32 s44, s44, s47
  s_sub_u32 s45, s45, s47
  s_mov_b32 m0, s45
  s_add_u32 s45, s45, 3072
  buffer_load_dwordx4 v1, s[4:7], s44 offen sc1 lds
  s_add_u32 s44, s44, 3072
  s_waitcnt vmcnt(0)
O2l_first:
  s_barrier
O2l_item:
  s_add_u32 s20, s20, 256
  s_add_u32 s19, s19, 262144
  buffer_load_dwordx4 v[104:107], v1, s[4:7], s25 offen sc1
  buffer_load_dword v22, v3, s[4:7], s20 offen sc1
  s_and_b32 s44, s18, 1
  s_mul_i32 s44, s44, 262144
  s_add_u32 s23, s44, s30
  s_bfe_u32 s24, s18, 0x10001
  ds_read_b128 v[24:27], v2 offset:0
  ds_read_b128 v[28:31], v2 offset:4096
  ds_read_b128 v[32:35], v2 offset:1024
  ds_read_b128 v[36:39], v2 offset:5120
  ds_read_b128 v[40:43], v2 offset:2048
  ds_read_b128 v[44:47], v2 offset:6144
  s_mov_b32 s22, s31
  s_cmp_lg_u32 s31, 0
  s_cbranch_scc1 O2l_mearly
  s_waitcnt lgkmcnt(4)
  v_mfma_f32_16x16x32_bf16 v[56:59], a[0:3], v[24:27], 0
  ds_read_b128 v[48:51], v2 offset:3072
  v_mfma_f32_16x16x32_bf16 v[60:63], a[0:3], v[28:31], 0
  ds_read_b128 v[52:55], v2 offset:7168
  v_mfma_f32_16x16x32_bf16 v[64:67], a[64:67], v[24:27], 0
  s_waitcnt lgkmcnt(4)
  v_mfma_f32_16x16x32_bf16 v[68:71], a[64:67], v[28:31], 0
  v_mfma_f32_16x16x32_bf16 v[56:59], a[4:7], v[32:35], v[56:59]
  ds_read_b128 v[24:27], v2 offset:8192
  v_mfma_f32_16x16x32_bf16 v[60:63], a[4:7], v[36:39], v[60:63]
  ds_read_b128 v[28:31], v2 offset:12288
  v_mfma_f32_16x16x32_bf16 v[64:67], a[68:71], v[32:35], v[64:67]
  s_waitcnt lgkmcnt(4)
  v_mfma_f32_16x16x32_bf16 v[68:71], a[68:71], v[36:39], v[68:71]
  v_mfma_f32_16x16x32_bf16 v[56:59], a[8:11], v[40:43], v[56:59]
  ds_read_b128 v[32:35], v2 offset:9216
  v_mfma_f32_16x16x32_bf16 v[60:63], a[8:11], v[44:47], v[60:63]
  ds_read_b128 v[36:39], v2 offset:13312
  v_mfma_f32_16x16x32_bf16 v[64:67], a[72:75], v[40:43], v[64:67]
  s_waitcnt lgkmcnt(4)
  v_mfma_f32_16x16x32_bf16 v[68:71], a[72:75], v[44:47], v[68:71]
  v_mfma_f32_16x16x32_bf16 v[56:59], a[12:15], v[48:51], v[56:59]
  ds_read_b128 v[40:43], v2 offset:10240
  v_mfma_f32_16x16x32_bf16 v[60:63], a[12:15], v[52:55], v[60:63]
  ds_read_b128 v[44:47], v2 offset:14336
  v_mfma_f32_16x16x32_bf16 v[64:67], a[76:79], v[48:51], v[64:67]
  s_waitcnt lgkmcnt(4)
  v_mfma_f32_16x16x32_bf16 v[68:71], a[76:79], v[52:55], v[68:71]
  v_mfma_f32_16x16x32_bf16 v[56:59], a[16:19], v[24:27], v[56:59]
  ds_read_b128 v[48:51], v2 offset:11264
  v_mfma_f32_16x16x32_bf16 v[60:63], a[16:19], v[28:31], v[60:63]
  ds_read_b128 v[52:55], v2 offset:15360
  v_mfma_f32_16x16x32_bf16 v[64:67], a[80:83], v[24:27], v[64:67]
  s_waitcnt lgkmcnt(4)
  v_mfma_f32_16x16x32_bf16 v[68:71], a[80:83], v[28:31], v[68:71]
  v_mfma_f32_16x16x32_bf16 v[56:59], a[20:23], v[32:35], v[56:59]
  ds_read_b128 v[24:27], v2 offset:16384
  v_mfma_f32_16x16x32_bf16 v[60:63], a[20:23], v[36:39], v[60:63]
  ds_read_b128 v[28:31], v2 offset:20480
  v_mfma_f32_16x16x32_bf16 v[64:67], a[84:87], v[32:35], v[64:67]
  s_waitcnt lgkmcnt(4)
  v_mfma_f32_16x16x32_bf16 v[68:71], a[84:87], v[36:39], v[68:71]
  v_mfma_f32_16x16x32_bf16 v[56:59], a[24:27], v[40:43], v[56:59]
  ds_read_b128 v[32:35], v2 offset:17408
  v_mfma_f32_16x16x32_bf16 v[60:63], a[24:27], v[44:47], v[60:63]
  ds_read_b128 v[36:39], v2 offset:21504
  v_mfma_f32_16x16x32_bf16 v[64:67], a[88:91], v[40:43], v[64:67]
  s_waitcnt lgkmcnt(4)
  v_mfma_f32_16x16x32_bf16 v[68:71], a[88:91], v[44:47], v[68:71]
  v_mfma_f32_16x16x32_bf16 v[56:59], a[28:31], v[48:51], v[56:59]
  ds_read_b128 v[40:43], v2 offset:18432
  v_mfma_f32_16x16x32_bf16 v[60:63], a[28:31], v[52:55], v[60:63]
  ds_read_b128 v[44:47], v2 offset:22528
  v_mfma_f32_16x16x32_bf16 v[64:67], a[92:95], v[48:51], v[64:67]
  s_waitcnt lgkmcnt(4)
  v_mfma_f32_16x16x32_bf16 v[68:71], a[92:95], v[52:55], v[68:71]
  v_mfma_f32_16x16x32_bf16 v[56:59], a[32:35], v[24:27], v[56:59]
  ds_read_b128 v[48:51], v2 offset:19456
  v_mfma_f32_16x16x32_bf16 v[60:63], a[32:35], v[28:31], v[60:63]
  ds_read_b128 v[52:55], v2 offset:23552
  v_mfma_f32_16x16x32_bf16 v[64:67], a[96:99], v[24:27], v[64:67]
  s_waitcnt lgkmcnt(4)
  v_mfma_f32_16x16x32_bf16 v[68:71], a[96:99], v[28:31], v[68:71]
  v_mfma_f32_16x16x32_bf16 v[56:59], a[36:39], v[32:35], v[56:59]
  ds_read_b128 v[24:27], v2 offset:24576
  v_mfma_f32_16x16x32_bf16 v[60:63], a[36:39], v[36:39], v[60:63]
  ds_read_b128 v[28:31], v2 offset:28672
  v_mfma_f32_16x16x32_bf16 v[64:67], a[100:103], v[32:35], v[64:67]
  s_waitcnt lgkmcnt(4)
  v_mfma_f32_16x16x32_bf16 v[68:71], a[100:103], v[36:39], v[68:71]
  v_mfma_f32_16x16x32_bf16 v[56:59], a[40:43], v[40:43], v[56:59]
  ds_read_b128 v[32:35], v2 offset:25600
  v_mfma_f32_16x16x32_bf16 v[60:63], a[40:43], v[44:47], v[60:63]
  ds_read_b128 v[36:39], v2 offset:29696
  v_mfma_f32_16x16x32_bf16 v[64:67], a[104:107], v[40:43], v[64:67]
  s_waitcnt lgkmcnt(4)
  v_mfma_f32_16x16x32_bf16 v[68:71], a[104:107], v[44:47], v[68:71]
  v_mfma_f32_16x16x32_bf16 v[56:59], a[44:47], v[48:51], v[56:59]
  ds_read_b128 v[40:43], v2 offset:26624
  v_mfma_f32_16x16x32_bf16 v[60:63], a[44:47], v[52:55], v[60:63]
  ds_read_b128 v[44:47], v2 offset:30720
  v_mfma_f32_16x16x32_bf16 v[64:67], a[108:111], v[48:51], v[64:67]
  s_waitcnt lgkmcnt(4)
  v_mfma_f32_16x16x32_bf16 v[68:71], a[108:111], v[52:55], v[68:71]
  v_mfma_f32_16x16x32_bf16 v[56:59], a[48:51], v[24:27], v[56:59]
  ds_read_b128 v[48:51], v2 offset:27648
  v_mfma_f32_16x16x32_bf16 v[60:63], a[48:51], v[28:31], v[60:63]
  ds_read_b128 v[52:55], v2 offset:31744
  v_mfma_f32_16x16x32_bf16 v[64:67], a[112:115], v[24:27], v[64:67]
  s_waitcnt lgkmcnt(4)
  v_mfma_f32_16x16x32_bf16 v[68:71], a[112:115], v[28:31], v[68:71]
  v_mfma_f32_16x16x32_bf16 v[56:59], a[52:55], v[32:35], v[56:59]
  v_mfma_f32_16x16x32_bf16 v[60:63], a[52:55], v[36:39], v[60:63]
  v_mfma_f32_16x16x32_bf16 v[64:67], a[116:119], v[32:35], v[64:67]
  s_waitcnt lgkmcnt(2)
  v_mfma_f32_16x16x32_bf16 v[68:71], a[116:119], v[36:39], v[68:71]
  v_mfma_f32_16x16x32_bf16 v[56:59], a[56:59], v[40:43], v[56:59]
  v_mfma_f32_16x16x32_bf16 v[60:63], a[56:59], v[44:47], v[60:63]
  v_mfma_f32_16x16x32_bf16 v[64:67], a[120:123], v[40:43], v[64:67]
  s_waitcnt lgkmcnt(0)
  v_mfma_f32_16x16x32_bf16 v[68:71], a[120:123], v[44:47], v[68:71]
  v_mfma_f32_16x16x32_bf16 v[56:59], a[60:63], v[48:51], v[56:59]
  v_mfma_f32_16x16x32_bf16 v[60:63], a[60:63], v[52:55], v[60:63]
  v_mfma_f32_16x16x32_bf16 v[64:67], a[124:127], v[48:51], v[64:67]
  v_mfma_f32_16x16x32_bf16 v[68:71], a[124:127], v[52:55], v[68:71]
  s_branch O2l_mdone
O2l_mearly:
  s_sub_u32 s46, 32768, s21
  s_waitcnt lgkmcnt(4)
  v_mfma_f32_16x16x32_bf16 v[56:59], a[0:3], v[24:27], 0
  ds_read_b128 v[48:51], v2 offset:3072
  v_mfma_f32_16x16x32_bf16 v[60:63], a[0:3], v[28:31], 0
  ds_read_b128 v[52:55], v2 offset:7168
  v_mfma_f32_16x16x32_bf16 v[64:67], a[64:67], v[24:27], 0
  s_waitcnt lgkmcnt(4)
  v_mfma_f32_16x16x32_bf16 v[68:71], a[64:67], v[28:31], 0
  s_sub_u32 s44, s12, 1
  s_lshl_b32 s44, s44, 10
  s_add_u32 s45, s44, s46
  s_add_u32 s44, s44, s19
  v_mfma_f32_16x16x32_bf16 v[56:59], a[4:7], v[32:35], v[56:59]
  ds_read_b128 v[24:27], v2 offset:8192
  v_mfma_f32_16x16x32_bf16 v[60:63], a[4:7], v[36:39], v[60:63]
  ds_read_b128 v[28:31], v2 offset:12288
  v_mfma_f32_16x16x32_bf16 v[64:67], a[68:71], v[32:35], v[64:67]
  s_waitcnt lgkmcnt(4)
  v_mfma_f32_16x16x32_bf16 v[68:71], a[68:71], v[36:39], v[68:71]
  s_mov_b32 m0, s45
  s_add_u32 s45, s45, 3072
  buffer_load_dwordx4 v1, s[4:7], s44 offen sc1 lds
  s_add_u32 s44, s44, 3072
  v_mfma_f32_16x16x32_bf16 v[56:59], a[8:11], v[40:43], v[56:59]
  ds_read_b128 v[32:35], v2 offset:9216
  v_mfma_f32_16x16x32_bf16 v[60:63], a[8:11], v[44:47], v[60:63]
  ds_read_b128 v[36:39], v2 offset:13312
  v_mfma_f32_16x16x32_bf16 v[64:67], a[72:75], v[40:43], v[64:67]
  s_waitcnt lgkmcnt(4)
  v_mfma_f32_16x16x32_bf16 v[68:71], a[72:75], v[44:47], v[68:71]
  s_mov_b32 m0, s45
  s_add_u32 s45, s45, 3072
  buffer_load_dwordx4 v1, s[4:7], s44 offen sc1 lds
  s_add_u32 s44, s44, 3072
  v_mfma_f32_16x16x32_bf16 v[56:59], a[12:15], v[48:51], v[56:59]
  ds_read_b128 v[40:43], v2 offset:10240
  v_mfma_f32_16x16x32_bf16 v[60:63], a[12:15], v[52:55], v[60:63]
  ds_read_b128 v[44:47], v2 offset:14336
  v_mfma_f32_16x16x32_bf16 v[64:67], a[76:79], v[48:51], v[64:67]
  s_waitcnt lgkmcnt(4)
  v_mfma_f32_16x16x32_bf16 v[68:71], a[76:79], v[52:55], v[68:71]
  s_mov_b32 m0, s45
  s_add_u32 s45, s45, 3072
  buffer_load_dwordx4 v1, s[4:7], s44 offen sc1 lds
  s_add_u32 s44, s44, 3072
  v_mfma_f32_16x16x32_bf16 v[56:59], a[16:19], v[24:27], v[56:59]
  ds_read_b128 v[48:51], v2 offset:11264
  v_mfma_f32_16x16x32_bf16 v[60:63], a[16:19], v[28:31], v[60:63]
  ds_read_b128 v[52:55], v2 offset:15360
  v_mfma_f32_16x16x32_bf16 v[64:67], a[80:83], v[24:27], v[64:67]
  s_waitcnt lgkmcnt(4)
  v_mfma_f32_16x16x32_bf16 v[68:71], a[80:83], v[28:31], v[68:71]
  s_mov_b32 m0, s45
  s_add_u32 s45, s45, 3072
  buffer_load_dwordx4 v1, s[4:7], s44 offen sc1 lds
  s_add_u32 s44, s44, 3072
  v_mfma_f32_16x16x32_bf16 v[56:59], a[20:23], v[32:35], v[56:59]
  ds_read_b128 v[24:27], v2 offset:16384
  v_mfma_f32_16x16x32_bf16 v[60:63], a[20:23], v[36:39], v[60:63]
  ds_read_b128 v[28:31], v2 offset:20480
  v_mfma_f32_16x16x32_bf16 v[64:67], a[84:87], v[32:35], v[64:67]
  s_waitcnt lgkmcnt(4)
  v_mfma_f32_16x16x32_bf16 v[68:71], a[84:87], v[36:39], v[68:71]
  s_mov_b32 m0, s45
  s_add_u32 s45, s45, 3072
  buffer_load_dwordx4 v1, s[4:7], s44 offen sc1 lds
  s_add_u32 s44, s44, 3072
  v_mfma_f32_16x16x32_bf16 v[56:59], a[24:27], v[40:43], v[56:59]
  ds_read_b128 v[32:35], v2 offset:17408
  v_mfma_f32_16x16x32_bf16 v[60:63], a[24:27], v[44:47], v[60:63]
  ds_read_b128 v[36:39], v2 offset:21504
  v_mfma_f32_16x16x32_bf16 v[64:67], a[88:91], v[40:43], v[64:67]
  s_waitcnt lgkmcnt(4)
  v_mfma_f32_16x16x32_bf16 v[68:71], a[88:91], v[44:47], v[68:71]
  s_mov_b32 m0, s45
  s_add_u32 s45, s45, 3072
  buffer_load_dwordx4 v1, s[4:7], s44 offen sc1 lds
  s_add_u32 s44, s44, 3072
  v_mfma_f32_16x16x32_bf16 v[56:59], a[28:31], v[48:51], v[56:59]
  ds_read_b128 v[40:43], v2 offset:18432
  v_mfma_f32_16x16x32_bf16 v[60:63], a[28:31], v[52:55], v[60:63]
  ds_read_b128 v[44:47], v2 offset:22528
  v_mfma_f32_16x16x32_bf16 v[64:67], a[92:95], v[48:51], v[64:67]
  s_waitcnt lgkmcnt(4)
  v_mfma_f32_16x16x32_bf16 v[68:71], a[92:95], v[52:55], v[68:71]
  s_mov_b32 m0, s45
  s_add_u32 s45, s45, 3072
  buffer_load_dwordx4 v1, s[4:7], s44 offen sc1 lds
  s_add_u32 s44, s44, 3072
  v_mfma_f32_16x16x32_bf16 v[56:59], a[32:35], v[24:27], v[56:59]
  ds_read_b128 v[48:51], v2 offset:19456
  v_mfma_f32_16x16x32_bf16 v[60:63], a[32:35], v[28:31], v[60:63]
  ds_read_b128 v[52:55], v2 offset:23552
  v_mfma_f32_16x16x32_bf16 v[64:67], a[96:99], v[24:27], v[64:67]
  s_waitcnt lgkmcnt(4)
  v_mfma_f32_16x16x32_bf16 v[68:71], a[96:99], v[28:31], v[68:71]
  s_mov_b32 m0, s45
  s_add_u32 s45, s45, 3072
  buffer_load_dwordx4 v1, s[4:7], s44 offen sc1 lds
  s_add_u32 s44, s44, 3072
  v_mfma_f32_16x16x32_bf16 v[56:59], a[36:39], v[32:35], v[56:59]
  ds_read_b128 v[24:27], v2 offset:24576
  v_mfma_f32_16x16x32_bf16 v[60:63], a[36:39], v[36:39], v[60:63]
  ds_read_b128 v[28:31], v2 offset:28672
  v_mfma_f32_16x16x32_bf16 v[64:67], a[100:103], v[32:35], v[64:67]
  s_waitcnt lgkmcnt(4)
  v_mfma_f32_16x16x32_bf16 v[68:71], a[100:103], v[36:39], v[68:71]
  s_mov_b32 m0, s45
  s_add_u32 s45, s45, 3072
  buffer_load_dwordx4 v1, s[4:7], s44 offen sc1 lds
  s_add_u32 s44, s44, 3072
  v_mfma_f32_16x16x32_bf16 v[56:59], a[40:43], v[40:43], v[56:59]
  ds_read_b128 v[32:35], v2 offset:25600
  v_mfma_f32_16x16x32_bf16 v[60:63], a[40:43], v[44:47], v[60:63]
  ds_read_b128 v[36:39], v2 offset:29696
  v_mfma_f32_16x16x32_bf16 v[64:67], a[104:107], v[40:43], v[64:67]
  s_waitcnt lgkmcnt(4)
  v_mfma_f32_16x16x32_bf16 v[68:71], a[104:107], v[44:47], v[68:71]
  s_mov_b32 m0, s45
  s_add_u32 s45, s45, 3072
  buffer_load_dwordx4 v1, s[4:7], s44 offen sc1 lds
  s_add_u32 s44, s44, 3072
  v_mfma_f32_16x16x32_bf16 v[56:59], a[44:47], v[48:51], v[56:59]
  ds_read_b128 v[40:43], v2 offset:26624
  v_mfma_f32_16x16x32_bf16 v[60:63], a[44:47], v[52:55], v[60:63]
  ds_read_b128 v[44:47], v2 offset:30720
  v_mfma_f32_16x16x32_bf16 v[64:67], a[108:111], v[48:51], v[64:67]
  s_waitcnt lgkmcnt(4)
  v_mfma_f32_16x16x32_bf16 v[68:71], a[108:111], v[52:55], v[68:71]
  s_cmp_eq_u32 s12, 3
  s_cselect_b32 s47, 1024, 0
  s_sub_u32 s44, s44, s47
  s_sub_u32 s45, s45, s47
  s_mov_b32 m0, s45
  s_add_u32 s45, s45, 3072
  buffer_load_dwordx4 v1, s[4:7], s44 offen sc1 lds
  s_add_u32 s44, s44, 3072
  v_mfma_f32_16x16x32_bf16 v[56:59], a[48:51], v[24:27], v[56:59]
  ds_read_b128 v[48:51], v2 offset:27648
  v_mfma_f32_16x16x32_bf16 v[60:63], a[48:51], v[28:31], v[60:63]
  ds_read_b128 v[52:55], v2 offset:31744
  v_mfma_f32_16x16x32_bf16 v[64:67], a[112:115], v[24:27], v[64:67]
  s_waitcnt lgkmcnt(4)
  v_mfma_f32_16x16x32_bf16 v[68:71], a[112:115], v[28:31], v[68:71]
  v_mfma_f32_16x16x32_bf16 v[56:59], a[52:55], v[32:35], v[56:59]
  v_mfma_f32_16x16x32_bf16 v[60:63], a[52:55], v[36:39], v[60:63]
  v_mfma_f32_16x16x32_bf16 v[64:67], a[116:119], v[32:35], v[64:67]
  s_waitcnt lgkmcnt(2)
  v_mfma_f32_16x16x32_bf16 v[68:71], a[116:119], v[36:39], v[68:71]
  v_mfma_f32_16x16x32_bf16 v[56:59], a[56:59], v[40:43], v[56:59]
  v_mfma_f32_16x16x32_bf16 v[60:63], a[56:59], v[44:47], v[60:63]
  v_mfma_f32_16x16x32_bf16 v[64:67], a[120:123], v[40:43], v[64:67]
  s_waitcnt lgkmcnt(0)
  v_mfma_f32_16x16x32_bf16 v[68:71], a[120:123], v[44:47], v[68:71]
  v_mfma_f32_16x16x32_bf16 v[56:59], a[60:63], v[48:51], v[56:59]
  v_mfma_f32_16x16x32_bf16 v[60:63], a[60:63], v[52:55], v[60:63]
  v_mfma_f32_16x16x32_bf16 v[64:67], a[124:127], v[48:51], v[64:67]
  v_mfma_f32_16x16x32_bf16 v[68:71], a[124:127], v[52:55], v[68:71]
O2l_mdone:
  s_nop 5
  v_cvt_pk_bf16_f32 v72, v56, v57
  v_cvt_pk_bf16_f32 v73, v58, v59
  v_cvt_pk_bf16_f32 v74, v64, v65
  v_cvt_pk_bf16_f32 v75, v66, v67
  v_bfi_b32 v72, 1, s24, v72
  s_add_u32 s44, s23, 0
  buffer_store_dwordx4 v[72:75], v4, s[4:7], s44 offen
  v_cvt_pk_bf16_f32 v76, v60, v61
  v_cvt_pk_bf16_f32 v77, v62, v63
  v_cvt_pk_bf16_f32 v78, v68, v69
  v_cvt_pk_bf16_f32 v79, v70, v71
  v_bfi_b32 v76, 1, s24, v76
  s_add_u32 s44, s23, 131072
  buffer_store_dwordx4 v[76:79], v4, s[4:7], s44 offen
  s_waitcnt vmcnt(0)
  buffer_load_dwordx4 v[80:83], v5, s[4:7], s23 offen nt
  s_add_u32 s44, s23, 4096
  buffer_load_dwordx4 v[84:87], v5, s[4:7], s44 offen nt
  s_waitcnt vmcnt(0)
  v_bitop3_b32 v21, v80, v84, s24 bitop3:0x7E
  v_and_b32 v21, 1, v21
  v_cmp_ne_u32 vcc, 0, v21
  s_cbranch_vccz O2l_in_ok
O2l_in:
  s_mov_b64 exec, vcc
  buffer_load_dwordx4 v[80:83], v5, s[4:7], s23 offen nt
  s_add_u32 s44, s23, 4096
  buffer_load_dwordx4 v[84:87], v5, s[4:7], s44 offen nt
  s_sub_u32 s15, s15, 1
  s_cbranch_scc1 O2l_in_ok
  s_waitcnt vmcnt(0)
  v_bitop3_b32 v21, v80, v84, s24 bitop3:0x7E
  v_and_b32 v21, 1, v21
  v_cmp_ne_u32 vcc, 0, v21
  s_cbranch_vccnz O2l_in
O2l_in_ok:
  s_mov_b64 exec, -1
  buffer_load_dword v20, v3, s[4:7], s20 offen sc1
  s_nop 2
  v_mfma_f32_16x16x32_bf16 v[88:91], v[80:83], v[12:15], 0
  v_mfma_f32_16x16x32_bf16 v[88:91], v[84:87], v[12:15], v[88:91]
  s_nop 7
  s_mov_b64 exec, s[32:33]
  ds_write_b32 v6, v88 offset:0
  ds_write_b32 v6, v89 offset:32
  ds_write_b32 v6, v90 offset:64
  ds_write_b32 v6, v91 offset:96
  s_mov_b64 exec, -1
  s_waitcnt lgkmcnt(0)
  s_barrier
  s_cmp_lg_u32 s12, 0
  s_cbranch_scc1 O2l_fin
  ds_read_b128 v[96:99], v7
  ds_read_b128 v[100:103], v7 offset:16
  s_waitcnt lgkmcnt(0)
  v_cvt_pk_bf16_f32 v108, v96, v97
  v_cvt_pk_bf16_f32 v109, v98, v99
  v_cvt_pk_bf16_f32 v110, v100, v101
  v_cvt_pk_bf16_f32 v111, v102, v103
  v_lshlrev_b32 v96, 16, v108
  v_and_b32 v97, 0xffff0000, v108
  v_lshlrev_b32 v98, 16, v109
  v_and_b32 v99, 0xffff0000, v109
  v_lshlrev_b32 v100, 16, v110
  v_and_b32 v101, 0xffff0000, v110
  v_lshlrev_b32 v102, 16, v111
  v_and_b32 v103, 0xffff0000, v111
  v_lshlrev_b32 v112, 16, v104
  v_and_b32 v113, 0xffff0000, v104
  v_lshlrev_b32 v114, 16, v105
  v_and_b32 v115, 0xffff0000, v105
  v_lshlrev_b32 v116, 16, v106
  v_and_b32 v117, 0xffff0000, v106
  v_lshlrev_b32 v118, 16, v107
  v_and_b32 v119, 0xffff0000, v107
  v_pk_add_f32 v[96:97], v[96:97], v[112:113]
  v_pk_add_f32 v[98:99], v[98:99], v[114:115]
  v_pk_add_f32 v[100:101], v[100:101], v[116:117]
  v_pk_add_f32 v[102:103], v[102:103], v[118:119]
  v_cvt_pk_bf16_f32 v104, v96, v97
  v_cvt_pk_bf16_f32 v105, v98, v99
  v_cvt_pk_bf16_f32 v106, v100, v101
  v_cvt_pk_bf16_f32 v107, v102, v103
  s_lshl_b32 s44, s34, 15
  s_lshl_b32 s45, s13, 10
  s_add_u32 s44, s44, s45
  buffer_store_dwordx4 v[104:107], v1, s[36:39], s44 offen
  s_waitcnt vmcnt(0)
  s_cmp_eq_u32 s34, 63
  s_cbranch_scc1 O2l_end
  s_branch O2l_go
O2l_fin:
  s_cmp_eq_u32 s34, 63
  s_cbranch_scc1 O2l_end
  s_cmp_eq_u32 s22, 0
  s_cbranch_scc1 O2l_late
  v_cmp_eq_u32 vcc, 0, v22
  s_and_b64 s[44:45], vcc, s[42:43]
  s_cselect_b32 s31, 0, 1
  s_cmp_ge_u32 s34, 62
  s_cselect_b32 s31, 0, s31
  s_branch O2l_go
O2l_late:
  s_waitcnt vmcnt(0)
  v_cmp_eq_u32 vcc, 0, v20
  s_and_b64 s[44:45], vcc, s[42:43]
  s_cselect_b32 s31, 0, 1
  s_cmp_ge_u32 s34, 62
  s_cselect_b32 s31, 0, s31
  s_and_b64 vcc, vcc, s[40:41]
  s_cbranch_scc0 O2l_chk
ofw_O2l1:
  buffer_load_dword v20, v3, s[4:7], s20 offen sc1
  s_waitcnt vmcnt(0)
  v_cmp_eq_u32 vcc, 0, v20
  s_and_b64 vcc, vcc, s[40:41]
  s_cbranch_scc0 ofw_O2l1_ok
  s_sub_u32 s15, s15, 1
  s_cbranch_scc1 ofw_O2l1_ok
  s_sleep 24
  s_branch ofw_O2l1
ofw_O2l1_ok:
  v_cmp_eq_u32 vcc, 0, v20
  s_and_b64 s[44:45], vcc, s[42:43]
  s_cselect_b32 s31, 0, 1
  s_cmp_ge_u32 s34, 62
  s_cselect_b32 s31, 0, s31
  s_and_b64 vcc, vcc, s[40:41]
  s_branch O2l_copy
O2l_chk:
  s_cmp_lg_u32 s22, 0
  s_cbranch_scc1 O2l_go
O2l_copy:
  s_sub_u32 s46, 32768, s21
  s_sub_u32 s44, s12, 1
  s_lshl_b32 s44, s44, 10
  s_add_u32 s45, s44, s46
  s_add_u32 s44, s44, s19
  s_mov_b32 m0, s45
  s_add_u32 s45, s45, 3072
  buffer_load_dwordx4 v1, s[4:7], s44 offen sc1 lds
  s_add_u32 s44, s44, 3072
  s_mov_b32 m0, s45
  s_add_u32 s45, s45, 3072
  buffer_load_dwordx4 v1, s[4:7], s44 offen sc1 lds
  s_add_u32 s44, s44, 3072
  s_mov_b32 m0, s45
  s_add_u32 s45, s45, 3072
  buffer_load_dwordx4 v1, s[4:7], s44 offen sc1 lds
  s_add_u32 s44, s44, 3072
  s_mov_b32 m0, s45
  s_add_u32 s45, s45, 3072
  buffer_load_dwordx4 v1, s[4:7], s44 offen sc1 lds
  s_add_u32 s44, s44, 3072
  s_mov_b32 m0, s45
  s_add_u32 s45, s45, 3072
  buffer_load_dwordx4 v1, s[4:7], s44 offen sc1 lds
  s_add_u32 s44, s44, 3072
  s_mov_b32 m0, s45
  s_add_u32 s45, s45, 3072
  buffer_load_dwordx4 v1, s[4:7], s44 offen sc1 lds
  s_add_u32 s44, s44, 3072
  s_mov_b32 m0, s45
  s_add_u32 s45, s45, 3072
  buffer_load_dwordx4 v1, s[4:7], s44 offen sc1 lds
  s_add_u32 s44, s44, 3072
  s_mov_b32 m0, s45
  s_add_u32 s45, s45, 3072
  buffer_load_dwordx4 v1, s[4:7], s44 offen sc1 lds
  s_add_u32 s44, s44, 3072
  s_mov_b32 m0, s45
  s_add_u32 s45, s45, 3072
  buffer_load_dwordx4 v1, s[4:7], s44 offen sc1 lds
  s_add_u32 s44, s44, 3072
  s_mov_b32 m0, s45
  s_add_u32 s45, s45, 3072
  buffer_load_dwordx4 v1, s[4:7], s44 offen sc1 lds
  s_add_u32 s44, s44, 3072
  s_cmp_eq_u32 s12, 3
  s_cselect_b32 s47, 1024, 0
  s_sub_u32 s44, s44, s47
  s_sub_u32 s45, s45, s47
  s_mov_b32 m0, s45
  s_add_u32 s45, s45, 3072
  buffer_load_dwordx4 v1, s[4:7], s44 offen sc1 lds
  s_add_u32 s44, s44, 3072
  s_waitcnt vmcnt(0)
O2l_go:
  s_sub_u32 s46, 32768, s21
  s_sub_u32 s44, s46, s21
  v_add_u32 v2, s44, v2
  s_mov_b32 s21, s46
  s_add_u32 s18, s18, 1
  s_add_u32 s34, s34, 1
  s_add_u32 s25, s25, 32768
  s_add_u32 s26, s26, 32768
  s_add_u32 s27, s27, 32768
  s_add_u32 s28, s28, 128
  s_barrier
  s_branch O2l_item
O2l_end:
  s_waitcnt vmcnt(0)
  s_endpgm
O_l0n:
  s_cmp_eq_u32 s12, 0
  s_cbranch_scc1 O0n_first
ofw_O0n0:
  buffer_load_dword v20, v3, s[4:7], s20 offen sc1
  s_waitcnt vmcnt(0)
  v_cmp_eq_u32 vcc, 0, v20
  s_and_b64 vcc, vcc, s[40:41]
  s_cbranch_scc0 ofw_O0n0_ok
  s_sub_u32 s15, s15, 1
  s_cbranch_scc1 ofw_O0n0_ok
  s_sleep 24
  s_branch ofw_O0n0
ofw_O0n0_ok:
  s_sub_u32 s44, s12, 1
  s_lshl_b32 s44, s44, 10
  s_add_u32 s45, s44, s21
  s_add_u32 s44, s44, s19
  s_mov_b32 m0, s45
  s_add_u32 s45, s45, 3072
  buffer_load_dwordx4 v1, s[4:7], s44 offen sc1 lds
  s_add_u32 s44, s44, 3072
  s_mov_b32 m0, s45
  s_add_u32 s45, s45, 3072
  buffer_load_dwordx4 v1, s[4:7], s44 offen sc1 lds
  s_add_u32 s44, s44, 3072
  s_mov_b32 m0, s45
  s_add_u32 s45, s45, 3072
  buffer_load_dwordx4 v1, s[4:7], s44 offen sc1 lds
  s_add_u32 s44, s44, 3072
  s_mov_b32 m0, s45
  s_add_u32 s45, s45, 3072
  buffer_load_dwordx4 v1, s[4:7], s44 offen sc1 lds
  s_add_u32 s44, s44, 3072
  s_mov_b32 m0, s45
  s_add_u32 s45, s45, 3072
  buffer_load_dwordx4 v1, s[4:7], s44 offen sc1 lds
  s_add_u32 s44, s44, 3072
  s_mov_b32 m0, s45
  s_add_u32 s45, s45, 3072
  buffer_load_dwordx4 v1, s[4:7], s44 offen sc1 lds
  s_add_u32 s44, s44, 3072
  s_mov_b32 m0, s45
  s_add_u32 s45, s45, 3072
  buffer_load_dwordx4 v1, s[4:7], s44 offen sc1 lds
  s_add_u32 s44, s44, 3072
  s_mov_b32 m0, s45
  s_add_u32 s45, s45, 3072
  buffer_load_dwordx4 v1, s[4:7], s44 offen sc1 lds
  s_add_u32 s44, s44, 3072
  s_mov_b32 m0, s45
  s_add_u32 s45, s45, 3072
  buffer_load_dwordx4 v1, s[4:7], s44 offen sc1 lds
  s_add_u32 s44, s44, 3072
  s_mov_b32 m0, s45
  s_add_u32 s45, s45, 3072
  buffer_load_dwordx4 v1, s[4:7], s44 offen sc1 lds
  s_add_u32 s44, s44, 3072
  s_cmp_eq_u32 s12, 3
  s_cselect_b32 s47, 1024, 0
  s_sub_u32 s44, s44, s47
  s_sub_u32 s45, s45, s47
  s_mov_b32 m0, s45
  s_add_u32 s45, s45, 3072
  buffer_load_dwordx4 v1, s[4:7], s44 offen sc1 lds
  s_add_u32 s44, s44, 3072
  s_waitcnt vmcnt(0)
O0n_first:
  s_barrier
O0n_item:
  s_add_u32 s20, s20, 256
  s_add_u32 s19, s19, 262144
  buffer_load_dwordx4 v[104:107], v1, s[4:7], s25 offen sc1
  buffer_load_dword v22, v3, s[4:7], s20 offen sc1
  s_and_b32 s44, s18, 1
  s_mul_i32 s44, s44, 262144
  s_add_u32 s23, s44, s30
  s_bfe_u32 s24, s18, 0x10001
  ds_read_b128 v[24:27], v2 offset:0
  ds_read_b128 v[28:31], v2 offset:4096
  ds_read_b128 v[32:35], v2 offset:1024
  ds_read_b128 v[36:39], v2 offset:5120
  ds_read_b128 v[40:43], v2 offset:2048
  ds_read_b128 v[44:47], v2 offset:6144
  s_mov_b32 s22, s31
  s_cmp_lg_u32 s31, 0
  s_cbranch_scc1 O0n_mearly
  s_waitcnt lgkmcnt(4)
  v_mfma_f32_16x16x32_bf16 v[56:59], a[0:3], v[24:27], 0
  ds_read_b128 v[48:51], v2 offset:3072
  v_mfma_f32_16x16x32_bf16 v[60:63], a[0:3], v[28:31], 0
  ds_read_b128 v[52:55], v2 offset:7168
  v_mfma_f32_16x16x32_bf16 v[64:67], a[64:67], v[24:27], 0
  s_waitcnt lgkmcnt(4)
  v_mfma_f32_16x16x32_bf16 v[68:71], a[64:67], v[28:31], 0
  v_mfma_f32_16x16x32_bf16 v[56:59], a[4:7], v[32:35], v[56:59]
  ds_read_b128 v[24:27], v2 offset:8192
  v_mfma_f32_16x16x32_bf16 v[60:63], a[4:7], v[36:39], v[60:63]
  ds_read_b128 v[28:31], v2 offset:12288
  v_mfma_f32_16x16x32_bf16 v[64:67], a[68:71], v[32:35], v[64:67]
  s_waitcnt lgkmcnt(4)
  v_mfma_f32_16x16x32_bf16 v[68:71], a[68:71], v[36:39], v[68:71]
  v_mfma_f32_16x16x32_bf16 v[56:59], a[8:11], v[40:43], v[56:59]
  ds_read_b128 v[32:35], v2 offset:9216
  v_mfma_f32_16x16x32_bf16 v[60:63], a[8:11], v[44:47], v[60:63]
  ds_read_b128 v[36:39], v2 offset:13312
  v_mfma_f32_16x16x32_bf16 v[64:67], a[72:75], v[40:43], v[64:67]
  s_waitcnt lgkmcnt(4)
  v_mfma_f32_16x16x32_bf16 v[68:71], a[72:75], v[44:47], v[68:71]
  v_mfma_f32_16x16x32_bf16 v[56:59], a[12:15], v[48:51], v[56:59]
  ds_read_b128 v[40:43], v2 offset:10240
  v_mfma_f32_16x16x32_bf16 v[60:63], a[12:15], v[52:55], v[60:63]
  ds_read_b128 v[44:47], v2 offset:14336
  v_mfma_f32_16x16x32_bf16 v[64:67], a[76:79], v[48:51], v[64:67]
  s_waitcnt lgkmcnt(4)
  v_mfma_f32_16x16x32_bf16 v[68:71], a[76:79], v[52:55], v[68:71]
  v_mfma_f32_16x16x32_bf16 v[56:59], a[16:19], v[24:27], v[56:59]
  ds_read_b128 v[48:51], v2 offset:11264
  v_mfma_f32_16x16x32_bf16 v[60:63], a[16:19], v[28:31], v[60:63]
  ds_read_b128 v[52:55], v2 offset:15360
  v_mfma_f32_16x16x32_bf16 v[64:67], a[80:83], v[24:27], v[64:67]
  s_waitcnt lgkmcnt(4)
  v_mfma_f32_16x16x32_bf16 v[68:71], a[80:83], v[28:31], v[68:71]
  v_mfma_f32_16x16x32_bf16 v[56:59], a[20:23], v[32:35], v[56:59]
  ds_read_b128 v[24:27], v2 offset:16384
  v_mfma_f32_16x16x32_bf16 v[60:63], a[20:23], v[36:39], v[60:63]
  ds_read_b128 v[28:31], v2 offset:20480
  v_mfma_f32_16x16x32_bf16 v[64:67], a[84:87], v[32:35], v[64:67]
  s_waitcnt lgkmcnt(4)
  v_mfma_f32_16x16x32_bf16 v[68:71], a[84:87], v[36:39], v[68:71]
  v_mfma_f32_16x16x32_bf16 v[56:59], a[24:27], v[40:43], v[56:59]
  ds_read_b128 v[32:35], v2 offset:17408
  v_mfma_f32_16x16x32_bf16 v[60:63], a[24:27], v[44:47], v[60:63]
  ds_read_b128 v[36:39], v2 offset:21504
  v_mfma_f32_16x16x32_bf16 v[64:67], a[88:91], v[40:43], v[64:67]
  s_waitcnt lgkmcnt(4)
  v_mfma_f32_16x16x32_bf16 v[68:71], a[88:91], v[44:47], v[68:71]
  v_mfma_f32_16x16x32_bf16 v[56:59], a[28:31], v[48:51], v[56:59]
  ds_read_b128 v[40:43], v2 offset:18432
  v_mfma_f32_16x16x32_bf16 v[60:63], a[28:31], v[52:55], v[60:63]
  ds_read_b128 v[44:47], v2 offset:22528
  v_mfma_f32_16x16x32_bf16 v[64:67], a[92:95], v[48:51], v[64:67]
  s_waitcnt lgkmcnt(4)
  v_mfma_f32_16x16x32_bf16 v[68:71], a[92:95], v[52:55], v[68:71]
  v_mfma_f32_16x16x32_bf16 v[56:59], a[32:35], v[24:27], v[56:59]
  ds_read_b128 v[48:51], v2 offset:19456
  v_mfma_f32_16x16x32_bf16 v[60:63], a[32:35], v[28:31], v[60:63]
  ds_read_b128 v[52:55], v2 offset:23552
  v_mfma_f32_16x16x32_bf16 v[64:67], a[96:99], v[24:27], v[64:67]
  s_waitcnt lgkmcnt(4)
  v_mfma_f32_16x16x32_bf16 v[68:71], a[96:99], v[28:31], v[68:71]
  v_mfma_f32_16x16x32_bf16 v[56:59], a[36:39], v[32:35], v[56:59]
  ds_read_b128 v[24:27], v2 offset:24576
  v_mfma_f32_16x16x32_bf16 v[60:63], a[36:39], v[36:39], v[60:63]
  ds_read_b128 v[28:31], v2 offset:28672
  v_mfma_f32_16x16x32_bf16 v[64:67], a[100:103], v[32:35], v[64:67]
  s_waitcnt lgkmcnt(4)
  v_mfma_f32_16x16x32_bf16 v[68:71], a[100:103], v[36:39], v[68:71]
  v_mfma_f32_16x16x32_bf16 v[56:59], a[40:43], v[40:43], v[56:59]
  ds_read_b128 v[32:35], v2 offset:25600
  v_mfma_f32_16x16x32_bf16 v[60:63], a[40:43], v[44:47], v[60:63]
  ds_read_b128 v[36:39], v2 offset:29696
  v_mfma_f32_16x16x32_bf16 v[64:67], a[104:107], v[40:43], v[64:67]
  s_waitcnt lgkmcnt(4)
  v_mfma_f32_16x16x32_bf16 v[68:71], a[104:107], v[44:47], v[68:71]
  v_mfma_f32_16x16x32_bf16 v[56:59], a[44:47], v[48:51], v[56:59]
  ds_read_b128 v[40:43], v2 offset:26624
  v_mfma_f32_16x16x32_bf16 v[60:63], a[44:47], v[52:55], v[60:63]
  ds_read_b128 v[44:47], v2 offset:30720
  v_mfma_f32_16x16x32_bf16 v[64:67], a[108:111], v[48:51], v[64:67]
  s_waitcnt lgkmcnt(4)
  v_mfma_f32_16x16x32_bf16 v[68:71], a[108:111], v[52:55], v[68:71]
  v_mfma_f32_16x16x32_bf16 v[56:59], a[48:51], v[24:27], v[56:59]
  ds_read_b128 v[48:51], v2 offset:27648
  v_mfma_f32_16x16x32_bf16 v[60:63], a[48:51], v[28:31], v[60:63]
  ds_read_b128 v[52:55], v2 offset:31744
  v_mfma_f32_16x16x32_bf16 v[64:67], a[112:115], v[24:27], v[64:67]
  s_waitcnt lgkmcnt(4)
  v_mfma_f32_16x16x32_bf16 v[68:71], a[112:115], v[28:31], v[68:71]
  v_mfma_f32_16x16x32_bf16 v[56:59], a[52:55], v[32:35], v[56:59]
  v_mfma_f32_16x16x32_bf16 v[60:63], a[52:55], v[36:39], v[60:63]
  v_mfma_f32_16x16x32_bf16 v[64:67], a[116:119], v[32:35], v[64:67]
  s_waitcnt lgkmcnt(2)
  v_mfma_f32_16x16x32_bf16 v[68:71], a[116:119], v[36:39], v[68:71]
  v_mfma_f32_16x16x32_bf16 v[56:59], a[56:59], v[40:43], v[56:59]
  v_mfma_f32_16x16x32_bf16 v[60:63], a[56:59], v[44:47], v[60:63]
  v_mfma_f32_16x16x32_bf16 v[64:67], a[120:123], v[40:43], v[64:67]
  s_waitcnt lgkmcnt(0)
  v_mfma_f32_16x16x32_bf16 v[68:71], a[120:123], v[44:47], v[68:71]
  v_mfma_f32_16x16x32_bf16 v[56:59], a[60:63], v[48:51], v[56:59]
  v_mfma_f32_16x16x32_bf16 v[60:63], a[60:63], v[52:55], v[60:63]
  v_mfma_f32_16x16x32_bf16 v[64:67], a[124:127], v[48:51], v[64:67]
  v_mfma_f32_16x16x32_bf16 v[68:71], a[124:127], v[52:55], v[68:71]
  s_branch O0n_mdone
O0n_mearly:
  s_sub_u32 s46, 32768, s21
  s_waitcnt lgkmcnt(4)
  v_mfma_f32_16x16x32_bf16 v[56:59], a[0:3], v[24:27], 0
  ds_read_b128 v[48:51], v2 offset:3072
  v_mfma_f32_16x16x32_bf16 v[60:63], a[0:3], v[28:31], 0
  ds_read_b128 v[52:55], v2 offset:7168
  v_mfma_f32_16x16x32_bf16 v[64:67], a[64:67], v[24:27], 0
  s_waitcnt lgkmcnt(4)
  v_mfma_f32_16x16x32_bf16 v[68:71], a[64:67], v[28:31], 0
  s_sub_u32 s44, s12, 1
  s_lshl_b32 s44, s44, 10
  s_add_u32 s45, s44, s46
  s_add_u32 s44, s44, s19
  v_mfma_f32_16x16x32_bf16 v[56:59], a[4:7], v[32:35], v[56:59]
  ds_read_b128 v[24:27], v2 offset:8192
  v_mfma_f32_16x16x32_bf16 v[60:63], a[4:7], v[36:39], v[60:63]
  ds_read_b128 v[28:31], v2 offset:12288
  v_mfma_f32_16x16x32_bf16 v[64:67], a[68:71], v[32:35], v[64:67]
  s_waitcnt lgkmcnt(4)
  v_mfma_f32_16x16x32_bf16 v[68:71], a[68:71], v[36:39], v[68:71]
  s_mov_b32 m0, s45
  s_add_u32 s45, s45, 3072
  buffer_load_dwordx4 v1, s[4:7], s44 offen sc1 lds
  s_add_u32 s44, s44, 3072
  v_mfma_f32_16x16x32_bf16 v[56:59], a[8:11], v[40:43], v[56:59]
  ds_read_b128 v[32:35], v2 offset:9216
  v_mfma_f32_16x16x32_bf16 v[60:63], a[8:11], v[44:47], v[60:63]
  ds_read_b128 v[36:39], v2 offset:13312
  v_mfma_f32_16x16x32_bf16 v[64:67], a[72:75], v[40:43], v[64:67]
  s_waitcnt lgkmcnt(4)
  v_mfma_f32_16x16x32_bf16 v[68:71], a[72:75], v[44:47], v[68:71]
  s_mov_b32 m0, s45
  s_add_u32 s45, s45, 3072
  buffer_load_dwordx4 v1, s[4:7], s44 offen sc1 lds
  s_add_u32 s44, s44, 3072
  v_mfma_f32_16x16x32_bf16 v[56:59], a[12:15], v[48:51], v[56:59]
  ds_read_b128 v[40:43], v2 offset:10240
  v_mfma_f32_16x16x32_bf16 v[60:63], a[12:15], v[52:55], v[60:63]
  ds_read_b128 v[44:47], v2 offset:14336
  v_mfma_f32_16x16x32_bf16 v[64:67], a[76:79], v[48:51], v[64:67]
  s_waitcnt lgkmcnt(4)
  v_mfma_f32_16x16x32_bf16 v[68:71], a[76:79], v[52:55], v[68:71]
  s_mov_b32 m0, s45
  s_add_u32 s45, s45, 3072
  buffer_load_dwordx4 v1, s[4:7], s44 offen sc1 lds
  s_add_u32 s44, s44, 3072
  v_mfma_f32_16x16x32_bf16 v[56:59], a[16:19], v[24:27], v[56:59]
  ds_read_b128 v[48:51], v2 offset:11264
  v_mfma_f32_16x16x32_bf16 v[60:63], a[16:19], v[28:31], v[60:63]
  ds_read_b128 v[52:55], v2 offset:15360
  v_mfma_f32_16x16x32_bf16 v[64:67], a[80:83], v[24:27], v[64:67]
  s_waitcnt lgkmcnt(4)
  v_mfma_f32_16x16x32_bf16 v[68:71], a[80:83], v[28:31], v[68:71]
  s_mov_b32 m0, s45
  s_add_u32 s45, s45, 3072
  buffer_load_dwordx4 v1, s[4:7], s44 offen sc1 lds
  s_add_u32 s44, s44, 3072
  v_mfma_f32_16x16x32_bf16 v[56:59], a[20:23], v[32:35], v[56:59]
  ds_read_b128 v[24:27], v2 offset:16384
  v_mfma_f32_16x16x32_bf16 v[60:63], a[20:23], v[36:39], v[60:63]
  ds_read_b128 v[28:31], v2 offset:20480
  v_mfma_f32_16x16x32_bf16 v[64:67], a[84:87], v[32:35], v[64:67]
  s_waitcnt lgkmcnt(4)
  v_mfma_f32_16x16x32_bf16 v[68:71], a[84:87], v[36:39], v[68:71]
  s_mov_b32 m0, s45
  s_add_u32 s45, s45, 3072
  buffer_load_dwordx4 v1, s[4:7], s44 offen sc1 lds
  s_add_u32 s44, s44, 3072
  v_mfma_f32_16x16x32_bf16 v[56:59], a[24:27], v[40:43], v[56:59]
  ds_read_b128 v[32:35], v2 offset:17408
  v_mfma_f32_16x16x32_bf16 v[60:63], a[24:27], v[44:47], v[60:63]
  ds_read_b128 v[36:39], v2 offset:21504
  v_mfma_f32_16x16x32_bf16 v[64:67], a[88:91], v[40:43], v[64:67]
  s_waitcnt lgkmcnt(4)
  v_mfma_f32_16x16x32_bf16 v[68:71], a[88:91], v[44:47], v[68:71]
  s_mov_b32 m0, s45
  s_add_u32 s45, s45, 3072
  buffer_load_dwordx4 v1, s[4:7], s44 offen sc1 lds
  s_add_u32 s44, s44, 3072
  v_mfma_f32_16x16x32_bf16 v[56:59], a[28:31], v[48:51], v[56:59]
  ds_read_b128 v[40:43], v2 offset:18432
  v_mfma_f32_16x16x32_bf16 v[60:63], a[28:31], v[52:55], v[60:63]
  ds_read_b128 v[44:47], v2 offset:22528
  v_mfma_f32_16x16x32_bf16 v[64:67], a[92:95], v[48:51], v[64:67]
  s_waitcnt lgkmcnt(4)
  v_mfma_f32_16x16x32_bf16 v[68:71], a[92:95], v[52:55], v[68:71]
  s_mov_b32 m0, s45
  s_add_u32 s45, s45, 3072
  buffer_load_dwordx4 v1, s[4:7], s44 offen sc1 lds
  s_add_u32 s44, s44, 3072
  v_mfma_f32_16x16x32_bf16 v[56:59], a[32:35], v[24:27], v[56:59]
  ds_read_b128 v[48:51], v2 offset:19456
  v_mfma_f32_16x16x32_bf16 v[60:63], a[32:35], v[28:31], v[60:63]
  ds_read_b128 v[52:55], v2 offset:23552
  v_mfma_f32_16x16x32_bf16 v[64:67], a[96:99], v[24:27], v[64:67]
  s_waitcnt lgkmcnt(4)
  v_mfma_f32_16x16x32_bf16 v[68:71], a[96:99], v[28:31], v[68:71]
  s_mov_b32 m0, s45
  s_add_u32 s45, s45, 3072
  buffer_load_dwordx4 v1, s[4:7], s44 offen sc1 lds
  s_add_u32 s44, s44, 3072
  v_mfma_f32_16x16x32_bf16 v[56:59], a[36:39], v[32:35], v[56:59]
  ds_read_b128 v[24:27], v2 offset:24576
  v_mfma_f32_16x16x32_bf16 v[60:63], a[36:39], v[36:39], v[60:63]
  ds_read_b128 v[28:31], v2 offset:28672
  v_mfma_f32_16x16x32_bf16 v[64:67], a[100:103], v[32:35], v[64:67]
  s_waitcnt lgkmcnt(4)
  v_mfma_f32_16x16x32_bf16 v[68:71], a[100:103], v[36:39], v[68:71]
  s_mov_b32 m0, s45
  s_add_u32 s45, s45, 3072
  buffer_load_dwordx4 v1, s[4:7], s44 offen sc1 lds
  s_add_u32 s44, s44, 3072
  v_mfma_f32_16x16x32_bf16 v[56:59], a[40:43], v[40:43], v[56:59]
  ds_read_b128 v[32:35], v2 offset:25600
  v_mfma_f32_16x16x32_bf16 v[60:63], a[40:43], v[44:47], v[60:63]
  ds_read_b128 v[36:39], v2 offset:29696
  v_mfma_f32_16x16x32_bf16 v[64:67], a[104:107], v[40:43], v[64:67]
  s_waitcnt lgkmcnt(4)
  v_mfma_f32_16x16x32_bf16 v[68:71], a[104:107], v[44:47], v[68:71]
  s_mov_b32 m0, s45
  s_add_u32 s45, s45, 3072
  buffer_load_dwordx4 v1, s[4:7], s44 offen sc1 lds
  s_add_u32 s44, s44, 3072
  v_mfma_f32_16x16x32_bf16 v[56:59], a[44:47], v[48:51], v[56:59]
  ds_read_b128 v[40:43], v2 offset:26624
  v_mfma_f32_16x16x32_bf16 v[60:63], a[44:47], v[52:55], v[60:63]
  ds_read_b128 v[44:47], v2 offset:30720
  v_mfma_f32_16x16x32_bf16 v[64:67], a[108:111], v[48:51], v[64:67]
  s_waitcnt lgkmcnt(4)
  v_mfma_f32_16x16x32_bf16 v[68:71], a[108:111], v[52:55], v[68:71]
  s_cmp_eq_u32 s12, 3
  s_cselect_b32 s47, 1024, 0
  s_sub_u32 s44, s44, s47
  s_sub_u32 s45, s45, s47
  s_mov_b32 m0, s45
  s_add_u32 s45, s45, 3072
  buffer_load_dwordx4 v1, s[4:7], s44 offen sc1 lds
  s_add_u32 s44, s44, 3072
  v_mfma_f32_16x16x32_bf16 v[56:59], a[48:51], v[24:27], v[56:59]
  ds_read_b128 v[48:51], v2 offset:27648
  v_mfma_f32_16x16x32_bf16 v[60:63], a[48:51], v[28:31], v[60:63]
  ds_read_b128 v[52:55], v2 offset:31744
  v_mfma_f32_16x16x32_bf16 v[64:67], a[112:115], v[24:27], v[64:67]
  s_waitcnt lgkmcnt(4)
  v_mfma_f32_16x16x32_bf16 v[68:71], a[112:115], v[28:31], v[68:71]
  v_mfma_f32_16x16x32_bf16 v[56:59], a[52:55], v[32:35], v[56:59]
  v_mfma_f32_16x16x32_bf16 v[60:63], a[52:55], v[36:39], v[60:63]
  v_mfma_f32_16x16x32_bf16 v[64:67], a[116:119], v[32:35], v[64:67]
  s_waitcnt lgkmcnt(2)
  v_mfma_f32_16x16x32_bf16 v[68:71], a[116:119], v[36:39], v[68:71]
  v_mfma_f32_16x16x32_bf16 v[56:59], a[56:59], v[40:43], v[56:59]
  v_mfma_f32_16x16x32_bf16 v[60:63], a[56:59], v[44:47], v[60:63]
  v_mfma_f32_16x16x32_bf16 v[64:67], a[120:123], v[40:43], v[64:67]
  s_waitcnt lgkmcnt(0)
  v_mfma_f32_16x16x32_bf16 v[68:71], a[120:123], v[44:47], v[68:71]
  v_mfma_f32_16x16x32_bf16 v[56:59], a[60:63], v[48:51], v[56:59]
  v_mfma_f32_16x16x32_bf16 v[60:63], a[60:63], v[52:55], v[60:63]
  v_mfma_f32_16x16x32_bf16 v[64:67], a[124:127], v[48:51], v[64:67]
  v_mfma_f32_16x16x32_bf16 v[68:71], a[124:127], v[52:55], v[68:71]
O0n_mdone:
  s_nop 5
  v_cvt_pk_bf16_f32 v72, v56, v57
  v_cvt_pk_bf16_f32 v73, v58, v59
  v_cvt_pk_bf16_f32 v74, v64, v65
  v_cvt_pk_bf16_f32 v75, v66, v67
  v_bfi_b32 v72, 1, s24, v72
  s_add_u32 s44, s23, 0
  buffer_store_dwordx4 v[72:75], v4, s[4:7], s44 offen sc1
  v_cvt_pk_bf16_f32 v76, v60, v61
  v_cvt_pk_bf16_f32 v77, v62, v63
  v_cvt_pk_bf16_f32 v78, v68, v69
  v_cvt_pk_bf16_f32 v79, v70, v71
  v_bfi_b32 v76, 1, s24, v76
  s_add_u32 s44, s23, 131072
  buffer_store_dwordx4 v[76:79], v4, s[4:7], s44 offen sc1
  s_waitcnt vmcnt(0)
  buffer_load_dwordx4 v[80:83], v5, s[4:7], s23 offen sc1
  s_add_u32 s44, s23, 4096
  buffer_load_dwordx4 v[84:87], v5, s[4:7], s44 offen sc1
  s_waitcnt vmcnt(0)
  v_bitop3_b32 v21, v80, v84, s24 bitop3:0x7E
  v_and_b32 v21, 1, v21
  v_cmp_ne_u32 vcc, 0, v21
  s_cbranch_vccz O0n_in_ok
O0n_in:
  s_mov_b64 exec, vcc
  buffer_load_dwordx4 v[80:83], v5, s[4:7], s23 offen sc1
  s_add_u32 s44, s23, 4096
  buffer_load_dwordx4 v[84:87], v5, s[4:7], s44 offen sc1
  s_sub_u32 s15, s15, 1
  s_cbranch_scc1 O0n_in_ok
  s_waitcnt vmcnt(0)
  v_bitop3_b32 v21, v80, v84, s24 bitop3:0x7E
  v_and_b32 v21, 1, v21
  v_cmp_ne_u32 vcc, 0, v21
  s_cbranch_vccnz O0n_in
O0n_in_ok:
  s_mov_b64 exec, -1
  buffer_load_dword v20, v3, s[4:7], s20 offen sc1
  s_nop 2
  v_mfma_f32_16x16x32_bf16 v[88:91], v[80:83], v[12:15], 0
  v_mfma_f32_16x16x32_bf16 v[88:91], v[84:87], v[12:15], v[88:91]
  s_nop 7
  s_mov_b64 exec, s[32:33]
  ds_write_b32 v6, v88 offset:0
  ds_write_b32 v6, v89 offset:32
  ds_write_b32 v6, v90 offset:64
  ds_write_b32 v6, v91 offset:96
  s_mov_b64 exec, -1
  s_waitcnt lgkmcnt(0)
  s_barrier
  s_cmp_lg_u32 s12, 0
  s_cbranch_scc1 O0n_fin
  ds_read_b128 v[96:99], v7
  ds_read_b128 v[100:103], v7 offset:16
  s_waitcnt lgkmcnt(0)
  v_cvt_pk_bf16_f32 v108, v96, v97
  v_cvt_pk_bf16_f32 v109, v98, v99
  v_cvt_pk_bf16_f32 v110, v100, v101
  v_cvt_pk_bf16_f32 v111, v102, v103
  v_lshlrev_b32 v96, 16, v108
  v_and_b32 v97, 0xffff0000, v108
  v_lshlrev_b32 v98, 16, v109
  v_and_b32 v99, 0xffff0000, v109
  v_lshlrev_b32 v100, 16, v110
  v_and_b32 v101, 0xffff0000, v110
  v_lshlrev_b32 v102, 16, v111
  v_and_b32 v103, 0xffff0000, v111
  v_lshlrev_b32 v112, 16, v104
  v_and_b32 v113, 0xffff0000, v104
  v_lshlrev_b32 v114, 16, v105
  v_and_b32 v115, 0xffff0000, v105
  v_lshlrev_b32 v116, 16, v106
  v_and_b32 v117, 0xffff0000, v106
  v_lshlrev_b32 v118, 16, v107
  v_and_b32 v119, 0xffff0000, v107
  v_pk_add_f32 v[96:97], v[96:97], v[112:113]
  v_pk_add_f32 v[98:99], v[98:99], v[114:115]
  v_pk_add_f32 v[100:101], v[100:101], v[116:117]
  v_pk_add_f32 v[102:103], v[102:103], v[118:119]
  v_cvt_pk_bf16_f32 v104, v96, v97
  v_cvt_pk_bf16_f32 v105, v98, v99
  v_cvt_pk_bf16_f32 v106, v100, v101
  v_cvt_pk_bf16_f32 v107, v102, v103
  v_lshlrev_b32 v96, 16, v104
  v_and_b32 v97, 0xffff0000, v104
  v_lshlrev_b32 v98, 16, v105
  v_and_b32 v99, 0xffff0000, v105
  v_lshlrev_b32 v100, 16, v106
  v_and_b32 v101, 0xffff0000, v106
  v_lshlrev_b32 v102, 16, v107
  v_and_b32 v103, 0xffff0000, v107
  v_pk_add_f32 v[108:109], v[96:97], v[98:99]
  v_pk_add_f32 v[110:111], v[100:101], v[102:103]
  v_pk_add_f32 v[108:109], v[108:109], v[110:111]
  v_add_f32 v112, v108, v109
  s_nop 1
  v_add_f32_dpp v112, v112, v112 quad_perm:[1,0,3,2] row_mask:0xf bank_mask:0xf
  s_nop 1
  v_add_f32_dpp v112, v112, v112 quad_perm:[2,3,0,1] row_mask:0xf bank_mask:0xf
  s_nop 1
  v_add_f32_dpp v112, v112, v112 row_ror:4 row_mask:0xf bank_mask:0xf
  s_nop 1
  v_add_f32_dpp v112, v112, v112 row_ror:8 row_mask:0xf bank_mask:0xf
  v_mov_b32 v113, v112
  s_nop 1
  v_permlane16_swap_b32 v112, v113
  v_add_f32 v112, v112, v113
  v_mov_b32 v113, v112
  s_nop 1
  v_permlane32_swap_b32 v112, v113
  v_add_f32 v112, v112, v113
  v_mul_f32 v112, 0xbb000000, v112
  v_mov_b32 v113, v112
  v_pk_add_f32 v[96:97], v[96:97], v[112:113]
  v_pk_add_f32 v[98:99], v[98:99], v[112:113]
  v_pk_add_f32 v[100:101], v[100:101], v[112:113]
  v_pk_add_f32 v[102:103], v[102:103], v[112:113]
  v_pk_mul_f32 v[108:109], v[96:97], v[96:97]
  v_pk_fma_f32 v[108:109], v[98:99], v[98:99], v[108:109]
  v_pk_fma_f32 v[108:109], v[100:101], v[100:101], v[108:109]
  v_pk_fma_f32 v[108:109], v[102:103], v[102:103], v[108:109]
  v_add_f32 v114, v108, v109
  s_nop 1
  v_add_f32_dpp v114, v114, v114 quad_perm:[1,0,3,2] row_mask:0xf bank_mask:0xf
  s_nop 1
  v_add_f32_dpp v114, v114, v114 quad_perm:[2,3,0,1] row_mask:0xf bank_mask:0xf
  s_nop 1
  v_add_f32_dpp v114, v114, v114 row_ror:4 row_mask:0xf bank_mask:0xf
  s_nop 1
  v_add_f32_dpp v114, v114, v114 row_ror:8 row_mask:0xf bank_mask:0xf
  v_mov_b32 v115, v114
  s_nop 1
  v_permlane16_swap_b32 v114, v115
  v_add_f32 v114, v114, v115
  v_mov_b32 v115, v114
  s_nop 1
  v_permlane32_swap_b32 v114, v115
  v_add_f32 v114, v114, v115
  v_mov_b32 v115, 0x3727c5ac
  v_fmac_f32 v115, 0x3b000000, v114
  v_rsq_f32 v114, v115
  s_nop 0
  v_mov_b32 v115, v114
  v_pk_mul_f32 v[96:97], v[96:97], v[114:115]
  v_pk_mul_f32 v[98:99], v[98:99], v[114:115]
  v_pk_mul_f32 v[100:101], v[100:101], v[114:115]
  v_pk_mul_f32 v[102:103], v[102:103], v[114:115]
  v_cvt_pk_bf16_f32 v108, v96, v97
  v_cvt_pk_bf16_f32 v109, v98, v99
  v_cvt_pk_bf16_f32 v110, v100, v101
  v_cvt_pk_bf16_f32 v111, v102, v103
  buffer_store_dwordx4 v[108:111], v1, s[4:7], s27 offen sc1
  buffer_store_dwordx4 v[104:107], v1, s[4:7], s26 offen sc1
  s_waitcnt vmcnt(0)
  v_mov_b32 v21, 1
  s_mov_b64 exec, 1
  buffer_store_dword v21, v8, s[4:7], s28 offen sc1
  s_mov_b64 exec, -1
  s_cmp_eq_u32 s34, 63
  s_cbranch_scc1 O0n_end
  s_branch O0n_go
O0n_fin:
  s_cmp_eq_u32 s34, 63
  s_cbranch_scc1 O0n_end
  s_cmp_eq_u32 s22, 0
  s_cbranch_scc1 O0n_late
  v_cmp_eq_u32 vcc, 0, v22
  s_and_b64 s[44:45], vcc, s[42:43]
  s_cselect_b32 s31, 0, 1
  s_cmp_ge_u32 s34, 62
  s_cselect_b32 s31, 0, s31
  s_branch O0n_go
O0n_late:
  s_waitcnt vmcnt(0)
  v_cmp_eq_u32 vcc, 0, v20
  s_and_b64 s[44:45], vcc, s[42:43]
  s_cselect_b32 s31, 0, 1
  s_cmp_ge_u32 s34, 62
  s_cselect_b32 s31, 0, s31
  s_and_b64 vcc, vcc, s[40:41]
  s_cbranch_scc0 O0n_chk
ofw_O0n1:
  buffer_load_dword v20, v3, s[4:7], s20 offen sc1
  s_waitcnt vmcnt(0)
  v_cmp_eq_u32 vcc, 0, v20
  s_and_b64 vcc, vcc, s[40:41]
  s_cbranch_scc0 ofw_O0n1_ok
  s_sub_u32 s15, s15, 1
  s_cbranch_scc1 ofw_O0n1_ok
  s_sleep 24
  s_branch ofw_O0n1
ofw_O0n1_ok:
  v_cmp_eq_u32 vcc, 0, v20
  s_and_b64 s[44:45], vcc, s[42:43]
  s_cselect_b32 s31, 0, 1
  s_cmp_ge_u32 s34, 62
  s_cselect_b32 s31, 0, s31
  s_and_b64 vcc, vcc, s[40:41]
  s_branch O0n_copy
O0n_chk:
  s_cmp_lg_u32 s22, 0
  s_cbranch_scc1 O0n_go
O0n_copy:
  s_sub_u32 s46, 32768, s21
  s_sub_u32 s44, s12, 1
  s_lshl_b32 s44, s44, 10
  s_add_u32 s45, s44, s46
  s_add_u32 s44, s44, s19
  s_mov_b32 m0, s45
  s_add_u32 s45, s45, 3072
  buffer_load_dwordx4 v1, s[4:7], s44 offen sc1 lds
  s_add_u32 s44, s44, 3072
  s_mov_b32 m0, s45
  s_add_u32 s45, s45, 3072
  buffer_load_dwordx4 v1, s[4:7], s44 offen sc1 lds
  s_add_u32 s44, s44, 3072
  s_mov_b32 m0, s45
  s_add_u32 s45, s45, 3072
  buffer_load_dwordx4 v1, s[4:7], s44 offen sc1 lds
  s_add_u32 s44, s44, 3072
  s_mov_b32 m0, s45
  s_add_u32 s45, s45, 3072
  buffer_load_dwordx4 v1, s[4:7], s44 offen sc1 lds
  s_add_u32 s44, s44, 3072
  s_mov_b32 m0, s45
  s_add_u32 s45, s45, 3072
  buffer_load_dwordx4 v1, s[4:7], s44 offen sc1 lds
  s_add_u32 s44, s44, 3072
  s_mov_b32 m0, s45
  s_add_u32 s45, s45, 3072
  buffer_load_dwordx4 v1, s[4:7], s44 offen sc1 lds
  s_add_u32 s44, s44, 3072
  s_mov_b32 m0, s45
  s_add_u32 s45, s45, 3072
  buffer_load_dwordx4 v1, s[4:7], s44 offen sc1 lds
  s_add_u32 s44, s44, 3072
  s_mov_b32 m0, s45
  s_add_u32 s45, s45, 3072
  buffer_load_dwordx4 v1, s[4:7], s44 offen sc1 lds
  s_add_u32 s44, s44, 3072
  s_mov_b32 m0, s45
  s_add_u32 s45, s45, 3072
  buffer_load_dwordx4 v1, s[4:7], s44 offen sc1 lds
  s_add_u32 s44, s44, 3072
  s_mov_b32 m0, s45
  s_add_u32 s45, s45, 3072
  buffer_load_dwordx4 v1, s[4:7], s44 offen sc1 lds
  s_add_u32 s44, s44, 3072
  s_cmp_eq_u32 s12, 3
  s_cselect_b32 s47, 1024, 0
  s_sub_u32 s44, s44, s47
  s_sub_u32 s45, s45, s47
  s_mov_b32 m0, s45
  s_add_u32 s45, s45, 3072
  buffer_load_dwordx4 v1, s[4:7], s44 offen sc1 lds
  s_add_u32 s44, s44, 3072
  s_waitcnt vmcnt(0)
O0n_go:
  s_sub_u32 s46, 32768, s21
  s_sub_u32 s44, s46, s21
  v_add_u32 v2, s44, v2
  s_mov_b32 s21, s46
  s_add_u32 s18, s18, 1
  s_add_u32 s34, s34, 1
  s_add_u32 s25, s25, 32768
  s_add_u32 s26, s26, 32768
  s_add_u32 s27, s27, 32768
  s_add_u32 s28, s28, 128
  s_barrier
  s_branch O0n_item
O0n_end:
  s_waitcnt vmcnt(0)
  s_barrier
  s_mov_b32 s18, 64
  s_mov_b32 s34, 52
  s_mov_b32 s31, 0
  s_lshr_b32 s16, s13, 2
  s_lshl_b32 s16, s16, 15
  s_add_u32 s19, s16, 198180864
  s_mov_b32 s20, 4551680
  s_lshl_b32 s17, s13, 10
  s_add_u32 s25, s17, 24772608
  s_cmp_eq_u32 s12, 0
  s_cbranch_scc1 O2n_first
ofw_O2n0:
  buffer_load_dword v20, v3, s[4:7], s20 offen sc1
  s_waitcnt vmcnt(0)
  v_cmp_eq_u32 vcc, 0, v20
  s_and_b64 vcc, vcc, s[40:41]
  s_cbranch_scc0 ofw_O2n0_ok
  s_sub_u32 s15, s15, 1
  s_cbranch_scc1 ofw_O2n0_ok
  s_sleep 24
  s_branch ofw_O2n0
ofw_O2n0_ok:
  s_sub_u32 s44, s12, 1
  s_lshl_b32 s44, s44, 10
  s_add_u32 s45, s44, s21
  s_add_u32 s44, s44, s19
  s_mov_b32 m0, s45
  s_add_u32 s45, s45, 3072
  buffer_load_dwordx4 v1, s[4:7], s44 offen sc1 lds
  s_add_u32 s44, s44, 3072
  s_mov_b32 m0, s45
  s_add_u32 s45, s45, 3072
  buffer_load_dwordx4 v1, s[4:7], s44 offen sc1 lds
  s_add_u32 s44, s44, 3072
  s_mov_b32 m0, s45
  s_add_u32 s45, s45, 3072
  buffer_load_dwordx4 v1, s[4:7], s44 offen sc1 lds
  s_add_u32 s44, s44, 3072
  s_mov_b32 m0, s45
  s_add_u32 s45, s45, 3072
  buffer_load_dwordx4 v1, s[4:7], s44 offen sc1 lds
  s_add_u32 s44, s44, 3072
  s_mov_b32 m0, s45
  s_add_u32 s45, s45, 3072
  buffer_load_dwordx4 v1, s[4:7], s44 offen sc1 lds
  s_add_u32 s44, s44, 3072
  s_mov_b32 m0, s45
  s_add_u32 s45, s45, 3072
  buffer_load_dwordx4 v1, s[4:7], s44 offen sc1 lds
  s_add_u32 s44, s44, 3072
  s_mov_b32 m0, s45
  s_add_u32 s45, s45, 3072
  buffer_load_dwordx4 v1, s[4:7], s44 offen sc1 lds
  s_add_u32 s44, s44, 3072
  s_mov_b32 m0, s45
  s_add_u32 s45, s45, 3072
  buffer_load_dwordx4 v1, s[4:7], s44 offen sc1 lds
  s_add_u32 s44, s44, 3072
  s_mov_b32 m0, s45
  s_add_u32 s45, s45, 3072
  buffer_load_dwordx4 v1, s[4:7], s44 offen sc1 lds
  s_add_u32 s44, s44, 3072
  s_mov_b32 m0, s45
  s_add_u32 s45, s45, 3072
  buffer_load_dwordx4 v1, s[4:7], s44 offen sc1 lds
  s_add_u32 s44, s44, 3072
  s_cmp_eq_u32 s12, 3
  s_cselect_b32 s47, 1024, 0
  s_sub_u32 s44, s44, s47
  s_sub_u32 s45, s45, s47
  s_mov_b32 m0, s45
  s_add_u32 s45, s45, 3072
  buffer_load_dwordx4 v1, s[4:7], s44 offen sc1 lds
  s_add_u32 s44, s44, 3072
  s_waitcnt vmcnt(0)
O2n_first:
  s_barrier
O2n_item:
  s_add_u32 s20, s20, 256
  s_add_u32 s19, s19, 262144
  buffer_load_dwordx4 v[104:107], v1, s[4:7], s25 offen sc1
  buffer_load_dword v22, v3, s[4:7], s20 offen sc1
  s_and_b32 s44, s18, 1
  s_mul_i32 s44, s44, 262144
  s_add_u32 s23, s44, s30
  s_bfe_u32 s24, s18, 0x10001
  ds_read_b128 v[24:27], v2 offset:0
  ds_read_b128 v[28:31], v2 offset:4096
  ds_read_b128 v[32:35], v2 offset:1024
  ds_read_b128 v[36:39], v2 offset:5120
  ds_read_b128 v[40:43], v2 offset:2048
  ds_read_b128 v[44:47], v2 offset:6144
  s_mov_b32 s22, s31
  s_cmp_lg_u32 s31, 0
  s_cbranch_scc1 O2n_mearly
  s_waitcnt lgkmcnt(4)
  v_mfma_f32_16x16x32_bf16 v[56:59], a[0:3], v[24:27], 0
  ds_read_b128 v[48:51], v2 offset:3072
  v_mfma_f32_16x16x32_bf16 v[60:63], a[0:3], v[28:31], 0
  ds_read_b128 v[52:55], v2 offset:7168
  v_mfma_f32_16x16x32_bf16 v[64:67], a[64:67], v[24:27], 0
  s_waitcnt lgkmcnt(4)
  v_mfma_f32_16x16x32_bf16 v[68:71], a[64:67], v[28:31], 0
  v_mfma_f32_16x16x32_bf16 v[56:59], a[4:7], v[32:35], v[56:59]
  ds_read_b128 v[24:27], v2 offset:8192
  v_mfma_f32_16x16x32_bf16 v[60:63], a[4:7], v[36:39], v[60:63]
  ds_read_b128 v[28:31], v2 offset:12288
  v_mfma_f32_16x16x32_bf16 v[64:67], a[68:71], v[32:35], v[64:67]
  s_waitcnt lgkmcnt(4)
  v_mfma_f32_16x16x32_bf16 v[68:71], a[68:71], v[36:39], v[68:71]
  v_mfma_f32_16x16x32_bf16 v[56:59], a[8:11], v[40:43], v[56:59]
  ds_read_b128 v[32:35], v2 offset:9216
  v_mfma_f32_16x16x32_bf16 v[60:63], a[8:11], v[44:47], v[60:63]
  ds_read_b128 v[36:39], v2 offset:13312
  v_mfma_f32_16x16x32_bf16 v[64:67], a[72:75], v[40:43], v[64:67]
  s_waitcnt lgkmcnt(4)
  v_mfma_f32_16x16x32_bf16 v[68:71], a[72:75], v[44:47], v[68:71]
  v_mfma_f32_16x16x32_bf16 v[56:59], a[12:15], v[48:51], v[56:59]
  ds_read_b128 v[40:43], v2 offset:10240
  v_mfma_f32_16x16x32_bf16 v[60:63], a[12:15], v[52:55], v[60:63]
  ds_read_b128 v[44:47], v2 offset:14336
  v_mfma_f32_16x16x32_bf16 v[64:67], a[76:79], v[48:51], v[64:67]
  s_waitcnt lgkmcnt(4)
  v_mfma_f32_16x16x32_bf16 v[68:71], a[76:79], v[52:55], v[68:71]
  v_mfma_f32_16x16x32_bf16 v[56:59], a[16:19], v[24:27], v[56:59]
  ds_read_b128 v[48:51], v2 offset:11264
  v_mfma_f32_16x16x32_bf16 v[60:63], a[16:19], v[28:31], v[60:63]
  ds_read_b128 v[52:55], v2 offset:15360
  v_mfma_f32_16x16x32_bf16 v[64:67], a[80:83], v[24:27], v[64:67]
  s_waitcnt lgkmcnt(4)
  v_mfma_f32_16x16x32_bf16 v[68:71], a[80:83], v[28:31], v[68:71]
  v_mfma_f32_16x16x32_bf16 v[56:59], a[20:23], v[32:35], v[56:59]
  ds_read_b128 v[24:27], v2 offset:16384
  v_mfma_f32_16x16x32_bf16 v[60:63], a[20:23], v[36:39], v[60:63]
  ds_read_b128 v[28:31], v2 offset:20480
  v_mfma_f32_16x16x32_bf16 v[64:67], a[84:87], v[32:35], v[64:67]
  s_waitcnt lgkmcnt(4)
  v_mfma_f32_16x16x32_bf16 v[68:71], a[84:87], v[36:39], v[68:71]
  v_mfma_f32_16x16x32_bf16 v[56:59], a[24:27], v[40:43], v[56:59]
  ds_read_b128 v[32:35], v2 offset:17408
  v_mfma_f32_16x16x32_bf16 v[60:63], a[24:27], v[44:47], v[60:63]
  ds_read_b128 v[36:39], v2 offset:21504
  v_mfma_f32_16x16x32_bf16 v[64:67], a[88:91], v[40:43], v[64:67]
  s_waitcnt lgkmcnt(4)
  v_mfma_f32_16x16x32_bf16 v[68:71], a[88:91], v[44:47], v[68:71]
  v_mfma_f32_16x16x32_bf16 v[56:59], a[28:31], v[48:51], v[56:59]
  ds_read_b128 v[40:43], v2 offset:18432
  v_mfma_f32_16x16x32_bf16 v[60:63], a[28:31], v[52:55], v[60:63]
  ds_read_b128 v[44:47], v2 offset:22528
  v_mfma_f32_16x16x32_bf16 v[64:67], a[92:95], v[48:51], v[64:67]
  s_waitcnt lgkmcnt(4)
  v_mfma_f32_16x16x32_bf16 v[68:71], a[92:95], v[52:55], v[68:71]
  v_mfma_f32_16x16x32_bf16 v[56:59], a[32:35], v[24:27], v[56:59]
  ds_read_b128 v[48:51], v2 offset:19456
  v_mfma_f32_16x16x32_bf16 v[60:63], a[32:35], v[28:31], v[60:63]
  ds_read_b128 v[52:55], v2 offset:23552
  v_mfma_f32_16x16x32_bf16 v[64:67], a[96:99], v[24:27], v[64:67]
  s_waitcnt lgkmcnt(4)
  v_mfma_f32_16x16x32_bf16 v[68:71], a[96:99], v[28:31], v[68:71]
  v_mfma_f32_16x16x32_bf16 v[56:59], a[36:39], v[32:35], v[56:59]
  ds_read_b128 v[24:27], v2 offset:24576
  v_mfma_f32_16x16x32_bf16 v[60:63], a[36:39], v[36:39], v[60:63]
  ds_read_b128 v[28:31], v2 offset:28672
  v_mfma_f32_16x16x32_bf16 v[64:67], a[100:103], v[32:35], v[64:67]
  s_waitcnt lgkmcnt(4)
  v_mfma_f32_16x16x32_bf16 v[68:71], a[100:103], v[36:39], v[68:71]
  v_mfma_f32_16x16x32_bf16 v[56:59], a[40:43], v[40:43], v[56:59]
  ds_read_b128 v[32:35], v2 offset:25600
  v_mfma_f32_16x16x32_bf16 v[60:63], a[40:43], v[44:47], v[60:63]
  ds_read_b128 v[36:39], v2 offset:29696
  v_mfma_f32_16x16x32_bf16 v[64:67], a[104:107], v[40:43], v[64:67]
  s_waitcnt lgkmcnt(4)
  v_mfma_f32_16x16x32_bf16 v[68:71], a[104:107], v[44:47], v[68:71]
  v_mfma_f32_16x16x32_bf16 v[56:59], a[44:47], v[48:51], v[56:59]
  ds_read_b128 v[40:43], v2 offset:26624
  v_mfma_f32_16x16x32_bf16 v[60:63], a[44:47], v[52:55], v[60:63]
  ds_read_b128 v[44:47], v2 offset:30720
  v_mfma_f32_16x16x32_bf16 v[64:67], a[108:111], v[48:51], v[64:67]
  s_waitcnt lgkmcnt(4)
  v_mfma_f32_16x16x32_bf16 v[68:71], a[108:111], v[52:55], v[68:71]
  v_mfma_f32_16x16x32_bf16 v[56:59], a[48:51], v[24:27], v[56:59]
  ds_read_b128 v[48:51], v2 offset:27648
  v_mfma_f32_16x16x32_bf16 v[60:63], a[48:51], v[28:31], v[60:63]
  ds_read_b128 v[52:55], v2 offset:31744
  v_mfma_f32_16x16x32_bf16 v[64:67], a[112:115], v[24:27], v[64:67]
  s_waitcnt lgkmcnt(4)
  v_mfma_f32_16x16x32_bf16 v[68:71], a[112:115], v[28:31], v[68:71]
  v_mfma_f32_16x16x32_bf16 v[56:59], a[52:55], v[32:35], v[56:59]
  v_mfma_f32_16x16x32_bf16 v[60:63], a[52:55], v[36:39], v[60:63]
  v_mfma_f32_16x16x32_bf16 v[64:67], a[116:119], v[32:35], v[64:67]
  s_waitcnt lgkmcnt(2)
  v_mfma_f32_16x16x32_bf16 v[68:71], a[116:119], v[36:39], v[68:71]
  v_mfma_f32_16x16x32_bf16 v[56:59], a[56:59], v[40:43], v[56:59]
  v_mfma_f32_16x16x32_bf16 v[60:63], a[56:59], v[44:47], v[60:63]
  v_mfma_f32_16x16x32_bf16 v[64:67], a[120:123], v[40:43], v[64:67]
  s_waitcnt lgkmcnt(0)
  v_mfma_f32_16x16x32_bf16 v[68:71], a[120:123], v[44:47], v[68:71]
  v_mfma_f32_16x16x32_bf16 v[56:59], a[60:63], v[48:51], v[56:59]
  v_mfma_f32_16x16x32_bf16 v[60:63], a[60:63], v[52:55], v[60:63]
  v_mfma_f32_16x16x32_bf16 v[64:67], a[124:127], v[48:51], v[64:67]
  v_mfma_f32_16x16x32_bf16 v[68:71], a[124:127], v[52:55], v[68:71]
  s_branch O2n_mdone
O2n_mearly:
  s_sub_u32 s46, 32768, s21
  s_waitcnt lgkmcnt(4)
  v_mfma_f32_16x16x32_bf16 v[56:59], a[0:3], v[24:27], 0
  ds_read_b128 v[48:51], v2 offset:3072
  v_mfma_f32_16x16x32_bf16 v[60:63], a[0:3], v[28:31], 0
  ds_read_b128 v[52:55], v2 offset:7168
  v_mfma_f32_16x16x32_bf16 v[64:67], a[64:67], v[24:27], 0
  s_waitcnt lgkmcnt(4)
  v_mfma_f32_16x16x32_bf16 v[68:71], a[64:67], v[28:31], 0
  s_sub_u32 s44, s12, 1
  s_lshl_b32 s44, s44, 10
  s_add_u32 s45, s44, s46
  s_add_u32 s44, s44, s19
  v_mfma_f32_16x16x32_bf16 v[56:59], a[4:7], v[32:35], v[56:59]
  ds_read_b128 v[24:27], v2 offset:8192
  v_mfma_f32_16x16x32_bf16 v[60:63], a[4:7], v[36:39], v[60:63]
  ds_read_b128 v[28:31], v2 offset:12288
  v_mfma_f32_16x16x32_bf16 v[64:67], a[68:71], v[32:35], v[64:67]
  s_waitcnt lgkmcnt(4)
  v_mfma_f32_16x16x32_bf16 v[68:71], a[68:71], v[36:39], v[68:71]
  s_mov_b32 m0, s45
  s_add_u32 s45, s45, 3072
  buffer_load_dwordx4 v1, s[4:7], s44 offen sc1 lds
  s_add_u32 s44, s44, 3072
  v_mfma_f32_16x16x32_bf16 v[56:59], a[8:11], v[40:43], v[56:59]
  ds_read_b128 v[32:35], v2 offset:9216
  v_mfma_f32_16x16x32_bf16 v[60:63], a[8:11], v[44:47], v[60:63]
  ds_read_b128 v[36:39], v2 offset:13312
  v_mfma_f32_16x16x32_bf16 v[64:67], a[72:75], v[40:43], v[64:67]
  s_waitcnt lgkmcnt(4)
  v_mfma_f32_16x16x32_bf16 v[68:71], a[72:75], v[44:47], v[68:71]
  s_mov_b32 m0, s45
  s_add_u32 s45, s45, 3072
  buffer_load_dwordx4 v1, s[4:7], s44 offen sc1 lds
  s_add_u32 s44, s44, 3072
  v_mfma_f32_16x16x32_bf16 v[56:59], a[12:15], v[48:51], v[56:59]
  ds_read_b128 v[40:43], v2 offset:10240
  v_mfma_f32_16x16x32_bf16 v[60:63], a[12:15], v[52:55], v[60:63]
  ds_read_b128 v[44:47], v2 offset:14336
  v_mfma_f32_16x16x32_bf16 v[64:67], a[76:79], v[48:51], v[64:67]
  s_waitcnt lgkmcnt(4)
  v_mfma_f32_16x16x32_bf16 v[68:71], a[76:79], v[52:55], v[68:71]
  s_mov_b32 m0, s45
  s_add_u32 s45, s45, 3072
  buffer_load_dwordx4 v1, s[4:7], s44 offen sc1 lds
  s_add_u32 s44, s44, 3072
  v_mfma_f32_16x16x32_bf16 v[56:59], a[16:19], v[24:27], v[56:59]
  ds_read_b128 v[48:51], v2 offset:11264
  v_mfma_f32_16x16x32_bf16 v[60:63], a[16:19], v[28:31], v[60:63]
  ds_read_b128 v[52:55], v2 offset:15360
  v_mfma_f32_16x16x32_bf16 v[64:67], a[80:83], v[24:27], v[64:67]
  s_waitcnt lgkmcnt(4)
  v_mfma_f32_16x16x32_bf16 v[68:71], a[80:83], v[28:31], v[68:71]
  s_mov_b32 m0, s45
  s_add_u32 s45, s45, 3072
  buffer_load_dwordx4 v1, s[4:7], s44 offen sc1 lds
  s_add_u32 s44, s44, 3072
  v_mfma_f32_16x16x32_bf16 v[56:59], a[20:23], v[32:35], v[56:59]
  ds_read_b128 v[24:27], v2 offset:16384
  v_mfma_f32_16x16x32_bf16 v[60:63], a[20:23], v[36:39], v[60:63]
  ds_read_b128 v[28:31], v2 offset:20480
  v_mfma_f32_16x16x32_bf16 v[64:67], a[84:87], v[32:35], v[64:67]
  s_waitcnt lgkmcnt(4)
  v_mfma_f32_16x16x32_bf16 v[68:71], a[84:87], v[36:39], v[68:71]
  s_mov_b32 m0, s45
  s_add_u32 s45, s45, 3072
  buffer_load_dwordx4 v1, s[4:7], s44 offen sc1 lds
  s_add_u32 s44, s44, 3072
  v_mfma_f32_16x16x32_bf16 v[56:59], a[24:27], v[40:43], v[56:59]
  ds_read_b128 v[32:35], v2 offset:17408
  v_mfma_f32_16x16x32_bf16 v[60:63], a[24:27], v[44:47], v[60:63]
  ds_read_b128 v[36:39], v2 offset:21504
  v_mfma_f32_16x16x32_bf16 v[64:67], a[88:91], v[40:43], v[64:67]
  s_waitcnt lgkmcnt(4)
  v_mfma_f32_16x16x32_bf16 v[68:71], a[88:91], v[44:47], v[68:71]
  s_mov_b32 m0, s45
  s_add_u32 s45, s45, 3072
  buffer_load_dwordx4 v1, s[4:7], s44 offen sc1 lds
  s_add_u32 s44, s44, 3072
  v_mfma_f32_16x16x32_bf16 v[56:59], a[28:31], v[48:51], v[56:59]
  ds_read_b128 v[40:43], v2 offset:18432
  v_mfma_f32_16x16x32_bf16 v[60:63], a[28:31], v[52:55], v[60:63]
  ds_read_b128 v[44:47], v2 offset:22528
  v_mfma_f32_16x16x32_bf16 v[64:67], a[92:95], v[48:51], v[64:67]
  s_waitcnt lgkmcnt(4)
  v_mfma_f32_16x16x32_bf16 v[68:71], a[92:95], v[52:55], v[68:71]
  s_mov_b32 m0, s45
  s_add_u32 s45, s45, 3072
  buffer_load_dwordx4 v1, s[4:7], s44 offen sc1 lds
  s_add_u32 s44, s44, 3072
  v_mfma_f32_16x16x32_bf16 v[56:59], a[32:35], v[24:27], v[56:59]
  ds_read_b128 v[48:51], v2 offset:19456
  v_mfma_f32_16x16x32_bf16 v[60:63], a[32:35], v[28:31], v[60:63]
  ds_read_b128 v[52:55], v2 offset:23552
  v_mfma_f32_16x16x32_bf16 v[64:67], a[96:99], v[24:27], v[64:67]
  s_waitcnt lgkmcnt(4)
  v_mfma_f32_16x16x32_bf16 v[68:71], a[96:99], v[28:31], v[68:71]
  s_mov_b32 m0, s45
  s_add_u32 s45, s45, 3072
  buffer_load_dwordx4 v1, s[4:7], s44 offen sc1 lds
  s_add_u32 s44, s44, 3072
  v_mfma_f32_16x16x32_bf16 v[56:59], a[36:39], v[32:35], v[56:59]
  ds_read_b128 v[24:27], v2 offset:24576
  v_mfma_f32_16x16x32_bf16 v[60:63], a[36:39], v[36:39], v[60:63]
  ds_read_b128 v[28:31], v2 offset:28672
  v_mfma_f32_16x16x32_bf16 v[64:67], a[100:103], v[32:35], v[64:67]
  s_waitcnt lgkmcnt(4)
  v_mfma_f32_16x16x32_bf16 v[68:71], a[100:103], v[36:39], v[68:71]
  s_mov_b32 m0, s45
  s_add_u32 s45, s45, 3072
  buffer_load_dwordx4 v1, s[4:7], s44 offen sc1 lds
  s_add_u32 s44, s44, 3072
  v_mfma_f32_16x16x32_bf16 v[56:59], a[40:43], v[40:43], v[56:59]
  ds_read_b128 v[32:35], v2 offset:25600
  v_mfma_f32_16x16x32_bf16 v[60:63], a[40:43], v[44:47], v[60:63]
  ds_read_b128 v[36:39], v2 offset:29696
  v_mfma_f32_16x16x32_bf16 v[64:67], a[104:107], v[40:43], v[64:67]
  s_waitcnt lgkmcnt(4)
  v_mfma_f32_16x16x32_bf16 v[68:71], a[104:107], v[44:47], v[68:71]
  s_mov_b32 m0, s45
  s_add_u32 s45, s45, 3072
  buffer_load_dwordx4 v1, s[4:7], s44 offen sc1 lds
  s_add_u32 s44, s44, 3072
  v_mfma_f32_16x16x32_bf16 v[56:59], a[44:47], v[48:51], v[56:59]
  ds_read_b128 v[40:43], v2 offset:26624
  v_mfma_f32_16x16x32_bf16 v[60:63], a[44:47], v[52:55], v[60:63]
  ds_read_b128 v[44:47], v2 offset:30720
  v_mfma_f32_16x16x32_bf16 v[64:67], a[108:111], v[48:51], v[64:67]
  s_waitcnt lgkmcnt(4)
  v_mfma_f32_16x16x32_bf16 v[68:71], a[108:111], v[52:55], v[68:71]
  s_cmp_eq_u32 s12, 3
  s_cselect_b32 s47, 1024, 0
  s_sub_u32 s44, s44, s47
  s_sub_u32 s45, s45, s47
  s_mov_b32 m0, s45
  s_add_u32 s45, s45, 3072
  buffer_load_dwordx4 v1, s[4:7], s44 offen sc1 lds
  s_add_u32 s44, s44, 3072
  v_mfma_f32_16x16x32_bf16 v[56:59], a[48:51], v[24:27], v[56:59]
  ds_read_b128 v[48:51], v2 offset:27648
  v_mfma_f32_16x16x32_bf16 v[60:63], a[48:51], v[28:31], v[60:63]
  ds_read_b128 v[52:55], v2 offset:31744
  v_mfma_f32_16x16x32_bf16 v[64:67], a[112:115], v[24:27], v[64:67]
  s_waitcnt lgkmcnt(4)
  v_mfma_f32_16x16x32_bf16 v[68:71], a[112:115], v[28:31], v[68:71]
  v_mfma_f32_16x16x32_bf16 v[56:59], a[52:55], v[32:35], v[56:59]
  v_mfma_f32_16x16x32_bf16 v[60:63], a[52:55], v[36:39], v[60:63]
  v_mfma_f32_16x16x32_bf16 v[64:67], a[116:119], v[32:35], v[64:67]
  s_waitcnt lgkmcnt(2)
  v_mfma_f32_16x16x32_bf16 v[68:71], a[116:119], v[36:39], v[68:71]
  v_mfma_f32_16x16x32_bf16 v[56:59], a[56:59], v[40:43], v[56:59]
  v_mfma_f32_16x16x32_bf16 v[60:63], a[56:59], v[44:47], v[60:63]
  v_mfma_f32_16x16x32_bf16 v[64:67], a[120:123], v[40:43], v[64:67]
  s_waitcnt lgkmcnt(0)
  v_mfma_f32_16x16x32_bf16 v[68:71], a[120:123], v[44:47], v[68:71]
  v_mfma_f32_16x16x32_bf16 v[56:59], a[60:63], v[48:51], v[56:59]
  v_mfma_f32_16x16x32_bf16 v[60:63], a[60:63], v[52:55], v[60:63]
  v_mfma_f32_16x16x32_bf16 v[64:67], a[124:127], v[48:51], v[64:67]
  v_mfma_f32_16x16x32_bf16 v[68:71], a[124:127], v[52:55], v[68:71]
O2n_mdone:
  s_nop 5
  v_cvt_pk_bf16_f32 v72, v56, v57
  v_cvt_pk_bf16_f32 v73, v58, v59
  v_cvt_pk_bf16_f32 v74, v64, v65
  v_cvt_pk_bf16_f32 v75, v66, v67
  v_bfi_b32 v72, 1, s24, v72
  s_add_u32 s44, s23, 0
  buffer_store_dwordx4 v[72:75], v4, s[4:7], s44 offen sc1
  v_cvt_pk_bf16_f32 v76, v60, v61
  v_cvt_pk_bf16_f32 v77, v62, v63
  v_cvt_pk_bf16_f32 v78, v68, v69
  v_cvt_pk_bf16_f32 v79, v70, v71
  v_bfi_b32 v76, 1, s24, v76
  s_add_u32 s44, s23, 131072
  buffer_store_dwordx4 v[76:79], v4, s[4:7], s44 offen sc1
  s_waitcnt vmcnt(0)
  buffer_load_dwordx4 v[80:83], v5, s[4:7], s23 offen sc1
  s_add_u32 s44, s23, 4096
  buffer_load_dwordx4 v[84:87], v5, s[4:7], s44 offen sc1
  s_waitcnt vmcnt(0)
  v_bitop3_b32 v21, v80, v84, s24 bitop3:0x7E
  v_and_b32 v21, 1, v21
  v_cmp_ne_u32 vcc, 0, v21
  s_cbranch_vccz O2n_in_ok
O2n_in:
  s_mov_b64 exec, vcc
  buffer_load_dwordx4 v[80:83], v5, s[4:7], s23 offen sc1
  s_add_u32 s44, s23, 4096
  buffer_load_dwordx4 v[84:87], v5, s[4:7], s44 offen sc1
  s_sub_u32 s15, s15, 1
  s_cbranch_scc1 O2n_in_ok
  s_waitcnt vmcnt(0)
  v_bitop3_b32 v21, v80, v84, s24 bitop3:0x7E
  v_and_b32 v21, 1, v21
  v_cmp_ne_u32 vcc, 0, v21
  s_cbranch_vccnz O2n_in
O2n_in_ok:
  s_mov_b64 exec, -1
  buffer_load_dword v20, v3, s[4:7], s20 offen sc1
  s_nop 2
  v_mfma_f32_16x16x32_bf16 v[88:91], v[80:83], v[12:15], 0
  v_mfma_f32_16x16x32_bf16 v[88:91], v[84:87], v[12:15], v[88:91]
  s_nop 7
  s_mov_b64 exec, s[32:33]
  ds_write_b32 v6, v88 offset:0
  ds_write_b32 v6, v89 offset:32
  ds_write_b32 v6, v90 offset:64
  ds_write_b32 v6, v91 offset:96
  s_mov_b64 exec, -1
  s_waitcnt lgkmcnt(0)
  s_barrier
  s_cmp_lg_u32 s12, 0
  s_cbranch_scc1 O2n_fin
  ds_read_b128 v[96:99], v7
  ds_read_b128 v[100:103], v7 offset:16
  s_waitcnt lgkmcnt(0)
  v_cvt_pk_bf16_f32 v108, v96, v97
  v_cvt_pk_bf16_f32 v109, v98, v99
  v_cvt_pk_bf16_f32 v110, v100, v101
  v_cvt_pk_bf16_f32 v111, v102, v103
  v_lshlrev_b32 v96, 16, v108
  v_and_b32 v97, 0xffff0000, v108
  v_lshlrev_b32 v98, 16, v109
  v_and_b32 v99, 0xffff0000, v109
  v_lshlrev_b32 v100, 16, v110
  v_and_b32 v101, 0xffff0000, v110
  v_lshlrev_b32 v102, 16, v111
  v_and_b32 v103, 0xffff0000, v111
  v_lshlrev_b32 v112, 16, v104
  v_and_b32 v113, 0xffff0000, v104
  v_lshlrev_b32 v114, 16, v105
  v_and_b32 v115, 0xffff0000, v105
  v_lshlrev_b32 v116, 16, v106
  v_and_b32 v117, 0xffff0000, v106
  v_lshlrev_b32 v118, 16, v107
  v_and_b32 v119, 0xffff0000, v107
  v_pk_add_f32 v[96:97], v[96:97], v[112:113]
  v_pk_add_f32 v[98:99], v[98:99], v[114:115]
  v_pk_add_f32 v[100:101], v[100:101], v[116:117]
  v_pk_add_f32 v[102:103], v[102:103], v[118:119]
  v_cvt_pk_bf16_f32 v104, v96, v97
  v_cvt_pk_bf16_f32 v105, v98, v99
  v_cvt_pk_bf16_f32 v106, v100, v101
  v_cvt_pk_bf16_f32 v107, v102, v103
  s_lshl_b32 s44, s34, 15
  s_lshl_b32 s45, s13, 10
  s_add_u32 s44, s44, s45
  buffer_store_dwordx4 v[104:107], v1, s[36:39], s44 offen
  s_waitcnt vmcnt(0)
  s_cmp_eq_u32 s34, 63
  s_cbranch_scc1 O2n_end
  s_branch O2n_go
O2n_fin:
  s_cmp_eq_u32 s34, 63
  s_cbranch_scc1 O2n_end
  s_cmp_eq_u32 s22, 0
  s_cbranch_scc1 O2n_late
  v_cmp_eq_u32 vcc, 0, v22
  s_and_b64 s[44:45], vcc, s[42:43]
  s_cselect_b32 s31, 0, 1
  s_cmp_ge_u32 s34, 62
  s_cselect_b32 s31, 0, s31
  s_branch O2n_go
O2n_late:
  s_waitcnt vmcnt(0)
  v_cmp_eq_u32 vcc, 0, v20
  s_and_b64 s[44:45], vcc, s[42:43]
  s_cselect_b32 s31, 0, 1
  s_cmp_ge_u32 s34, 62
  s_cselect_b32 s31, 0, s31
  s_and_b64 vcc, vcc, s[40:41]
  s_cbranch_scc0 O2n_chk
ofw_O2n1:
  buffer_load_dword v20, v3, s[4:7], s20 offen sc1
  s_waitcnt vmcnt(0)
  v_cmp_eq_u32 vcc, 0, v20
  s_and_b64 vcc, vcc, s[40:41]
  s_cbranch_scc0 ofw_O2n1_ok
  s_sub_u32 s15, s15, 1
  s_cbranch_scc1 ofw_O2n1_ok
  s_sleep 24
  s_branch ofw_O2n1
ofw_O2n1_ok:
  v_cmp_eq_u32 vcc, 0, v20
  s_and_b64 s[44:45], vcc, s[42:43]
  s_cselect_b32 s31, 0, 1
  s_cmp_ge_u32 s34, 62
  s_cselect_b32 s31, 0, s31
  s_and_b64 vcc, vcc, s[40:41]
  s_branch O2n_copy
O2n_chk:
  s_cmp_lg_u32 s22, 0
  s_cbranch_scc1 O2n_go
O2n_copy:
  s_sub_u32 s46, 32768, s21
  s_sub_u32 s44, s12, 1
  s_lshl_b32 s44, s44, 10
  s_add_u32 s45, s44, s46
  s_add_u32 s44, s44, s19
  s_mov_b32 m0, s45
  s_add_u32 s45, s45, 3072
  buffer_load_dwordx4 v1, s[4:7], s44 offen sc1 lds
  s_add_u32 s44, s44, 3072
  s_mov_b32 m0, s45
  s_add_u32 s45, s45, 3072
  buffer_load_dwordx4 v1, s[4:7], s44 offen sc1 lds
  s_add_u32 s44, s44, 3072
  s_mov_b32 m0, s45
  s_add_u32 s45, s45, 3072
  buffer_load_dwordx4 v1, s[4:7], s44 offen sc1 lds
  s_add_u32 s44, s44, 3072
  s_mov_b32 m0, s45
  s_add_u32 s45, s45, 3072
  buffer_load_dwordx4 v1, s[4:7], s44 offen sc1 lds
  s_add_u32 s44, s44, 3072
  s_mov_b32 m0, s45
  s_add_u32 s45, s45, 3072
  buffer_load_dwordx4 v1, s[4:7], s44 offen sc1 lds
  s_add_u32 s44, s44, 3072
  s_mov_b32 m0, s45
  s_add_u32 s45, s45, 3072
  buffer_load_dwordx4 v1, s[4:7], s44 offen sc1 lds
  s_add_u32 s44, s44, 3072
  s_mov_b32 m0, s45
  s_add_u32 s45, s45, 3072
  buffer_load_dwordx4 v1, s[4:7], s44 offen sc1 lds
  s_add_u32 s44, s44, 3072
  s_mov_b32 m0, s45
  s_add_u32 s45, s45, 3072
  buffer_load_dwordx4 v1, s[4:7], s44 offen sc1 lds
  s_add_u32 s44, s44, 3072
  s_mov_b32 m0, s45
  s_add_u32 s45, s45, 3072
  buffer_load_dwordx4 v1, s[4:7], s44 offen sc1 lds
  s_add_u32 s44, s44, 3072
  s_mov_b32 m0, s45
  s_add_u32 s45, s45, 3072
  buffer_load_dwordx4 v1, s[4:7], s44 offen sc1 lds
  s_add_u32 s44, s44, 3072
  s_cmp_eq_u32 s12, 3
  s_cselect_b32 s47, 1024, 0
  s_sub_u32 s44, s44, s47
  s_sub_u32 s45, s45, s47
  s_mov_b32 m0, s45
  s_add_u32 s45, s45, 3072
  buffer_load_dwordx4 v1, s[4:7], s44 offen sc1 lds
  s_add_u32 s44, s44, 3072
  s_waitcnt vmcnt(0)
O2n_go:
  s_sub_u32 s46, 32768, s21
  s_sub_u32 s44, s46, s21
  v_add_u32 v2, s44, v2
  s_mov_b32 s21, s46
  s_add_u32 s18, s18, 1
  s_add_u32 s34, s34, 1
  s_add_u32 s25, s25, 32768
  s_add_u32 s26, s26, 32768
  s_add_u32 s27, s27, 32768
  s_add_u32 s28, s28, 128
  s_barrier
  s_branch O2n_item
O2n_end:
  s_waitcnt vmcnt(0)
  s_endpgm
X6_entry:
  s_cmp_lt_u32 s13, 16
  s_cbranch_scc1 O16_entry
  s_sub_u32 s13, s13, 16
  s_branch TA_entry
O16_entry:
  s_lshr_b32 s18, s13, 2
  s_lshl_b32 s18, s18, 20
  s_and_b32 s19, s13, 3
  s_lshl_b32 s19, s19, 8
  s_add_u32 s18, s18, s19
  s_add_u32 s18, s18, 0
  v_lshrrev_b32 v28, 4, v0
  v_and_b32 v29, 15, v0
  v_lshrrev_b32 v29, 1, v29
  v_xor_b32 v24, v29, v28
  v_xor_b32 v25, 4, v24
  v_lshlrev_b32 v24, 5, v24
  v_lshlrev_b32 v25, 5, v25
  v_lshlrev_b32 v28, 10, v28
  v_and_b32 v29, 1, v0
  v_lshlrev_b32 v29, 4, v29
  v_add3_u32 v24, v24, v28, v29
  v_add3_u32 v25, v25, v28, v29
  v_lshrrev_b32 v28, 4, v0
  v_bfe_u32 v29, v0, 2, 2
  v_lshlrev_b32 v26, 3, v28
  v_add_u32 v26, v26, v29
  v_lshlrev_b32 v26, 8, v26
  v_and_b32 v28, 1, v28
  v_lshl_add_u32 v29, v28, 2, v29
  v_bfe_u32 v28, v0, 1, 1
  s_lshl_b32 s16, s12, 1
  v_add_u32 v28, s16, v28
  v_xor_b32 v28, v28, v29
  v_lshl_add_u32 v26, v28, 5, v26
  v_and_b32 v28, 1, v0
  v_lshl_add_u32 v26, v28, 4, v26
  v_add_u32 v27, 0x10000, v26
  s_load_dwordx2 s[8:9], s[0:1], 64
  s_waitcnt lgkmcnt(0)
  s_mov_b32 s10, 4194304
  s_mov_b32 s11, 0x20000
  s_lshl_b32 s16, s12, 17
  s_add_u32 s16, s16, s18
  s_lshl_b32 s17, s12, 15
  s_mov_b32 m0, s17
  s_add_u32 s17, s17, 1024
  buffer_load_dwordx4 v24, s[8:11], s16 offen lds
  s_add_u32 s16, s16, 4096
  s_mov_b32 m0, s17
  s_add_u32 s17, s17, 1024
  buffer_load_dwordx4 v24, s[8:11], s16 offen lds
  s_add_u32 s16, s16, 4096
  s_mov_b32 m0, s17
  s_add_u32 s17, s17, 1024
  buffer_load_dwordx4 v25, s[8:11], s16 offen lds
  s_add_u32 s16, s16, 4096
  s_mov_b32 m0, s17
  s_add_u32 s17, s17, 1024
  buffer_load_dwordx4 v25, s[8:11], s16 offen lds
  s_add_u32 s16, s16, 4096
  s_mov_b32 m0, s17
  s_add_u32 s17, s17, 1024
  buffer_load_dwordx4 v24, s[8:11], s16 offen lds
  s_add_u32 s16, s16, 4096
  s_mov_b32 m0, s17
  s_add_u32 s17, s17, 1024
  buffer_load_dwordx4 v24, s[8:11], s16 offen lds
  s_add_u32 s16, s16, 4096
  s_mov_b32 m0, s17
  s_add_u32 s17, s17, 1024
  buffer_load_dwordx4 v25, s[8:11], s16 offen lds
  s_add_u32 s16, s16, 4096
  s_mov_b32 m0, s17
  s_add_u32 s17, s17, 1024
  buffer_load_dwordx4 v25, s[8:11], s16 offen lds
  s_add_u32 s16, s16, 4096
  s_mov_b32 m0, s17
  s_add_u32 s17, s17, 1024
  buffer_load_dwordx4 v24, s[8:11], s16 offen lds
  s_add_u32 s16, s16, 4096
  s_mov_b32 m0, s17
  s_add_u32 s17, s17, 1024
  buffer_load_dwordx4 v24, s[8:11], s16 offen lds
  s_add_u32 s16, s16, 4096
  s_mov_b32 m0, s17
  s_add_u32 s17, s17, 1024
  buffer_load_dwordx4 v25, s[8:11], s16 offen lds
  s_add_u32 s16, s16, 4096
  s_mov_b32 m0, s17
  s_add_u32 s17, s17, 1024
  buffer_load_dwordx4 v25, s[8:11], s16 offen lds
  s_add_u32 s16, s16, 4096
  s_mov_b32 m0, s17
  s_add_u32 s17, s17, 1024
  buffer_load_dwordx4 v24, s[8:11], s16 offen lds
  s_add_u32 s16, s16, 4096
  s_mov_b32 m0, s17
  s_add_u32 s17, s17, 1024
  buffer_load_dwordx4 v24, s[8:11], s16 offen lds
  s_add_u32 s16, s16, 4096
  s_mov_b32 m0, s17
  s_add_u32 s17, s17, 1024
  buffer_load_dwordx4 v25, s[8:11], s16 offen lds
  s_add_u32 s16, s16, 4096
  s_mov_b32 m0, s17
  s_add_u32 s17, s17, 1024
  buffer_load_dwordx4 v25, s[8:11], s16 offen lds
  s_add_u32 s16, s16, 4096
  s_mov_b32 m0, s17
  s_add_u32 s17, s17, 1024
  buffer_load_dwordx4 v24, s[8:11], s16 offen lds
  s_add_u32 s16, s16, 4096
  s_mov_b32 m0, s17
  s_add_u32 s17, s17, 1024
  buffer_load_dwordx4 v24, s[8:11], s16 offen lds
  s_add_u32 s16, s16, 4096
  s_mov_b32 m0, s17
  s_add_u32 s17, s17, 1024
  buffer_load_dwordx4 v25, s[8:11], s16 offen lds
  s_add_u32 s16, s16, 4096
  s_mov_b32 m0, s17
  s_add_u32 s17, s17, 1024
  buffer_load_dwordx4 v25, s[8:11], s16 offen lds
  s_add_u32 s16, s16, 4096
  s_mov_b32 m0, s17
  s_add_u32 s17, s17, 1024
  buffer_load_dwordx4 v24, s[8:11], s16 offen lds
  s_add_u32 s16, s16, 4096
  s_mov_b32 m0, s17
  s_add_u32 s17, s17, 1024
  buffer_load_dwordx4 v24, s[8:11], s16 offen lds
  s_add_u32 s16, s16, 4096
  s_mov_b32 m0, s17
  s_add_u32 s17, s17, 1024
  buffer_load_dwordx4 v25, s[8:11], s16 offen lds
  s_add_u32 s16, s16, 4096
  s_mov_b32 m0, s17
  s_add_u32 s17, s17, 1024
  buffer_load_dwordx4 v25, s[8:11], s16 offen lds
  s_add_u32 s16, s16, 4096
  s_mov_b32 m0, s17
  s_add_u32 s17, s17, 1024
  buffer_load_dwordx4 v24, s[8:11], s16 offen lds
  s_add_u32 s16, s16, 4096
  s_mov_b32 m0, s17
  s_add_u32 s17, s17, 1024
  buffer_load_dwordx4 v24, s[8:11], s16 offen lds
  s_add_u32 s16, s16, 4096
  s_mov_b32 m0, s17
  s_add_u32 s17, s17, 1024
  buffer_load_dwordx4 v25, s[8:11], s16 offen lds
  s_add_u32 s16, s16, 4096
  s_mov_b32 m0, s17
  s_add_u32 s17, s17, 1024
  buffer_load_dwordx4 v25, s[8:11], s16 offen lds
  s_add_u32 s16, s16, 4096
  s_mov_b32 m0, s17
  s_add_u32 s17, s17, 1024
  buffer_load_dwordx4 v24, s[8:11], s16 offen lds
  s_add_u32 s16, s16, 4096
  s_mov_b32 m0, s17
  s_add_u32 s17, s17, 1024
  buffer_load_dwordx4 v24, s[8:11], s16 offen lds
  s_add_u32 s16, s16, 4096
  s_mov_b32 m0, s17
  s_add_u32 s17, s17, 1024
  buffer_load_dwordx4 v25, s[8:11], s16 offen lds
  s_add_u32 s16, s16, 4096
  s_mov_b32 m0, s17
  s_add_u32 s17, s17, 1024
  buffer_load_dwordx4 v25, s[8:11], s16 offen lds
  s_add_u32 s16, s16, 4096
  s_waitcnt vmcnt(0)
  s_barrier
  ds_read_b64_tr_b16 a[0:1], v26 offset:0
  ds_read_b64_tr_b16 a[2:3], v26 offset:1024
  ds_read_b64_tr_b16 a[4:5], v26 offset:8192
  ds_read_b64_tr_b16 a[6:7], v26 offset:9216
  ds_read_b64_tr_b16 a[8:9], v26 offset:16384
  ds_read_b64_tr_b16 a[10:11], v26 offset:17408
  ds_read_b64_tr_b16 a[12:13], v26 offset:24576
  ds_read_b64_tr_b16 a[14:15], v26 offset:25600
  ds_read_b64_tr_b16 a[16:17], v26 offset:32768
  ds_read_b64_tr_b16 a[18:19], v26 offset:33792
  ds_read_b64_tr_b16 a[20:21], v26 offset:40960
  ds_read_b64_tr_b16 a[22:23], v26 offset:41984
  ds_read_b64_tr_b16 a[24:25], v26 offset:49152
  ds_read_b64_tr_b16 a[26:27], v26 offset:50176
  ds_read_b64_tr_b16 a[28:29], v26 offset:57344
  ds_read_b64_tr_b16 a[30:31], v26 offset:58368
  ds_read_b64_tr_b16 a[32:33], v27 offset:0
  ds_read_b64_tr_b16 a[34:35], v27 offset:1024
  ds_read_b64_tr_b16 a[36:37], v27 offset:8192
  ds_read_b64_tr_b16 a[38:39], v27 offset:9216
  ds_read_b64_tr_b16 a[40:41], v27 offset:16384
  ds_read_b64_tr_b16 a[42:43], v27 offset:17408
  ds_read_b64_tr_b16 a[44:45], v27 offset:24576
  ds_read_b64_tr_b16 a[46:47], v27 offset:25600
  ds_read_b64_tr_b16 a[48:49], v27 offset:32768
  ds_read_b64_tr_b16 a[50:51], v27 offset:33792
  ds_read_b64_tr_b16 a[52:53], v27 offset:40960
  ds_read_b64_tr_b16 a[54:55], v27 offset:41984
  ds_read_b64_tr_b16 a[56:57], v27 offset:49152
  ds_read_b64_tr_b16 a[58:59], v27 offset:50176
  ds_read_b64_tr_b16 a[60:61], v27 offset:57344
  ds_read_b64_tr_b16 a[62:63], v27 offset:58368
  ds_read_b64_tr_b16 a[64:65], v26 offset:8
  ds_read_b64_tr_b16 a[66:67], v26 offset:1032
  ds_read_b64_tr_b16 a[68:69], v26 offset:8200
  ds_read_b64_tr_b16 a[70:71], v26 offset:9224
  ds_read_b64_tr_b16 a[72:73], v26 offset:16392
  ds_read_b64_tr_b16 a[74:75], v26 offset:17416
  ds_read_b64_tr_b16 a[76:77], v26 offset:24584
  ds_read_b64_tr_b16 a[78:79], v26 offset:25608
  ds_read_b64_tr_b16 a[80:81], v26 offset:32776
  ds_read_b64_tr_b16 a[82:83], v26 offset:33800
  ds_read_b64_tr_b16 a[84:85], v26 offset:40968
  ds_read_b64_tr_b16 a[86:87], v26 offset:41992
  ds_read_b64_tr_b16 a[88:89], v26 offset:49160
  ds_read_b64_tr_b16 a[90:91], v26 offset:50184
  ds_read_b64_tr_b16 a[92:93], v26 offset:57352
  ds_read_b64_tr_b16 a[94:95], v26 offset:58376
  ds_read_b64_tr_b16 a[96:97], v27 offset:8
  ds_read_b64_tr_b16 a[98:99], v27 offset:1032
  ds_read_b64_tr_b16 a[100:101], v27 offset:8200
  ds_read_b64_tr_b16 a[102:103], v27 offset:9224
  ds_read_b64_tr_b16 a[104:105], v27 offset:16392
  ds_read_b64_tr_b16 a[106:107], v27 offset:17416
  ds_read_b64_tr_b16 a[108:109], v27 offset:24584
  ds_read_b64_tr_b16 a[110:111], v27 offset:25608
  ds_read_b64_tr_b16 a[112:113], v27 offset:32776
  ds_read_b64_tr_b16 a[114:115], v27 offset:33800
  ds_read_b64_tr_b16 a[116:117], v27 offset:40968
  ds_read_b64_tr_b16 a[118:119], v27 offset:41992
  ds_read_b64_tr_b16 a[120:121], v27 offset:49160
  ds_read_b64_tr_b16 a[122:123], v27 offset:50184
  ds_read_b64_tr_b16 a[124:125], v27 offset:57352
  ds_read_b64_tr_b16 a[126:127], v27 offset:58376
  s_waitcnt lgkmcnt(0)
  s_barrier
  s_lshr_b32 s18, s13, 2
  s_lshl_b32 s18, s18, 20
  s_and_b32 s19, s13, 3
  s_lshl_b32 s19, s19, 8
  s_add_u32 s18, s18, s19
  s_add_u32 s18, s18, 524288
  v_lshrrev_b32 v28, 4, v0
  v_and_b32 v29, 15, v0
  v_lshrrev_b32 v29, 1, v29
  v_xor_b32 v24, v29, v28
  v_xor_b32 v25, 4, v24
  v_lshlrev_b32 v24, 5, v24
  v_lshlrev_b32 v25, 5, v25
  v_lshlrev_b32 v28, 10, v28
  v_and_b32 v29, 1, v0
  v_lshlrev_b32 v29, 4, v29
  v_add3_u32 v24, v24, v28, v29
  v_add3_u32 v25, v25, v28, v29
  v_lshrrev_b32 v28, 4, v0
  v_bfe_u32 v29, v0, 2, 2
  v_lshlrev_b32 v26, 3, v28
  v_add_u32 v26, v26, v29
  v_lshlrev_b32 v26, 8, v26
  v_and_b32 v28, 1, v28
  v_lshl_add_u32 v29, v28, 2, v29
  v_bfe_u32 v28, v0, 1, 1
  s_lshl_b32 s16, s12, 1
  v_add_u32 v28, s16, v28
  v_xor_b32 v28, v28, v29
  v_lshl_add_u32 v26, v28, 5, v26
  v_and_b32 v28, 1, v0
  v_lshl_add_u32 v26, v28, 4, v26
  v_add_u32 v27, 0x10000, v26
  s_load_dwordx2 s[8:9], s[0:1], 64
  s_waitcnt lgkmcnt(0)
  s_mov_b32 s10, 4194304
  s_mov_b32 s11, 0x20000
  s_lshl_b32 s16, s12, 17
  s_add_u32 s16, s16, s18
  s_lshl_b32 s17, s12, 15
  s_mov_b32 m0, s17
  s_add_u32 s17, s17, 1024
  buffer_load_dwordx4 v24, s[8:11], s16 offen lds
  s_add_u32 s16, s16, 4096
  s_mov_b32 m0, s17
  s_add_u32 s17, s17, 1024
  buffer_load_dwordx4 v24, s[8:11], s16 offen lds
  s_add_u32 s16, s16, 4096
  s_mov_b32 m0, s17
  s_add_u32 s17, s17, 1024
  buffer_load_dwordx4 v25, s[8:11], s16 offen lds
  s_add_u32 s16, s16, 4096
  s_mov_b32 m0, s17
  s_add_u32 s17, s17, 1024
  buffer_load_dwordx4 v25, s[8:11], s16 offen lds
  s_add_u32 s16, s16, 4096
  s_mov_b32 m0, s17
  s_add_u32 s17, s17, 1024
  buffer_load_dwordx4 v24, s[8:11], s16 offen lds
  s_add_u32 s16, s16, 4096
  s_mov_b32 m0, s17
  s_add_u32 s17, s17, 1024
  buffer_load_dwordx4 v24, s[8:11], s16 offen lds
  s_add_u32 s16, s16, 4096
  s_mov_b32 m0, s17
  s_add_u32 s17, s17, 1024
  buffer_load_dwordx4 v25, s[8:11], s16 offen lds
  s_add_u32 s16, s16, 4096
  s_mov_b32 m0, s17
  s_add_u32 s17, s17, 1024
  buffer_load_dwordx4 v25, s[8:11], s16 offen lds
  s_add_u32 s16, s16, 4096
  s_mov_b32 m0, s17
  s_add_u32 s17, s17, 1024
  buffer_load_dwordx4 v24, s[8:11], s16 offen lds
  s_add_u32 s16, s16, 4096
  s_mov_b32 m0, s17
  s_add_u32 s17, s17, 1024
  buffer_load_dwordx4 v24, s[8:11], s16 offen lds
  s_add_u32 s16, s16, 4096
  s_mov_b32 m0, s17
  s_add_u32 s17, s17, 1024
  buffer_load_dwordx4 v25, s[8:11], s16 offen lds
  s_add_u32 s16, s16, 4096
  s_mov_b32 m0, s17
  s_add_u32 s17, s17, 1024
  buffer_load_dwordx4 v25, s[8:11], s16 offen lds
  s_add_u32 s16, s16, 4096
  s_mov_b32 m0, s17
  s_add_u32 s17, s17, 1024
  buffer_load_dwordx4 v24, s[8:11], s16 offen lds
  s_add_u32 s16, s16, 4096
  s_mov_b32 m0, s17
  s_add_u32 s17, s17, 1024
  buffer_load_dwordx4 v24, s[8:11], s16 offen lds
  s_add_u32 s16, s16, 4096
  s_mov_b32 m0, s17
  s_add_u32 s17, s17, 1024
  buffer_load_dwordx4 v25, s[8:11], s16 offen lds
  s_add_u32 s16, s16, 4096
  s_mov_b32 m0, s17
  s_add_u32 s17, s17, 1024
  buffer_load_dwordx4 v25, s[8:11], s16 offen lds
  s_add_u32 s16, s16, 4096
  s_mov_b32 m0, s17
  s_add_u32 s17, s17, 1024
  buffer_load_dwordx4 v24, s[8:11], s16 offen lds
  s_add_u32 s16, s16, 4096
  s_mov_b32 m0, s17
  s_add_u32 s17, s17, 1024
  buffer_load_dwordx4 v24, s[8:11], s16 offen lds
  s_add_u32 s16, s16, 4096
  s_mov_b32 m0, s17
  s_add_u32 s17, s17, 1024
  buffer_load_dwordx4 v25, s[8:11], s16 offen lds
  s_add_u32 s16, s16, 4096
  s_mov_b32 m0, s17
  s_add_u32 s17, s17, 1024
  buffer_load_dwordx4 v25, s[8:11], s16 offen lds
  s_add_u32 s16, s16, 4096
  s_mov_b32 m0, s17
  s_add_u32 s17, s17, 1024
  buffer_load_dwordx4 v24, s[8:11], s16 offen lds
  s_add_u32 s16, s16, 4096
  s_mov_b32 m0, s17
  s_add_u32 s17, s17, 1024
  buffer_load_dwordx4 v24, s[8:11], s16 offen lds
  s_add_u32 s16, s16, 4096
  s_mov_b32 m0, s17
  s_add_u32 s17, s17, 1024
  buffer_load_dwordx4 v25, s[8:11], s16 offen lds
  s_add_u32 s16, s16, 4096
  s_mov_b32 m0, s17
  s_add_u32 s17, s17, 1024
  buffer_load_dwordx4 v25, s[8:11], s16 offen lds
  s_add_u32 s16, s16, 4096
  s_mov_b32 m0, s17
  s_add_u32 s17, s17, 1024
  buffer_load_dwordx4 v24, s[8:11], s16 offen lds
  s_add_u32 s16, s16, 4096
  s_mov_b32 m0, s17
  s_add_u32 s17, s17, 1024
  buffer_load_dwordx4 v24, s[8:11], s16 offen lds
  s_add_u32 s16, s16, 4096
  s_mov_b32 m0, s17
  s_add_u32 s17, s17, 1024
  buffer_load_dwordx4 v25, s[8:11], s16 offen lds
  s_add_u32 s16, s16, 4096
  s_mov_b32 m0, s17
  s_add_u32 s17, s17, 1024
  buffer_load_dwordx4 v25, s[8:11], s16 offen lds
  s_add_u32 s16, s16, 4096
  s_mov_b32 m0, s17
  s_add_u32 s17, s17, 1024
  buffer_load_dwordx4 v24, s[8:11], s16 offen lds
  s_add_u32 s16, s16, 4096
  s_mov_b32 m0, s17
  s_add_u32 s17, s17, 1024
  buffer_load_dwordx4 v24, s[8:11], s16 offen lds
  s_add_u32 s16, s16, 4096
  s_mov_b32 m0, s17
  s_add_u32 s17, s17, 1024
  buffer_load_dwordx4 v25, s[8:11], s16 offen lds
  s_add_u32 s16, s16, 4096
  s_mov_b32 m0, s17
  s_add_u32 s17, s17, 1024
  buffer_load_dwordx4 v25, s[8:11], s16 offen lds
  s_add_u32 s16, s16, 4096
  s_waitcnt vmcnt(0)
  s_barrier
  ds_read_b64_tr_b16 a[128:129], v26 offset:0
  ds_read_b64_tr_b16 a[130:131], v26 offset:1024
  ds_read_b64_tr_b16 a[132:133], v26 offset:8192
  ds_read_b64_tr_b16 a[134:135], v26 offset:9216
  ds_read_b64_tr_b16 a[136:137], v26 offset:16384
  ds_read_b64_tr_b16 a[138:139], v26 offset:17408
  ds_read_b64_tr_b16 a[140:141], v26 offset:24576
  ds_read_b64_tr_b16 a[142:143], v26 offset:25600
  ds_read_b64_tr_b16 a[144:145], v26 offset:32768
  ds_read_b64_tr_b16 a[146:147], v26 offset:33792
  ds_read_b64_tr_b16 a[148:149], v26 offset:40960
  ds_read_b64_tr_b16 a[150:151], v26 offset:41984
  ds_read_b64_tr_b16 a[152:153], v26 offset:49152
  ds_read_b64_tr_b16 a[154:155], v26 offset:50176
  ds_read_b64_tr_b16 a[156:157], v26 offset:57344
  ds_read_b64_tr_b16 a[158:159], v26 offset:58368
  ds_read_b64_tr_b16 a[160:161], v27 offset:0
  ds_read_b64_tr_b16 a[162:163], v27 offset:1024
  ds_read_b64_tr_b16 a[164:165], v27 offset:8192
  ds_read_b64_tr_b16 a[166:167], v27 offset:9216
  ds_read_b64_tr_b16 a[168:169], v27 offset:16384
  ds_read_b64_tr_b16 a[170:171], v27 offset:17408
  ds_read_b64_tr_b16 a[172:173], v27 offset:24576
  ds_read_b64_tr_b16 a[174:175], v27 offset:25600
  ds_read_b64_tr_b16 a[176:177], v27 offset:32768
  ds_read_b64_tr_b16 a[178:179], v27 offset:33792
  ds_read_b64_tr_b16 a[180:181], v27 offset:40960
  ds_read_b64_tr_b16 a[182:183], v27 offset:41984
  ds_read_b64_tr_b16 a[184:185], v27 offset:49152
  ds_read_b64_tr_b16 a[186:187], v27 offset:50176
  ds_read_b64_tr_b16 a[188:189], v27 offset:57344
  ds_read_b64_tr_b16 a[190:191], v27 offset:58368
  ds_read_b64_tr_b16 a[192:193], v26 offset:8
  ds_read_b64_tr_b16 a[194:195], v26 offset:1032
  ds_read_b64_tr_b16 a[196:197], v26 offset:8200
  ds_read_b64_tr_b16 a[198:199], v26 offset:9224
  ds_read_b64_tr_b16 a[200:201], v26 offset:16392
  ds_read_b64_tr_b16 a[202:203], v26 offset:17416
  ds_read_b64_tr_b16 a[204:205], v26 offset:24584
  ds_read_b64_tr_b16 a[206:207], v26 offset:25608
  ds_read_b64_tr_b16 a[208:209], v26 offset:32776
  ds_read_b64_tr_b16 a[210:211], v26 offset:33800
  ds_read_b64_tr_b16 a[212:213], v26 offset:40968
  ds_read_b64_tr_b16 a[214:215], v26 offset:41992
  ds_read_b64_tr_b16 a[216:217], v26 offset:49160
  ds_read_b64_tr_b16 a[218:219], v26 offset:50184
  ds_read_b64_tr_b16 a[220:221], v26 offset:57352
  ds_read_b64_tr_b16 a[222:223], v26 offset:58376
  ds_read_b64_tr_b16 a[224:225], v27 offset:8
  ds_read_b64_tr_b16 a[226:227], v27 offset:1032
  ds_read_b64_tr_b16 a[228:229], v27 offset:8200
  ds_read_b64_tr_b16 a[230:231], v27 offset:9224
  ds_read_b64_tr_b16 a[232:233], v27 offset:16392
  ds_read_b64_tr_b16 a[234:235], v27 offset:17416
  ds_read_b64_tr_b16 a[236:237], v27 offset:24584
  ds_read_b64_tr_b16 a[238:239], v27 offset:25608
  ds_read_b64_tr_b16 a[240:241], v27 offset:32776
  ds_read_b64_tr_b16 a[242:243], v27 offset:33800
  ds_read_b64_tr_b16 a[244:245], v27 offset:40968
  ds_read_b64_tr_b16 a[246:247], v27 offset:41992
  ds_read_b64_tr_b16 a[248:249], v27 offset:49160
  ds_read_b64_tr_b16 a[250:251], v27 offset:50184
  ds_read_b64_tr_b16 a[252:253], v27 offset:57352
  ds_read_b64_tr_b16 a[254:255], v27 offset:58376
  s_waitcnt lgkmcnt(0)
  s_barrier
  v_and_b32 v24, 15, v0
  v_lshrrev_b32 v25, 4, v0
  v_lshlrev_b32 v1, 4, v0
  v_mov_b32 v2, v1
  v_add_u32 v8, 32768, v1
  v_lshlrev_b32 v3, 2, v24
  v_bfe_u32 v26, v0, 4, 1
  v_lshl_add_u32 v3, v26, 8, v3
  s_lshr_b32 s16, s13, 2
  s_lshl_b32 s16, s16, 6
  v_add_u32 v3, s16, v3
  v_lshlrev_b32 v4, 12, v24
  v_lshl_add_u32 v4, v25, 4, v4
  s_lshr_b32 s16, s13, 2
  s_lshl_b32 s16, s16, 10
  s_and_b32 s17, s13, 3
  s_lshl_b32 s17, s17, 8
  s_add_u32 s16, s16, s17
  s_lshl_b32 s17, s12, 6
  s_add_u32 s16, s16, s17
  v_add_u32 v4, s16, v4
  v_lshlrev_b32 v5, 10, v25
  v_lshl_add_u32 v5, v24, 4, v5
  s_lshl_b32 s16, s13, 13
  s_lshl_b32 s17, s12, 8
  s_add_u32 s16, s16, s17
  v_add_u32 v5, s16, v5
  v_lshl_add_u32 v26, v25, 5, v24
  s_lshl_b32 s16, s12, 7
  v_add_u32 v26, s16, v26
  v_lshlrev_b32 v6, 2, v26
  v_add_u32 v6, 131072, v6
  s_and_b32 s16, s12, 1
  s_lshl_b32 s16, s16, 11
  s_add_u32 s16, s16, 131072
  v_lshlrev_b32 v7, 5, v0
  v_add_u32 v7, s16, v7
  v_mov_b32 v12, 0
  v_cmp_eq_u32 vcc, 0, v24
  v_mov_b32 v26, 0x3f80
  s_nop 0
  v_cndmask_b32 v12, v12, v26, vcc
  v_cmp_eq_u32 vcc, 1, v24
  v_mov_b32 v26, 0x3f800000
  s_nop 0
  v_cndmask_b32 v12, v12, v26, vcc
  v_mov_b32 v13, 0
  v_cmp_eq_u32 vcc, 2, v24
  v_mov_b32 v26, 0x3f80
  s_nop 0
  v_cndmask_b32 v13, v13, v26, vcc
  v_cmp_eq_u32 vcc, 3, v24
  v_mov_b32 v26, 0x3f800000
  s_nop 0
  v_cndmask_b32 v13, v13, v26, vcc
  v_mov_b32 v14, 0
  v_cmp_eq_u32 vcc, 4, v24
  v_mov_b32 v26, 0x3f80
  s_nop 0
  v_cndmask_b32 v14, v14, v26, vcc
  v_cmp_eq_u32 vcc, 5, v24
  v_mov_b32 v26, 0x3f800000
  s_nop 0
  v_cndmask_b32 v14, v14, v26, vcc
  v_mov_b32 v15, 0
  v_cmp_eq_u32 vcc, 6, v24
  v_mov_b32 v26, 0x3f80
  s_nop 0
  v_cndmask_b32 v15, v15, v26, vcc
  v_cmp_eq_u32 vcc, 7, v24
  v_mov_b32 v26, 0x3f800000
  s_nop 0
  v_cndmask_b32 v15, v15, v26, vcc
  s_mov_b32 s32, 0x00FF00FF
  s_mov_b32 s33, 0x00FF00FF
  s_mov_b32 s40, 0x0000FFFF
  s_mov_b32 s41, 0x0000FFFF
  s_mov_b32 s42, 0xFFFF0000
  s_mov_b32 s43, 0xFFFF0000
  s_mov_b32 s31, 0
  s_lshr_b32 s16, s13, 2
  s_lshl_b32 s16, s16, 16
  s_add_u32 s19, s16, 184549376
  s_mov_b32 s20, 4538368
  s_mov_b32 s30, 2621440
  s_lshl_b32 s16, s13, 1
  s_and_b32 s17, s12, 1
  s_add_u32 s16, s16, s17
  s_lshl_b32 s25, s16, 10
  s_load_dwordx2 s[36:37], s[0:1], 80
  s_waitcnt lgkmcnt(0)
  s_mov_b32 s38, 2097152
  s_mov_b32 s39, 0x20000
  s_mov_b32 s18, 0
  s_mov_b32 s21, 0
  s_mov_b32 s99, 6
  s_load_dwordx2 s[8:9], s[0:1], 88
  s_waitcnt lgkmcnt(0)
  s_mov_b32 s10, 256
  s_mov_b32 s11, 0x20000
  v_and_b32 v21, 7, v0
  v_lshlrev_b32 v21, 4, v21
census_O16:
  buffer_load_dword v20, v21, s[8:11], 0 offen sc1
  s_waitcnt vmcnt(0)
  s_mov_b32 s16, 0
  v_readlane_b32 s17, v20, 0
  s_nop 0
  s_add_u32 s16, s16, s17
  v_readlane_b32 s17, v20, 1
  s_nop 0
  s_add_u32 s16, s16, s17
  v_readlane_b32 s17, v20, 2
  s_nop 0
  s_add_u32 s16, s16, s17
  v_readlane_b32 s17, v20, 3
  s_nop 0
  s_add_u32 s16, s16, s17
  v_readlane_b32 s17, v20, 4
  s_nop 0
  s_add_u32 s16, s16, s17
  v_readlane_b32 s17, v20, 5
  s_nop 0
  s_add_u32 s16, s16, s17
  v_readlane_b32 s17, v20, 6
  s_nop 0
  s_add_u32 s16, s16, s17
  v_readlane_b32 s17, v20, 7
  s_nop 0
  s_add_u32 s16, s16, s17
  s_cmp_ge_u32 s16, 256
  s_cbranch_scc1 census_O16_ok
  s_sub_u32 s15, s15, 1
  s_cbranch_scc1 census_O16_ok
  s_branch census_O16
census_O16_ok:
  v_readlane_b32 s17, v20, s99
  s_nop 0
  s_cmp_ge_u32 s17, 32
  s_cselect_b32 s100, 1, 0
  s_mov_b32 s18, 0
  s_cmp_eq_u32 s100, 0
  s_cbranch_scc1 O16_n
ofw_O16l0:
  buffer_load_dword v20, v3, s[4:7], s20 offen sc1
  s_waitcnt vmcnt(0)
  v_cmp_eq_u32 vcc, 0, v20
  s_and_b64 vcc, vcc, s[40:41]
  s_cbranch_scc0 ofw_O16l0_ok
  s_sub_u32 s15, s15, 1
  s_cbranch_scc1 ofw_O16l0_ok
  s_sleep 24
  s_branch ofw_O16l0
ofw_O16l0_ok:
  s_lshl_b32 s44, s12, 14
  s_add_u32 s45, s44, s21
  s_add_u32 s44, s44, s19
  s_mov_b32 m0, s45
  s_nop 0
  buffer_load_dwordx4 v1, s[4:7], s44 offen offset:0 sc1 lds
  buffer_load_dwordx4 v1, s[4:7], s44 offen offset:1024 sc1 lds
  buffer_load_dwordx4 v1, s[4:7], s44 offen offset:2048 sc1 lds
  buffer_load_dwordx4 v1, s[4:7], s44 offen offset:3072 sc1 lds
  s_add_u32 s45, s45, 4096
  s_mov_b32 m0, s45
  s_add_u32 s44, s44, 4096
  buffer_load_dwordx4 v1, s[4:7], s44 offen offset:0 sc1 lds
  buffer_load_dwordx4 v1, s[4:7], s44 offen offset:1024 sc1 lds
  buffer_load_dwordx4 v1, s[4:7], s44 offen offset:2048 sc1 lds
  buffer_load_dwordx4 v1, s[4:7], s44 offen offset:3072 sc1 lds
  s_add_u32 s45, s45, 4096
  s_mov_b32 m0, s45
  s_add_u32 s44, s44, 4096
  buffer_load_dwordx4 v1, s[4:7], s44 offen offset:0 sc1 lds
  buffer_load_dwordx4 v1, s[4:7], s44 offen offset:1024 sc1 lds
  buffer_load_dwordx4 v1, s[4:7], s44 offen offset:2048 sc1 lds
  buffer_load_dwordx4 v1, s[4:7], s44 offen offset:3072 sc1 lds
  s_add_u32 s45, s45, 4096
  s_mov_b32 m0, s45
  s_add_u32 s44, s44, 4096
  buffer_load_dwordx4 v1, s[4:7], s44 offen offset:0 sc1 lds
  buffer_load_dwordx4 v1, s[4:7], s44 offen offset:1024 sc1 lds
  buffer_load_dwordx4 v1, s[4:7], s44 offen offset:2048 sc1 lds
  buffer_load_dwordx4 v1, s[4:7], s44 offen offset:3072 sc1 lds
  s_waitcnt vmcnt(0)
  s_barrier
O16l_item:
  s_add_u32 s20, s20, 256
  s_add_u32 s19, s19, 262144
  s_lshl_b32 s44, s18, 15
  s_add_u32 s44, s44, s25
  s_add_u32 s44, s44, 23068672
  buffer_load_dwordx4 v[104:107], v1, s[4:7], s44 offen sc1
  buffer_load_dword v22, v3, s[4:7], s20 offen sc1
  s_and_b32 s44, s18, 1
  s_mul_i32 s44, s44, 131072
  s_add_u32 s23, s44, s30
  s_bfe_u32 s24, s18, 0x10001
  ds_read_b128 v[24:27], v2 offset:0
  ds_read_b128 v[28:31], v2 offset:4096
  ds_read_b128 v[32:35], v2 offset:1024
  ds_read_b128 v[36:39], v2 offset:5120
  ds_read_b128 v[40:43], v2 offset:2048
  ds_read_b128 v[44:47], v2 offset:6144
  s_sub_u32 s47, s19, 262144
  s_cmp_lg_u32 s31, 0
  s_cselect_b32 s47, s19, s47
  s_sub_u32 s46, 65536, s21
  s_mov_b32 s22, s31
  s_waitcnt lgkmcnt(4)
  v_mfma_f32_16x16x32_bf16 v[56:59], a[0:3], v[24:27], 0
  ds_read_b128 v[48:51], v2 offset:3072
  v_mfma_f32_16x16x32_bf16 v[60:63], a[0:3], v[28:31], 0
  ds_read_b128 v[52:55], v2 offset:7168
  v_mfma_f32_16x16x32_bf16 v[64:67], a[64:67], v[24:27], 0
  s_waitcnt lgkmcnt(4)
  v_mfma_f32_16x16x32_bf16 v[68:71], a[64:67], v[28:31], 0
  s_lshl_b32 s44, s12, 14
  s_add_u32 s45, s44, s46
  s_add_u32 s44, s44, s47
  s_mov_b32 m0, s45
  s_nop 0
  v_mfma_f32_16x16x32_bf16 v[56:59], a[4:7], v[32:35], v[56:59]
  ds_read_b128 v[24:27], v2 offset:8192
  v_mfma_f32_16x16x32_bf16 v[60:63], a[4:7], v[36:39], v[60:63]
  ds_read_b128 v[28:31], v2 offset:12288
  v_mfma_f32_16x16x32_bf16 v[64:67], a[68:71], v[32:35], v[64:67]
  s_waitcnt lgkmcnt(4)
  v_mfma_f32_16x16x32_bf16 v[68:71], a[68:71], v[36:39], v[68:71]
  buffer_load_dwordx4 v1, s[4:7], s44 offen offset:0 sc1 lds
  v_mfma_f32_16x16x32_bf16 v[56:59], a[8:11], v[40:43], v[56:59]
  ds_read_b128 v[32:35], v2 offset:9216
  v_mfma_f32_16x16x32_bf16 v[60:63], a[8:11], v[44:47], v[60:63]
  ds_read_b128 v[36:39], v2 offset:13312
  v_mfma_f32_16x16x32_bf16 v[64:67], a[72:75], v[40:43], v[64:67]
  s_waitcnt lgkmcnt(4)
  v_mfma_f32_16x16x32_bf16 v[68:71], a[72:75], v[44:47], v[68:71]
  buffer_load_dwordx4 v1, s[4:7], s44 offen offset:1024 sc1 lds
  v_mfma_f32_16x16x32_bf16 v[56:59], a[12:15], v[48:51], v[56:59]
  ds_read_b128 v[40:43], v2 offset:10240
  v_mfma_f32_16x16x32_bf16 v[60:63], a[12:15], v[52:55], v[60:63]
  ds_read_b128 v[44:47], v2 offset:14336
  v_mfma_f32_16x16x32_bf16 v[64:67], a[76:79], v[48:51], v[64:67]
  s_waitcnt lgkmcnt(4)
  v_mfma_f32_16x16x32_bf16 v[68:71], a[76:79], v[52:55], v[68:71]
  buffer_load_dwordx4 v1, s[4:7], s44 offen offset:2048 sc1 lds
  v_mfma_f32_16x16x32_bf16 v[56:59], a[16:19], v[24:27], v[56:59]
  ds_read_b128 v[48:51], v2 offset:11264
  v_mfma_f32_16x16x32_bf16 v[60:63], a[16:19], v[28:31], v[60:63]
  ds_read_b128 v[52:55], v2 offset:15360
  v_mfma_f32_16x16x32_bf16 v[64:67], a[80:83], v[24:27], v[64:67]
  s_waitcnt lgkmcnt(4)
  v_mfma_f32_16x16x32_bf16 v[68:71], a[80:83], v[28:31], v[68:71]
  buffer_load_dwordx4 v1, s[4:7], s44 offen offset:3072 sc1 lds
  v_mfma_f32_16x16x32_bf16 v[56:59], a[20:23], v[32:35], v[56:59]
  ds_read_b128 v[24:27], v2 offset:16384
  v_mfma_f32_16x16x32_bf16 v[60:63], a[20:23], v[36:39], v[60:63]
  ds_read_b128 v[28:31], v2 offset:20480
  v_mfma_f32_16x16x32_bf16 v[64:67], a[84:87], v[32:35], v[64:67]
  s_waitcnt lgkmcnt(4)
  v_mfma_f32_16x16x32_bf16 v[68:71], a[84:87], v[36:39], v[68:71]
  s_add_u32 s45, s45, 4096
  s_mov_b32 m0, s45
  s_add_u32 s44, s44, 4096
  v_mfma_f32_16x16x32_bf16 v[56:59], a[24:27], v[40:43], v[56:59]
  ds_read_b128 v[32:35], v2 offset:17408
  v_mfma_f32_16x16x32_bf16 v[60:63], a[24:27], v[44:47], v[60:63]
  ds_read_b128 v[36:39], v2 offset:21504
  v_mfma_f32_16x16x32_bf16 v[64:67], a[88:91], v[40:43], v[64:67]
  s_waitcnt lgkmcnt(4)
  v_mfma_f32_16x16x32_bf16 v[68:71], a[88:91], v[44:47], v[68:71]
  buffer_load_dwordx4 v1, s[4:7], s44 offen offset:0 sc1 lds
  v_mfma_f32_16x16x32_bf16 v[56:59], a[28:31], v[48:51], v[56:59]
  ds_read_b128 v[40:43], v2 offset:18432
  v_mfma_f32_16x16x32_bf16 v[60:63], a[28:31], v[52:55], v[60:63]
  ds_read_b128 v[44:47], v2 offset:22528
  v_mfma_f32_16x16x32_bf16 v[64:67], a[92:95], v[48:51], v[64:67]
  s_waitcnt lgkmcnt(4)
  v_mfma_f32_16x16x32_bf16 v[68:71], a[92:95], v[52:55], v[68:71]
  buffer_load_dwordx4 v1, s[4:7], s44 offen offset:1024 sc1 lds
  v_mfma_f32_16x16x32_bf16 v[56:59], a[32:35], v[24:27], v[56:59]
  ds_read_b128 v[48:51], v2 offset:19456
  v_mfma_f32_16x16x32_bf16 v[60:63], a[32:35], v[28:31], v[60:63]
  ds_read_b128 v[52:55], v2 offset:23552
  v_mfma_f32_16x16x32_bf16 v[64:67], a[96:99], v[24:27], v[64:67]
  s_waitcnt lgkmcnt(4)
  v_mfma_f32_16x16x32_bf16 v[68:71], a[96:99], v[28:31], v[68:71]
  buffer_load_dwordx4 v1, s[4:7], s44 offen offset:2048 sc1 lds
  v_mfma_f32_16x16x32_bf16 v[56:59], a[36:39], v[32:35], v[56:59]
  ds_read_b128 v[24:27], v2 offset:24576
  v_mfma_f32_16x16x32_bf16 v[60:63], a[36:39], v[36:39], v[60:63]
  ds_read_b128 v[28:31], v2 offset:28672
  v_mfma_f32_16x16x32_bf16 v[64:67], a[100:103], v[32:35], v[64:67]
  s_waitcnt lgkmcnt(4)
  v_mfma_f32_16x16x32_bf16 v[68:71], a[100:103], v[36:39], v[68:71]
  buffer_load_dwordx4 v1, s[4:7], s44 offen offset:3072 sc1 lds
  v_mfma_f32_16x16x32_bf16 v[56:59], a[40:43], v[40:43], v[56:59]
  ds_read_b128 v[32:35], v2 offset:25600
  v_mfma_f32_16x16x32_bf16 v[60:63], a[40:43], v[44:47], v[60:63]
  ds_read_b128 v[36:39], v2 offset:29696
  v_mfma_f32_16x16x32_bf16 v[64:67], a[104:107], v[40:43], v[64:67]
  s_waitcnt lgkmcnt(4)
  v_mfma_f32_16x16x32_bf16 v[68:71], a[104:107], v[44:47], v[68:71]
  s_add_u32 s45, s45, 4096
  s_mov_b32 m0, s45
  s_add_u32 s44, s44, 4096
  v_mfma_f32_16x16x32_bf16 v[56:59], a[44:47], v[48:51], v[56:59]
  ds_read_b128 v[40:43], v2 offset:26624
  v_mfma_f32_16x16x32_bf16 v[60:63], a[44:47], v[52:55], v[60:63]
  ds_read_b128 v[44:47], v2 offset:30720
  v_mfma_f32_16x16x32_bf16 v[64:67], a[108:111], v[48:51], v[64:67]
  s_waitcnt lgkmcnt(4)
  v_mfma_f32_16x16x32_bf16 v[68:71], a[108:111], v[52:55], v[68:71]
  buffer_load_dwordx4 v1, s[4:7], s44 offen offset:0 sc1 lds
  v_mfma_f32_16x16x32_bf16 v[56:59], a[48:51], v[24:27], v[56:59]
  ds_read_b128 v[48:51], v2 offset:27648
  v_mfma_f32_16x16x32_bf16 v[60:63], a[48:51], v[28:31], v[60:63]
  ds_read_b128 v[52:55], v2 offset:31744
  v_mfma_f32_16x16x32_bf16 v[64:67], a[112:115], v[24:27], v[64:67]
  s_waitcnt lgkmcnt(4)
  v_mfma_f32_16x16x32_bf16 v[68:71], a[112:115], v[28:31], v[68:71]
  buffer_load_dwordx4 v1, s[4:7], s44 offen offset:1024 sc1 lds
  v_mfma_f32_16x16x32_bf16 v[56:59], a[52:55], v[32:35], v[56:59]
  ds_read_b128 v[24:27], v8 offset:0
  v_mfma_f32_16x16x32_bf16 v[60:63], a[52:55], v[36:39], v[60:63]
  ds_read_b128 v[28:31], v8 offset:4096
  v_mfma_f32_16x16x32_bf16 v[64:67], a[116:119], v[32:35], v[64:67]
  s_waitcnt lgkmcnt(4)
  v_mfma_f32_16x16x32_bf16 v[68:71], a[116:119], v[36:39], v[68:71]
  buffer_load_dwordx4 v1, s[4:7], s44 offen offset:2048 sc1 lds
  v_mfma_f32_16x16x32_bf16 v[56:59], a[56:59], v[40:43], v[56:59]
  ds_read_b128 v[32:35], v8 offset:1024
  v_mfma_f32_16x16x32_bf16 v[60:63], a[56:59], v[44:47], v[60:63]
  ds_read_b128 v[36:39], v8 offset:5120
  v_mfma_f32_16x16x32_bf16 v[64:67], a[120:123], v[40:43], v[64:67]
  s_waitcnt lgkmcnt(4)
  v_mfma_f32_16x16x32_bf16 v[68:71], a[120:123], v[44:47], v[68:71]
  buffer_load_dwordx4 v1, s[4:7], s44 offen offset:3072 sc1 lds
  v_mfma_f32_16x16x32_bf16 v[56:59], a[60:63], v[48:51], v[56:59]
  ds_read_b128 v[40:43], v8 offset:2048
  v_mfma_f32_16x16x32_bf16 v[60:63], a[60:63], v[52:55], v[60:63]
  ds_read_b128 v[44:47], v8 offset:6144
  v_mfma_f32_16x16x32_bf16 v[64:67], a[124:127], v[48:51], v[64:67]
  s_waitcnt lgkmcnt(4)
  v_mfma_f32_16x16x32_bf16 v[68:71], a[124:127], v[52:55], v[68:71]
  s_add_u32 s45, s45, 4096
  s_mov_b32 m0, s45
  s_add_u32 s44, s44, 4096
  v_mfma_f32_16x16x32_bf16 v[56:59], a[128:131], v[24:27], v[56:59]
  ds_read_b128 v[48:51], v8 offset:3072
  v_mfma_f32_16x16x32_bf16 v[60:63], a[128:131], v[28:31], v[60:63]
  ds_read_b128 v[52:55], v8 offset:7168
  v_mfma_f32_16x16x32_bf16 v[64:67], a[192:195], v[24:27], v[64:67]
  s_waitcnt lgkmcnt(4)
  v_mfma_f32_16x16x32_bf16 v[68:71], a[192:195], v[28:31], v[68:71]
  buffer_load_dwordx4 v1, s[4:7], s44 offen offset:0 sc1 lds
  v_mfma_f32_16x16x32_bf16 v[56:59], a[132:135], v[32:35], v[56:59]
  ds_read_b128 v[24:27], v8 offset:8192
  v_mfma_f32_16x16x32_bf16 v[60:63], a[132:135], v[36:39], v[60:63]
  ds_read_b128 v[28:31], v8 offset:12288
  v_mfma_f32_16x16x32_bf16 v[64:67], a[196:199], v[32:35], v[64:67]
  s_waitcnt lgkmcnt(4)
  v_mfma_f32_16x16x32_bf16 v[68:71], a[196:199], v[36:39], v[68:71]
  buffer_load_dwordx4 v1, s[4:7], s44 offen offset:1024 sc1 lds
  v_mfma_f32_16x16x32_bf16 v[56:59], a[136:139], v[40:43], v[56:59]
  ds_read_b128 v[32:35], v8 offset:9216
  v_mfma_f32_16x16x32_bf16 v[60:63], a[136:139], v[44:47], v[60:63]
  ds_read_b128 v[36:39], v8 offset:13312
  v_mfma_f32_16x16x32_bf16 v[64:67], a[200:203], v[40:43], v[64:67]
  s_waitcnt lgkmcnt(4)
  v_mfma_f32_16x16x32_bf16 v[68:71], a[200:203], v[44:47], v[68:71]
  buffer_load_dwordx4 v1, s[4:7], s44 offen offset:2048 sc1 lds
  v_mfma_f32_16x16x32_bf16 v[56:59], a[140:143], v[48:51], v[56:59]
  ds_read_b128 v[40:43], v8 offset:10240
  v_mfma_f32_16x16x32_bf16 v[60:63], a[140:143], v[52:55], v[60:63]
  ds_read_b128 v[44:47], v8 offset:14336
  v_mfma_f32_16x16x32_bf16 v[64:67], a[204:207], v[48:51], v[64:67]
  s_waitcnt lgkmcnt(4)
  v_mfma_f32_16x16x32_bf16 v[68:71], a[204:207], v[52:55], v[68:71]
  buffer_load_dwordx4 v1, s[4:7], s44 offen offset:3072 sc1 lds
  v_mfma_f32_16x16x32_bf16 v[56:59], a[144:147], v[24:27], v[56:59]
  ds_read_b128 v[48:51], v8 offset:11264
  v_mfma_f32_16x16x32_bf16 v[60:63], a[144:147], v[28:31], v[60:63]
  ds_read_b128 v[52:55], v8 offset:15360
  v_mfma_f32_16x16x32_bf16 v[64:67], a[208:211], v[24:27], v[64:67]
  s_waitcnt lgkmcnt(4)
  v_mfma_f32_16x16x32_bf16 v[68:71], a[208:211], v[28:31], v[68:71]
  v_mfma_f32_16x16x32_bf16 v[56:59], a[148:151], v[32:35], v[56:59]
  ds_read_b128 v[24:27], v8 offset:16384
  v_mfma_f32_16x16x32_bf16 v[60:63], a[148:151], v[36:39], v[60:63]
  ds_read_b128 v[28:31], v8 offset:20480
  v_mfma_f32_16x16x32_bf16 v[64:67], a[212:215], v[32:35], v[64:67]
  s_waitcnt lgkmcnt(4)
  v_mfma_f32_16x16x32_bf16 v[68:71], a[212:215], v[36:39], v[68:71]
  v_mfma_f32_16x16x32_bf16 v[56:59], a[152:155], v[40:43], v[56:59]
  ds_read_b128 v[32:35], v8 offset:17408
  v_mfma_f32_16x16x32_bf16 v[60:63], a[152:155], v[44:47], v[60:63]
  ds_read_b128 v[36:39], v8 offset:21504
  v_mfma_f32_16x16x32_bf16 v[64:67], a[216:219], v[40:43], v[64:67]
  s_waitcnt lgkmcnt(4)
  v_mfma_f32_16x16x32_bf16 v[68:71], a[216:219], v[44:47], v[68:71]
  v_mfma_f32_16x16x32_bf16 v[56:59], a[156:159], v[48:51], v[56:59]
  ds_read_b128 v[40:43], v8 offset:18432
  v_mfma_f32_16x16x32_bf16 v[60:63], a[156:159], v[52:55], v[60:63]
  ds_read_b128 v[44:47], v8 offset:22528
  v_mfma_f32_16x16x32_bf16 v[64:67], a[220:223], v[48:51], v[64:67]
  s_waitcnt lgkmcnt(4)
  v_mfma_f32_16x16x32_bf16 v[68:71], a[220:223], v[52:55], v[68:71]
  v_mfma_f32_16x16x32_bf16 v[56:59], a[160:163], v[24:27], v[56:59]
  ds_read_b128 v[48:51], v8 offset:19456
  v_mfma_f32_16x16x32_bf16 v[60:63], a[160:163], v[28:31], v[60:63]
  ds_read_b128 v[52:55], v8 offset:23552
  v_mfma_f32_16x16x32_bf16 v[64:67], a[224:227], v[24:27], v[64:67]
  s_waitcnt lgkmcnt(4)
  v_mfma_f32_16x16x32_bf16 v[68:71], a[224:227], v[28:31], v[68:71]
  v_mfma_f32_16x16x32_bf16 v[56:59], a[164:167], v[32:35], v[56:59]
  ds_read_b128 v[24:27], v8 offset:24576
  v_mfma_f32_16x16x32_bf16 v[60:63], a[164:167], v[36:39], v[60:63]
  ds_read_b128 v[28:31], v8 offset:28672
  v_mfma_f32_16x16x32_bf16 v[64:67], a[228:231], v[32:35], v[64:67]
  s_waitcnt lgkmcnt(4)
  v_mfma_f32_16x16x32_bf16 v[68:71], a[228:231], v[36:39], v[68:71]
  v_mfma_f32_16x16x32_bf16 v[56:59], a[168:171], v[40:43], v[56:59]
  ds_read_b128 v[32:35], v8 offset:25600
  v_mfma_f32_16x16x32_bf16 v[60:63], a[168:171], v[44:47], v[60:63]
  ds_read_b128 v[36:39], v8 offset:29696
  v_mfma_f32_16x16x32_bf16 v[64:67], a[232:235], v[40:43], v[64:67]
  s_waitcnt lgkmcnt(4)
  v_mfma_f32_16x16x32_bf16 v[68:71], a[232:235], v[44:47], v[68:71]
  v_mfma_f32_16x16x32_bf16 v[56:59], a[172:175], v[48:51], v[56:59]
  ds_read_b128 v[40:43], v8 offset:26624
  v_mfma_f32_16x16x32_bf16 v[60:63], a[172:175], v[52:55], v[60:63]
  ds_read_b128 v[44:47], v8 offset:30720
  v_mfma_f32_16x16x32_bf16 v[64:67], a[236:239], v[48:51], v[64:67]
  s_waitcnt lgkmcnt(4)
  v_mfma_f32_16x16x32_bf16 v[68:71], a[236:239], v[52:55], v[68:71]
  v_mfma_f32_16x16x32_bf16 v[56:59], a[176:179], v[24:27], v[56:59]
  ds_read_b128 v[48:51], v8 offset:27648
  v_mfma_f32_16x16x32_bf16 v[60:63], a[176:179], v[28:31], v[60:63]
  ds_read_b128 v[52:55], v8 offset:31744
  v_mfma_f32_16x16x32_bf16 v[64:67], a[240:243], v[24:27], v[64:67]
  s_waitcnt lgkmcnt(4)
  v_mfma_f32_16x16x32_bf16 v[68:71], a[240:243], v[28:31], v[68:71]
  v_mfma_f32_16x16x32_bf16 v[56:59], a[180:183], v[32:35], v[56:59]
  v_mfma_f32_16x16x32_bf16 v[60:63], a[180:183], v[36:39], v[60:63]
  v_mfma_f32_16x16x32_bf16 v[64:67], a[244:247], v[32:35], v[64:67]
  s_waitcnt lgkmcnt(2)
  v_mfma_f32_16x16x32_bf16 v[68:71], a[244:247], v[36:39], v[68:71]
  v_mfma_f32_16x16x32_bf16 v[56:59], a[184:187], v[40:43], v[56:59]
  v_mfma_f32_16x16x32_bf16 v[60:63], a[184:187], v[44:47], v[60:63]
  v_mfma_f32_16x16x32_bf16 v[64:67], a[248:251], v[40:43], v[64:67]
  s_waitcnt lgkmcnt(0)
  v_mfma_f32_16x16x32_bf16 v[68:71], a[248:251], v[44:47], v[68:71]
  v_mfma_f32_16x16x32_bf16 v[56:59], a[188:191], v[48:51], v[56:59]
  v_mfma_f32_16x16x32_bf16 v[60:63], a[188:191], v[52:55], v[60:63]
  v_mfma_f32_16x16x32_bf16 v[64:67], a[252:255], v[48:51], v[64:67]
  v_mfma_f32_16x16x32_bf16 v[68:71], a[252:255], v[52:55], v[68:71]
  s_nop 5
  v_cvt_pk_bf16_f32 v72, v56, v57
  v_cvt_pk_bf16_f32 v73, v58, v59
  v_cvt_pk_bf16_f32 v74, v64, v65
  v_cvt_pk_bf16_f32 v75, v66, v67
  v_bfi_b32 v72, 1, s24, v72
  s_add_u32 s44, s23, 0
  buffer_store_dwordx4 v[72:75], v4, s[4:7], s44 offen
  v_cvt_pk_bf16_f32 v76, v60, v61
  v_cvt_pk_bf16_f32 v77, v62, v63
  v_cvt_pk_bf16_f32 v78, v68, v69
  v_cvt_pk_bf16_f32 v79, v70, v71
  v_bfi_b32 v76, 1, s24, v76
  s_add_u32 s44, s23, 65536
  buffer_store_dwordx4 v[76:79], v4, s[4:7], s44 offen
  s_waitcnt vmcnt(0)
  buffer_load_dwordx4 v[80:83], v5, s[4:7], s23 offen nt
  s_add_u32 s44, s23, 4096
  buffer_load_dwordx4 v[84:87], v5, s[4:7], s44 offen nt
  s_waitcnt vmcnt(0)
  v_bitop3_b32 v21, v80, v84, s24 bitop3:0x7E
  v_and_b32 v21, 1, v21
  v_cmp_ne_u32 vcc, 0, v21
  s_cbranch_vccz O16l_in_ok
O16l_in:
  s_mov_b64 exec, vcc
  buffer_load_dwordx4 v[80:83], v5, s[4:7], s23 offen nt
  s_add_u32 s44, s23, 4096
  buffer_load_dwordx4 v[84:87], v5, s[4:7], s44 offen nt
  s_sub_u32 s15, s15, 1
  s_cbranch_scc1 O16l_in_ok
  s_waitcnt vmcnt(0)
  v_bitop3_b32 v21, v80, v84, s24 bitop3:0x7E
  v_and_b32 v21, 1, v21
  v_cmp_ne_u32 vcc, 0, v21
  s_cbranch_vccnz O16l_in
O16l_in_ok:
  s_mov_b64 exec, -1
  buffer_load_dword v20, v3, s[4:7], s20 offen sc1
  s_nop 2
  v_mfma_f32_16x16x32_bf16 v[88:91], v[80:83], v[12:15], 0
  v_mfma_f32_16x16x32_bf16 v[92:95], v[84:87], v[12:15], 0
  s_nop 7
  s_mov_b64 exec, s[32:33]
  ds_write_b32 v6, v88 offset:0
  ds_write_b32 v6, v92 offset:2048
  ds_write_b32 v6, v89 offset:32
  ds_write_b32 v6, v93 offset:2080
  ds_write_b32 v6, v90 offset:64
  ds_write_b32 v6, v94 offset:2112
  ds_write_b32 v6, v91 offset:96
  ds_write_b32 v6, v95 offset:2144
  s_mov_b64 exec, -1
  s_waitcnt lgkmcnt(0)
  s_barrier
  s_cmp_ge_u32 s12, 2
  s_cbranch_scc1 O16l_fin
  ds_read_b128 v[96:99], v7
  ds_read_b128 v[100:103], v7 offset:16
  s_waitcnt lgkmcnt(0)
  v_cvt_pk_bf16_f32 v108, v96, v97
  v_cvt_pk_bf16_f32 v109, v98, v99
  v_cvt_pk_bf16_f32 v110, v100, v101
  v_cvt_pk_bf16_f32 v111, v102, v103
  v_lshlrev_b32 v96, 16, v108
  v_and_b32 v97, 0xffff0000, v108
  v_lshlrev_b32 v98, 16, v109
  v_and_b32 v99, 0xffff0000, v109
  v_lshlrev_b32 v100, 16, v110
  v_and_b32 v101, 0xffff0000, v110
  v_lshlrev_b32 v102, 16, v111
  v_and_b32 v103, 0xffff0000, v111
  v_lshlrev_b32 v112, 16, v104
  v_and_b32 v113, 0xffff0000, v104
  v_lshlrev_b32 v114, 16, v105
  v_and_b32 v115, 0xffff0000, v105
  v_lshlrev_b32 v116, 16, v106
  v_and_b32 v117, 0xffff0000, v106
  v_lshlrev_b32 v118, 16, v107
  v_and_b32 v119, 0xffff0000, v107
  v_pk_add_f32 v[96:97], v[96:97], v[112:113]
  v_pk_add_f32 v[98:99], v[98:99], v[114:115]
  v_pk_add_f32 v[100:101], v[100:101], v[116:117]
  v_pk_add_f32 v[102:103], v[102:103], v[118:119]
  v_cvt_pk_bf16_f32 v104, v96, v97
  v_cvt_pk_bf16_f32 v105, v98, v99
  v_cvt_pk_bf16_f32 v106, v100, v101
  v_cvt_pk_bf16_f32 v107, v102, v103
  s_lshl_b32 s44, s18, 15
  s_add_u32 s44, s44, s25
  buffer_store_dwordx4 v[104:107], v1, s[36:39], s44 offen
O16l_fin:
  s_cmp_eq_u32 s18, 51
  s_cbranch_scc1 O16l_end
  s_cmp_eq_u32 s22, 0
  s_cbranch_scc1 O16l_late
  v_cmp_eq_u32 vcc, 0, v22
  s_and_b64 s[44:45], vcc, s[42:43]
  s_cselect_b32 s31, 0, 1
  s_cmp_ge_u32 s18, 50
  s_cselect_b32 s31, 0, s31
  s_branch O16l_go
O16l_late:
  s_cmp_ge_u32 s12, 2
  s_cbranch_scc1 O16l_w23
  s_waitcnt vmcnt(1)
  s_branch O16l_lk
O16l_w23:
  s_waitcnt vmcnt(0)
O16l_lk:
  v_cmp_eq_u32 vcc, 0, v20
  s_and_b64 s[44:45], vcc, s[42:43]
  s_cselect_b32 s31, 0, 1
  s_cmp_ge_u32 s18, 50
  s_cselect_b32 s31, 0, s31
  s_and_b64 vcc, vcc, s[40:41]
  s_cbranch_scc0 O16l_chk
ofw_O16l1:
  buffer_load_dword v20, v3, s[4:7], s20 offen sc1
  s_waitcnt vmcnt(0)
  v_cmp_eq_u32 vcc, 0, v20
  s_and_b64 vcc, vcc, s[40:41]
  s_cbranch_scc0 ofw_O16l1_ok
  s_sub_u32 s15, s15, 1
  s_cbranch_scc1 ofw_O16l1_ok
  s_sleep 24
  s_branch ofw_O16l1
ofw_O16l1_ok:
  v_cmp_eq_u32 vcc, 0, v20
  s_and_b64 s[44:45], vcc, s[42:43]
  s_cselect_b32 s31, 0, 1
  s_cmp_ge_u32 s18, 50
  s_cselect_b32 s31, 0, s31
  s_and_b64 vcc, vcc, s[40:41]
  s_branch O16l_copy
O16l_chk:
  s_cmp_lg_u32 s22, 0
  s_cbranch_scc1 O16l_go
O16l_copy:
  s_sub_u32 s46, 65536, s21
  s_lshl_b32 s44, s12, 14
  s_add_u32 s45, s44, s46
  s_add_u32 s44, s44, s19
  s_mov_b32 m0, s45
  s_nop 0
  buffer_load_dwordx4 v1, s[4:7], s44 offen offset:0 sc1 lds
  buffer_load_dwordx4 v1, s[4:7], s44 offen offset:1024 sc1 lds
  buffer_load_dwordx4 v1, s[4:7], s44 offen offset:2048 sc1 lds
  buffer_load_dwordx4 v1, s[4:7], s44 offen offset:3072 sc1 lds
  s_add_u32 s45, s45, 4096
  s_mov_b32 m0, s45
  s_add_u32 s44, s44, 4096
  buffer_load_dwordx4 v1, s[4:7], s44 offen offset:0 sc1 lds
  buffer_load_dwordx4 v1, s[4:7], s44 offen offset:1024 sc1 lds
  buffer_load_dwordx4 v1, s[4:7], s44 offen offset:2048 sc1 lds
  buffer_load_dwordx4 v1, s[4:7], s44 offen offset:3072 sc1 lds
  s_add_u32 s45, s45, 4096
  s_mov_b32 m0, s45
  s_add_u32 s44, s44, 4096
  buffer_load_dwordx4 v1, s[4:7], s44 offen offset:0 sc1 lds
  buffer_load_dwordx4 v1, s[4:7], s44 offen offset:1024 sc1 lds
  buffer_load_dwordx4 v1, s[4:7], s44 offen offset:2048 sc1 lds
  buffer_load_dwordx4 v1, s[4:7], s44 offen offset:3072 sc1 lds
  s_add_u32 s45, s45, 4096
  s_mov_b32 m0, s45
  s_add_u32 s44, s44, 4096
  buffer_load_dwordx4 v1, s[4:7], s44 offen offset:0 sc1 lds
  buffer_load_dwordx4 v1, s[4:7], s44 offen offset:1024 sc1 lds
  buffer_load_dwordx4 v1, s[4:7], s44 offen offset:2048 sc1 lds
  buffer_load_dwordx4 v1, s[4:7], s44 offen offset:3072 sc1 lds
  s_waitcnt vmcnt(0)
O16l_go:
  s_sub_u32 s46, 65536, s21
  s_sub_u32 s44, s46, s21
  v_add_u32 v2, s44, v2
  v_add_u32 v8, s44, v8
  s_mov_b32 s21, s46
  s_add_u32 s18, s18, 1
  s_barrier
  s_branch O16l_item
O16l_end:
  s_waitcnt vmcnt(0)
  s_endpgm
O16_n:
ofw_O16n0:
  buffer_load_dword v20, v3, s[4:7], s20 offen sc1
  s_waitcnt vmcnt(0)
  v_cmp_eq_u32 vcc, 0, v20
  s_and_b64 vcc, vcc, s[40:41]
  s_cbranch_scc0 ofw_O16n0_ok
  s_sub_u32 s15, s15, 1
  s_cbranch_scc1 ofw_O16n0_ok
  s_sleep 24
  s_branch ofw_O16n0
ofw_O16n0_ok:
  s_lshl_b32 s44, s12, 14
  s_add_u32 s45, s44, s21
  s_add_u32 s44, s44, s19
  s_mov_b32 m0, s45
  s_nop 0
  buffer_load_dwordx4 v1, s[4:7], s44 offen offset:0 sc1 lds
  buffer_load_dwordx4 v1, s[4:7], s44 offen offset:1024 sc1 lds
  buffer_load_dwordx4 v1, s[4:7], s44 offen offset:2048 sc1 lds
  buffer_load_dwordx4 v1, s[4:7], s44 offen offset:3072 sc1 lds
  s_add_u32 s45, s45, 4096
  s_mov_b32 m0, s45
  s_add_u32 s44, s44, 4096
  buffer_load_dwordx4 v1, s[4:7], s44 offen offset:0 sc1 lds
  buffer_load_dwordx4 v1, s[4:7], s44 offen offset:1024 sc1 lds
  buffer_load_dwordx4 v1, s[4:7], s44 offen offset:2048 sc1 lds
  buffer_load_dwordx4 v1, s[4:7], s44 offen offset:3072 sc1 lds
  s_add_u32 s45, s45, 4096
  s_mov_b32 m0, s45
  s_add_u32 s44, s44, 4096
  buffer_load_dwordx4 v1, s[4:7], s44 offen offset:0 sc1 lds
  buffer_load_dwordx4 v1, s[4:7], s44 offen offset:1024 sc1 lds
  buffer_load_dwordx4 v1, s[4:7], s44 offen offset:2048 sc1 lds
  buffer_load_dwordx4 v1, s[4:7], s44 offen offset:3072 sc1 lds
  s_add_u32 s45, s45, 4096
  s_mov_b32 m0, s45
  s_add_u32 s44, s44, 4096
  buffer_load_dwordx4 v1, s[4:7], s44 offen offset:0 sc1 lds
  buffer_load_dwordx4 v1, s[4:7], s44 offen offset:1024 sc1 lds
  buffer_load_dwordx4 v1, s[4:7], s44 offen offset:2048 sc1 lds
  buffer_load_dwordx4 v1, s[4:7], s44 offen offset:3072 sc1 lds
  s_waitcnt vmcnt(0)
  s_barrier
O16n_item:
  s_add_u32 s20, s20, 256
  s_add_u32 s19, s19, 262144
  s_lshl_b32 s44, s18, 15
  s_add_u32 s44, s44, s25
  s_add_u32 s44, s44, 23068672
  buffer_load_dwordx4 v[104:107], v1, s[4:7], s44 offen sc1
  buffer_load_dword v22, v3, s[4:7], s20 offen sc1
  s_and_b32 s44, s18, 1
  s_mul_i32 s44, s44, 131072
  s_add_u32 s23, s44, s30
  s_bfe_u32 s24, s18, 0x10001
  ds_read_b128 v[24:27], v2 offset:0
  ds_read_b128 v[28:31], v2 offset:4096
  ds_read_b128 v[32:35], v2 offset:1024
  ds_read_b128 v[36:39], v2 offset:5120
  ds_read_b128 v[40:43], v2 offset:2048
  ds_read_b128 v[44:47], v2 offset:6144
  s_sub_u32 s47, s19, 262144
  s_cmp_lg_u32 s31, 0
  s_cselect_b32 s47, s19, s47
  s_sub_u32 s46, 65536, s21
  s_mov_b32 s22, s31
  s_waitcnt lgkmcnt(4)
  v_mfma_f32_16x16x32_bf16 v[56:59], a[0:3], v[24:27], 0
  ds_read_b128 v[48:51], v2 offset:3072
  v_mfma_f32_16x16x32_bf16 v[60:63], a[0:3], v[28:31], 0
  ds_read_b128 v[52:55], v2 offset:7168
  v_mfma_f32_16x16x32_bf16 v[64:67], a[64:67], v[24:27], 0
  s_waitcnt lgkmcnt(4)
  v_mfma_f32_16x16x32_bf16 v[68:71], a[64:67], v[28:31], 0
  s_lshl_b32 s44, s12, 14
  s_add_u32 s45, s44, s46
  s_add_u32 s44, s44, s47
  s_mov_b32 m0, s45
  s_nop 0
  v_mfma_f32_16x16x32_bf16 v[56:59], a[4:7], v[32:35], v[56:59]
  ds_read_b128 v[24:27], v2 offset:8192
  v_mfma_f32_16x16x32_bf16 v[60:63], a[4:7], v[36:39], v[60:63]
  ds_read_b128 v[28:31], v2 offset:12288
  v_mfma_f32_16x16x32_bf16 v[64:67], a[68:71], v[32:35], v[64:67]
  s_waitcnt lgkmcnt(4)
  v_mfma_f32_16x16x32_bf16 v[68:71], a[68:71], v[36:39], v[68:71]
  buffer_load_dwordx4 v1, s[4:7], s44 offen offset:0 sc1 lds
  v_mfma_f32_16x16x32_bf16 v[56:59], a[8:11], v[40:43], v[56:59]
  ds_read_b128 v[32:35], v2 offset:9216
  v_mfma_f32_16x16x32_bf16 v[60:63], a[8:11], v[44:47], v[60:63]
  ds_read_b128 v[36:39], v2 offset:13312
  v_mfma_f32_16x16x32_bf16 v[64:67], a[72:75], v[40:43], v[64:67]
  s_waitcnt lgkmcnt(4)
  v_mfma_f32_16x16x32_bf16 v[68:71], a[72:75], v[44:47], v[68:71]
  buffer_load_dwordx4 v1, s[4:7], s44 offen offset:1024 sc1 lds
  v_mfma_f32_16x16x32_bf16 v[56:59], a[12:15], v[48:51], v[56:59]
  ds_read_b128 v[40:43], v2 offset:10240
  v_mfma_f32_16x16x32_bf16 v[60:63], a[12:15], v[52:55], v[60:63]
  ds_read_b128 v[44:47], v2 offset:14336
  v_mfma_f32_16x16x32_bf16 v[64:67], a[76:79], v[48:51], v[64:67]
  s_waitcnt lgkmcnt(4)
  v_mfma_f32_16x16x32_bf16 v[68:71], a[76:79], v[52:55], v[68:71]
  buffer_load_dwordx4 v1, s[4:7], s44 offen offset:2048 sc1 lds
  v_mfma_f32_16x16x32_bf16 v[56:59], a[16:19], v[24:27], v[56:59]
  ds_read_b128 v[48:51], v2 offset:11264
  v_mfma_f32_16x16x32_bf16 v[60:63], a[16:19], v[28:31], v[60:63]
  ds_read_b128 v[52:55], v2 offset:15360
  v_mfma_f32_16x16x32_bf16 v[64:67], a[80:83], v[24:27], v[64:67]
  s_waitcnt lgkmcnt(4)
  v_mfma_f32_16x16x32_bf16 v[68:71], a[80:83], v[28:31], v[68:71]
  buffer_load_dwordx4 v1, s[4:7], s44 offen offset:3072 sc1 lds
  v_mfma_f32_16x16x32_bf16 v[56:59], a[20:23], v[32:35], v[56:59]
  ds_read_b128 v[24:27], v2 offset:16384
  v_mfma_f32_16x16x32_bf16 v[60:63], a[20:23], v[36:39], v[60:63]
  ds_read_b128 v[28:31], v2 offset:20480
  v_mfma_f32_16x16x32_bf16 v[64:67], a[84:87], v[32:35], v[64:67]
  s_waitcnt lgkmcnt(4)
  v_mfma_f32_16x16x32_bf16 v[68:71], a[84:87], v[36:39], v[68:71]
  s_add_u32 s45, s45, 4096
  s_mov_b32 m0, s45
  s_add_u32 s44, s44, 4096
  v_mfma_f32_16x16x32_bf16 v[56:59], a[24:27], v[40:43], v[56:59]
  ds_read_b128 v[32:35], v2 offset:17408
  v_mfma_f32_16x16x32_bf16 v[60:63], a[24:27], v[44:47], v[60:63]
  ds_read_b128 v[36:39], v2 offset:21504
  v_mfma_f32_16x16x32_bf16 v[64:67], a[88:91], v[40:43], v[64:67]
  s_waitcnt lgkmcnt(4)
  v_mfma_f32_16x16x32_bf16 v[68:71], a[88:91], v[44:47], v[68:71]
  buffer_load_dwordx4 v1, s[4:7], s44 offen offset:0 sc1 lds
  v_mfma_f32_16x16x32_bf16 v[56:59], a[28:31], v[48:51], v[56:59]
  ds_read_b128 v[40:43], v2 offset:18432
  v_mfma_f32_16x16x32_bf16 v[60:63], a[28:31], v[52:55], v[60:63]
  ds_read_b128 v[44:47], v2 offset:22528
  v_mfma_f32_16x16x32_bf16 v[64:67], a[92:95], v[48:51], v[64:67]
  s_waitcnt lgkmcnt(4)
  v_mfma_f32_16x16x32_bf16 v[68:71], a[92:95], v[52:55], v[68:71]
  buffer_load_dwordx4 v1, s[4:7], s44 offen offset:1024 sc1 lds
  v_mfma_f32_16x16x32_bf16 v[56:59], a[32:35], v[24:27], v[56:59]
  ds_read_b128 v[48:51], v2 offset:19456
  v_mfma_f32_16x16x32_bf16 v[60:63], a[32:35], v[28:31], v[60:63]
  ds_read_b128 v[52:55], v2 offset:23552
  v_mfma_f32_16x16x32_bf16 v[64:67], a[96:99], v[24:27], v[64:67]
  s_waitcnt lgkmcnt(4)
  v_mfma_f32_16x16x32_bf16 v[68:71], a[96:99], v[28:31], v[68:71]
  buffer_load_dwordx4 v1, s[4:7], s44 offen offset:2048 sc1 lds
  v_mfma_f32_16x16x32_bf16 v[56:59], a[36:39], v[32:35], v[56:59]
  ds_read_b128 v[24:27], v2 offset:24576
  v_mfma_f32_16x16x32_bf16 v[60:63], a[36:39], v[36:39], v[60:63]
  ds_read_b128 v[28:31], v2 offset:28672
  v_mfma_f32_16x16x32_bf16 v[64:67], a[100:103], v[32:35], v[64:67]
  s_waitcnt lgkmcnt(4)
  v_mfma_f32_16x16x32_bf16 v[68:71], a[100:103], v[36:39], v[68:71]
  buffer_load_dwordx4 v1, s[4:7], s44 offen offset:3072 sc1 lds
  v_mfma_f32_16x16x32_bf16 v[56:59], a[40:43], v[40:43], v[56:59]
  ds_read_b128 v[32:35], v2 offset:25600
  v_mfma_f32_16x16x32_bf16 v[60:63], a[40:43], v[44:47], v[60:63]
  ds_read_b128 v[36:39], v2 offset:29696
  v_mfma_f32_16x16x32_bf16 v[64:67], a[104:107], v[40:43], v[64:67]
  s_waitcnt lgkmcnt(4)
  v_mfma_f32_16x16x32_bf16 v[68:71], a[104:107], v[44:47], v[68:71]
  s_add_u32 s45, s45, 4096
  s_mov_b32 m0, s45
  s_add_u32 s44, s44, 4096
  v_mfma_f32_16x16x32_bf16 v[56:59], a[44:47], v[48:51], v[56:59]
  ds_read_b128 v[40:43], v2 offset:26624
  v_mfma_f32_16x16x32_bf16 v[60:63], a[44:47], v[52:55], v[60:63]
  ds_read_b128 v[44:47], v2 offset:30720
  v_mfma_f32_16x16x32_bf16 v[64:67], a[108:111], v[48:51], v[64:67]
  s_waitcnt lgkmcnt(4)
  v_mfma_f32_16x16x32_bf16 v[68:71], a[108:111], v[52:55], v[68:71]
  buffer_load_dwordx4 v1, s[4:7], s44 offen offset:0 sc1 lds
  v_mfma_f32_16x16x32_bf16 v[56:59], a[48:51], v[24:27], v[56:59]
  ds_read_b128 v[48:51], v2 offset:27648
  v_mfma_f32_16x16x32_bf16 v[60:63], a[48:51], v[28:31], v[60:63]
  ds_read_b128 v[52:55], v2 offset:31744
  v_mfma_f32_16x16x32_bf16 v[64:67], a[112:115], v[24:27], v[64:67]
  s_waitcnt lgkmcnt(4)
  v_mfma_f32_16x16x32_bf16 v[68:71], a[112:115], v[28:31], v[68:71]
  buffer_load_dwordx4 v1, s[4:7], s44 offen offset:1024 sc1 lds
  v_mfma_f32_16x16x32_bf16 v[56:59], a[52:55], v[32:35], v[56:59]
  ds_read_b128 v[24:27], v8 offset:0
  v_mfma_f32_16x16x32_bf16 v[60:63], a[52:55], v[36:39], v[60:63]
  ds_read_b128 v[28:31], v8 offset:4096
  v_mfma_f32_16x16x32_bf16 v[64:67], a[116:119], v[32:35], v[64:67]
  s_waitcnt lgkmcnt(4)
  v_mfma_f32_16x16x32_bf16 v[68:71], a[116:119], v[36:39], v[68:71]
  buffer_load_dwordx4 v1, s[4:7], s44 offen offset:2048 sc1 lds
  v_mfma_f32_16x16x32_bf16 v[56:59], a[56:59], v[40:43], v[56:59]
  ds_read_b128 v[32:35], v8 offset:1024
  v_mfma_f32_16x16x32_bf16 v[60:63], a[56:59], v[44:47], v[60:63]
  ds_read_b128 v[36:39], v8 offset:5120
  v_mfma_f32_16x16x32_bf16 v[64:67], a[120:123], v[40:43], v[64:67]
  s_waitcnt lgkmcnt(4)
  v_mfma_f32_16x16x32_bf16 v[68:71], a[120:123], v[44:47], v[68:71]
  buffer_load_dwordx4 v1, s[4:7], s44 offen offset:3072 sc1 lds
  v_mfma_f32_16x16x32_bf16 v[56:59], a[60:63], v[48:51], v[56:59]
  ds_read_b128 v[40:43], v8 offset:2048
  v_mfma_f32_16x16x32_bf16 v[60:63], a[60:63], v[52:55], v[60:63]
  ds_read_b128 v[44:47], v8 offset:6144
  v_mfma_f32_16x16x32_bf16 v[64:67], a[124:127], v[48:51], v[64:67]
  s_waitcnt lgkmcnt(4)
  v_mfma_f32_16x16x32_bf16 v[68:71], a[124:127], v[52:55], v[68:71]
  s_add_u32 s45, s45, 4096
  s_mov_b32 m0, s45
  s_add_u32 s44, s44, 4096
  v_mfma_f32_16x16x32_bf16 v[56:59], a[128:131], v[24:27], v[56:59]
  ds_read_b128 v[48:51], v8 offset:3072
  v_mfma_f32_16x16x32_bf16 v[60:63], a[128:131], v[28:31], v[60:63]
  ds_read_b128 v[52:55], v8 offset:7168
  v_mfma_f32_16x16x32_bf16 v[64:67], a[192:195], v[24:27], v[64:67]
  s_waitcnt lgkmcnt(4)
  v_mfma_f32_16x16x32_bf16 v[68:71], a[192:195], v[28:31], v[68:71]
  buffer_load_dwordx4 v1, s[4:7], s44 offen offset:0 sc1 lds
  v_mfma_f32_16x16x32_bf16 v[56:59], a[132:135], v[32:35], v[56:59]
  ds_read_b128 v[24:27], v8 offset:8192
  v_mfma_f32_16x16x32_bf16 v[60:63], a[132:135], v[36:39], v[60:63]
  ds_read_b128 v[28:31], v8 offset:12288
  v_mfma_f32_16x16x32_bf16 v[64:67], a[196:199], v[32:35], v[64:67]
  s_waitcnt lgkmcnt(4)
  v_mfma_f32_16x16x32_bf16 v[68:71], a[196:199], v[36:39], v[68:71]
  buffer_load_dwordx4 v1, s[4:7], s44 offen offset:1024 sc1 lds
  v_mfma_f32_16x16x32_bf16 v[56:59], a[136:139], v[40:43], v[56:59]
  ds_read_b128 v[32:35], v8 offset:9216
  v_mfma_f32_16x16x32_bf16 v[60:63], a[136:139], v[44:47], v[60:63]
  ds_read_b128 v[36:39], v8 offset:13312
  v_mfma_f32_16x16x32_bf16 v[64:67], a[200:203], v[40:43], v[64:67]
  s_waitcnt lgkmcnt(4)
  v_mfma_f32_16x16x32_bf16 v[68:71], a[200:203], v[44:47], v[68:71]
  buffer_load_dwordx4 v1, s[4:7], s44 offen offset:2048 sc1 lds
  v_mfma_f32_16x16x32_bf16 v[56:59], a[140:143], v[48:51], v[56:59]
  ds_read_b128 v[40:43], v8 offset:10240
  v_mfma_f32_16x16x32_bf16 v[60:63], a[140:143], v[52:55], v[60:63]
  ds_read_b128 v[44:47], v8 offset:14336
  v_mfma_f32_16x16x32_bf16 v[64:67], a[204:207], v[48:51], v[64:67]
  s_waitcnt lgkmcnt(4)
  v_mfma_f32_16x16x32_bf16 v[68:71], a[204:207], v[52:55], v[68:71]
  buffer_load_dwordx4 v1, s[4:7], s44 offen offset:3072 sc1 lds
  v_mfma_f32_16x16x32_bf16 v[56:59], a[144:147], v[24:27], v[56:59]
  ds_read_b128 v[48:51], v8 offset:11264
  v_mfma_f32_16x16x32_bf16 v[60:63], a[144:147], v[28:31], v[60:63]
  ds_read_b128 v[52:55], v8 offset:15360
  v_mfma_f32_16x16x32_bf16 v[64:67], a[208:211], v[24:27], v[64:67]
  s_waitcnt lgkmcnt(4)
  v_mfma_f32_16x16x32_bf16 v[68:71], a[208:211], v[28:31], v[68:71]
  v_mfma_f32_16x16x32_bf16 v[56:59], a[148:151], v[32:35], v[56:59]
  ds_read_b128 v[24:27], v8 offset:16384
  v_mfma_f32_16x16x32_bf16 v[60:63], a[148:151], v[36:39], v[60:63]
  ds_read_b128 v[28:31], v8 offset:20480
  v_mfma_f32_16x16x32_bf16 v[64:67], a[212:215], v[32:35], v[64:67]
  s_waitcnt lgkmcnt(4)
  v_mfma_f32_16x16x32_bf16 v[68:71], a[212:215], v[36:39], v[68:71]
  v_mfma_f32_16x16x32_bf16 v[56:59], a[152:155], v[40:43], v[56:59]
  ds_read_b128 v[32:35], v8 offset:17408
  v_mfma_f32_16x16x32_bf16 v[60:63], a[152:155], v[44:47], v[60:63]
  ds_read_b128 v[36:39], v8 offset:21504
  v_mfma_f32_16x16x32_bf16 v[64:67], a[216:219], v[40:43], v[64:67]
  s_waitcnt lgkmcnt(4)
  v_mfma_f32_16x16x32_bf16 v[68:71], a[216:219], v[44:47], v[68:71]
  v_mfma_f32_16x16x32_bf16 v[56:59], a[156:159], v[48:51], v[56:59]
  ds_read_b128 v[40:43], v8 offset:18432
  v_mfma_f32_16x16x32_bf16 v[60:63], a[156:159], v[52:55], v[60:63]
  ds_read_b128 v[44:47], v8 offset:22528
  v_mfma_f32_16x16x32_bf16 v[64:67], a[220:223], v[48:51], v[64:67]
  s_waitcnt lgkmcnt(4)
  v_mfma_f32_16x16x32_bf16 v[68:71], a[220:223], v[52:55], v[68:71]
  v_mfma_f32_16x16x32_bf16 v[56:59], a[160:163], v[24:27], v[56:59]
  ds_read_b128 v[48:51], v8 offset:19456
  v_mfma_f32_16x16x32_bf16 v[60:63], a[160:163], v[28:31], v[60:63]
  ds_read_b128 v[52:55], v8 offset:23552
  v_mfma_f32_16x16x32_bf16 v[64:67], a[224:227], v[24:27], v[64:67]
  s_waitcnt lgkmcnt(4)
  v_mfma_f32_16x16x32_bf16 v[68:71], a[224:227], v[28:31], v[68:71]
  v_mfma_f32_16x16x32_bf16 v[56:59], a[164:167], v[32:35], v[56:59]
  ds_read_b128 v[24:27], v8 offset:24576
  v_mfma_f32_16x16x32_bf16 v[60:63], a[164:167], v[36:39], v[60:63]
  ds_read_b128 v[28:31], v8 offset:28672
  v_mfma_f32_16x16x32_bf16 v[64:67], a[228:231], v[32:35], v[64:67]
  s_waitcnt lgkmcnt(4)
  v_mfma_f32_16x16x32_bf16 v[68:71], a[228:231], v[36:39], v[68:71]
  v_mfma_f32_16x16x32_bf16 v[56:59], a[168:171], v[40:43], v[56:59]
  ds_read_b128 v[32:35], v8 offset:25600
  v_mfma_f32_16x16x32_bf16 v[60:63], a[168:171], v[44:47], v[60:63]
  ds_read_b128 v[36:39], v8 offset:29696
  v_mfma_f32_16x16x32_bf16 v[64:67], a[232:235], v[40:43], v[64:67]
  s_waitcnt lgkmcnt(4)
  v_mfma_f32_16x16x32_bf16 v[68:71], a[232:235], v[44:47], v[68:71]
  v_mfma_f32_16x16x32_bf16 v[56:59], a[172:175], v[48:51], v[56:59]
  ds_read_b128 v[40:43], v8 offset:26624
  v_mfma_f32_16x16x32_bf16 v[60:63], a[172:175], v[52:55], v[60:63]
  ds_read_b128 v[44:47], v8 offset:30720
  v_mfma_f32_16x16x32_bf16 v[64:67], a[236:239], v[48:51], v[64:67]
  s_waitcnt lgkmcnt(4)
  v_mfma_f32_16x16x32_bf16 v[68:71], a[236:239], v[52:55], v[68:71]
  v_mfma_f32_16x16x32_bf16 v[56:59], a[176:179], v[24:27], v[56:59]
  ds_read_b128 v[48:51], v8 offset:27648
  v_mfma_f32_16x16x32_bf16 v[60:63], a[176:179], v[28:31], v[60:63]
  ds_read_b128 v[52:55], v8 offset:31744
  v_mfma_f32_16x16x32_bf16 v[64:67], a[240:243], v[24:27], v[64:67]
  s_waitcnt lgkmcnt(4)
  v_mfma_f32_16x16x32_bf16 v[68:71], a[240:243], v[28:31], v[68:71]
  v_mfma_f32_16x16x32_bf16 v[56:59], a[180:183], v[32:35], v[56:59]
  v_mfma_f32_16x16x32_bf16 v[60:63], a[180:183], v[36:39], v[60:63]
  v_mfma_f32_16x16x32_bf16 v[64:67], a[244:247], v[32:35], v[64:67]
  s_waitcnt lgkmcnt(2)
  v_mfma_f32_16x16x32_bf16 v[68:71], a[244:247], v[36:39], v[68:71]
  v_mfma_f32_16x16x32_bf16 v[56:59], a[184:187], v[40:43], v[56:59]
  v_mfma_f32_16x16x32_bf16 v[60:63], a[184:187], v[44:47], v[60:63]
  v_mfma_f32_16x16x32_bf16 v[64:67], a[248:251], v[40:43], v[64:67]
  s_waitcnt lgkmcnt(0)
  v_mfma_f32_16x16x32_bf16 v[68:71], a[248:251], v[44:47], v[68:71]
  v_mfma_f32_16x16x32_bf16 v[56:59], a[188:191], v[48:51], v[56:59]
  v_mfma_f32_16x16x32_bf16 v[60:63], a[188:191], v[52:55], v[60:63]
  v_mfma_f32_16x16x32_bf16 v[64:67], a[252:255], v[48:51], v[64:67]
  v_mfma_f32_16x16x32_bf16 v[68:71], a[252:255], v[52:55], v[68:71]
  s_nop 5
  v_cvt_pk_bf16_f32 v72, v56, v57
  v_cvt_pk_bf16_f32 v73, v58, v59
  v_cvt_pk_bf16_f32 v74, v64, v65
  v_cvt_pk_bf16_f32 v75, v66, v67
  v_bfi_b32 v72, 1, s24, v72
  s_add_u32 s44, s23, 0
  buffer_store_dwordx4 v[72:75], v4, s[4:7], s44 offen sc1
  v_cvt_pk_bf16_f32 v76, v60, v61
  v_cvt_pk_bf16_f32 v77, v62, v63
  v_cvt_pk_bf16_f32 v78, v68, v69
  v_cvt_pk_bf16_f32 v79, v70, v71
  v_bfi_b32 v76, 1, s24, v76
  s_add_u32 s44, s23, 65536
  buffer_store_dwordx4 v[76:79], v4, s[4:7], s44 offen sc1
  s_waitcnt vmcnt(0)
  buffer_load_dwordx4 v[80:83], v5, s[4:7], s23 offen sc1
  s_add_u32 s44, s23, 4096
  buffer_load_dwordx4 v[84:87], v5, s[4:7], s44 offen sc1
  s_waitcnt vmcnt(0)
  v_bitop3_b32 v21, v80, v84, s24 bitop3:0x7E
  v_and_b32 v21, 1, v21
  v_cmp_ne_u32 vcc, 0, v21
  s_cbranch_vccz O16n_in_ok
O16n_in:
  s_mov_b64 exec, vcc
  buffer_load_dwordx4 v[80:83], v5, s[4:7], s23 offen sc1
  s_add_u32 s44, s23, 4096
  buffer_load_dwordx4 v[84:87], v5, s[4:7], s44 offen sc1
  s_sub_u32 s15, s15, 1
  s_cbranch_scc1 O16n_in_ok
  s_waitcnt vmcnt(0)
  v_bitop3_b32 v21, v80, v84, s24 bitop3:0x7E
  v_and_b32 v21, 1, v21
  v_cmp_ne_u32 vcc, 0, v21
  s_cbranch_vccnz O16n_in
O16n_in_ok:
  s_mov_b64 exec, -1
  buffer_load_dword v20, v3, s[4:7], s20 offen sc1
  s_nop 2
  v_mfma_f32_16x16x32_bf16 v[88:91], v[80:83], v[12:15], 0
  v_mfma_f32_16x16x32_bf16 v[92:95], v[84:87], v[12:15], 0
  s_nop 7
  s_mov_b64 exec, s[32:33]
  ds_write_b32 v6, v88 offset:0
  ds_write_b32 v6, v92 offset:2048
  ds_write_b32 v6, v89 offset:32
  ds_write_b32 v6, v93 offset:2080
  ds_write_b32 v6, v90 offset:64
  ds_write_b32 v6, v94 offset:2112
  ds_write_b32 v6, v91 offset:96
  ds_write_b32 v6, v95 offset:2144
  s_mov_b64 exec, -1
  s_waitcnt lgkmcnt(0)
  s_barrier
  s_cmp_ge_u32 s12, 2
  s_cbranch_scc1 O16n_fin
  ds_read_b128 v[96:99], v7
  ds_read_b128 v[100:103], v7 offset:16
  s_waitcnt lgkmcnt(0)
  v_cvt_pk_bf16_f32 v108, v96, v97
  v_cvt_pk_bf16_f32 v109, v98, v99
  v_cvt_pk_bf16_f32 v110, v100, v101
  v_cvt_pk_bf16_f32 v111, v102, v103
  v_lshlrev_b32 v96, 16, v108
  v_and_b32 v97, 0xffff0000, v108
  v_lshlrev_b32 v98, 16, v109
  v_and_b32 v99, 0xffff0000, v109
  v_lshlrev_b32 v100, 16, v110
  v_and_b32 v101, 0xffff0000, v110
  v_lshlrev_b32 v102, 16, v111
  v_and_b32 v103, 0xffff0000, v111
  v_lshlrev_b32 v112, 16, v104
  v_and_b32 v113, 0xffff0000, v104
  v_lshlrev_b32 v114, 16, v105
  v_and_b32 v115, 0xffff0000, v105
  v_lshlrev_b32 v116, 16, v106
  v_and_b32 v117, 0xffff0000, v106
  v_lshlrev_b32 v118, 16, v107
  v_and_b32 v119, 0xffff0000, v107
  v_pk_add_f32 v[96:97], v[96:97], v[112:113]
  v_pk_add_f32 v[98:99], v[98:99], v[114:115]
  v_pk_add_f32 v[100:101], v[100:101], v[116:117]
  v_pk_add_f32 v[102:103], v[102:103], v[118:119]
  v_cvt_pk_bf16_f32 v104, v96, v97
  v_cvt_pk_bf16_f32 v105, v98, v99
  v_cvt_pk_bf16_f32 v106, v100, v101
  v_cvt_pk_bf16_f32 v107, v102, v103
  s_lshl_b32 s44, s18, 15
  s_add_u32 s44, s44, s25
  buffer_store_dwordx4 v[104:107], v1, s[36:39], s44 offen
O16n_fin:
  s_cmp_eq_u32 s18, 51
  s_cbranch_scc1 O16n_end
  s_cmp_eq_u32 s22, 0
  s_cbranch_scc1 O16n_late
  v_cmp_eq_u32 vcc, 0, v22
  s_and_b64 s[44:45], vcc, s[42:43]
  s_cselect_b32 s31, 0, 1
  s_cmp_ge_u32 s18, 50
  s_cselect_b32 s31, 0, s31
  s_branch O16n_go
O16n_late:
  s_cmp_ge_u32 s12, 2
  s_cbranch_scc1 O16n_w23
  s_waitcnt vmcnt(1)
  s_branch O16n_lk
O16n_w23:
  s_waitcnt vmcnt(0)
O16n_lk:
  v_cmp_eq_u32 vcc, 0, v20
  s_and_b64 s[44:45], vcc, s[42:43]
  s_cselect_b32 s31, 0, 1
  s_cmp_ge_u32 s18, 50
  s_cselect_b32 s31, 0, s31
  s_and_b64 vcc, vcc, s[40:41]
  s_cbranch_scc0 O16n_chk
ofw_O16n1:
  buffer_load_dword v20, v3, s[4:7], s20 offen sc1
  s_waitcnt vmcnt(0)
  v_cmp_eq_u32 vcc, 0, v20
  s_and_b64 vcc, vcc, s[40:41]
  s_cbranch_scc0 ofw_O16n1_ok
  s_sub_u32 s15, s15, 1
  s_cbranch_scc1 ofw_O16n1_ok
  s_sleep 24
  s_branch ofw_O16n1
ofw_O16n1_ok:
  v_cmp_eq_u32 vcc, 0, v20
  s_and_b64 s[44:45], vcc, s[42:43]
  s_cselect_b32 s31, 0, 1
  s_cmp_ge_u32 s18, 50
  s_cselect_b32 s31, 0, s31
  s_and_b64 vcc, vcc, s[40:41]
  s_branch O16n_copy
O16n_chk:
  s_cmp_lg_u32 s22, 0
  s_cbranch_scc1 O16n_go
O16n_copy:
  s_sub_u32 s46, 65536, s21
  s_lshl_b32 s44, s12, 14
  s_add_u32 s45, s44, s46
  s_add_u32 s44, s44, s19
  s_mov_b32 m0, s45
  s_nop 0
  buffer_load_dwordx4 v1, s[4:7], s44 offen offset:0 sc1 lds
  buffer_load_dwordx4 v1, s[4:7], s44 offen offset:1024 sc1 lds
  buffer_load_dwordx4 v1, s[4:7], s44 offen offset:2048 sc1 lds
  buffer_load_dwordx4 v1, s[4:7], s44 offen offset:3072 sc1 lds
  s_add_u32 s45, s45, 4096
  s_mov_b32 m0, s45
  s_add_u32 s44, s44, 4096
  buffer_load_dwordx4 v1, s[4:7], s44 offen offset:0 sc1 lds
  buffer_load_dwordx4 v1, s[4:7], s44 offen offset:1024 sc1 lds
  buffer_load_dwordx4 v1, s[4:7], s44 offen offset:2048 sc1 lds
  buffer_load_dwordx4 v1, s[4:7], s44 offen offset:3072 sc1 lds
  s_add_u32 s45, s45, 4096
  s_mov_b32 m0, s45
  s_add_u32 s44, s44, 4096
  buffer_load_dwordx4 v1, s[4:7], s44 offen offset:0 sc1 lds
  buffer_load_dwordx4 v1, s[4:7], s44 offen offset:1024 sc1 lds
  buffer_load_dwordx4 v1, s[4:7], s44 offen offset:2048 sc1 lds
  buffer_load_dwordx4 v1, s[4:7], s44 offen offset:3072 sc1 lds
  s_add_u32 s45, s45, 4096
  s_mov_b32 m0, s45
  s_add_u32 s44, s44, 4096
  buffer_load_dwordx4 v1, s[4:7], s44 offen offset:0 sc1 lds
  buffer_load_dwordx4 v1, s[4:7], s44 offen offset:1024 sc1 lds
  buffer_load_dwordx4 v1, s[4:7], s44 offen offset:2048 sc1 lds
  buffer_load_dwordx4 v1, s[4:7], s44 offen offset:3072 sc1 lds
  s_waitcnt vmcnt(0)
O16n_go:
  s_sub_u32 s46, 65536, s21
  s_sub_u32 s44, s46, s21
  v_add_u32 v2, s44, v2
  v_add_u32 v8, s44, v8
  s_mov_b32 s21, s46
  s_add_u32 s18, s18, 1
  s_barrier
  s_branch O16n_item
O16n_end:
  s_waitcnt vmcnt(0)
  s_endpgm
X7_entry:
  s_mov_b32 s14, 0
  s_cmp_lt_u32 s13, 16
  s_cbranch_scc1 TA_entry
  s_sub_u32 s13, s13, 16
  s_load_dwordx2 s[8:9], s[0:1], 16
  s_waitcnt lgkmcnt(0)
  s_mov_b32 s10, 524288
  s_mov_b32 s11, 0x20000
  v_lshrrev_b32 v26, 4, v0
  v_bfe_u32 v27, v0, 2, 2
  v_lshl_add_u32 v28, v26, 3, v27
  v_lshlrev_b32 v28, 10, v28
  v_and_b32 v26, 1, v26
  v_lshl_add_u32 v27, v26, 2, v27
  v_lshl_add_u32 v28, v27, 5, v28
  v_and_b32 v26, 3, v0
  v_lshl_add_u32 v28, v26, 3, v28
  s_lshl_b32 s16, s12, 8
  v_add_u32 v28, s16, v28
  s_mov_b32 s18, 0
  v_lshlrev_b32 v24, 4, v0
  s_mul_i32 s17, s12, 32768
  s_lshl_b32 s16, s18, 10
  s_add_u32 s16, s16, s17
  s_add_u32 s17, s17, 0
  v_xor_b32 v25, 0, v24
  s_mov_b32 m0, s17
  s_add_u32 s17, s17, 1024
  buffer_load_dwordx4 v25, s[8:11], s16 offen lds
  s_add_u32 s16, s16, 1024
  v_xor_b32 v25, 32, v24
  s_mov_b32 m0, s17
  s_add_u32 s17, s17, 1024
  buffer_load_dwordx4 v25, s[8:11], s16 offen lds
  s_add_u32 s16, s16, 1024
  v_xor_b32 v25, 64, v24
  s_mov_b32 m0, s17
  s_add_u32 s17, s17, 1024
  buffer_load_dwordx4 v25, s[8:11], s16 offen lds
  s_add_u32 s16, s16, 1024
  v_xor_b32 v25, 96, v24
  s_mov_b32 m0, s17
  s_add_u32 s17, s17, 1024
  buffer_load_dwordx4 v25, s[8:11], s16 offen lds
  s_add_u32 s16, s16, 1024
  v_xor_b32 v25, 0, v24
  s_mov_b32 m0, s17
  s_add_u32 s17, s17, 1024
  buffer_load_dwordx4 v25, s[8:11], s16 offen lds
  s_add_u32 s16, s16, 1024
  v_xor_b32 v25, 32, v24
  s_mov_b32 m0, s17
  s_add_u32 s17, s17, 1024
  buffer_load_dwordx4 v25, s[8:11], s16 offen lds
  s_add_u32 s16, s16, 1024
  v_xor_b32 v25, 64, v24
  s_mov_b32 m0, s17
  s_add_u32 s17, s17, 1024
  buffer_load_dwordx4 v25, s[8:11], s16 offen lds
  s_add_u32 s16, s16, 1024
  v_xor_b32 v25, 96, v24
  s_mov_b32 m0, s17
  s_add_u32 s17, s17, 1024
  buffer_load_dwordx4 v25, s[8:11], s16 offen lds
  s_add_u32 s16, s16, 1024
  v_xor_b32 v25, 128, v24
  s_mov_b32 m0, s17
  s_add_u32 s17, s17, 1024
  buffer_load_dwordx4 v25, s[8:11], s16 offen lds
  s_add_u32 s16, s16, 1024
  v_xor_b32 v25, 160, v24
  s_mov_b32 m0, s17
  s_add_u32 s17, s17, 1024
  buffer_load_dwordx4 v25, s[8:11], s16 offen lds
  s_add_u32 s16, s16, 1024
  v_xor_b32 v25, 192, v24
  s_mov_b32 m0, s17
  s_add_u32 s17, s17, 1024
  buffer_load_dwordx4 v25, s[8:11], s16 offen lds
  s_add_u32 s16, s16, 1024
  v_xor_b32 v25, 224, v24
  s_mov_b32 m0, s17
  s_add_u32 s17, s17, 1024
  buffer_load_dwordx4 v25, s[8:11], s16 offen lds
  s_add_u32 s16, s16, 1024
  v_xor_b32 v25, 128, v24
  s_mov_b32 m0, s17
  s_add_u32 s17, s17, 1024
  buffer_load_dwordx4 v25, s[8:11], s16 offen lds
  s_add_u32 s16, s16, 1024
  v_xor_b32 v25, 160, v24
  s_mov_b32 m0, s17
  s_add_u32 s17, s17, 1024
  buffer_load_dwordx4 v25, s[8:11], s16 offen lds
  s_add_u32 s16, s16, 1024
  v_xor_b32 v25, 192, v24
  s_mov_b32 m0, s17
  s_add_u32 s17, s17, 1024
  buffer_load_dwordx4 v25, s[8:11], s16 offen lds
  s_add_u32 s16, s16, 1024
  v_xor_b32 v25, 224, v24
  s_mov_b32 m0, s17
  s_add_u32 s17, s17, 1024
  buffer_load_dwordx4 v25, s[8:11], s16 offen lds
  s_add_u32 s16, s16, 1024
  v_xor_b32 v25, 0, v24
  s_mov_b32 m0, s17
  s_add_u32 s17, s17, 1024
  buffer_load_dwordx4 v25, s[8:11], s16 offen lds
  s_add_u32 s16, s16, 1024
  v_xor_b32 v25, 32, v24
  s_mov_b32 m0, s17
  s_add_u32 s17, s17, 1024
  buffer_load_dwordx4 v25, s[8:11], s16 offen lds
  s_add_u32 s16, s16, 1024
  v_xor_b32 v25, 64, v24
  s_mov_b32 m0, s17
  s_add_u32 s17, s17, 1024
  buffer_load_dwordx4 v25, s[8:11], s16 offen lds
  s_add_u32 s16, s16, 1024
  v_xor_b32 v25, 96, v24
  s_mov_b32 m0, s17
  s_add_u32 s17, s17, 1024
  buffer_load_dwordx4 v25, s[8:11], s16 offen lds
  s_add_u32 s16, s16, 1024
  v_xor_b32 v25, 0, v24
  s_mov_b32 m0, s17
  s_add_u32 s17, s17, 1024
  buffer_load_dwordx4 v25, s[8:11], s16 offen lds
  s_add_u32 s16, s16, 1024
  v_xor_b32 v25, 32, v24
  s_mov_b32 m0, s17
  s_add_u32 s17, s17, 1024
  buffer_load_dwordx4 v25, s[8:11], s16 offen lds
  s_add_u32 s16, s16, 1024
  v_xor_b32 v25, 64, v24
  s_mov_b32 m0, s17
  s_add_u32 s17, s17, 1024
  buffer_load_dwordx4 v25, s[8:11], s16 offen lds
  s_add_u32 s16, s16, 1024
  v_xor_b32 v25, 96, v24
  s_mov_b32 m0, s17
  s_add_u32 s17, s17, 1024
  buffer_load_dwordx4 v25, s[8:11], s16 offen lds
  s_add_u32 s16, s16, 1024
  v_xor_b32 v25, 128, v24
  s_mov_b32 m0, s17
  s_add_u32 s17, s17, 1024
  buffer_load_dwordx4 v25, s[8:11], s16 offen lds
  s_add_u32 s16, s16, 1024
  v_xor_b32 v25, 160, v24
  s_mov_b32 m0, s17
  s_add_u32 s17, s17, 1024
  buffer_load_dwordx4 v25, s[8:11], s16 offen lds
  s_add_u32 s16, s16, 1024
  v_xor_b32 v25, 192, v24
  s_mov_b32 m0, s17
  s_add_u32 s17, s17, 1024
  buffer_load_dwordx4 v25, s[8:11], s16 offen lds
  s_add_u32 s16, s16, 1024
  v_xor_b32 v25, 224, v24
  s_mov_b32 m0, s17
  s_add_u32 s17, s17, 1024
  buffer_load_dwordx4 v25, s[8:11], s16 offen lds
  s_add_u32 s16, s16, 1024
  v_xor_b32 v25, 128, v24
  s_mov_b32 m0, s17
  s_add_u32 s17, s17, 1024
  buffer_load_dwordx4 v25, s[8:11], s16 offen lds
  s_add_u32 s16, s16, 1024
  v_xor_b32 v25, 160, v24
  s_mov_b32 m0, s17
  s_add_u32 s17, s17, 1024
  buffer_load_dwordx4 v25, s[8:11], s16 offen lds
  s_add_u32 s16, s16, 1024
  v_xor_b32 v25, 192, v24
  s_mov_b32 m0, s17
  s_add_u32 s17, s17, 1024
  buffer_load_dwordx4 v25, s[8:11], s16 offen lds
  s_add_u32 s16, s16, 1024
  v_xor_b32 v25, 224, v24
  s_mov_b32 m0, s17
  s_add_u32 s17, s17, 1024
  buffer_load_dwordx4 v25, s[8:11], s16 offen lds
  s_add_u32 s16, s16, 1024
  s_waitcnt vmcnt(0)
  s_barrier
  v_xor_b32 v30, 0, v28
  ds_read_b64_tr_b16 a[0:1], v30 offset:0
  ds_read_b64_tr_b16 a[2:3], v30 offset:4096
  v_xor_b32 v30, 32, v28
  ds_read_b64_tr_b16 a[48:49], v30 offset:0
  ds_read_b64_tr_b16 a[50:51], v30 offset:4096
  v_xor_b32 v30, 64, v28
  ds_read_b64_tr_b16 a[96:97], v30 offset:0
  ds_read_b64_tr_b16 a[98:99], v30 offset:4096
  v_xor_b32 v30, 96, v28
  ds_read_b64_tr_b16 a[144:145], v30 offset:0
  ds_read_b64_tr_b16 a[146:147], v30 offset:4096
  v_xor_b32 v30, 128, v28
  ds_read_b64_tr_b16 a[192:193], v30 offset:0
  ds_read_b64_tr_b16 a[194:195], v30 offset:4096
  v_xor_b32 v30, 160, v28
  ds_read_b64_tr_b16 a[240:241], v30 offset:0
  ds_read_b64_tr_b16 a[242:243], v30 offset:4096
  v_xor_b32 v30, 192, v28
  ds_read_b64_tr_b16 v[160:161], v30 offset:0
  ds_read_b64_tr_b16 v[162:163], v30 offset:4096
  v_xor_b32 v30, 224, v28
  ds_read_b64_tr_b16 v[208:209], v30 offset:0
  ds_read_b64_tr_b16 v[210:211], v30 offset:4096
  v_xor_b32 v30, 0, v28
  ds_read_b64_tr_b16 a[4:5], v30 offset:32768
  ds_read_b64_tr_b16 a[6:7], v30 offset:36864
  v_xor_b32 v30, 32, v28
  ds_read_b64_tr_b16 a[52:53], v30 offset:32768
  ds_read_b64_tr_b16 a[54:55], v30 offset:36864
  v_xor_b32 v30, 64, v28
  ds_read_b64_tr_b16 a[100:101], v30 offset:32768
  ds_read_b64_tr_b16 a[102:103], v30 offset:36864
  v_xor_b32 v30, 96, v28
  ds_read_b64_tr_b16 a[148:149], v30 offset:32768
  ds_read_b64_tr_b16 a[150:151], v30 offset:36864
  v_xor_b32 v30, 128, v28
  ds_read_b64_tr_b16 a[196:197], v30 offset:32768
  ds_read_b64_tr_b16 a[198:199], v30 offset:36864
  v_xor_b32 v30, 160, v28
  ds_read_b64_tr_b16 a[244:245], v30 offset:32768
  ds_read_b64_tr_b16 a[246:247], v30 offset:36864
  v_xor_b32 v30, 192, v28
  ds_read_b64_tr_b16 v[164:165], v30 offset:32768
  ds_read_b64_tr_b16 v[166:167], v30 offset:36864
  v_xor_b32 v30, 224, v28
  ds_read_b64_tr_b16 v[212:213], v30 offset:32768
  ds_read_b64_tr_b16 v[214:215], v30 offset:36864
  v_xor_b32 v30, 0, v28
  v_add_u32 v30, 0x10000, v30
  ds_read_b64_tr_b16 a[8:9], v30 offset:0
  ds_read_b64_tr_b16 a[10:11], v30 offset:4096
  v_xor_b32 v30, 32, v28
  v_add_u32 v30, 0x10000, v30
  ds_read_b64_tr_b16 a[56:57], v30 offset:0
  ds_read_b64_tr_b16 a[58:59], v30 offset:4096
  v_xor_b32 v30, 64, v28
  v_add_u32 v30, 0x10000, v30
  ds_read_b64_tr_b16 a[104:105], v30 offset:0
  ds_read_b64_tr_b16 a[106:107], v30 offset:4096
  v_xor_b32 v30, 96, v28
  v_add_u32 v30, 0x10000, v30
  ds_read_b64_tr_b16 a[152:153], v30 offset:0
  ds_read_b64_tr_b16 a[154:155], v30 offset:4096
  v_xor_b32 v30, 128, v28
  v_add_u32 v30, 0x10000, v30
  ds_read_b64_tr_b16 a[200:201], v30 offset:0
  ds_read_b64_tr_b16 a[202:203], v30 offset:4096
  v_xor_b32 v30, 160, v28
  v_add_u32 v30, 0x10000, v30
  ds_read_b64_tr_b16 a[248:249], v30 offset:0
  ds_read_b64_tr_b16 a[250:251], v30 offset:4096
  v_xor_b32 v30, 192, v28
  v_add_u32 v30, 0x10000, v30
  ds_read_b64_tr_b16 v[168:169], v30 offset:0
  ds_read_b64_tr_b16 v[170:171], v30 offset:4096
  v_xor_b32 v30, 224, v28
  v_add_u32 v30, 0x10000, v30
  ds_read_b64_tr_b16 v[216:217], v30 offset:0
  ds_read_b64_tr_b16 v[218:219], v30 offset:4096
  v_xor_b32 v30, 0, v28
  v_add_u32 v30, 0x10000, v30
  ds_read_b64_tr_b16 a[12:13], v30 offset:32768
  ds_read_b64_tr_b16 a[14:15], v30 offset:36864
  v_xor_b32 v30, 32, v28
  v_add_u32 v30, 0x10000, v30
  ds_read_b64_tr_b16 a[60:61], v30 offset:32768
  ds_read_b64_tr_b16 a[62:63], v30 offset:36864
  v_xor_b32 v30, 64, v28
  v_add_u32 v30, 0x10000, v30
  ds_read_b64_tr_b16 a[108:109], v30 offset:32768
  ds_read_b64_tr_b16 a[110:111], v30 offset:36864
  v_xor_b32 v30, 96, v28
  v_add_u32 v30, 0x10000, v30
  ds_read_b64_tr_b16 a[156:157], v30 offset:32768
  ds_read_b64_tr_b16 a[158:159], v30 offset:36864
  v_xor_b32 v30, 128, v28
  v_add_u32 v30, 0x10000, v30
  ds_read_b64_tr_b16 a[204:205], v30 offset:32768
  ds_read_b64_tr_b16 a[206:207], v30 offset:36864
  v_xor_b32 v30, 160, v28
  v_add_u32 v30, 0x10000, v30
  ds_read_b64_tr_b16 a[252:253], v30 offset:32768
  ds_read_b64_tr_b16 a[254:255], v30 offset:36864
  v_xor_b32 v30, 192, v28
  v_add_u32 v30, 0x10000, v30
  ds_read_b64_tr_b16 v[172:173], v30 offset:32768
  ds_read_b64_tr_b16 v[174:175], v30 offset:36864
  v_xor_b32 v30, 224, v28
  v_add_u32 v30, 0x10000, v30
  ds_read_b64_tr_b16 v[220:221], v30 offset:32768
  ds_read_b64_tr_b16 v[222:223], v30 offset:36864
  s_waitcnt lgkmcnt(0)
  s_barrier
  s_mov_b32 s18, 128
  v_lshlrev_b32 v24, 4, v0
  s_mul_i32 s17, s12, 32768
  s_lshl_b32 s16, s18, 10
  s_add_u32 s16, s16, s17
  s_add_u32 s17, s17, 0
  v_xor_b32 v25, 0, v24
  s_mov_b32 m0, s17
  s_add_u32 s17, s17, 1024
  buffer_load_dwordx4 v25, s[8:11], s16 offen lds
  s_add_u32 s16, s16, 1024
  v_xor_b32 v25, 32, v24
  s_mov_b32 m0, s17
  s_add_u32 s17, s17, 1024
  buffer_load_dwordx4 v25, s[8:11], s16 offen lds
  s_add_u32 s16, s16, 1024
  v_xor_b32 v25, 64, v24
  s_mov_b32 m0, s17
  s_add_u32 s17, s17, 1024
  buffer_load_dwordx4 v25, s[8:11], s16 offen lds
  s_add_u32 s16, s16, 1024
  v_xor_b32 v25, 96, v24
  s_mov_b32 m0, s17
  s_add_u32 s17, s17, 1024
  buffer_load_dwordx4 v25, s[8:11], s16 offen lds
  s_add_u32 s16, s16, 1024
  v_xor_b32 v25, 0, v24
  s_mov_b32 m0, s17
  s_add_u32 s17, s17, 1024
  buffer_load_dwordx4 v25, s[8:11], s16 offen lds
  s_add_u32 s16, s16, 1024
  v_xor_b32 v25, 32, v24
  s_mov_b32 m0, s17
  s_add_u32 s17, s17, 1024
  buffer_load_dwordx4 v25, s[8:11], s16 offen lds
  s_add_u32 s16, s16, 1024
  v_xor_b32 v25, 64, v24
  s_mov_b32 m0, s17
  s_add_u32 s17, s17, 1024
  buffer_load_dwordx4 v25, s[8:11], s16 offen lds
  s_add_u32 s16, s16, 1024
  v_xor_b32 v25, 96, v24
  s_mov_b32 m0, s17
  s_add_u32 s17, s17, 1024
  buffer_load_dwordx4 v25, s[8:11], s16 offen lds
  s_add_u32 s16, s16, 1024
  v_xor_b32 v25, 128, v24
  s_mov_b32 m0, s17
  s_add_u32 s17, s17, 1024
  buffer_load_dwordx4 v25, s[8:11], s16 offen lds
  s_add_u32 s16, s16, 1024
  v_xor_b32 v25, 160, v24
  s_mov_b32 m0, s17
  s_add_u32 s17, s17, 1024
  buffer_load_dwordx4 v25, s[8:11], s16 offen lds
  s_add_u32 s16, s16, 1024
  v_xor_b32 v25, 192, v24
  s_mov_b32 m0, s17
  s_add_u32 s17, s17, 1024
  buffer_load_dwordx4 v25, s[8:11], s16 offen lds
  s_add_u32 s16, s16, 1024
  v_xor_b32 v25, 224, v24
  s_mov_b32 m0, s17
  s_add_u32 s17, s17, 1024
  buffer_load_dwordx4 v25, s[8:11], s16 offen lds
  s_add_u32 s16, s16, 1024
  v_xor_b32 v25, 128, v24
  s_mov_b32 m0, s17
  s_add_u32 s17, s17, 1024
  buffer_load_dwordx4 v25, s[8:11], s16 offen lds
  s_add_u32 s16, s16, 1024
  v_xor_b32 v25, 160, v24
  s_mov_b32 m0, s17
  s_add_u32 s17, s17, 1024
  buffer_load_dwordx4 v25, s[8:11], s16 offen lds
  s_add_u32 s16, s16, 1024
  v_xor_b32 v25, 192, v24
  s_mov_b32 m0, s17
  s_add_u32 s17, s17, 1024
  buffer_load_dwordx4 v25, s[8:11], s16 offen lds
  s_add_u32 s16, s16, 1024
  v_xor_b32 v25, 224, v24
  s_mov_b32 m0, s17
  s_add_u32 s17, s17, 1024
  buffer_load_dwordx4 v25, s[8:11], s16 offen lds
  s_add_u32 s16, s16, 1024
  v_xor_b32 v25, 0, v24
  s_mov_b32 m0, s17
  s_add_u32 s17, s17, 1024
  buffer_load_dwordx4 v25, s[8:11], s16 offen lds
  s_add_u32 s16, s16, 1024
  v_xor_b32 v25, 32, v24
  s_mov_b32 m0, s17
  s_add_u32 s17, s17, 1024
  buffer_load_dwordx4 v25, s[8:11], s16 offen lds
  s_add_u32 s16, s16, 1024
  v_xor_b32 v25, 64, v24
  s_mov_b32 m0, s17
  s_add_u32 s17, s17, 1024
  buffer_load_dwordx4 v25, s[8:11], s16 offen lds
  s_add_u32 s16, s16, 1024
  v_xor_b32 v25, 96, v24
  s_mov_b32 m0, s17
  s_add_u32 s17, s17, 1024
  buffer_load_dwordx4 v25, s[8:11], s16 offen lds
  s_add_u32 s16, s16, 1024
  v_xor_b32 v25, 0, v24
  s_mov_b32 m0, s17
  s_add_u32 s17, s17, 1024
  buffer_load_dwordx4 v25, s[8:11], s16 offen lds
  s_add_u32 s16, s16, 1024
  v_xor_b32 v25, 32, v24
  s_mov_b32 m0, s17
  s_add_u32 s17, s17, 1024
  buffer_load_dwordx4 v25, s[8:11], s16 offen lds
  s_add_u32 s16, s16, 1024
  v_xor_b32 v25, 64, v24
  s_mov_b32 m0, s17
  s_add_u32 s17, s17, 1024
  buffer_load_dwordx4 v25, s[8:11], s16 offen lds
  s_add_u32 s16, s16, 1024
  v_xor_b32 v25, 96, v24
  s_mov_b32 m0, s17
  s_add_u32 s17, s17, 1024
  buffer_load_dwordx4 v25, s[8:11], s16 offen lds
  s_add_u32 s16, s16, 1024
  v_xor_b32 v25, 128, v24
  s_mov_b32 m0, s17
  s_add_u32 s17, s17, 1024
  buffer_load_dwordx4 v25, s[8:11], s16 offen lds
  s_add_u32 s16, s16, 1024
  v_xor_b32 v25, 160, v24
  s_mov_b32 m0, s17
  s_add_u32 s17, s17, 1024
  buffer_load_dwordx4 v25, s[8:11], s16 offen lds
  s_add_u32 s16, s16, 1024
  v_xor_b32 v25, 192, v24
  s_mov_b32 m0, s17
  s_add_u32 s17, s17, 1024
  buffer_load_dwordx4 v25, s[8:11], s16 offen lds
  s_add_u32 s16, s16, 1024
  v_xor_b32 v25, 224, v24
  s_mov_b32 m0, s17
  s_add_u32 s17, s17, 1024
  buffer_load_dwordx4 v25, s[8:11], s16 offen lds
  s_add_u32 s16, s16, 1024
  v_xor_b32 v25, 128, v24
  s_mov_b32 m0, s17
  s_add_u32 s17, s17, 1024
  buffer_load_dwordx4 v25, s[8:11], s16 offen lds
  s_add_u32 s16, s16, 1024
  v_xor_b32 v25, 160, v24
  s_mov_b32 m0, s17
  s_add_u32 s17, s17, 1024
  buffer_load_dwordx4 v25, s[8:11], s16 offen lds
  s_add_u32 s16, s16, 1024
  v_xor_b32 v25, 192, v24
  s_mov_b32 m0, s17
  s_add_u32 s17, s17, 1024
  buffer_load_dwordx4 v25, s[8:11], s16 offen lds
  s_add_u32 s16, s16, 1024
  v_xor_b32 v25, 224, v24
  s_mov_b32 m0, s17
  s_add_u32 s17, s17, 1024
  buffer_load_dwordx4 v25, s[8:11], s16 offen lds
  s_add_u32 s16, s16, 1024
  s_waitcnt vmcnt(0)
  s_barrier
  v_xor_b32 v30, 0, v28
  ds_read_b64_tr_b16 a[16:17], v30 offset:0
  ds_read_b64_tr_b16 a[18:19], v30 offset:4096
  v_xor_b32 v30, 32, v28
  ds_read_b64_tr_b16 a[64:65], v30 offset:0
  ds_read_b64_tr_b16 a[66:67], v30 offset:4096
  v_xor_b32 v30, 64, v28
  ds_read_b64_tr_b16 a[112:113], v30 offset:0
  ds_read_b64_tr_b16 a[114:115], v30 offset:4096
  v_xor_b32 v30, 96, v28
  ds_read_b64_tr_b16 a[160:161], v30 offset:0
  ds_read_b64_tr_b16 a[162:163], v30 offset:4096
  v_xor_b32 v30, 128, v28
  ds_read_b64_tr_b16 a[208:209], v30 offset:0
  ds_read_b64_tr_b16 a[210:211], v30 offset:4096
  v_xor_b32 v30, 160, v28
  ds_read_b64_tr_b16 v[128:129], v30 offset:0
  ds_read_b64_tr_b16 v[130:131], v30 offset:4096
  v_xor_b32 v30, 192, v28
  ds_read_b64_tr_b16 v[176:177], v30 offset:0
  ds_read_b64_tr_b16 v[178:179], v30 offset:4096
  v_xor_b32 v30, 224, v28
  ds_read_b64_tr_b16 v[224:225], v30 offset:0
  ds_read_b64_tr_b16 v[226:227], v30 offset:4096
  v_xor_b32 v30, 0, v28
  ds_read_b64_tr_b16 a[20:21], v30 offset:32768
  ds_read_b64_tr_b16 a[22:23], v30 offset:36864
  v_xor_b32 v30, 32, v28
  ds_read_b64_tr_b16 a[68:69], v30 offset:32768
  ds_read_b64_tr_b16 a[70:71], v30 offset:36864
  v_xor_b32 v30, 64, v28
  ds_read_b64_tr_b16 a[116:117], v30 offset:32768
  ds_read_b64_tr_b16 a[118:119], v30 offset:36864
  v_xor_b32 v30, 96, v28
  ds_read_b64_tr_b16 a[164:165], v30 offset:32768
  ds_read_b64_tr_b16 a[166:167], v30 offset:36864
  v_xor_b32 v30, 128, v28
  ds_read_b64_tr_b16 a[212:213], v30 offset:32768
  ds_read_b64_tr_b16 a[214:215], v30 offset:36864
  v_xor_b32 v30, 160, v28
  ds_read_b64_tr_b16 v[132:133], v30 offset:32768
  ds_read_b64_tr_b16 v[134:135], v30 offset:36864
  v_xor_b32 v30, 192, v28
  ds_read_b64_tr_b16 v[180:181], v30 offset:32768
  ds_read_b64_tr_b16 v[182:183], v30 offset:36864
  v_xor_b32 v30, 224, v28
  ds_read_b64_tr_b16 v[228:229], v30 offset:32768
  ds_read_b64_tr_b16 v[230:231], v30 offset:36864
  v_xor_b32 v30, 0, v28
  v_add_u32 v30, 0x10000, v30
  ds_read_b64_tr_b16 a[24:25], v30 offset:0
  ds_read_b64_tr_b16 a[26:27], v30 offset:4096
  v_xor_b32 v30, 32, v28
  v_add_u32 v30, 0x10000, v30
  ds_read_b64_tr_b16 a[72:73], v30 offset:0
  ds_read_b64_tr_b16 a[74:75], v30 offset:4096
  v_xor_b32 v30, 64, v28
  v_add_u32 v30, 0x10000, v30
  ds_read_b64_tr_b16 a[120:121], v30 offset:0
  ds_read_b64_tr_b16 a[122:123], v30 offset:4096
  v_xor_b32 v30, 96, v28
  v_add_u32 v30, 0x10000, v30
  ds_read_b64_tr_b16 a[168:169], v30 offset:0
  ds_read_b64_tr_b16 a[170:171], v30 offset:4096
  v_xor_b32 v30, 128, v28
  v_add_u32 v30, 0x10000, v30
  ds_read_b64_tr_b16 a[216:217], v30 offset:0
  ds_read_b64_tr_b16 a[218:219], v30 offset:4096
  v_xor_b32 v30, 160, v28
  v_add_u32 v30, 0x10000, v30
  ds_read_b64_tr_b16 v[136:137], v30 offset:0
  ds_read_b64_tr_b16 v[138:139], v30 offset:4096
  v_xor_b32 v30, 192, v28
  v_add_u32 v30, 0x10000, v30
  ds_read_b64_tr_b16 v[184:185], v30 offset:0
  ds_read_b64_tr_b16 v[186:187], v30 offset:4096
  v_xor_b32 v30, 224, v28
  v_add_u32 v30, 0x10000, v30
  ds_read_b64_tr_b16 v[232:233], v30 offset:0
  ds_read_b64_tr_b16 v[234:235], v30 offset:4096
  v_xor_b32 v30, 0, v28
  v_add_u32 v30, 0x10000, v30
  ds_read_b64_tr_b16 a[28:29], v30 offset:32768
  ds_read_b64_tr_b16 a[30:31], v30 offset:36864
  v_xor_b32 v30, 32, v28
  v_add_u32 v30, 0x10000, v30
  ds_read_b64_tr_b16 a[76:77], v30 offset:32768
  ds_read_b64_tr_b16 a[78:79], v30 offset:36864
  v_xor_b32 v30, 64, v28
  v_add_u32 v30, 0x10000, v30
  ds_read_b64_tr_b16 a[124:125], v30 offset:32768
  ds_read_b64_tr_b16 a[126:127], v30 offset:36864
  v_xor_b32 v30, 96, v28
  v_add_u32 v30, 0x10000, v30
  ds_read_b64_tr_b16 a[172:173], v30 offset:32768
  ds_read_b64_tr_b16 a[174:175], v30 offset:36864
  v_xor_b32 v30, 128, v28
  v_add_u32 v30, 0x10000, v30
  ds_read_b64_tr_b16 a[220:221], v30 offset:32768
  ds_read_b64_tr_b16 a[222:223], v30 offset:36864
  v_xor_b32 v30, 160, v28
  v_add_u32 v30, 0x10000, v30
  ds_read_b64_tr_b16 v[140:141], v30 offset:32768
  ds_read_b64_tr_b16 v[142:143], v30 offset:36864
  v_xor_b32 v30, 192, v28
  v_add_u32 v30, 0x10000, v30
  ds_read_b64_tr_b16 v[188:189], v30 offset:32768
  ds_read_b64_tr_b16 v[190:191], v30 offset:36864
  v_xor_b32 v30, 224, v28
  v_add_u32 v30, 0x10000, v30
  ds_read_b64_tr_b16 v[236:237], v30 offset:32768
  ds_read_b64_tr_b16 v[238:239], v30 offset:36864
  s_waitcnt lgkmcnt(0)
  s_barrier
  s_mov_b32 s18, 256
  v_lshlrev_b32 v24, 4, v0
  s_mul_i32 s17, s12, 32768
  s_lshl_b32 s16, s18, 10
  s_add_u32 s16, s16, s17
  s_add_u32 s17, s17, 0
  v_xor_b32 v25, 0, v24
  s_mov_b32 m0, s17
  s_add_u32 s17, s17, 1024
  buffer_load_dwordx4 v25, s[8:11], s16 offen lds
  s_add_u32 s16, s16, 1024
  v_xor_b32 v25, 32, v24
  s_mov_b32 m0, s17
  s_add_u32 s17, s17, 1024
  buffer_load_dwordx4 v25, s[8:11], s16 offen lds
  s_add_u32 s16, s16, 1024
  v_xor_b32 v25, 64, v24
  s_mov_b32 m0, s17
  s_add_u32 s17, s17, 1024
  buffer_load_dwordx4 v25, s[8:11], s16 offen lds
  s_add_u32 s16, s16, 1024
  v_xor_b32 v25, 96, v24
  s_mov_b32 m0, s17
  s_add_u32 s17, s17, 1024
  buffer_load_dwordx4 v25, s[8:11], s16 offen lds
  s_add_u32 s16, s16, 1024
  v_xor_b32 v25, 0, v24
  s_mov_b32 m0, s17
  s_add_u32 s17, s17, 1024
  buffer_load_dwordx4 v25, s[8:11], s16 offen lds
  s_add_u32 s16, s16, 1024
  v_xor_b32 v25, 32, v24
  s_mov_b32 m0, s17
  s_add_u32 s17, s17, 1024
  buffer_load_dwordx4 v25, s[8:11], s16 offen lds
  s_add_u32 s16, s16, 1024
  v_xor_b32 v25, 64, v24
  s_mov_b32 m0, s17
  s_add_u32 s17, s17, 1024
  buffer_load_dwordx4 v25, s[8:11], s16 offen lds
  s_add_u32 s16, s16, 1024
  v_xor_b32 v25, 96, v24
  s_mov_b32 m0, s17
  s_add_u32 s17, s17, 1024
  buffer_load_dwordx4 v25, s[8:11], s16 offen lds
  s_add_u32 s16, s16, 1024
  v_xor_b32 v25, 128, v24
  s_mov_b32 m0, s17
  s_add_u32 s17, s17, 1024
  buffer_load_dwordx4 v25, s[8:11], s16 offen lds
  s_add_u32 s16, s16, 1024
  v_xor_b32 v25, 160, v24
  s_mov_b32 m0, s17
  s_add_u32 s17, s17, 1024
  buffer_load_dwordx4 v25, s[8:11], s16 offen lds
  s_add_u32 s16, s16, 1024
  v_xor_b32 v25, 192, v24
  s_mov_b32 m0, s17
  s_add_u32 s17, s17, 1024
  buffer_load_dwordx4 v25, s[8:11], s16 offen lds
  s_add_u32 s16, s16, 1024
  v_xor_b32 v25, 224, v24
  s_mov_b32 m0, s17
  s_add_u32 s17, s17, 1024
  buffer_load_dwordx4 v25, s[8:11], s16 offen lds
  s_add_u32 s16, s16, 1024
  v_xor_b32 v25, 128, v24
  s_mov_b32 m0, s17
  s_add_u32 s17, s17, 1024
  buffer_load_dwordx4 v25, s[8:11], s16 offen lds
  s_add_u32 s16, s16, 1024
  v_xor_b32 v25, 160, v24
  s_mov_b32 m0, s17
  s_add_u32 s17, s17, 1024
  buffer_load_dwordx4 v25, s[8:11], s16 offen lds
  s_add_u32 s16, s16, 1024
  v_xor_b32 v25, 192, v24
  s_mov_b32 m0, s17
  s_add_u32 s17, s17, 1024
  buffer_load_dwordx4 v25, s[8:11], s16 offen lds
  s_add_u32 s16, s16, 1024
  v_xor_b32 v25, 224, v24
  s_mov_b32 m0, s17
  s_add_u32 s17, s17, 1024
  buffer_load_dwordx4 v25, s[8:11], s16 offen lds
  s_add_u32 s16, s16, 1024
  v_xor_b32 v25, 0, v24
  s_mov_b32 m0, s17
  s_add_u32 s17, s17, 1024
  buffer_load_dwordx4 v25, s[8:11], s16 offen lds
  s_add_u32 s16, s16, 1024
  v_xor_b32 v25, 32, v24
  s_mov_b32 m0, s17
  s_add_u32 s17, s17, 1024
  buffer_load_dwordx4 v25, s[8:11], s16 offen lds
  s_add_u32 s16, s16, 1024
  v_xor_b32 v25, 64, v24
  s_mov_b32 m0, s17
  s_add_u32 s17, s17, 1024
  buffer_load_dwordx4 v25, s[8:11], s16 offen lds
  s_add_u32 s16, s16, 1024
  v_xor_b32 v25, 96, v24
  s_mov_b32 m0, s17
  s_add_u32 s17, s17, 1024
  buffer_load_dwordx4 v25, s[8:11], s16 offen lds
  s_add_u32 s16, s16, 1024
  v_xor_b32 v25, 0, v24
  s_mov_b32 m0, s17
  s_add_u32 s17, s17, 1024
  buffer_load_dwordx4 v25, s[8:11], s16 offen lds
  s_add_u32 s16, s16, 1024
  v_xor_b32 v25, 32, v24
  s_mov_b32 m0, s17
  s_add_u32 s17, s17, 1024
  buffer_load_dwordx4 v25, s[8:11], s16 offen lds
  s_add_u32 s16, s16, 1024
  v_xor_b32 v25, 64, v24
  s_mov_b32 m0, s17
  s_add_u32 s17, s17, 1024
  buffer_load_dwordx4 v25, s[8:11], s16 offen lds
  s_add_u32 s16, s16, 1024
  v_xor_b32 v25, 96, v24
  s_mov_b32 m0, s17
  s_add_u32 s17, s17, 1024
  buffer_load_dwordx4 v25, s[8:11], s16 offen lds
  s_add_u32 s16, s16, 1024
  v_xor_b32 v25, 128, v24
  s_mov_b32 m0, s17
  s_add_u32 s17, s17, 1024
  buffer_load_dwordx4 v25, s[8:11], s16 offen lds
  s_add_u32 s16, s16, 1024
  v_xor_b32 v25, 160, v24
  s_mov_b32 m0, s17
  s_add_u32 s17, s17, 1024
  buffer_load_dwordx4 v25, s[8:11], s16 offen lds
  s_add_u32 s16, s16, 1024
  v_xor_b32 v25, 192, v24
  s_mov_b32 m0, s17
  s_add_u32 s17, s17, 1024
  buffer_load_dwordx4 v25, s[8:11], s16 offen lds
  s_add_u32 s16, s16, 1024
  v_xor_b32 v25, 224, v24
  s_mov_b32 m0, s17
  s_add_u32 s17, s17, 1024
  buffer_load_dwordx4 v25, s[8:11], s16 offen lds
  s_add_u32 s16, s16, 1024
  v_xor_b32 v25, 128, v24
  s_mov_b32 m0, s17
  s_add_u32 s17, s17, 1024
  buffer_load_dwordx4 v25, s[8:11], s16 offen lds
  s_add_u32 s16, s16, 1024
  v_xor_b32 v25, 160, v24
  s_mov_b32 m0, s17
  s_add_u32 s17, s17, 1024
  buffer_load_dwordx4 v25, s[8:11], s16 offen lds
  s_add_u32 s16, s16, 1024
  v_xor_b32 v25, 192, v24
  s_mov_b32 m0, s17
  s_add_u32 s17, s17, 1024
  buffer_load_dwordx4 v25, s[8:11], s16 offen lds
  s_add_u32 s16, s16, 1024
  v_xor_b32 v25, 224, v24
  s_mov_b32 m0, s17
  s_add_u32 s17, s17, 1024
  buffer_load_dwordx4 v25, s[8:11], s16 offen lds
  s_add_u32 s16, s16, 1024
  s_waitcnt vmcnt(0)
  s_barrier
  v_xor_b32 v30, 0, v28
  ds_read_b64_tr_b16 a[32:33], v30 offset:0
  ds_read_b64_tr_b16 a[34:35], v30 offset:4096
  v_xor_b32 v30, 32, v28
  ds_read_b64_tr_b16 a[80:81], v30 offset:0
  ds_read_b64_tr_b16 a[82:83], v30 offset:4096
  v_xor_b32 v30, 64, v28
  ds_read_b64_tr_b16 a[128:129], v30 offset:0
  ds_read_b64_tr_b16 a[130:131], v30 offset:4096
  v_xor_b32 v30, 96, v28
  ds_read_b64_tr_b16 a[176:177], v30 offset:0
  ds_read_b64_tr_b16 a[178:179], v30 offset:4096
  v_xor_b32 v30, 128, v28
  ds_read_b64_tr_b16 a[224:225], v30 offset:0
  ds_read_b64_tr_b16 a[226:227], v30 offset:4096
  v_xor_b32 v30, 160, v28
  ds_read_b64_tr_b16 v[144:145], v30 offset:0
  ds_read_b64_tr_b16 v[146:147], v30 offset:4096
  v_xor_b32 v30, 192, v28
  ds_read_b64_tr_b16 v[192:193], v30 offset:0
  ds_read_b64_tr_b16 v[194:195], v30 offset:4096
  v_xor_b32 v30, 224, v28
  ds_read_b64_tr_b16 v[240:241], v30 offset:0
  ds_read_b64_tr_b16 v[242:243], v30 offset:4096
  v_xor_b32 v30, 0, v28
  ds_read_b64_tr_b16 a[36:37], v30 offset:32768
  ds_read_b64_tr_b16 a[38:39], v30 offset:36864
  v_xor_b32 v30, 32, v28
  ds_read_b64_tr_b16 a[84:85], v30 offset:32768
  ds_read_b64_tr_b16 a[86:87], v30 offset:36864
  v_xor_b32 v30, 64, v28
  ds_read_b64_tr_b16 a[132:133], v30 offset:32768
  ds_read_b64_tr_b16 a[134:135], v30 offset:36864
  v_xor_b32 v30, 96, v28
  ds_read_b64_tr_b16 a[180:181], v30 offset:32768
  ds_read_b64_tr_b16 a[182:183], v30 offset:36864
  v_xor_b32 v30, 128, v28
  ds_read_b64_tr_b16 a[228:229], v30 offset:32768
  ds_read_b64_tr_b16 a[230:231], v30 offset:36864
  v_xor_b32 v30, 160, v28
  ds_read_b64_tr_b16 v[148:149], v30 offset:32768
  ds_read_b64_tr_b16 v[150:151], v30 offset:36864
  v_xor_b32 v30, 192, v28
  ds_read_b64_tr_b16 v[196:197], v30 offset:32768
  ds_read_b64_tr_b16 v[198:199], v30 offset:36864
  v_xor_b32 v30, 224, v28
  ds_read_b64_tr_b16 v[244:245], v30 offset:32768
  ds_read_b64_tr_b16 v[246:247], v30 offset:36864
  v_xor_b32 v30, 0, v28
  v_add_u32 v30, 0x10000, v30
  ds_read_b64_tr_b16 a[40:41], v30 offset:0
  ds_read_b64_tr_b16 a[42:43], v30 offset:4096
  v_xor_b32 v30, 32, v28
  v_add_u32 v30, 0x10000, v30
  ds_read_b64_tr_b16 a[88:89], v30 offset:0
  ds_read_b64_tr_b16 a[90:91], v30 offset:4096
  v_xor_b32 v30, 64, v28
  v_add_u32 v30, 0x10000, v30
  ds_read_b64_tr_b16 a[136:137], v30 offset:0
  ds_read_b64_tr_b16 a[138:139], v30 offset:4096
  v_xor_b32 v30, 96, v28
  v_add_u32 v30, 0x10000, v30
  ds_read_b64_tr_b16 a[184:185], v30 offset:0
  ds_read_b64_tr_b16 a[186:187], v30 offset:4096
  v_xor_b32 v30, 128, v28
  v_add_u32 v30, 0x10000, v30
  ds_read_b64_tr_b16 a[232:233], v30 offset:0
  ds_read_b64_tr_b16 a[234:235], v30 offset:4096
  v_xor_b32 v30, 160, v28
  v_add_u32 v30, 0x10000, v30
  ds_read_b64_tr_b16 v[152:153], v30 offset:0
  ds_read_b64_tr_b16 v[154:155], v30 offset:4096
  v_xor_b32 v30, 192, v28
  v_add_u32 v30, 0x10000, v30
  ds_read_b64_tr_b16 v[200:201], v30 offset:0
  ds_read_b64_tr_b16 v[202:203], v30 offset:4096
  v_xor_b32 v30, 224, v28
  v_add_u32 v30, 0x10000, v30
  ds_read_b64_tr_b16 v[248:249], v30 offset:0
  ds_read_b64_tr_b16 v[250:251], v30 offset:4096
  v_xor_b32 v30, 0, v28
  v_add_u32 v30, 0x10000, v30
  ds_read_b64_tr_b16 a[44:45], v30 offset:32768
  ds_read_b64_tr_b16 a[46:47], v30 offset:36864
  v_xor_b32 v30, 32, v28
  v_add_u32 v30, 0x10000, v30
  ds_read_b64_tr_b16 a[92:93], v30 offset:32768
  ds_read_b64_tr_b16 a[94:95], v30 offset:36864
  v_xor_b32 v30, 64, v28
  v_add_u32 v30, 0x10000, v30
  ds_read_b64_tr_b16 a[140:141], v30 offset:32768
  ds_read_b64_tr_b16 a[142:143], v30 offset:36864
  v_xor_b32 v30, 96, v28
  v_add_u32 v30, 0x10000, v30
  ds_read_b64_tr_b16 a[188:189], v30 offset:32768
  ds_read_b64_tr_b16 a[190:191], v30 offset:36864
  v_xor_b32 v30, 128, v28
  v_add_u32 v30, 0x10000, v30
  ds_read_b64_tr_b16 a[236:237], v30 offset:32768
  ds_read_b64_tr_b16 a[238:239], v30 offset:36864
  v_xor_b32 v30, 160, v28
  v_add_u32 v30, 0x10000, v30
  ds_read_b64_tr_b16 v[156:157], v30 offset:32768
  ds_read_b64_tr_b16 v[158:159], v30 offset:36864
  v_xor_b32 v30, 192, v28
  v_add_u32 v30, 0x10000, v30
  ds_read_b64_tr_b16 v[204:205], v30 offset:32768
  ds_read_b64_tr_b16 v[206:207], v30 offset:36864
  v_xor_b32 v30, 224, v28
  v_add_u32 v30, 0x10000, v30
  ds_read_b64_tr_b16 v[252:253], v30 offset:32768
  ds_read_b64_tr_b16 v[254:255], v30 offset:36864
  s_waitcnt lgkmcnt(0)
  s_barrier
  s_mov_b32 s18, 384
  v_lshlrev_b32 v24, 4, v0
  s_mul_i32 s17, s12, 32768
  s_lshl_b32 s16, s18, 10
  s_add_u32 s16, s16, s17
  s_add_u32 s17, s17, 32768
  v_xor_b32 v25, 0, v24
  s_mov_b32 m0, s17
  s_add_u32 s17, s17, 1024
  buffer_load_dwordx4 v25, s[8:11], s16 offen lds
  s_add_u32 s16, s16, 1024
  v_xor_b32 v25, 32, v24
  s_mov_b32 m0, s17
  s_add_u32 s17, s17, 1024
  buffer_load_dwordx4 v25, s[8:11], s16 offen lds
  s_add_u32 s16, s16, 1024
  v_xor_b32 v25, 64, v24
  s_mov_b32 m0, s17
  s_add_u32 s17, s17, 1024
  buffer_load_dwordx4 v25, s[8:11], s16 offen lds
  s_add_u32 s16, s16, 1024
  v_xor_b32 v25, 96, v24
  s_mov_b32 m0, s17
  s_add_u32 s17, s17, 1024
  buffer_load_dwordx4 v25, s[8:11], s16 offen lds
  s_add_u32 s16, s16, 1024
  v_xor_b32 v25, 0, v24
  s_mov_b32 m0, s17
  s_add_u32 s17, s17, 1024
  buffer_load_dwordx4 v25, s[8:11], s16 offen lds
  s_add_u32 s16, s16, 1024
  v_xor_b32 v25, 32, v24
  s_mov_b32 m0, s17
  s_add_u32 s17, s17, 1024
  buffer_load_dwordx4 v25, s[8:11], s16 offen lds
  s_add_u32 s16, s16, 1024
  v_xor_b32 v25, 64, v24
  s_mov_b32 m0, s17
  s_add_u32 s17, s17, 1024
  buffer_load_dwordx4 v25, s[8:11], s16 offen lds
  s_add_u32 s16, s16, 1024
  v_xor_b32 v25, 96, v24
  s_mov_b32 m0, s17
  s_add_u32 s17, s17, 1024
  buffer_load_dwordx4 v25, s[8:11], s16 offen lds
  s_add_u32 s16, s16, 1024
  v_xor_b32 v25, 128, v24
  s_mov_b32 m0, s17
  s_add_u32 s17, s17, 1024
  buffer_load_dwordx4 v25, s[8:11], s16 offen lds
  s_add_u32 s16, s16, 1024
  v_xor_b32 v25, 160, v24
  s_mov_b32 m0, s17
  s_add_u32 s17, s17, 1024
  buffer_load_dwordx4 v25, s[8:11], s16 offen lds
  s_add_u32 s16, s16, 1024
  v_xor_b32 v25, 192, v24
  s_mov_b32 m0, s17
  s_add_u32 s17, s17, 1024
  buffer_load_dwordx4 v25, s[8:11], s16 offen lds
  s_add_u32 s16, s16, 1024
  v_xor_b32 v25, 224, v24
  s_mov_b32 m0, s17
  s_add_u32 s17, s17, 1024
  buffer_load_dwordx4 v25, s[8:11], s16 offen lds
  s_add_u32 s16, s16, 1024
  v_xor_b32 v25, 128, v24
  s_mov_b32 m0, s17
  s_add_u32 s17, s17, 1024
  buffer_load_dwordx4 v25, s[8:11], s16 offen lds
  s_add_u32 s16, s16, 1024
  v_xor_b32 v25, 160, v24
  s_mov_b32 m0, s17
  s_add_u32 s17, s17, 1024
  buffer_load_dwordx4 v25, s[8:11], s16 offen lds
  s_add_u32 s16, s16, 1024
  v_xor_b32 v25, 192, v24
  s_mov_b32 m0, s17
  s_add_u32 s17, s17, 1024
  buffer_load_dwordx4 v25, s[8:11], s16 offen lds
  s_add_u32 s16, s16, 1024
  v_xor_b32 v25, 224, v24
  s_mov_b32 m0, s17
  s_add_u32 s17, s17, 1024
  buffer_load_dwordx4 v25, s[8:11], s16 offen lds
  s_add_u32 s16, s16, 1024
  v_xor_b32 v25, 0, v24
  s_mov_b32 m0, s17
  s_add_u32 s17, s17, 1024
  buffer_load_dwordx4 v25, s[8:11], s16 offen lds
  s_add_u32 s16, s16, 1024
  v_xor_b32 v25, 32, v24
  s_mov_b32 m0, s17
  s_add_u32 s17, s17, 1024
  buffer_load_dwordx4 v25, s[8:11], s16 offen lds
  s_add_u32 s16, s16, 1024
  v_xor_b32 v25, 64, v24
  s_mov_b32 m0, s17
  s_add_u32 s17, s17, 1024
  buffer_load_dwordx4 v25, s[8:11], s16 offen lds
  s_add_u32 s16, s16, 1024
  v_xor_b32 v25, 96, v24
  s_mov_b32 m0, s17
  s_add_u32 s17, s17, 1024
  buffer_load_dwordx4 v25, s[8:11], s16 offen lds
  s_add_u32 s16, s16, 1024
  v_xor_b32 v25, 0, v24
  s_mov_b32 m0, s17
  s_add_u32 s17, s17, 1024
  buffer_load_dwordx4 v25, s[8:11], s16 offen lds
  s_add_u32 s16, s16, 1024
  v_xor_b32 v25, 32, v24
  s_mov_b32 m0, s17
  s_add_u32 s17, s17, 1024
  buffer_load_dwordx4 v25, s[8:11], s16 offen lds
  s_add_u32 s16, s16, 1024
  v_xor_b32 v25, 64, v24
  s_mov_b32 m0, s17
  s_add_u32 s17, s17, 1024
  buffer_load_dwordx4 v25, s[8:11], s16 offen lds
  s_add_u32 s16, s16, 1024
  v_xor_b32 v25, 96, v24
  s_mov_b32 m0, s17
  s_add_u32 s17, s17, 1024
  buffer_load_dwordx4 v25, s[8:11], s16 offen lds
  s_add_u32 s16, s16, 1024
  v_xor_b32 v25, 128, v24
  s_mov_b32 m0, s17
  s_add_u32 s17, s17, 1024
  buffer_load_dwordx4 v25, s[8:11], s16 offen lds
  s_add_u32 s16, s16, 1024
  v_xor_b32 v25, 160, v24
  s_mov_b32 m0, s17
  s_add_u32 s17, s17, 1024
  buffer_load_dwordx4 v25, s[8:11], s16 offen lds
  s_add_u32 s16, s16, 1024
  v_xor_b32 v25, 192, v24
  s_mov_b32 m0, s17
  s_add_u32 s17, s17, 1024
  buffer_load_dwordx4 v25, s[8:11], s16 offen lds
  s_add_u32 s16, s16, 1024
  v_xor_b32 v25, 224, v24
  s_mov_b32 m0, s17
  s_add_u32 s17, s17, 1024
  buffer_load_dwordx4 v25, s[8:11], s16 offen lds
  s_add_u32 s16, s16, 1024
  v_xor_b32 v25, 128, v24
  s_mov_b32 m0, s17
  s_add_u32 s17, s17, 1024
  buffer_load_dwordx4 v25, s[8:11], s16 offen lds
  s_add_u32 s16, s16, 1024
  v_xor_b32 v25, 160, v24
  s_mov_b32 m0, s17
  s_add_u32 s17, s17, 1024
  buffer_load_dwordx4 v25, s[8:11], s16 offen lds
  s_add_u32 s16, s16, 1024
  v_xor_b32 v25, 192, v24
  s_mov_b32 m0, s17
  s_add_u32 s17, s17, 1024
  buffer_load_dwordx4 v25, s[8:11], s16 offen lds
  s_add_u32 s16, s16, 1024
  v_xor_b32 v25, 224, v24
  s_mov_b32 m0, s17
  s_add_u32 s17, s17, 1024
  buffer_load_dwordx4 v25, s[8:11], s16 offen lds
  s_add_u32 s16, s16, 1024
  v_add_u32 v28, 0x8000, v28
  s_lshl_b32 s16, s12, 13
  v_lshlrev_b32 v29, 4, v0
  v_add_u32 v29, s16, v29
  s_waitcnt vmcnt(0)
  s_barrier
  v_xor_b32 v30, 0, v28
  ds_read_b64_tr_b16 v[32:33], v30 offset:0
  ds_read_b64_tr_b16 v[34:35], v30 offset:4096
  v_xor_b32 v30, 32, v28
  ds_read_b64_tr_b16 v[36:37], v30 offset:0
  ds_read_b64_tr_b16 v[38:39], v30 offset:4096
  v_xor_b32 v30, 64, v28
  ds_read_b64_tr_b16 v[40:41], v30 offset:0
  ds_read_b64_tr_b16 v[42:43], v30 offset:4096
  v_xor_b32 v30, 96, v28
  ds_read_b64_tr_b16 v[44:45], v30 offset:0
  ds_read_b64_tr_b16 v[46:47], v30 offset:4096
  v_xor_b32 v30, 128, v28
  ds_read_b64_tr_b16 v[48:49], v30 offset:0
  ds_read_b64_tr_b16 v[50:51], v30 offset:4096
  v_xor_b32 v30, 160, v28
  ds_read_b64_tr_b16 v[52:53], v30 offset:0
  ds_read_b64_tr_b16 v[54:55], v30 offset:4096
  v_xor_b32 v30, 192, v28
  ds_read_b64_tr_b16 v[56:57], v30 offset:0
  ds_read_b64_tr_b16 v[58:59], v30 offset:4096
  v_xor_b32 v30, 224, v28
  ds_read_b64_tr_b16 v[60:61], v30 offset:0
  ds_read_b64_tr_b16 v[62:63], v30 offset:4096
  s_waitcnt lgkmcnt(0)
  ds_write_b128 v29, v[32:35] offset:0
  ds_write_b128 v29, v[36:39] offset:1024
  ds_write_b128 v29, v[40:43] offset:2048
  ds_write_b128 v29, v[44:47] offset:3072
  ds_write_b128 v29, v[48:51] offset:4096
  ds_write_b128 v29, v[52:55] offset:5120
  ds_write_b128 v29, v[56:59] offset:6144
  ds_write_b128 v29, v[60:63] offset:7168
  v_add_u32 v28, 0x8000, v28
  v_add_u32 v29, 0x8000, v29
  s_waitcnt lgkmcnt(0)
  s_barrier
  v_xor_b32 v30, 0, v28
  ds_read_b64_tr_b16 v[32:33], v30 offset:0
  ds_read_b64_tr_b16 v[34:35], v30 offset:4096
  v_xor_b32 v30, 32, v28
  ds_read_b64_tr_b16 v[36:37], v30 offset:0
  ds_read_b64_tr_b16 v[38:39], v30 offset:4096
  v_xor_b32 v30, 64, v28
  ds_read_b64_tr_b16 v[40:41], v30 offset:0
  ds_read_b64_tr_b16 v[42:43], v30 offset:4096
  v_xor_b32 v30, 96, v28
  ds_read_b64_tr_b16 v[44:45], v30 offset:0
  ds_read_b64_tr_b16 v[46:47], v30 offset:4096
  v_xor_b32 v30, 128, v28
  ds_read_b64_tr_b16 v[48:49], v30 offset:0
  ds_read_b64_tr_b16 v[50:51], v30 offset:4096
  v_xor_b32 v30, 160, v28
  ds_read_b64_tr_b16 v[52:53], v30 offset:0
  ds_read_b64_tr_b16 v[54:55], v30 offset:4096
  v_xor_b32 v30, 192, v28
  ds_read_b64_tr_b16 v[56:57], v30 offset:0
  ds_read_b64_tr_b16 v[58:59], v30 offset:4096
  v_xor_b32 v30, 224, v28
  ds_read_b64_tr_b16 v[60:61], v30 offset:0
  ds_read_b64_tr_b16 v[62:63], v30 offset:4096
  s_waitcnt lgkmcnt(0)
  ds_write_b128 v29, v[32:35] offset:0
  ds_write_b128 v29, v[36:39] offset:1024
  ds_write_b128 v29, v[40:43] offset:2048
  ds_write_b128 v29, v[44:47] offset:3072
  ds_write_b128 v29, v[48:51] offset:4096
  ds_write_b128 v29, v[52:55] offset:5120
  ds_write_b128 v29, v[56:59] offset:6144
  ds_write_b128 v29, v[60:63] offset:7168
  v_add_u32 v28, 0x8000, v28
  v_add_u32 v29, 0x8000, v29
  s_waitcnt lgkmcnt(0)
  s_barrier
  v_xor_b32 v30, 0, v28
  ds_read_b64_tr_b16 v[32:33], v30 offset:0
  ds_read_b64_tr_b16 v[34:35], v30 offset:4096
  v_xor_b32 v30, 32, v28
  ds_read_b64_tr_b16 v[36:37], v30 offset:0
  ds_read_b64_tr_b16 v[38:39], v30 offset:4096
  v_xor_b32 v30, 64, v28
  ds_read_b64_tr_b16 v[40:41], v30 offset:0
  ds_read_b64_tr_b16 v[42:43], v30 offset:4096
  v_xor_b32 v30, 96, v28
  ds_read_b64_tr_b16 v[44:45], v30 offset:0
  ds_read_b64_tr_b16 v[46:47], v30 offset:4096
  v_xor_b32 v30, 128, v28
  ds_read_b64_tr_b16 v[48:49], v30 offset:0
  ds_read_b64_tr_b16 v[50:51], v30 offset:4096
  v_xor_b32 v30, 160, v28
  ds_read_b64_tr_b16 v[52:53], v30 offset:0
  ds_read_b64_tr_b16 v[54:55], v30 offset:4096
  v_xor_b32 v30, 192, v28
  ds_read_b64_tr_b16 v[56:57], v30 offset:0
  ds_read_b64_tr_b16 v[58:59], v30 offset:4096
  v_xor_b32 v30, 224, v28
  ds_read_b64_tr_b16 v[60:61], v30 offset:0
  ds_read_b64_tr_b16 v[62:63], v30 offset:4096
  s_waitcnt lgkmcnt(0)
  ds_write_b128 v29, v[32:35] offset:0
  ds_write_b128 v29, v[36:39] offset:1024
  ds_write_b128 v29, v[40:43] offset:2048
  ds_write_b128 v29, v[44:47] offset:3072
  ds_write_b128 v29, v[48:51] offset:4096
  ds_write_b128 v29, v[52:55] offset:5120
  ds_write_b128 v29, v[56:59] offset:6144
  ds_write_b128 v29, v[60:63] offset:7168
  v_add_u32 v28, 0x8000, v28
  v_add_u32 v29, 0x8000, v29
  s_waitcnt lgkmcnt(0)
  s_barrier
  v_xor_b32 v30, 0, v28
  ds_read_b64_tr_b16 v[32:33], v30 offset:0
  ds_read_b64_tr_b16 v[34:35], v30 offset:4096
  v_xor_b32 v30, 32, v28
  ds_read_b64_tr_b16 v[36:37], v30 offset:0
  ds_read_b64_tr_b16 v[38:39], v30 offset:4096
  v_xor_b32 v30, 64, v28
  ds_read_b64_tr_b16 v[40:41], v30 offset:0
  ds_read_b64_tr_b16 v[42:43], v30 offset:4096
  v_xor_b32 v30, 96, v28
  ds_read_b64_tr_b16 v[44:45], v30 offset:0
  ds_read_b64_tr_b16 v[46:47], v30 offset:4096
  v_xor_b32 v30, 128, v28
  ds_read_b64_tr_b16 v[48:49], v30 offset:0
  ds_read_b64_tr_b16 v[50:51], v30 offset:4096
  v_xor_b32 v30, 160, v28
  ds_read_b64_tr_b16 v[52:53], v30 offset:0
  ds_read_b64_tr_b16 v[54:55], v30 offset:4096
  v_xor_b32 v30, 192, v28
  ds_read_b64_tr_b16 v[56:57], v30 offset:0
  ds_read_b64_tr_b16 v[58:59], v30 offset:4096
  v_xor_b32 v30, 224, v28
  ds_read_b64_tr_b16 v[60:61], v30 offset:0
  ds_read_b64_tr_b16 v[62:63], v30 offset:4096
  s_waitcnt lgkmcnt(0)
  ds_write_b128 v29, v[32:35] offset:0
  ds_write_b128 v29, v[36:39] offset:1024
  ds_write_b128 v29, v[40:43] offset:2048
  ds_write_b128 v29, v[44:47] offset:3072
  ds_write_b128 v29, v[48:51] offset:4096
  ds_write_b128 v29, v[52:55] offset:5120
  ds_write_b128 v29, v[56:59] offset:6144
  ds_write_b128 v29, v[60:63] offset:7168
  v_add_u32 v28, 0x8000, v28
  v_add_u32 v29, 0x8000, v29
  s_waitcnt lgkmcnt(0)
  s_barrier
  v_and_b32 v24, 15, v0
  v_lshrrev_b32 v25, 4, v0
  v_lshlrev_b32 v1, 4, v0
  v_add_u32 v2, 131072, v1
  s_lshl_b32 s16, s12, 13
  v_add_u32 v3, s16, v1
  v_add_u32 v4, 0x10000, v3
  s_lshl_b32 s16, s12, 11
  v_add_u32 v6, s16, v1
  v_bfe_u32 v26, v24, 1, 1
  v_mul_u32_u24 v26, 0xAAAA, v26
  v_add_u32 v5, 0x4444, v26
  v_mul_u32_u24 v7, 2112, v25
  v_lshl_add_u32 v7, v24, 2, v7
  s_lshl_b32 s16, s12, 9
  s_add_u32 s16, s16, 139264
  v_add_u32 v7, s16, v7
  s_mul_i32 s16, s12, 4224
  s_add_u32 s16, s16, 139264
  v_lshlrev_b32 v8, 5, v0
  v_add_u32 v8, s16, v8
  v_lshlrev_b32 v9, 2, v0
  v_mov_b32 v10, 0
  s_lshr_b32 s19, s13, 3
  s_and_b32 s17, s13, 3
  s_mul_i32 s20, s19, 2097152
  s_lshl_b32 s16, s17, 13
  s_add_u32 s20, s20, s16
  s_add_u32 s20, s20, 25165824
  s_mul_i32 s21, s19, 16384
  s_add_u32 s21, s21, 4456448
  s_lshl_b32 s16, s17, 3
  s_lshl_b32 s17, s12, 1
  s_add_u32 s16, s16, s17
  s_lshl_b32 s24, s16, 10
  s_lshl_b32 s17, s19, 1
  s_add_u32 s17, s17, 1
  s_mul_i32 s25, s17, 2097152
  s_add_u32 s26, s25, 8388608
  s_add_u32 s25, s25, 16777216
  s_mul_i32 s27, s17, 8192
  s_lshl_b32 s16, s16, 2
  s_add_u32 s27, s27, s16
  s_add_u32 s27, s27, 4489216
  s_cmp_eq_u32 s19, 0
  s_cbranch_scc0 Ao_res1
  s_load_dwordx2 s[36:37], s[0:1], 0
  s_waitcnt lgkmcnt(0)
  s_mov_b32 s38, 2097152
  s_mov_b32 s39, 0x20000
  s_branch Ao_res2
Ao_res1:
  s_load_dwordx2 s[36:37], s[0:1], 96
  s_waitcnt lgkmcnt(0)
  s_add_u32 s36, s36, 20971520
  s_addc_u32 s37, s37, 0
  s_mov_b32 s38, 2097152
  s_mov_b32 s39, 0x20000
Ao_res2:
  s_bfe_u32 s18, s13, 0x10002
  s_lshl_b32 s16, s18, 15
  s_add_u32 s20, s20, s16
  s_lshl_b32 s16, s18, 8
  s_add_u32 s21, s21, s16
  s_lshl_b32 s16, s18, 7
  s_add_u32 s27, s27, s16
  s_mov_b32 s23, 0
fw_Ao0:
  buffer_load_dword v11, v9, s[4:7], s21 offen sc1
  s_waitcnt vmcnt(0)
  v_cmp_eq_u32 vcc, 0, v11
  s_cbranch_vccz fw_Ao0_ok
  s_sub_u32 s15, s15, 1
  s_cbranch_scc1 fw_Ao0_ok
  s_sleep 24
  s_branch fw_Ao0
fw_Ao0_ok:
  s_lshl_b32 s44, s12, 11
  s_add_u32 m0, s44, 131072
  s_nop 0
  buffer_load_dwordx4 v6, s[4:7], s20 offen sc1 lds
  buffer_load_dwordx4 v6, s[4:7], s20 offen offset:1024 sc1 lds
  s_waitcnt vmcnt(0)
  s_barrier
Ao_item:
  ds_read_b128 v[16:19], v2 offset:0
  ds_read_b128 v[20:23], v2 offset:1024
  ds_read_b128 v[24:27], v2 offset:2048
  ds_read_b128 v[28:31], v2 offset:3072
  v_mov_b64 v[32:33], 0
  v_mov_b64 v[34:35], 0
  v_mov_b64 v[36:37], 0
  v_mov_b64 v[38:39], 0
  v_mov_b64 v[40:41], 0
  v_mov_b64 v[42:43], 0
  v_mov_b64 v[44:45], 0
  v_mov_b64 v[46:47], 0
  v_mov_b64 v[48:49], 0
  v_mov_b64 v[50:51], 0
  v_mov_b64 v[52:53], 0
  v_mov_b64 v[54:55], 0
  v_mov_b64 v[56:57], 0
  v_mov_b64 v[58:59], 0
  v_mov_b64 v[60:61], 0
  v_mov_b64 v[62:63], 0
  s_add_u32 s21, s21, 512
  buffer_load_dword v11, v9, s[4:7], s21 offen sc1
  s_waitcnt lgkmcnt(3)
  v_smfmac_f32_16x16x64_bf16 v[32:35], v[16:19], a[0:7], v5
  v_smfmac_f32_16x16x64_bf16 v[36:39], v[16:19], a[48:55], v5
  v_smfmac_f32_16x16x64_bf16 v[40:43], v[16:19], a[96:103], v5
  v_smfmac_f32_16x16x64_bf16 v[44:47], v[16:19], a[144:151], v5
  v_smfmac_f32_16x16x64_bf16 v[48:51], v[16:19], a[192:199], v5
  v_smfmac_f32_16x16x64_bf16 v[52:55], v[16:19], a[240:247], v5
  v_smfmac_f32_16x16x64_bf16 v[56:59], v[16:19], v[160:167], v5
  v_smfmac_f32_16x16x64_bf16 v[60:63], v[16:19], v[208:215], v5
  ds_read_b128 v[16:19], v2 offset:4096
  s_waitcnt lgkmcnt(3)
  v_smfmac_f32_16x16x64_bf16 v[32:35], v[20:23], a[8:15], v5
  ds_read_b128 v[64:67], v3 offset:0
  ds_read_b128 v[68:71], v3 offset:32768
  v_smfmac_f32_16x16x64_bf16 v[36:39], v[20:23], a[56:63], v5
  v_smfmac_f32_16x16x64_bf16 v[40:43], v[20:23], a[104:111], v5
  ds_read_b128 v[72:75], v3 offset:1024
  ds_read_b128 v[76:79], v3 offset:33792
  v_smfmac_f32_16x16x64_bf16 v[44:47], v[20:23], a[152:159], v5
  v_smfmac_f32_16x16x64_bf16 v[48:51], v[20:23], a[200:207], v5
  ds_read_b128 v[80:83], v3 offset:2048
  ds_read_b128 v[84:87], v3 offset:34816
  v_smfmac_f32_16x16x64_bf16 v[52:55], v[20:23], a[248:255], v5
  v_smfmac_f32_16x16x64_bf16 v[56:59], v[20:23], v[168:175], v5
  ds_read_b128 v[88:91], v3 offset:3072
  ds_read_b128 v[92:95], v3 offset:35840
  v_smfmac_f32_16x16x64_bf16 v[60:63], v[20:23], v[216:223], v5
  ds_read_b128 v[20:23], v2 offset:5120
  s_waitcnt lgkmcnt(11)
  v_smfmac_f32_16x16x64_bf16 v[32:35], v[24:27], a[16:23], v5
  ds_read_b128 v[96:99], v3 offset:4096
  ds_read_b128 v[100:103], v3 offset:36864
  v_smfmac_f32_16x16x64_bf16 v[36:39], v[24:27], a[64:71], v5
  v_smfmac_f32_16x16x64_bf16 v[40:43], v[24:27], a[112:119], v5
  ds_read_b128 v[104:107], v3 offset:5120
  ds_read_b128 v[108:111], v3 offset:37888
  v_smfmac_f32_16x16x64_bf16 v[44:47], v[24:27], a[160:167], v5
  v_smfmac_f32_16x16x64_bf16 v[48:51], v[24:27], a[208:215], v5
  ds_read_b128 v[112:115], v3 offset:6144
  ds_read_b128 v[116:119], v3 offset:38912
  v_smfmac_f32_16x16x64_bf16 v[52:55], v[24:27], v[128:135], v5
  v_smfmac_f32_16x16x64_bf16 v[56:59], v[24:27], v[176:183], v5
  ds_read_b128 v[120:123], v3 offset:7168
  ds_read_b128 v[124:127], v3 offset:39936
  v_smfmac_f32_16x16x64_bf16 v[60:63], v[24:27], v[224:231], v5
  ds_read_b128 v[24:27], v2 offset:6144
  s_waitcnt lgkmcnt(15)
  v_smfmac_f32_16x16x64_bf16 v[32:35], v[28:31], a[24:31], v5
  v_smfmac_f32_16x16x64_bf16 v[36:39], v[28:31], a[72:79], v5
  v_smfmac_f32_16x16x64_bf16 v[40:43], v[28:31], a[120:127], v5
  v_smfmac_f32_16x16x64_bf16 v[44:47], v[28:31], a[168:175], v5
  v_smfmac_f32_16x16x64_bf16 v[48:51], v[28:31], a[216:223], v5
  v_smfmac_f32_16x16x64_bf16 v[52:55], v[28:31], v[136:143], v5
  v_smfmac_f32_16x16x64_bf16 v[56:59], v[28:31], v[184:191], v5
  v_smfmac_f32_16x16x64_bf16 v[60:63], v[28:31], v[232:239], v5
  ds_read_b128 v[28:31], v2 offset:7168
  v_smfmac_f32_16x16x64_bf16 v[32:35], v[16:19], a[32:39], v5
  v_smfmac_f32_16x16x64_bf16 v[36:39], v[16:19], a[80:87], v5
  v_smfmac_f32_16x16x64_bf16 v[40:43], v[16:19], a[128:135], v5
  v_smfmac_f32_16x16x64_bf16 v[44:47], v[16:19], a[176:183], v5
  v_smfmac_f32_16x16x64_bf16 v[48:51], v[16:19], a[224:231], v5
  v_smfmac_f32_16x16x64_bf16 v[52:55], v[16:19], v[144:151], v5
  v_smfmac_f32_16x16x64_bf16 v[56:59], v[16:19], v[192:199], v5
  v_smfmac_f32_16x16x64_bf16 v[60:63], v[16:19], v[240:247], v5
  s_waitcnt lgkmcnt(10)
  v_smfmac_f32_16x16x64_bf16 v[32:35], v[20:23], a[40:47], v5
  v_smfmac_f32_16x16x64_bf16 v[36:39], v[20:23], a[88:95], v5
  v_smfmac_f32_16x16x64_bf16 v[40:43], v[20:23], a[136:143], v5
  v_smfmac_f32_16x16x64_bf16 v[44:47], v[20:23], a[184:191], v5
  v_smfmac_f32_16x16x64_bf16 v[48:51], v[20:23], a[232:239], v5
  v_smfmac_f32_16x16x64_bf16 v[52:55], v[20:23], v[152:159], v5
  v_smfmac_f32_16x16x64_bf16 v[56:59], v[20:23], v[200:207], v5
  v_smfmac_f32_16x16x64_bf16 v[60:63], v[20:23], v[248:255], v5
  s_lshl_b32 s44, s18, 15
  s_add_u32 s44, s44, s24
  buffer_load_dwordx4 v[16:19], v1, s[36:39], s44 offen sc1
  buffer_load_dwordx4 v[20:23], v1, s[36:39], s44 offen offset:1024 sc1
  s_waitcnt lgkmcnt(1)
  v_smfmac_f32_16x16x64_bf16 v[32:35], v[24:27], v[64:71], v5
  ds_read_b128 v[64:67], v4 offset:0
  ds_read_b128 v[68:71], v4 offset:32768
  v_smfmac_f32_16x16x64_bf16 v[36:39], v[24:27], v[72:79], v5
  ds_read_b128 v[72:75], v4 offset:1024
  ds_read_b128 v[76:79], v4 offset:33792
  v_smfmac_f32_16x16x64_bf16 v[40:43], v[24:27], v[80:87], v5
  ds_read_b128 v[80:83], v4 offset:2048
  ds_read_b128 v[84:87], v4 offset:34816
  v_smfmac_f32_16x16x64_bf16 v[44:47], v[24:27], v[88:95], v5
  ds_read_b128 v[88:91], v4 offset:3072
  ds_read_b128 v[92:95], v4 offset:35840
  v_smfmac_f32_16x16x64_bf16 v[48:51], v[24:27], v[96:103], v5
  ds_read_b128 v[96:99], v4 offset:4096
  ds_read_b128 v[100:103], v4 offset:36864
  v_smfmac_f32_16x16x64_bf16 v[52:55], v[24:27], v[104:111], v5
  ds_read_b128 v[104:107], v4 offset:5120
  ds_read_b128 v[108:111], v4 offset:37888
  v_smfmac_f32_16x16x64_bf16 v[56:59], v[24:27], v[112:119], v5
  ds_read_b128 v[112:115], v4 offset:6144
  ds_read_b128 v[116:119], v4 offset:38912
  v_smfmac_f32_16x16x64_bf16 v[60:63], v[24:27], v[120:127], v5
  ds_read_b128 v[120:123], v4 offset:7168
  ds_read_b128 v[124:127], v4 offset:39936
  s_waitcnt lgkmcnt(15)
  s_waitcnt lgkmcnt(14)
  v_smfmac_f32_16x16x64_bf16 v[32:35], v[28:31], v[64:71], v5
  s_waitcnt lgkmcnt(12)
  v_smfmac_f32_16x16x64_bf16 v[36:39], v[28:31], v[72:79], v5
  s_waitcnt lgkmcnt(10)
  v_smfmac_f32_16x16x64_bf16 v[40:43], v[28:31], v[80:87], v5
  s_waitcnt lgkmcnt(8)
  v_smfmac_f32_16x16x64_bf16 v[44:47], v[28:31], v[88:95], v5
  s_waitcnt lgkmcnt(6)
  v_smfmac_f32_16x16x64_bf16 v[48:51], v[28:31], v[96:103], v5
  s_waitcnt lgkmcnt(4)
  v_smfmac_f32_16x16x64_bf16 v[52:55], v[28:31], v[104:111], v5
  s_waitcnt lgkmcnt(2)
  v_smfmac_f32_16x16x64_bf16 v[56:59], v[28:31], v[112:119], v5
  s_waitcnt lgkmcnt(0)
  v_smfmac_f32_16x16x64_bf16 v[60:63], v[28:31], v[120:127], v5
  s_cmp_eq_u32 s23, 0
  s_cbranch_scc1 Ao_pf
  s_waitcnt vmcnt(3)
  v_mov_b32 v24, 1
  v_lshlrev_b32 v25, 2, v0
  s_sub_u32 s45, s27, 256
  s_mov_b64 exec, 3
  buffer_store_dword v24, v25, s[4:7], s45 offen sc1
  s_mov_b64 exec, -1
  s_mov_b32 s23, 0
Ao_pf:
  s_nop 1
  v_pk_add_f32 v[32:33], v[32:33], v[34:35]
  ds_write_b32 v7, v32 offset:0
  ds_write_b32 v7, v33 offset:8448
  v_pk_add_f32 v[36:37], v[36:37], v[38:39]
  ds_write_b32 v7, v36 offset:64
  ds_write_b32 v7, v37 offset:8512
  v_pk_add_f32 v[40:41], v[40:41], v[42:43]
  ds_write_b32 v7, v40 offset:128
  ds_write_b32 v7, v41 offset:8576
  v_pk_add_f32 v[44:45], v[44:45], v[46:47]
  ds_write_b32 v7, v44 offset:192
  ds_write_b32 v7, v45 offset:8640
  v_pk_add_f32 v[48:49], v[48:49], v[50:51]
  ds_write_b32 v7, v48 offset:256
  ds_write_b32 v7, v49 offset:8704
  v_pk_add_f32 v[52:53], v[52:53], v[54:55]
  ds_write_b32 v7, v52 offset:320
  ds_write_b32 v7, v53 offset:8768
  v_pk_add_f32 v[56:57], v[56:57], v[58:59]
  ds_write_b32 v7, v56 offset:384
  ds_write_b32 v7, v57 offset:8832
  v_pk_add_f32 v[60:61], v[60:61], v[62:63]
  ds_write_b32 v7, v60 offset:448
  ds_write_b32 v7, v61 offset:8896
  s_waitcnt lgkmcnt(0)
  s_barrier
  s_add_u32 s20, s20, 65536
  s_mov_b32 s22, 0
  ds_read_b128 v[64:67], v8
  ds_read_b128 v[68:71], v8 offset:16
  ds_read_b128 v[72:75], v8 offset:2112
  ds_read_b128 v[76:79], v8 offset:2128
  s_waitcnt vmcnt(0)
  s_cmp_ge_u32 s18, 62
  s_cbranch_scc1 Ao_pre
  v_cmp_eq_u32 vcc, 0, v11
  s_cbranch_vccnz Ao_pre
  s_lshl_b32 s44, s12, 11
  s_add_u32 m0, s44, 131072
  s_nop 0
  buffer_load_dwordx4 v6, s[4:7], s20 offen sc1 lds
  buffer_load_dwordx4 v6, s[4:7], s20 offen offset:1024 sc1 lds
  s_mov_b32 s22, 1
Ao_pre:
  s_waitcnt lgkmcnt(0)
  v_cvt_pk_bf16_f32 v80, v64, v65
  v_cvt_pk_bf16_f32 v96, v72, v73
  v_cvt_pk_bf16_f32 v81, v66, v67
  v_cvt_pk_bf16_f32 v97, v74, v75
  v_cvt_pk_bf16_f32 v82, v68, v69
  v_cvt_pk_bf16_f32 v98, v76, v77
  v_cvt_pk_bf16_f32 v83, v70, v71
  v_cvt_pk_bf16_f32 v99, v78, v79
  v_lshlrev_b32 v64, 16, v80
  v_lshlrev_b32 v72, 16, v96
  v_and_b32 v65, 0xffff0000, v80
  v_and_b32 v73, 0xffff0000, v96
  v_lshlrev_b32 v66, 16, v81
  v_lshlrev_b32 v74, 16, v97
  v_and_b32 v67, 0xffff0000, v81
  v_and_b32 v75, 0xffff0000, v97
  v_lshlrev_b32 v68, 16, v82
  v_lshlrev_b32 v76, 16, v98
  v_and_b32 v69, 0xffff0000, v82
  v_and_b32 v77, 0xffff0000, v98
  v_lshlrev_b32 v70, 16, v83
  v_lshlrev_b32 v78, 16, v99
  v_and_b32 v71, 0xffff0000, v83
  v_and_b32 v79, 0xffff0000, v99
  v_lshlrev_b32 v84, 16, v16
  v_lshlrev_b32 v100, 16, v20
  v_and_b32 v85, 0xffff0000, v16
  v_and_b32 v101, 0xffff0000, v20
  v_lshlrev_b32 v86, 16, v17
  v_lshlrev_b32 v102, 16, v21
  v_and_b32 v87, 0xffff0000, v17
  v_and_b32 v103, 0xffff0000, v21
  v_lshlrev_b32 v88, 16, v18
  v_lshlrev_b32 v104, 16, v22
  v_and_b32 v89, 0xffff0000, v18
  v_and_b32 v105, 0xffff0000, v22
  v_lshlrev_b32 v90, 16, v19
  v_lshlrev_b32 v106, 16, v23
  v_and_b32 v91, 0xffff0000, v19
  v_and_b32 v107, 0xffff0000, v23
  v_pk_add_f32 v[64:65], v[64:65], v[84:85]
  v_pk_add_f32 v[72:73], v[72:73], v[100:101]
  v_pk_add_f32 v[66:67], v[66:67], v[86:87]
  v_pk_add_f32 v[74:75], v[74:75], v[102:103]
  v_pk_add_f32 v[68:69], v[68:69], v[88:89]
  v_pk_add_f32 v[76:77], v[76:77], v[104:105]
  v_pk_add_f32 v[70:71], v[70:71], v[90:91]
  v_pk_add_f32 v[78:79], v[78:79], v[106:107]
  v_cvt_pk_bf16_f32 v16, v64, v65
  v_cvt_pk_bf16_f32 v20, v72, v73
  v_cvt_pk_bf16_f32 v17, v66, v67
  v_cvt_pk_bf16_f32 v21, v74, v75
  v_cvt_pk_bf16_f32 v18, v68, v69
  v_cvt_pk_bf16_f32 v22, v76, v77
  v_cvt_pk_bf16_f32 v19, v70, v71
  v_cvt_pk_bf16_f32 v23, v78, v79
  v_lshlrev_b32 v64, 16, v16
  v_lshlrev_b32 v72, 16, v20
  v_and_b32 v65, 0xffff0000, v16
  v_and_b32 v73, 0xffff0000, v20
  v_lshlrev_b32 v66, 16, v17
  v_lshlrev_b32 v74, 16, v21
  v_and_b32 v67, 0xffff0000, v17
  v_and_b32 v75, 0xffff0000, v21
  v_lshlrev_b32 v68, 16, v18
  v_lshlrev_b32 v76, 16, v22
  v_and_b32 v69, 0xffff0000, v18
  v_and_b32 v77, 0xffff0000, v22
  v_lshlrev_b32 v70, 16, v19
  v_lshlrev_b32 v78, 16, v23
  v_and_b32 v71, 0xffff0000, v19
  v_and_b32 v79, 0xffff0000, v23
  v_pk_add_f32 v[80:81], v[64:65], v[66:67]
  v_pk_add_f32 v[96:97], v[72:73], v[74:75]
  v_pk_add_f32 v[82:83], v[68:69], v[70:71]
  v_pk_add_f32 v[98:99], v[76:77], v[78:79]
  v_pk_add_f32 v[80:81], v[80:81], v[82:83]
  v_pk_add_f32 v[96:97], v[96:97], v[98:99]
  v_add_f32 v84, v80, v81
  v_add_f32 v100, v96, v97
  s_nop 0
  v_add_f32_dpp v84, v84, v84 quad_perm:[1,0,3,2] row_mask:0xf bank_mask:0xf
  v_add_f32_dpp v100, v100, v100 quad_perm:[1,0,3,2] row_mask:0xf bank_mask:0xf
  s_nop 0
  v_add_f32_dpp v84, v84, v84 quad_perm:[2,3,0,1] row_mask:0xf bank_mask:0xf
  v_add_f32_dpp v100, v100, v100 quad_perm:[2,3,0,1] row_mask:0xf bank_mask:0xf
  s_nop 0
  v_add_f32_dpp v84, v84, v84 row_ror:4 row_mask:0xf bank_mask:0xf
  v_add_f32_dpp v100, v100, v100 row_ror:4 row_mask:0xf bank_mask:0xf
  s_nop 0
  v_add_f32_dpp v84, v84, v84 row_ror:8 row_mask:0xf bank_mask:0xf
  v_add_f32_dpp v100, v100, v100 row_ror:8 row_mask:0xf bank_mask:0xf
  v_mov_b32 v85, v84
  v_mov_b32 v101, v100
  s_nop 0
  v_permlane16_swap_b32 v84, v85
  v_permlane16_swap_b32 v100, v101
  v_add_f32 v84, v84, v85
  v_add_f32 v100, v100, v101
  v_mov_b32 v85, v84
  v_mov_b32 v101, v100
  s_nop 0
  v_permlane32_swap_b32 v84, v85
  v_permlane32_swap_b32 v100, v101
  v_add_f32 v84, v84, v85
  v_add_f32 v100, v100, v101
  v_mul_f32 v84, 0xbb000000, v84
  v_mul_f32 v100, 0xbb000000, v100
  v_mov_b32 v85, v84
  v_mov_b32 v101, v100
  v_pk_add_f32 v[64:65], v[64:65], v[84:85]
  v_pk_add_f32 v[72:73], v[72:73], v[100:101]
  v_pk_add_f32 v[66:67], v[66:67], v[84:85]
  v_pk_add_f32 v[74:75], v[74:75], v[100:101]
  v_pk_add_f32 v[68:69], v[68:69], v[84:85]
  v_pk_add_f32 v[76:77], v[76:77], v[100:101]
  v_pk_add_f32 v[70:71], v[70:71], v[84:85]
  v_pk_add_f32 v[78:79], v[78:79], v[100:101]
  v_pk_mul_f32 v[80:81], v[64:65], v[64:65]
  v_pk_mul_f32 v[96:97], v[72:73], v[72:73]
  v_pk_fma_f32 v[80:81], v[66:67], v[66:67], v[80:81]
  v_pk_fma_f32 v[96:97], v[74:75], v[74:75], v[96:97]
  v_pk_fma_f32 v[80:81], v[68:69], v[68:69], v[80:81]
  v_pk_fma_f32 v[96:97], v[76:77], v[76:77], v[96:97]
  v_pk_fma_f32 v[80:81], v[70:71], v[70:71], v[80:81]
  v_pk_fma_f32 v[96:97], v[78:79], v[78:79], v[96:97]
  v_add_f32 v86, v80, v81
  v_add_f32 v102, v96, v97
  s_nop 0
  v_add_f32_dpp v86, v86, v86 quad_perm:[1,0,3,2] row_mask:0xf bank_mask:0xf
  v_add_f32_dpp v102, v102, v102 quad_perm:[1,0,3,2] row_mask:0xf bank_mask:0xf
  s_nop 0
  v_add_f32_dpp v86, v86, v86 quad_perm:[2,3,0,1] row_mask:0xf bank_mask:0xf
  v_add_f32_dpp v102, v102, v102 quad_perm:[2,3,0,1] row_mask:0xf bank_mask:0xf
  s_nop 0
  v_add_f32_dpp v86, v86, v86 row_ror:4 row_mask:0xf bank_mask:0xf
  v_add_f32_dpp v102, v102, v102 row_ror:4 row_mask:0xf bank_mask:0xf
  s_nop 0
  v_add_f32_dpp v86, v86, v86 row_ror:8 row_mask:0xf bank_mask:0xf
  v_add_f32_dpp v102, v102, v102 row_ror:8 row_mask:0xf bank_mask:0xf
  v_mov_b32 v87, v86
  v_mov_b32 v103, v102
  s_nop 0
  v_permlane16_swap_b32 v86, v87
  v_permlane16_swap_b32 v102, v103
  v_add_f32 v86, v86, v87
  v_add_f32 v102, v102, v103
  v_mov_b32 v87, v86
  v_mov_b32 v103, v102
  s_nop 0
  v_permlane32_swap_b32 v86, v87
  v_permlane32_swap_b32 v102, v103
  v_add_f32 v86, v86, v87
  v_add_f32 v102, v102, v103
  v_mov_b32 v87, 0x3727c5ac
  v_mov_b32 v103, 0x3727c5ac
  v_fmac_f32 v87, 0x3b000000, v86
  v_fmac_f32 v103, 0x3b000000, v102
  v_rsq_f32 v86, v87
  v_rsq_f32 v102, v103
  v_mov_b32 v87, v86
  v_mov_b32 v103, v102
  v_pk_mul_f32 v[64:65], v[64:65], v[86:87]
  v_pk_mul_f32 v[72:73], v[72:73], v[102:103]
  v_pk_mul_f32 v[66:67], v[66:67], v[86:87]
  v_pk_mul_f32 v[74:75], v[74:75], v[102:103]
  v_pk_mul_f32 v[68:69], v[68:69], v[86:87]
  v_pk_mul_f32 v[76:77], v[76:77], v[102:103]
  v_pk_mul_f32 v[70:71], v[70:71], v[86:87]
  v_pk_mul_f32 v[78:79], v[78:79], v[102:103]
  v_cvt_pk_bf16_f32 v80, v64, v65
  v_cvt_pk_bf16_f32 v96, v72, v73
  v_cvt_pk_bf16_f32 v81, v66, v67
  v_cvt_pk_bf16_f32 v97, v74, v75
  v_cvt_pk_bf16_f32 v82, v68, v69
  v_cvt_pk_bf16_f32 v98, v76, v77
  v_cvt_pk_bf16_f32 v83, v70, v71
  v_cvt_pk_bf16_f32 v99, v78, v79
  s_lshl_b32 s44, s18, 15
  s_add_u32 s44, s44, s24
  s_add_u32 s45, s44, s25
  s_add_u32 s46, s44, s26
  buffer_store_dwordx4 v[80:83], v1, s[4:7], s46 offen sc1
  buffer_store_dwordx4 v[96:99], v1, s[4:7], s46 offen offset:1024 sc1
  buffer_store_dwordx4 v[16:19], v1, s[4:7], s45 offen sc1
  buffer_store_dwordx4 v[20:23], v1, s[4:7], s45 offen offset:1024 sc1
  s_cmp_lg_u32 s22, 0
  s_cbranch_scc1 Ao_defer
  buffer_load_dword v11, v9, s[4:7], s21 offen sc1
  s_waitcnt vmcnt(0)
  v_mov_b32 v24, 1
  v_lshlrev_b32 v25, 2, v0
  s_mov_b64 exec, 3
  buffer_store_dword v24, v25, s[4:7], s27 offen sc1
  s_mov_b64 exec, -1
  s_cmp_ge_u32 s18, 62
  s_cbranch_scc1 Ao_end
  v_cmp_eq_u32 vcc, 0, v11
  s_cbranch_vccz Ao_cp
fw_Ao1:
  buffer_load_dword v11, v9, s[4:7], s21 offen sc1
  s_waitcnt vmcnt(0)
  v_cmp_eq_u32 vcc, 0, v11
  s_cbranch_vccz fw_Ao1_ok
  s_sub_u32 s15, s15, 1
  s_cbranch_scc1 fw_Ao1_ok
  s_sleep 24
  s_branch fw_Ao1
fw_Ao1_ok:
Ao_cp:
  s_lshl_b32 s44, s12, 11
  s_add_u32 m0, s44, 131072
  s_nop 0
  buffer_load_dwordx4 v6, s[4:7], s20 offen sc1 lds
  buffer_load_dwordx4 v6, s[4:7], s20 offen offset:1024 sc1 lds
  s_waitcnt vmcnt(0)
  s_branch Ao_go
Ao_defer:
  s_mov_b32 s23, 1
  s_waitcnt vmcnt(4)
Ao_go:
  s_add_u32 s18, s18, 2
  s_add_u32 s27, s27, 256
  s_barrier
  s_branch Ao_item
Ao_end:
  s_waitcnt vmcnt(0)
  s_endpgm
TA_entry:
  s_and_b32 s16, s13, 7
  s_lshl_b32 s16, s16, 2
  s_add_u32 s16, s16, s12
  s_mov_b32 s19, s16
  s_mov_b32 s21, 0
  v_and_b32 v16, 15, v0
  v_lshrrev_b32 v17, 4, v0
  v_lshlrev_b32 v1, 4, v0
  v_and_b32 v18, 3, v0
  v_lshlrev_b32 v2, 2, v18
  v_bfe_u32 v19, v0, 2, 1
  v_mul_u32_u24 v19, 131072, v19
  v_add_u32 v2, v2, v19
  v_lshlrev_b32 v3, 10, v18
  v_or_b32 v18, 2, v16
  v_lshl_add_u32 v18, v17, 4, v18
  v_lshlrev_b32 v4, 4, v18
  v_bfe_u32 v18, v16, 1, 1
  v_lshl_add_u32 v4, v18, 3, v4
  v_lshlrev_b32 v18, 2, v17
  v_sub_u32 v5, v16, v18
  v_mov_b32 v6, 0
  v_mov_b32 v113, 0
  v_mov_b32 v115, 0
  v_mov_b32 v117, 0
  v_mov_b32 v119, 0
  v_mov_b32 v121, 0
  v_mov_b32 v123, 0
  v_mov_b32 v125, 0
  v_mov_b32 v127, 0
  v_mov_b32 v145, 0
  v_mov_b32 v197, 0
  s_mul_i32 s23, s14, 16777216
  s_lshl_b32 s16, s19, 13
  s_add_u32 s23, s23, s16
  s_mul_i32 s24, s14, 8650752
  s_lshl_b32 s16, s19, 12
  s_add_u32 s24, s24, s16
  s_add_u32 s24, s24, 135266304
  s_mul_i32 s25, s14, 33280
  s_lshl_b32 s16, s19, 4
  s_add_u32 s25, s25, s16
  s_add_u32 s25, s25, 4194304
  s_mul_i32 s27, s14, 16384
  s_lshl_b32 s16, s19, 3
  s_add_u32 s27, s27, s16
  s_add_u32 s27, s27, 4521984
  s_mov_b32 s28, 0x3e0293ee
  s_lshr_b32 s18, s13, 3
  s_mul_i32 s16, s18, 262144
  s_add_u32 s23, s23, s16
  s_mul_i32 s16, s18, 131072
  s_add_u32 s24, s24, s16
  s_mul_i32 s16, s18, 512
  s_add_u32 s25, s25, s16
  s_mul_i32 s16, s18, 256
  s_add_u32 s27, s27, s16
fw_TA0:
  buffer_load_dword v180, v2, s[4:7], s25 offen sc1
  s_waitcnt vmcnt(0)
  v_cmp_eq_u32 vcc, 0, v180
  s_cbranch_vccz fw_TA0_ok
  s_sub_u32 s15, s15, 1
  s_cbranch_scc1 fw_TA0_ok
  s_sleep 24
  s_branch fw_TA0
fw_TA0_ok:
  s_add_u32 s46, s23, 67108864
  s_add_u32 s47, s46, 4096
  buffer_load_dwordx4 v[32:35], v1, s[4:7], s46 offen offset:0 sc1
  buffer_load_dwordx4 v[36:39], v1, s[4:7], s46 offen offset:1024 sc1
  buffer_load_dwordx4 v[40:43], v1, s[4:7], s46 offen offset:2048 sc1
  buffer_load_dwordx4 v[44:47], v1, s[4:7], s46 offen offset:3072 sc1
  buffer_load_dwordx4 v[48:51], v1, s[4:7], s47 offen offset:0 sc1
  buffer_load_dwordx4 v[52:55], v1, s[4:7], s47 offen offset:1024 sc1
  buffer_load_dwordx4 v[56:59], v1, s[4:7], s47 offen offset:2048 sc1
  buffer_load_dwordx4 v[60:63], v1, s[4:7], s47 offen offset:3072 sc1
  s_add_u32 s48, s21, 0
  s_lshl_b32 s48, s48, 12
  s_add_u32 s48, s48, s23
  s_add_u32 s48, s48, 33554432
  buffer_load_dwordx4 v[200:203], v1, s[4:7], s48 offen offset:0 sc1
  buffer_load_dwordx4 v[204:207], v1, s[4:7], s48 offen offset:1024 sc1
  buffer_load_dwordx4 v[208:211], v1, s[4:7], s48 offen offset:2048 sc1
  buffer_load_dwordx4 v[212:215], v1, s[4:7], s48 offen offset:3072 sc1
  s_add_u32 s48, s21, 1
  s_lshl_b32 s48, s48, 12
  s_add_u32 s48, s48, s23
  s_add_u32 s48, s48, 33554432
  buffer_load_dwordx4 v[216:219], v1, s[4:7], s48 offen offset:0 sc1
  buffer_load_dwordx4 v[220:223], v1, s[4:7], s48 offen offset:1024 sc1
  buffer_load_dwordx4 v[224:227], v1, s[4:7], s48 offen offset:2048 sc1
  buffer_load_dwordx4 v[228:231], v1, s[4:7], s48 offen offset:3072 sc1
  s_add_u32 s46, s23, 100663296
  s_add_u32 s47, s46, 4096
  buffer_load_dwordx4 v[64:67], v1, s[4:7], s46 offen offset:0 sc1
  buffer_load_dwordx4 v[68:71], v1, s[4:7], s46 offen offset:1024 sc1
  buffer_load_dwordx4 v[72:75], v1, s[4:7], s46 offen offset:2048 sc1
  buffer_load_dwordx4 v[76:79], v1, s[4:7], s46 offen offset:3072 sc1
  buffer_load_dwordx4 v[80:83], v1, s[4:7], s47 offen offset:0 sc1
  buffer_load_dwordx4 v[84:87], v1, s[4:7], s47 offen offset:1024 sc1
  buffer_load_dwordx4 v[88:91], v1, s[4:7], s47 offen offset:2048 sc1
  buffer_load_dwordx4 v[92:95], v1, s[4:7], s47 offen offset:3072 sc1
  s_waitcnt vmcnt(8)
TA_item:
  v_mfma_f32_16x16x32_bf16 v[232:235], v[32:35], v[200:203], 0
  v_mfma_f32_16x16x32_bf16 v[236:239], v[48:51], v[200:203], 0
  v_mfma_f32_16x16x32_bf16 v[232:235], v[36:39], v[204:207], v[232:235]
  v_mfma_f32_16x16x32_bf16 v[236:239], v[52:55], v[204:207], v[236:239]
  v_mfma_f32_16x16x32_bf16 v[232:235], v[40:43], v[208:211], v[232:235]
  v_mfma_f32_16x16x32_bf16 v[236:239], v[56:59], v[208:211], v[236:239]
  v_mfma_f32_16x16x32_bf16 v[232:235], v[44:47], v[212:215], v[232:235]
  v_mfma_f32_16x16x32_bf16 v[236:239], v[60:63], v[212:215], v[236:239]
  v_mfma_f32_16x16x32_bf16 v[240:243], v[32:35], v[216:219], 0
  v_mfma_f32_16x16x32_bf16 v[244:247], v[48:51], v[216:219], 0
  v_mfma_f32_16x16x32_bf16 v[240:243], v[36:39], v[220:223], v[240:243]
  v_mfma_f32_16x16x32_bf16 v[244:247], v[52:55], v[220:223], v[244:247]
  v_mfma_f32_16x16x32_bf16 v[240:243], v[40:43], v[224:227], v[240:243]
  v_mfma_f32_16x16x32_bf16 v[244:247], v[56:59], v[224:227], v[244:247]
  v_mfma_f32_16x16x32_bf16 v[240:243], v[44:47], v[228:231], v[240:243]
  v_mfma_f32_16x16x32_bf16 v[244:247], v[60:63], v[228:231], v[244:247]
  s_add_u32 s25, s25, 1024
  buffer_load_dword v7, v2, s[4:7], s25 offen sc1
  s_add_u32 s49, s21, 0
  s_lshl_b32 s49, s49, 4
  v_add_u32 v180, s49, v5
  v_cmp_le_i32 s[30:31], 0, v180
  v_cmp_le_i32 s[32:33], 1, v180
  v_cmp_le_i32 s[34:35], 2, v180
  v_cmp_le_i32 s[36:37], 3, v180
  v_cmp_le_i32 s[38:39], 16, v180
  v_cmp_le_i32 s[40:41], 17, v180
  v_cmp_le_i32 s[42:43], 18, v180
  v_cmp_le_i32 s[44:45], 19, v180
  v_mov_b32 v181, 0xff800000
  v_cndmask_b32 v232, v181, v232, s[30:31]
  v_cndmask_b32 v233, v181, v233, s[32:33]
  v_cndmask_b32 v234, v181, v234, s[34:35]
  v_cndmask_b32 v235, v181, v235, s[36:37]
  v_cndmask_b32 v236, v181, v236, s[38:39]
  v_cndmask_b32 v237, v181, v237, s[40:41]
  v_cndmask_b32 v238, v181, v238, s[42:43]
  v_cndmask_b32 v239, v181, v239, s[44:45]
  s_add_u32 s49, s21, 1
  s_lshl_b32 s49, s49, 4
  v_add_u32 v180, s49, v5
  v_cmp_le_i32 s[30:31], 0, v180
  v_cmp_le_i32 s[32:33], 1, v180
  v_cmp_le_i32 s[34:35], 2, v180
  v_cmp_le_i32 s[36:37], 3, v180
  v_cmp_le_i32 s[38:39], 16, v180
  v_cmp_le_i32 s[40:41], 17, v180
  v_cmp_le_i32 s[42:43], 18, v180
  v_cmp_le_i32 s[44:45], 19, v180
  v_mov_b32 v181, 0xff800000
  v_cndmask_b32 v240, v181, v240, s[30:31]
  v_cndmask_b32 v241, v181, v241, s[32:33]
  v_cndmask_b32 v242, v181, v242, s[34:35]
  v_cndmask_b32 v243, v181, v243, s[36:37]
  v_cndmask_b32 v244, v181, v244, s[38:39]
  v_cndmask_b32 v245, v181, v245, s[40:41]
  v_cndmask_b32 v246, v181, v246, s[42:43]
  v_cndmask_b32 v247, v181, v247, s[44:45]
  s_waitcnt vmcnt(0)
  s_add_u32 s46, s24, 131072
TA_m:
  buffer_load_dword v182, v3, s[4:7], s46 offen sc1
  s_waitcnt vmcnt(0)
  v_cmp_eq_u32 vcc, -1, v182
  s_cbranch_vccz TA_m_got
  s_sleep 24
  s_sub_u32 s15, s15, 1
  s_cbranch_scc0 TA_m
TA_m_got:
  s_add_u32 s46, s24, 131072
  buffer_load_dword v182, v3, s[4:7], s46 offen sc1
  buffer_load_dwordx4 v[96:99], v1, s[4:7], s24 offen offset:0 sc1
  buffer_load_dwordx4 v[100:103], v1, s[4:7], s24 offen offset:1024 sc1
  buffer_load_dwordx4 v[104:107], v1, s[4:7], s24 offen offset:2048 sc1
  buffer_load_dwordx4 v[108:111], v1, s[4:7], s24 offen offset:3072 sc1
  buffer_load_dword v112, v4, s[4:7], s24 offen offset:0 sc1
  buffer_load_dword v114, v4, s[4:7], s24 offen offset:4 sc1
  buffer_load_dword v116, v4, s[4:7], s24 offen offset:1024 sc1
  buffer_load_dword v118, v4, s[4:7], s24 offen offset:1028 sc1
  buffer_load_dword v120, v4, s[4:7], s24 offen offset:2048 sc1
  buffer_load_dword v122, v4, s[4:7], s24 offen offset:2052 sc1
  buffer_load_dword v124, v4, s[4:7], s24 offen offset:3072 sc1
  buffer_load_dword v126, v4, s[4:7], s24 offen offset:3076 sc1
  s_waitcnt vmcnt(0)
TA_m_ok:
  v_mfma_f32_16x16x32_bf16 v[136:139], v[96:99], v[200:203], 0
  v_mfma_f32_16x16x32_bf16 v[8:11], v[96:99], v[216:219], 0
  v_mfma_f32_16x16x32_bf16 v[136:139], v[100:103], v[204:207], v[136:139]
  v_mfma_f32_16x16x32_bf16 v[8:11], v[100:103], v[220:223], v[8:11]
  v_mfma_f32_16x16x32_bf16 v[136:139], v[104:107], v[208:211], v[136:139]
  v_mfma_f32_16x16x32_bf16 v[8:11], v[104:107], v[224:227], v[8:11]
  v_mfma_f32_16x16x32_bf16 v[136:139], v[108:111], v[212:215], v[136:139]
  v_mfma_f32_16x16x32_bf16 v[8:11], v[108:111], v[228:231], v[8:11]
  v_max3_f32 v180, v232, v233, v234
  v_max3_f32 v16, v240, v241, v242
  v_max3_f32 v181, v235, v236, v237
  v_max3_f32 v17, v243, v244, v245
  v_max3_f32 v180, v180, v238, v239
  v_max3_f32 v16, v16, v246, v247
  v_max_f32 v180, v180, v181
  v_max_f32 v16, v16, v17
  s_nop 3
  v_max3_f32 v180, v180, v136, v137
  v_max3_f32 v16, v16, v8, v9
  v_mov_b32 v181, v180
  v_mov_b32 v17, v16
  s_nop 0
  v_permlane16_swap_b32 v180, v181
  v_permlane16_swap_b32 v16, v17
  v_max_f32 v180, v180, v181
  v_max_f32 v16, v16, v17
  v_mov_b32 v181, v180
  v_mov_b32 v17, v16
  s_nop 0
  v_permlane32_swap_b32 v180, v181
  v_permlane32_swap_b32 v16, v17
  v_max_f32 v180, v180, v181
  v_max_f32 v16, v16, v17
  v_mul_f32 v180, s28, v180
  v_mul_f32 v16, s28, v16
  v_fma_f32 v232, v232, s28, -v180
  v_fma_f32 v240, v240, s28, -v16
  v_fma_f32 v233, v233, s28, -v180
  v_fma_f32 v241, v241, s28, -v16
  v_fma_f32 v234, v234, s28, -v180
  v_fma_f32 v242, v242, s28, -v16
  v_fma_f32 v235, v235, s28, -v180
  v_fma_f32 v243, v243, s28, -v16
  v_fma_f32 v236, v236, s28, -v180
  v_fma_f32 v244, v244, s28, -v16
  v_fma_f32 v237, v237, s28, -v180
  v_fma_f32 v245, v245, s28, -v16
  v_fma_f32 v238, v238, s28, -v180
  v_fma_f32 v246, v246, s28, -v16
  v_fma_f32 v239, v239, s28, -v180
  v_fma_f32 v247, v247, s28, -v16
  v_fma_f32 v136, v136, s28, -v180
  v_fma_f32 v8, v8, s28, -v16
  v_fma_f32 v137, v137, s28, -v180
  v_fma_f32 v9, v9, s28, -v16
  v_exp_f32 v232, v232
  v_exp_f32 v240, v240
  v_exp_f32 v233, v233
  v_exp_f32 v241, v241
  v_exp_f32 v234, v234
  v_exp_f32 v242, v242
  v_exp_f32 v235, v235
  v_exp_f32 v243, v243
  v_exp_f32 v236, v236
  v_exp_f32 v244, v244
  v_exp_f32 v237, v237
  v_exp_f32 v245, v245
  v_exp_f32 v238, v238
  v_exp_f32 v246, v246
  v_exp_f32 v239, v239
  v_exp_f32 v247, v247
  v_exp_f32 v136, v136
  v_exp_f32 v8, v8
  v_exp_f32 v137, v137
  v_exp_f32 v9, v9
  s_nop 0
  v_cvt_pk_bf16_f32 v140, v232, v233
  v_cvt_pk_bf16_f32 v12, v240, v241
  v_cvt_pk_bf16_f32 v141, v234, v235
  v_cvt_pk_bf16_f32 v13, v242, v243
  v_cvt_pk_bf16_f32 v142, v236, v237
  v_cvt_pk_bf16_f32 v14, v244, v245
  v_cvt_pk_bf16_f32 v143, v238, v239
  v_cvt_pk_bf16_f32 v15, v246, v247
  v_cvt_pk_bf16_f32 v144, v136, v137
  v_cvt_pk_bf16_f32 v196, v8, v9
  s_nop 1
  v_mfma_f32_16x16x32_bf16 v[148:151], v[64:67], v[140:143], 0
  v_mfma_f32_16x16x32_bf16 v[32:35], v[64:67], v[12:15], 0
  v_mfma_f32_16x16x32_bf16 v[152:155], v[68:71], v[140:143], 0
  v_mfma_f32_16x16x32_bf16 v[36:39], v[68:71], v[12:15], 0
  v_mfma_f32_16x16x32_bf16 v[156:159], v[72:75], v[140:143], 0
  v_mfma_f32_16x16x32_bf16 v[40:43], v[72:75], v[12:15], 0
  v_mfma_f32_16x16x32_bf16 v[160:163], v[76:79], v[140:143], 0
  v_mfma_f32_16x16x32_bf16 v[44:47], v[76:79], v[12:15], 0
  v_mfma_f32_16x16x32_bf16 v[164:167], v[80:83], v[140:143], 0
  v_mfma_f32_16x16x32_bf16 v[48:51], v[80:83], v[12:15], 0
  v_mfma_f32_16x16x32_bf16 v[168:171], v[84:87], v[140:143], 0
  v_mfma_f32_16x16x32_bf16 v[52:55], v[84:87], v[12:15], 0
  v_mfma_f32_16x16x32_bf16 v[172:175], v[88:91], v[140:143], 0
  v_mfma_f32_16x16x32_bf16 v[56:59], v[88:91], v[12:15], 0
  v_mfma_f32_16x16x32_bf16 v[176:179], v[92:95], v[140:143], 0
  v_mfma_f32_16x16x32_bf16 v[60:63], v[92:95], v[12:15], 0
  v_mfma_f32_16x16x16_bf16 v[148:151], v[112:113], v[144:145], v[148:151]
  v_mfma_f32_16x16x16_bf16 v[32:35], v[112:113], v[196:197], v[32:35]
  v_mfma_f32_16x16x16_bf16 v[152:155], v[114:115], v[144:145], v[152:155]
  v_mfma_f32_16x16x16_bf16 v[36:39], v[114:115], v[196:197], v[36:39]
  v_mfma_f32_16x16x16_bf16 v[156:159], v[116:117], v[144:145], v[156:159]
  v_mfma_f32_16x16x16_bf16 v[40:43], v[116:117], v[196:197], v[40:43]
  v_mfma_f32_16x16x16_bf16 v[160:163], v[118:119], v[144:145], v[160:163]
  v_mfma_f32_16x16x16_bf16 v[44:47], v[118:119], v[196:197], v[44:47]
  v_mfma_f32_16x16x16_bf16 v[164:167], v[120:121], v[144:145], v[164:167]
  v_mfma_f32_16x16x16_bf16 v[48:51], v[120:121], v[196:197], v[48:51]
  v_mfma_f32_16x16x16_bf16 v[168:171], v[122:123], v[144:145], v[168:171]
  v_mfma_f32_16x16x16_bf16 v[52:55], v[122:123], v[196:197], v[52:55]
  v_mfma_f32_16x16x16_bf16 v[172:175], v[124:125], v[144:145], v[172:175]
  v_mfma_f32_16x16x16_bf16 v[56:59], v[124:125], v[196:197], v[56:59]
  v_mfma_f32_16x16x16_bf16 v[176:179], v[126:127], v[144:145], v[176:179]
  v_mfma_f32_16x16x16_bf16 v[60:63], v[126:127], v[196:197], v[60:63]
  v_add_f32 v180, v232, v233
  v_add_f32 v16, v240, v241
  v_add_f32 v181, v234, v235
  v_add_f32 v17, v242, v243
  v_add_f32 v182, v236, v237
  v_add_f32 v18, v244, v245
  v_add_f32 v183, v238, v239
  v_add_f32 v19, v246, v247
  v_add_f32 v180, v180, v181
  v_add_f32 v16, v16, v17
  v_add_f32 v182, v182, v183
  v_add_f32 v18, v18, v19
  v_add_f32 v181, v136, v137
  v_add_f32 v17, v8, v9
  v_add_f32 v180, v180, v182
  v_add_f32 v16, v16, v18
  v_add_f32 v180, v180, v181
  v_add_f32 v16, v16, v17
  v_mov_b32 v181, v180
  v_mov_b32 v17, v16
  s_nop 0
  v_permlane16_swap_b32 v180, v181
  v_permlane16_swap_b32 v16, v17
  v_add_f32 v180, v180, v181
  v_add_f32 v16, v16, v17
  v_mov_b32 v181, v180
  v_mov_b32 v17, v16
  s_nop 0
  v_permlane32_swap_b32 v180, v181
  v_permlane32_swap_b32 v16, v17
  v_add_f32 v180, v180, v181
  v_add_f32 v16, v16, v17
  v_rcp_f32 v180, v180
  v_rcp_f32 v16, v16
  s_nop 0
  v_mov_b32 v181, v180
  v_mov_b32 v17, v16
  s_add_u32 s48, s23, 167772160
  s_add_u32 s49, s23, 167776256
  v_pk_mul_f32 v[148:149], v[148:149], v[180:181]
  v_pk_mul_f32 v[32:33], v[32:33], v[16:17]
  v_pk_mul_f32 v[150:151], v[150:151], v[180:181]
  v_pk_mul_f32 v[34:35], v[34:35], v[16:17]
  v_pk_mul_f32 v[152:153], v[152:153], v[180:181]
  v_pk_mul_f32 v[36:37], v[36:37], v[16:17]
  v_pk_mul_f32 v[154:155], v[154:155], v[180:181]
  v_pk_mul_f32 v[38:39], v[38:39], v[16:17]
  v_cvt_pk_bf16_f32 v184, v148, v149
  v_cvt_pk_bf16_f32 v20, v32, v33
  v_cvt_pk_bf16_f32 v185, v150, v151
  v_cvt_pk_bf16_f32 v21, v34, v35
  v_cvt_pk_bf16_f32 v186, v152, v153
  v_cvt_pk_bf16_f32 v22, v36, v37
  v_cvt_pk_bf16_f32 v187, v154, v155
  v_cvt_pk_bf16_f32 v23, v38, v39
  buffer_store_dwordx4 v[184:187], v1, s[4:7], s48 offen offset:0 sc1
  buffer_store_dwordx4 v[20:23], v1, s[4:7], s49 offen offset:0 sc1
  v_pk_mul_f32 v[156:157], v[156:157], v[180:181]
  v_pk_mul_f32 v[40:41], v[40:41], v[16:17]
  v_pk_mul_f32 v[158:159], v[158:159], v[180:181]
  v_pk_mul_f32 v[42:43], v[42:43], v[16:17]
  v_pk_mul_f32 v[160:161], v[160:161], v[180:181]
  v_pk_mul_f32 v[44:45], v[44:45], v[16:17]
  v_pk_mul_f32 v[162:163], v[162:163], v[180:181]
  v_pk_mul_f32 v[46:47], v[46:47], v[16:17]
  v_cvt_pk_bf16_f32 v188, v156, v157
  v_cvt_pk_bf16_f32 v24, v40, v41
  v_cvt_pk_bf16_f32 v189, v158, v159
  v_cvt_pk_bf16_f32 v25, v42, v43
  v_cvt_pk_bf16_f32 v190, v160, v161
  v_cvt_pk_bf16_f32 v26, v44, v45
  v_cvt_pk_bf16_f32 v191, v162, v163
  v_cvt_pk_bf16_f32 v27, v46, v47
  buffer_store_dwordx4 v[188:191], v1, s[4:7], s48 offen offset:1024 sc1
  buffer_store_dwordx4 v[24:27], v1, s[4:7], s49 offen offset:1024 sc1
  v_pk_mul_f32 v[164:165], v[164:165], v[180:181]
  v_pk_mul_f32 v[48:49], v[48:49], v[16:17]
  v_pk_mul_f32 v[166:167], v[166:167], v[180:181]
  v_pk_mul_f32 v[50:51], v[50:51], v[16:17]
  v_pk_mul_f32 v[168:169], v[168:169], v[180:181]
  v_pk_mul_f32 v[52:53], v[52:53], v[16:17]
  v_pk_mul_f32 v[170:171], v[170:171], v[180:181]
  v_pk_mul_f32 v[54:55], v[54:55], v[16:17]
  v_cvt_pk_bf16_f32 v184, v164, v165
  v_cvt_pk_bf16_f32 v20, v48, v49
  v_cvt_pk_bf16_f32 v185, v166, v167
  v_cvt_pk_bf16_f32 v21, v50, v51
  v_cvt_pk_bf16_f32 v186, v168, v169
  v_cvt_pk_bf16_f32 v22, v52, v53
  v_cvt_pk_bf16_f32 v187, v170, v171
  v_cvt_pk_bf16_f32 v23, v54, v55
  buffer_store_dwordx4 v[184:187], v1, s[4:7], s48 offen offset:2048 sc1
  buffer_store_dwordx4 v[20:23], v1, s[4:7], s49 offen offset:2048 sc1
  v_pk_mul_f32 v[172:173], v[172:173], v[180:181]
  v_pk_mul_f32 v[56:57], v[56:57], v[16:17]
  v_pk_mul_f32 v[174:175], v[174:175], v[180:181]
  v_pk_mul_f32 v[58:59], v[58:59], v[16:17]
  v_pk_mul_f32 v[176:177], v[176:177], v[180:181]
  v_pk_mul_f32 v[60:61], v[60:61], v[16:17]
  v_pk_mul_f32 v[178:179], v[178:179], v[180:181]
  v_pk_mul_f32 v[62:63], v[62:63], v[16:17]
  v_cvt_pk_bf16_f32 v188, v172, v173
  v_cvt_pk_bf16_f32 v24, v56, v57
  v_cvt_pk_bf16_f32 v189, v174, v175
  v_cvt_pk_bf16_f32 v25, v58, v59
  v_cvt_pk_bf16_f32 v190, v176, v177
  v_cvt_pk_bf16_f32 v26, v60, v61
  v_cvt_pk_bf16_f32 v191, v178, v179
  v_cvt_pk_bf16_f32 v27, v62, v63
  buffer_store_dwordx4 v[188:191], v1, s[4:7], s48 offen offset:3072 sc1
  buffer_store_dwordx4 v[24:27], v1, s[4:7], s49 offen offset:3072 sc1
  s_add_u32 s23, s23, 524288
  s_add_u32 s24, s24, 262144
  s_cmp_ge_u32 s18, 62
  s_cbranch_scc1 TA_pre_last
  buffer_load_dword v7, v2, s[4:7], s25 offen sc1
  s_waitcnt vmcnt(0)
  v_mov_b32 v180, 1
  v_lshlrev_b32 v181, 2, v0
  s_mov_b64 exec, 3
  buffer_store_dword v180, v181, s[4:7], s27 offen sc1
  s_mov_b64 exec, -1
  v_cmp_eq_u32 vcc, 0, v7
  s_cbranch_vccz TA_pre_cp
fw_TA1:
  buffer_load_dword v180, v2, s[4:7], s25 offen sc1
  s_waitcnt vmcnt(0)
  v_cmp_eq_u32 vcc, 0, v180
  s_cbranch_vccz fw_TA1_ok
  s_sub_u32 s15, s15, 1
  s_cbranch_scc1 fw_TA1_ok
  s_sleep 24
  s_branch fw_TA1
fw_TA1_ok:
TA_pre_cp:
  s_add_u32 s46, s23, 67108864
  s_add_u32 s47, s46, 4096
  buffer_load_dwordx4 v[32:35], v1, s[4:7], s46 offen offset:0 sc1
  buffer_load_dwordx4 v[36:39], v1, s[4:7], s46 offen offset:1024 sc1
  buffer_load_dwordx4 v[40:43], v1, s[4:7], s46 offen offset:2048 sc1
  buffer_load_dwordx4 v[44:47], v1, s[4:7], s46 offen offset:3072 sc1
  buffer_load_dwordx4 v[48:51], v1, s[4:7], s47 offen offset:0 sc1
  buffer_load_dwordx4 v[52:55], v1, s[4:7], s47 offen offset:1024 sc1
  buffer_load_dwordx4 v[56:59], v1, s[4:7], s47 offen offset:2048 sc1
  buffer_load_dwordx4 v[60:63], v1, s[4:7], s47 offen offset:3072 sc1
  s_add_u32 s48, s21, 0
  s_lshl_b32 s48, s48, 12
  s_add_u32 s48, s48, s23
  s_add_u32 s48, s48, 33554432
  buffer_load_dwordx4 v[200:203], v1, s[4:7], s48 offen offset:0 sc1
  buffer_load_dwordx4 v[204:207], v1, s[4:7], s48 offen offset:1024 sc1
  buffer_load_dwordx4 v[208:211], v1, s[4:7], s48 offen offset:2048 sc1
  buffer_load_dwordx4 v[212:215], v1, s[4:7], s48 offen offset:3072 sc1
  s_add_u32 s48, s21, 1
  s_lshl_b32 s48, s48, 12
  s_add_u32 s48, s48, s23
  s_add_u32 s48, s48, 33554432
  buffer_load_dwordx4 v[216:219], v1, s[4:7], s48 offen offset:0 sc1
  buffer_load_dwordx4 v[220:223], v1, s[4:7], s48 offen offset:1024 sc1
  buffer_load_dwordx4 v[224:227], v1, s[4:7], s48 offen offset:2048 sc1
  buffer_load_dwordx4 v[228:231], v1, s[4:7], s48 offen offset:3072 sc1
  s_add_u32 s46, s23, 100663296
  s_add_u32 s47, s46, 4096
  buffer_load_dwordx4 v[64:67], v1, s[4:7], s46 offen offset:0 sc1
  buffer_load_dwordx4 v[68:71], v1, s[4:7], s46 offen offset:1024 sc1
  buffer_load_dwordx4 v[72:75], v1, s[4:7], s46 offen offset:2048 sc1
  buffer_load_dwordx4 v[76:79], v1, s[4:7], s46 offen offset:3072 sc1
  buffer_load_dwordx4 v[80:83], v1, s[4:7], s47 offen offset:0 sc1
  buffer_load_dwordx4 v[84:87], v1, s[4:7], s47 offen offset:1024 sc1
  buffer_load_dwordx4 v[88:91], v1, s[4:7], s47 offen offset:2048 sc1
  buffer_load_dwordx4 v[92:95], v1, s[4:7], s47 offen offset:3072 sc1
  s_waitcnt vmcnt(8)
TA_go:
  s_add_u32 s18, s18, 2
  s_add_u32 s27, s27, 512
  s_branch TA_item
TA_pre_last:
  s_waitcnt vmcnt(0)
  v_mov_b32 v180, 1
  v_lshlrev_b32 v181, 2, v0
  s_mov_b64 exec, 3
  buffer_store_dword v180, v181, s[4:7], s27 offen sc1
  s_mov_b64 exec, -1
TA_end:
  s_waitcnt vmcnt(0)
  s_endpgm
.section .rodata,"a"
.p2align 6
.amdhsa_kernel prep_kernel
  .amdhsa_next_free_vgpr 64
  .amdhsa_next_free_sgpr 48
  .amdhsa_accum_offset 64
  .amdhsa_group_segment_fixed_size 0
  .amdhsa_kernarg_size 104
  .amdhsa_user_sgpr_count 2
  .amdhsa_user_sgpr_kernarg_segment_ptr 1
  .amdhsa_system_sgpr_workgroup_id_x 1
  .amdhsa_float_denorm_mode_32 3
  .amdhsa_float_denorm_mode_16_64 3
.end_amdhsa_kernel
.p2align 6
.amdhsa_kernel interleave_layers__sliding_block__memory_aug_recurrent_mem_tr__prompt_kernel
  .amdhsa_next_free_vgpr 512
  .amdhsa_next_free_sgpr 102
  .amdhsa_accum_offset 256
  .amdhsa_group_segment_fixed_size 0
  .amdhsa_kernarg_size 104
  .amdhsa_user_sgpr_count 2
  .amdhsa_user_sgpr_kernarg_segment_ptr 1
  .amdhsa_system_sgpr_workgroup_id_x 1
  .amdhsa_float_denorm_mode_32 3
  .amdhsa_float_denorm_mode_16_64 3
.end_amdhsa_kernel
```
